```python
import torch

def _softmax(x, axis=-1):
    return torch.softmax(x, dim=axis)

def _gelu(x):
    return torch.nn.functional.gelu(x, approximate='tanh')

def _silu(x):
    return torch.nn.functional.silu(x)

def _sigmoid(x):
    return torch.sigmoid(x)

def _layernorm(x, axis=-1, eps=1e-05):
    m = x.mean(dim=axis, keepdim=True)
    v = x.var(dim=axis, keepdim=True, unbiased=False)
    return (x - m) / torch.sqrt(v + eps)

def _scatter_add(tgt, idx, src, axis=0):
    return tgt.clone().index_add_(axis, idx, src)

def _segment_sum(src, seg, n):
    out = torch.zeros((n,) + src.shape[1:], dtype=src.dtype)
    return out.index_add_(0, seg, src)

def _pad(x, pw):
    flat = tuple((v for pair in reversed(pw) for v in pair))
    return torch.nn.functional.pad(x, flat)
kernel_name = 'adaLN_cond__memory_aug_recurrent_mem_tr__moe_arch_mod__prompt'

def setup_inputs():

    _w = lambda a: (lambda t: t.to(torch.bfloat16) if t.is_floating_point() else t)(torch.as_tensor(a))

    def _A_setup():
        B, S, Dm = (1, 2048, 512)
        H, Dh = (32, 128)
        M, seg = (8, 32)
        seg = min(seg, S)
        S = S // seg * seg
        return {'x': _w((lambda *s: torch.randn(*s, dtype=torch.bfloat16) * 0.05)(B, S, Dm)), 'mem0': _w((lambda *s: torch.randn(*s, dtype=torch.bfloat16) * 0.4)(B, M, Dm)), 'Wq': _w((lambda *s: torch.randn(*s, dtype=torch.bfloat16) * 3.2)(Dm, H, Dh) * Dm ** (-0.5)), 'Wk': _w((lambda *s: torch.randn(*s, dtype=torch.bfloat16) * 3.2)(Dm, H, Dh) * Dm ** (-0.5)), 'Wv': _w((lambda *s: torch.randn(*s, dtype=torch.bfloat16) * 0.4)(Dm, H, Dh) * Dm ** (-0.5)), 'Wo': _w((lambda *s: torch.randn(*s, dtype=torch.bfloat16) * 0.4)(H, Dh, Dm) * (H * Dh) ** (-0.5)), 'seg_len': seg}
    _A_in = _A_setup()

    def _B_setup():
        B, S, D, F, C = (1, 2048, 512, 1376, 2)
        return {'x': _w((lambda *s: torch.randn(*s, dtype=torch.bfloat16) * 0.05)(B, S, D)), 'w_r': _w((lambda *s: torch.randn(*s, dtype=torch.bfloat16) * 0.05)(D)), 'w_gate': _w((lambda *s: torch.randn(*s, dtype=torch.bfloat16) * 0.05)(D, F)), 'w_up': _w((lambda *s: torch.randn(*s, dtype=torch.bfloat16) * 0.05)(D, F)), 'w_down': _w((lambda *s: torch.randn(*s, dtype=torch.bfloat16) * 0.05)(F, D))}
    _B_in = _B_setup()
    return {'A_x': _A_in['x'], 'A_mem0': _A_in['mem0'], 'A_Wq': _A_in['Wq'], 'A_Wk': _A_in['Wk'], 'A_Wv': _A_in['Wv'], 'A_Wo': _A_in['Wo'], 'A_seg_len': _A_in['seg_len'], 'B_x': _B_in['x'], 'B_w_r': _B_in['w_r'], 'B_w_gate': _B_in['w_gate'], 'B_w_up': _B_in['w_up'], 'B_w_down': _B_in['w_down'], 'c': _w((lambda *s: torch.randn(*s, dtype=torch.bfloat16) * 0.05)(1, 512) * 8.0), 'w_mod': _w((lambda *s: torch.randn(*s, dtype=torch.bfloat16) * 0.05)(512, 6 * 512) * 512 ** (-0.5) * 8.0)}

def reference(A_x, A_mem0, A_Wq, A_Wk, A_Wv, A_Wo, A_seg_len, B_x, B_w_r, B_w_gate, B_w_up, B_w_down, c, w_mod):

    def _A_ref(x, mem0, Wq, Wk, Wv, Wo, seg_len):
        B, S, Dm = x.shape
        H, Dh = (Wq.shape[1], Wq.shape[2])
        M = mem0.shape[1]
        scale = Dh ** (-0.5)
        n_seg = S // seg_len
        L = M + seg_len
        idx = torch.arange(L)
        mask = (idx[:, None] < M) | (idx[:, None] >= idx[None, :])
        mem = mem0
        outs = []
        for s in range(n_seg):
            xs = x[:, s * seg_len:(s + 1) * seg_len, :].clone()
            h = torch.concatenate([mem, xs], axis=1)
            q = torch.einsum('btd,dhe->bhte', h, Wq)
            k = torch.einsum('btd,dhe->bhte', h, Wk)
            v = torch.einsum('btd,dhe->bhte', h, Wv)
            scores = torch.einsum('bhqe,bhke->bhqk', q, k) * scale
            scores = torch.where(mask[None, None], scores, -1000000000.0)
            p = _softmax(scores, axis=-1)
            o = torch.einsum('bhqk,bhke->bhqe', p, v)
            o = torch.einsum('bhte,hed->btd', o, Wo)
            mem = o[:, :M, :].clone()
            outs.append(o[:, M:, :])
        return torch.concatenate(outs, axis=1)

    def _B_ref(x, w_r, w_gate, w_up, w_down):
        B, S, D = x.shape
        C = 2
        r = x @ w_r
        idx = torch.argsort(-r, axis=-1)[:, :C]
        idx_e = (lambda x, n, axis: torch.repeat_interleave(x, n, dim=axis))(idx.reshape(B, C, 1), D, axis=2)
        x_sel = (lambda x, i, axis: torch.take_along_dim(x, i, dim=axis))(x, idx_e, axis=1)
        g = _silu(x_sel @ w_gate)
        u = x_sel @ w_up
        y = g * u @ w_down
        r_sel = _sigmoid((lambda x, i, axis: torch.take_along_dim(x, i, dim=axis))(r, idx, axis=1))
        y = y * r_sel.reshape(B, C, 1)
        b_off = (torch.arange(B) * S).reshape(B, 1)
        flat_idx = (idx + b_off).reshape(B * C)
        zero = (x * 0.0).reshape(B * S, D)
        upd = _scatter_add(zero, flat_idx, y.reshape(B * C, D), axis=0)
        return x + upd.reshape(B, S, D)
    x = A_x
    mod = (_silu(c) @ w_mod).reshape(c.shape[0], 6, 1, -1)
    sa, ca, ga, sb, cb, gb = (mod[:, 0].clone(), mod[:, 1].clone(), mod[:, 2].clone(), mod[:, 3].clone(), mod[:, 4].clone(), mod[:, 5].clone())
    h = _layernorm(x, axis=-1) * (1 + ca) + sa
    x = x + ga * _A_ref(h, A_mem0, A_Wq, A_Wk, A_Wv, A_Wo, A_seg_len)
    h = _layernorm(x, axis=-1) * (1 + cb) + sb
    x = x + gb * _B_ref(h, B_w_r, B_w_gate, B_w_up, B_w_down)
    return x
```

```asm
; @launch grid=(256,1,1) block=(256,1,1) lds=163840
.amdgcn_target "amdgcn-amd-amdhsa--gfx950"
.text
.globl adaLN_cond__memory_aug_recurrent_mem_tr__moe_arch_mod__prompt_kernel
.p2align 8
.type adaLN_cond__memory_aug_recurrent_mem_tr__moe_arch_mod__prompt_kernel,@function
adaLN_cond__memory_aug_recurrent_mem_tr__moe_arch_mod__prompt_kernel:
L_code_start:
    s_getpc_b64 s[90:91]
    s_cmp_ge_u32 s2, 256
    s_cbranch_scc1 L_exit
    s_load_dwordx2 s[4:5], s[0:1], 128
    s_load_dwordx2 s[6:7], s[0:1], 120
    s_load_dwordx2 s[8:9], s[0:1], 16
    s_load_dwordx2 s[10:11], s[0:1], 24
    s_load_dwordx2 s[12:13], s[0:1], 32
    s_load_dwordx2 s[14:15], s[0:1], 40
    s_load_dwordx2 s[16:17], s[0:1], 8
    s_load_dwordx2 s[18:19], s[0:1], 0
    s_load_dwordx2 s[20:21], s[0:1], 112
    s_load_dwordx2 s[22:23], s[0:1], 104
    s_load_dwordx2 s[24:25], s[0:1], 96
    s_load_dwordx2 s[26:27], s[0:1], 64
    s_load_dwordx2 s[28:29], s[0:1], 72
    s_load_dwordx2 s[30:31], s[0:1], 80
    s_load_dwordx2 s[32:33], s[0:1], 88
    s_mov_b32 s38, s2
    s_getreg_b32 s39, hwreg(HW_REG_XCC_ID, 0, 4)
    v_lshrrev_b32 v1, 6, v0
    s_nop 0
    v_readfirstlane_b32 s34, v1
    s_and_b32 s39, s39, 7
    s_lshl_b32 s70, s39, 3
    s_lshl_b64 s[72:73], 1, s70
    v_mov_b32 v1, 0
    v_mov_b32 v2, 1
    v_mov_b32 v10, s72
    v_mov_b32 v11, s73
    v_mov_b32 v9, 0xffff
    v_and_b32 v3, 63, v0
    s_lshl_b32 s71, s38, 8
    v_lshl_add_u32 v4, v3, 2, s71
    s_waitcnt lgkmcnt(0)
    s_cmp_lg_u32 s34, 0
    s_cbranch_scc1 L_st1
    s_mov_b64 exec, 1
    s_cmp_lg_u32 s39, 0
    s_cbranch_scc1 L_st0
    global_atomic_add v8, v1, v2, s[6:7] sc0
    s_waitcnt vmcnt(0)
    v_cmp_gt_u32 vcc, 32, v8
    s_cbranch_vccnz L_st0b
L_st0:
    global_atomic_add_x2 v[12:13], v1, v[10:11], s[6:7] offset:128 sc0
    s_waitcnt vmcnt(0)
    v_lshrrev_b64 v[14:15], s70, v[12:13]
    v_and_b32 v8, 0xff, v14
    v_sad_u8 v9, v12, 0, 0
    v_sad_u8 v9, v13, 0, v9
L_st0b:
    ds_write_b64 v1, v[8:9]
    s_mov_b64 exec, -1
    s_branch L_st3
L_st1:
    s_cmp_lg_u32 s34, 1
    s_cbranch_scc1 L_st2
    v_mov_b32 v6, 0
    global_store_dword v4, v6, s[4:5] sc1
    v_mov_b32 v6, -1
    v_add_u32 v4, 98304, v4
    global_store_dword v4, v6, s[4:5] sc1
    v_mov_b32 v12, 2139193217
    v_mov_b32 v13, 2139193217
    v_mov_b32 v14, 2139193217
    v_mov_b32 v15, 2139193217
    s_lshl_b32 s71, s38, 10
    s_add_u32 s71, s71, 16515072
    v_lshl_add_u32 v5, v3, 4, s71
    global_store_dwordx4 v5, v[12:15], s[4:5] sc1
    s_lshl_b32 s71, s38, 9
    s_add_u32 s71, s71, 20905984
    v_lshl_add_u32 v5, v3, 3, s71
    global_store_dwordx2 v5, v[12:13], s[4:5] sc1
    s_branch L_st3
L_st2:
    s_lshl_b32 s71, s38, 11
    s_and_b32 s70, s34, 1
    s_lshl_b32 s70, s70, 10
    s_add_u32 s71, s71, s70
    s_add_u32 s71, s71, 524288
    v_lshl_add_u32 v5, v3, 4, s71
    v_mov_b32 v12, 2139193217
    v_mov_b32 v13, 2139193217
    v_mov_b32 v14, 2139193217
    v_mov_b32 v15, 2139193217
    global_store_dwordx4 v5, v[12:15], s[4:5] sc1
L_st3:
    s_waitcnt vmcnt(0) lgkmcnt(0)
    s_barrier
    v_mov_b32 v1, 0
    ds_read_b64 v[8:9], v1
    s_cmp_lg_u32 s34, 1
    s_cbranch_scc1 L_st4
    s_mov_b64 exec, 1
    v_mov_b32 v1, 8
    global_atomic_add v1, v2, s[6:7]
    s_mov_b64 exec, -1
L_st4:
    s_waitcnt lgkmcnt(0)
    v_readfirstlane_b32 s2, v8
    v_readfirstlane_b32 s3, v9
    s_mov_b32 s35, s39
    s_mov_b32 s36, s2
    s_barrier
    s_cmp_lg_u32 s34, 3
    s_cbranch_scc1 L_nowarm
    s_cmp_lt_u32 s3, 96
    s_cbranch_scc1 L_nowarm
    s_and_b32 s70, s2, 7
    s_cmp_lg_u32 s70, 7
    s_cbranch_scc1 L_nowarm
    v_and_b32 v1, 63, v0
    v_lshlrev_b32 v1, 7, v1
    s_mov_b32 s70, L_code_end - L_code_start - 128
L_warm:
    v_min_u32 v3, s70, v1
    global_load_dword v249, v3, s[90:91]
    v_add_u32 v1, 0x2000, v1
    s_nop 0
    v_readfirstlane_b32 s71, v1
    s_nop 0
    s_cmp_lt_u32 s71, s70
    s_cbranch_scc1 L_warm
L_nowarm:
    s_nop 1
    s_cmp_lt_u32 s3, 224
    s_cbranch_scc1 L_bulk
    s_cmp_eq_u32 s3, 0xffff
    s_cbranch_scc1 L_chain
    s_cmp_lg_u32 s34, 0
    s_cbranch_scc1 polld_2
    v_mov_b32 v2, 8
    s_mov_b32 s79, 0
    s_mov_b64 exec, 1
poll_1:
    global_load_dword v3, v2, s[6:7] sc1
    s_add_u32 s79, s79, 1
    s_cmp_gt_u32 s79, 0x80000
    s_cbranch_scc1 L_fail
    s_waitcnt vmcnt(0)
    v_cmp_le_u32 vcc, 256, v3
    s_cbranch_vccnz polld_2
    s_sleep 4
    s_branch poll_1
polld_2:
    s_mov_b64 exec, -1
    s_barrier
    v_mov_b32 v1, 0
    global_load_dwordx2 v[4:5], v1, s[6:7] offset:128 sc1
    global_load_dword v6, v1, s[6:7] sc1
    s_waitcnt vmcnt(0)
    v_readfirstlane_b32 s78, v6
    v_xor_b32 v4, 0x20202000, v4
    v_xor_b32 v5, 0x20202020, v5
    v_xor_b32 v6, 32, v6
    v_or3_b32 v4, v4, v5, v6
    s_nop 0
    v_readfirstlane_b32 s37, v4
    s_nop 0
    s_cmp_lg_u32 s37, 0
    s_cselect_b32 s37, 1, 0
    s_min_u32 s78, s78, 32
    s_add_u32 s36, s78, s3
    s_sub_u32 s36, s36, 224
    s_mov_b32 s35, 0
    s_cmp_ge_u32 s36, 32
    s_cbranch_scc1 L_fail
L_chain:
    v_mbcnt_lo_u32_b32 v122, -1, 0
    v_mbcnt_hi_u32_b32 v122, -1, v122
    v_lshrrev_b32 v123, 4, v122
    v_and_b32 v124, 15, v122
    v_lshlrev_b32 v105, 4, v122
    v_add_u32 v116, 131072, v105
    s_lshl_b32 s70, s34, 10
    s_add_u32 s70, s70, 147456
    v_add_u32 v117, s70, v105
    s_lshl_b32 s70, s34, 11
    s_add_u32 s70, s70, 139264
    v_add_u32 v119, s70, v105
    s_lshl_b32 s70, s34, 12
    v_add_u32 v114, s70, v105
    v_add_u32 v115, 0x10000, v114
    s_lshl_b32 s70, s34, 9
    v_lshl_add_u32 v121, v122, 2, s70
    s_mov_b32 s40, 0xAAAAAAAA
    s_mov_b32 s41, 0xAAAAAAAA
    v_mov_b32 v125, 0x4444
    v_mov_b32 v126, 0xEEEE
    s_mov_b32 s92, 0xCCCCCCCC
    s_mov_b32 s93, 0xCCCCCCCC
    v_cndmask_b32 v104, v125, v126, s[92:93]
    v_lshrrev_b32 v30, 2, v124
    v_and_b32 v31, 1, v124
    v_lshl_add_u32 v30, v30, 1, v31
    v_bfe_u32 v31, v124, 1, 1
    v_lshlrev_b32 v125, 11, v123
    v_lshl_add_u32 v125, v30, 5, v125
    v_lshl_add_u32 v125, v31, 4, v125
    s_lshl_b32 s70, s34, 8
    v_add_u32 v106, s70, v125
    s_lshl_b32 s70, s36, 10
    s_lshl_b32 s71, s34, 16
    s_add_u32 s70, s70, s71
    v_add_u32 v107, s70, v105
    s_lshr_b32 s70, s36, 2
    s_lshl_b32 s70, s70, 15
    s_and_b32 s71, s36, 3
    s_lshl_b32 s72, s71, 8
    s_add_u32 s70, s70, s72
    v_lshlrev_b32 v125, 10, v123
    v_lshl_add_u32 v125, v124, 4, v125
    v_add_u32 v118, s70, v125
    v_lshrrev_b32 v125, 1, v124
    v_lshlrev_b32 v125, 8, v125
    v_and_b32 v126, 1, v124
    v_lshl_add_u32 v125, v126, 5, v125
    v_lshl_add_u32 v125, v123, 3, v125
    s_lshr_b32 s70, s36, 2
    s_lshl_b32 s70, s70, 10
    s_lshl_b32 s71, s71, 6
    s_add_u32 s70, s70, s71
    v_add_u32 v108, s70, v125
    s_mov_b32 s42, 0x00FF00FF
    s_mov_b32 s43, 0x00FF00FF
    v_lshlrev_b32 v126, 4, v126
    v_mov_b32 v125, 0x3F80
    v_lshlrev_b32 v120, v126, v125
    s_mov_b32 s52, 196611
    s_mov_b32 s53, 196611
    s_mov_b32 s54, 786444
    s_mov_b32 s55, 786444
    s_mov_b32 s56, 3145776
    s_mov_b32 s57, 3145776
    s_mov_b32 s58, 12583104
    s_mov_b32 s59, 12583104
    s_mov_b32 s98, 0x33333333
    s_mov_b32 s99, 0x33333333
    v_mul_u32_u24 v125, 576, v123
    v_lshl_add_u32 v125, v124, 2, v125
    s_lshl_b32 s70, s34, 6
    s_add_u32 s70, s70, 155648
    v_add_u32 v109, s70, v125
    v_lshrrev_b32 v125, 1, v124
    v_mul_u32_u24 v125, 288, v125
    v_lshl_add_u32 v126, v123, 4, v125
    v_add_u32 v110, 155648, v126
    v_and_b32 v127, 1, v124
    v_lshl_add_u32 v126, v127, 5, v125
    v_lshl_add_u32 v126, v123, 3, v126
    s_lshl_b32 s70, s34, 6
    s_add_u32 s70, s70, 160256
    v_add_u32 v112, s70, v126
    v_mul_u32_u24 v126, 288, v30
    v_lshl_add_u32 v126, v123, 5, v126
    v_lshl_add_u32 v126, v31, 4, v126
    v_add_u32 v113, 160256, v126
    v_lshrrev_b32 v125, 2, v124
    v_lshl_add_u32 v125, v125, 1, v127
    v_mul_u32_u24 v125, 288, v125
    v_lshl_add_u32 v125, v123, 4, v125
    v_add_u32 v111, 157952, v125
    v_lshrrev_b32 v20, 2, v124
    v_and_b32 v126, 1, v20
    v_lshrrev_b32 v127, 1, v20
    v_lshl_add_u32 v20, v127, 3, v126
    v_lshl_add_u32 v21, v127, 2, v126
    v_and_b32 v127, 1, v123
    v_lshl_add_u32 v21, v127, 1, v21
    v_lshl_add_u32 v20, v127, 2, v20
    v_lshrrev_b32 v127, 1, v123
    v_lshl_add_u32 v20, v127, 4, v20
    v_lshlrev_b32 v20, 8, v20
    v_and_b32 v127, 3, v124
    v_lshl_add_u32 v20, v127, 3, v20
    s_lshl_b32 s70, s34, 1
    s_add_u32 s70, s70, 0
    v_xor_b32 v127, s70, v21
    v_lshl_add_u32 v22, v127, 5, v20
    v_add_u32 v23, 0x10000, v22
    v_add_u32 v24, 0x20000, v22
    s_lshl_b32 s70, s34, 1
    s_add_u32 s70, s70, 1
    v_xor_b32 v127, s70, v21
    v_lshl_add_u32 v25, v127, 5, v20
    v_add_u32 v26, 0x10000, v25
    v_add_u32 v27, 0x20000, v25
    v_lshrrev_b32 v8, 4, v122
    v_bfe_u32 v9, v122, 1, 3
    v_and_b32 v10, 1, v8
    v_xor_b32 v9, v9, v10
    v_and_b32 v10, 1, v122
    v_lshlrev_b32 v10, 4, v10
    v_xor_b32 v11, 0, v9
    v_lshl_add_u32 v11, v11, 5, v10
    v_add_u32 v12, 0, v8
    v_lshl_add_u32 v0, v12, 13, v11
    v_lshl_add_u32 v4, v12, 10, v11
    v_xor_b32 v11, 2, v9
    v_lshl_add_u32 v11, v11, 5, v10
    v_add_u32 v12, 4, v8
    v_lshl_add_u32 v1, v12, 13, v11
    v_lshl_add_u32 v5, v12, 10, v11
    v_xor_b32 v11, 4, v9
    v_lshl_add_u32 v11, v11, 5, v10
    v_add_u32 v12, 8, v8
    v_lshl_add_u32 v2, v12, 13, v11
    v_lshl_add_u32 v6, v12, 10, v11
    v_xor_b32 v11, 6, v9
    v_lshl_add_u32 v11, v11, 5, v10
    v_add_u32 v12, 12, v8
    v_lshl_add_u32 v3, v12, 13, v11
    v_lshl_add_u32 v7, v12, 10, v11
    s_lshl_b32 s70, s36, 8
    s_lshl_b32 s71, s34, 20
    s_add_u32 s70, s70, s71
    s_lshl_b32 s71, s36, 17
    s_lshl_b32 s72, s34, 14
    s_add_u32 s71, s71, s72
    s_lshl_b32 s72, s34, 12
    s_add_u32 s73, s70, 0
    s_add_u32 s74, s8, s73
    s_addc_u32 s75, s9, 0
    s_add_u32 m0, s72, 0
    s_nop 0
    global_load_lds_dwordx4 v0, s[74:75]
    s_add_u32 m0, s72, 1024
    s_nop 0
    global_load_lds_dwordx4 v1, s[74:75]
    s_add_u32 m0, s72, 2048
    s_nop 0
    global_load_lds_dwordx4 v2, s[74:75]
    s_add_u32 m0, s72, 3072
    s_nop 0
    global_load_lds_dwordx4 v3, s[74:75]
    s_add_u32 s73, s70, 131072
    s_add_u32 s74, s8, s73
    s_addc_u32 s75, s9, 0
    s_add_u32 m0, s72, 16384
    s_nop 0
    global_load_lds_dwordx4 v0, s[74:75]
    s_add_u32 m0, s72, 17408
    s_nop 0
    global_load_lds_dwordx4 v1, s[74:75]
    s_add_u32 m0, s72, 18432
    s_nop 0
    global_load_lds_dwordx4 v2, s[74:75]
    s_add_u32 m0, s72, 19456
    s_nop 0
    global_load_lds_dwordx4 v3, s[74:75]
    s_add_u32 s73, s70, 262144
    s_add_u32 s74, s8, s73
    s_addc_u32 s75, s9, 0
    s_add_u32 m0, s72, 32768
    s_nop 0
    global_load_lds_dwordx4 v0, s[74:75]
    s_add_u32 m0, s72, 33792
    s_nop 0
    global_load_lds_dwordx4 v1, s[74:75]
    s_add_u32 m0, s72, 34816
    s_nop 0
    global_load_lds_dwordx4 v2, s[74:75]
    s_add_u32 m0, s72, 35840
    s_nop 0
    global_load_lds_dwordx4 v3, s[74:75]
    s_add_u32 s73, s70, 393216
    s_add_u32 s74, s8, s73
    s_addc_u32 s75, s9, 0
    s_add_u32 m0, s72, 49152
    s_nop 0
    global_load_lds_dwordx4 v0, s[74:75]
    s_add_u32 m0, s72, 50176
    s_nop 0
    global_load_lds_dwordx4 v1, s[74:75]
    s_add_u32 m0, s72, 51200
    s_nop 0
    global_load_lds_dwordx4 v2, s[74:75]
    s_add_u32 m0, s72, 52224
    s_nop 0
    global_load_lds_dwordx4 v3, s[74:75]
    s_add_u32 s73, s70, 524288
    s_add_u32 s74, s8, s73
    s_addc_u32 s75, s9, 0
    s_add_u32 m0, s72, 65536
    s_nop 0
    global_load_lds_dwordx4 v0, s[74:75]
    s_add_u32 m0, s72, 66560
    s_nop 0
    global_load_lds_dwordx4 v1, s[74:75]
    s_add_u32 m0, s72, 67584
    s_nop 0
    global_load_lds_dwordx4 v2, s[74:75]
    s_add_u32 m0, s72, 68608
    s_nop 0
    global_load_lds_dwordx4 v3, s[74:75]
    s_add_u32 s73, s70, 655360
    s_add_u32 s74, s8, s73
    s_addc_u32 s75, s9, 0
    s_add_u32 m0, s72, 81920
    s_nop 0
    global_load_lds_dwordx4 v0, s[74:75]
    s_add_u32 m0, s72, 82944
    s_nop 0
    global_load_lds_dwordx4 v1, s[74:75]
    s_add_u32 m0, s72, 83968
    s_nop 0
    global_load_lds_dwordx4 v2, s[74:75]
    s_add_u32 m0, s72, 84992
    s_nop 0
    global_load_lds_dwordx4 v3, s[74:75]
    s_add_u32 s73, s70, 786432
    s_add_u32 s74, s8, s73
    s_addc_u32 s75, s9, 0
    s_add_u32 m0, s72, 98304
    s_nop 0
    global_load_lds_dwordx4 v0, s[74:75]
    s_add_u32 m0, s72, 99328
    s_nop 0
    global_load_lds_dwordx4 v1, s[74:75]
    s_add_u32 m0, s72, 100352
    s_nop 0
    global_load_lds_dwordx4 v2, s[74:75]
    s_add_u32 m0, s72, 101376
    s_nop 0
    global_load_lds_dwordx4 v3, s[74:75]
    s_add_u32 s73, s70, 917504
    s_add_u32 s74, s8, s73
    s_addc_u32 s75, s9, 0
    s_add_u32 m0, s72, 114688
    s_nop 0
    global_load_lds_dwordx4 v0, s[74:75]
    s_add_u32 m0, s72, 115712
    s_nop 0
    global_load_lds_dwordx4 v1, s[74:75]
    s_add_u32 m0, s72, 116736
    s_nop 0
    global_load_lds_dwordx4 v2, s[74:75]
    s_add_u32 m0, s72, 117760
    s_nop 0
    global_load_lds_dwordx4 v3, s[74:75]
    s_waitcnt vmcnt(16)
    s_barrier
    ds_read_b64_tr_b16 a[0:1], v22 offset:0
    ds_read_b64_tr_b16 a[2:3], v22 offset:512
    ds_read_b64_tr_b16 a[4:5], v22 offset:8192
    ds_read_b64_tr_b16 a[6:7], v22 offset:8704
    ds_read_b64_tr_b16 a[64:65], v25 offset:0
    ds_read_b64_tr_b16 a[66:67], v25 offset:512
    ds_read_b64_tr_b16 a[68:69], v25 offset:8192
    ds_read_b64_tr_b16 a[70:71], v25 offset:8704
    ds_read_b64_tr_b16 a[8:9], v22 offset:16384
    ds_read_b64_tr_b16 a[10:11], v22 offset:16896
    ds_read_b64_tr_b16 a[12:13], v22 offset:24576
    ds_read_b64_tr_b16 a[14:15], v22 offset:25088
    ds_read_b64_tr_b16 a[72:73], v25 offset:16384
    ds_read_b64_tr_b16 a[74:75], v25 offset:16896
    ds_read_b64_tr_b16 a[76:77], v25 offset:24576
    ds_read_b64_tr_b16 a[78:79], v25 offset:25088
    ds_read_b64_tr_b16 a[16:17], v22 offset:32768
    ds_read_b64_tr_b16 a[18:19], v22 offset:33280
    ds_read_b64_tr_b16 a[20:21], v22 offset:40960
    ds_read_b64_tr_b16 a[22:23], v22 offset:41472
    ds_read_b64_tr_b16 a[80:81], v25 offset:32768
    ds_read_b64_tr_b16 a[82:83], v25 offset:33280
    ds_read_b64_tr_b16 a[84:85], v25 offset:40960
    ds_read_b64_tr_b16 a[86:87], v25 offset:41472
    ds_read_b64_tr_b16 a[24:25], v22 offset:49152
    ds_read_b64_tr_b16 a[26:27], v22 offset:49664
    ds_read_b64_tr_b16 a[28:29], v22 offset:57344
    ds_read_b64_tr_b16 a[30:31], v22 offset:57856
    ds_read_b64_tr_b16 a[88:89], v25 offset:49152
    ds_read_b64_tr_b16 a[90:91], v25 offset:49664
    ds_read_b64_tr_b16 a[92:93], v25 offset:57344
    ds_read_b64_tr_b16 a[94:95], v25 offset:57856
    s_waitcnt lgkmcnt(0)
    s_barrier
    s_add_u32 s73, s70, 0
    s_add_u32 s74, s10, s73
    s_addc_u32 s75, s11, 0
    s_add_u32 m0, s72, 0
    s_nop 0
    global_load_lds_dwordx4 v0, s[74:75]
    s_add_u32 m0, s72, 1024
    s_nop 0
    global_load_lds_dwordx4 v1, s[74:75]
    s_add_u32 m0, s72, 2048
    s_nop 0
    global_load_lds_dwordx4 v2, s[74:75]
    s_add_u32 m0, s72, 3072
    s_nop 0
    global_load_lds_dwordx4 v3, s[74:75]
    s_add_u32 s73, s70, 131072
    s_add_u32 s74, s10, s73
    s_addc_u32 s75, s11, 0
    s_add_u32 m0, s72, 16384
    s_nop 0
    global_load_lds_dwordx4 v0, s[74:75]
    s_add_u32 m0, s72, 17408
    s_nop 0
    global_load_lds_dwordx4 v1, s[74:75]
    s_add_u32 m0, s72, 18432
    s_nop 0
    global_load_lds_dwordx4 v2, s[74:75]
    s_add_u32 m0, s72, 19456
    s_nop 0
    global_load_lds_dwordx4 v3, s[74:75]
    s_add_u32 s73, s70, 262144
    s_add_u32 s74, s10, s73
    s_addc_u32 s75, s11, 0
    s_add_u32 m0, s72, 32768
    s_nop 0
    global_load_lds_dwordx4 v0, s[74:75]
    s_add_u32 m0, s72, 33792
    s_nop 0
    global_load_lds_dwordx4 v1, s[74:75]
    s_add_u32 m0, s72, 34816
    s_nop 0
    global_load_lds_dwordx4 v2, s[74:75]
    s_add_u32 m0, s72, 35840
    s_nop 0
    global_load_lds_dwordx4 v3, s[74:75]
    s_add_u32 s73, s70, 393216
    s_add_u32 s74, s10, s73
    s_addc_u32 s75, s11, 0
    s_add_u32 m0, s72, 49152
    s_nop 0
    global_load_lds_dwordx4 v0, s[74:75]
    s_add_u32 m0, s72, 50176
    s_nop 0
    global_load_lds_dwordx4 v1, s[74:75]
    s_add_u32 m0, s72, 51200
    s_nop 0
    global_load_lds_dwordx4 v2, s[74:75]
    s_add_u32 m0, s72, 52224
    s_nop 0
    global_load_lds_dwordx4 v3, s[74:75]
    s_waitcnt vmcnt(16)
    s_barrier
    ds_read_b64_tr_b16 a[32:33], v23 offset:0
    ds_read_b64_tr_b16 a[34:35], v23 offset:512
    ds_read_b64_tr_b16 a[36:37], v23 offset:8192
    ds_read_b64_tr_b16 a[38:39], v23 offset:8704
    ds_read_b64_tr_b16 a[96:97], v26 offset:0
    ds_read_b64_tr_b16 a[98:99], v26 offset:512
    ds_read_b64_tr_b16 a[100:101], v26 offset:8192
    ds_read_b64_tr_b16 a[102:103], v26 offset:8704
    ds_read_b64_tr_b16 a[40:41], v23 offset:16384
    ds_read_b64_tr_b16 a[42:43], v23 offset:16896
    ds_read_b64_tr_b16 a[44:45], v23 offset:24576
    ds_read_b64_tr_b16 a[46:47], v23 offset:25088
    ds_read_b64_tr_b16 a[104:105], v26 offset:16384
    ds_read_b64_tr_b16 a[106:107], v26 offset:16896
    ds_read_b64_tr_b16 a[108:109], v26 offset:24576
    ds_read_b64_tr_b16 a[110:111], v26 offset:25088
    ds_read_b64_tr_b16 a[48:49], v23 offset:32768
    ds_read_b64_tr_b16 a[50:51], v23 offset:33280
    ds_read_b64_tr_b16 a[52:53], v23 offset:40960
    ds_read_b64_tr_b16 a[54:55], v23 offset:41472
    ds_read_b64_tr_b16 a[112:113], v26 offset:32768
    ds_read_b64_tr_b16 a[114:115], v26 offset:33280
    ds_read_b64_tr_b16 a[116:117], v26 offset:40960
    ds_read_b64_tr_b16 a[118:119], v26 offset:41472
    ds_read_b64_tr_b16 a[56:57], v23 offset:49152
    ds_read_b64_tr_b16 a[58:59], v23 offset:49664
    ds_read_b64_tr_b16 a[60:61], v23 offset:57344
    ds_read_b64_tr_b16 a[62:63], v23 offset:57856
    ds_read_b64_tr_b16 a[120:121], v26 offset:49152
    ds_read_b64_tr_b16 a[122:123], v26 offset:49664
    ds_read_b64_tr_b16 a[124:125], v26 offset:57344
    ds_read_b64_tr_b16 a[126:127], v26 offset:57856
    s_waitcnt lgkmcnt(0)
    s_barrier
    s_add_u32 s73, s70, 524288
    s_add_u32 s74, s10, s73
    s_addc_u32 s75, s11, 0
    s_add_u32 m0, s72, 65536
    s_nop 0
    global_load_lds_dwordx4 v0, s[74:75]
    s_add_u32 m0, s72, 66560
    s_nop 0
    global_load_lds_dwordx4 v1, s[74:75]
    s_add_u32 m0, s72, 67584
    s_nop 0
    global_load_lds_dwordx4 v2, s[74:75]
    s_add_u32 m0, s72, 68608
    s_nop 0
    global_load_lds_dwordx4 v3, s[74:75]
    s_add_u32 s73, s70, 655360
    s_add_u32 s74, s10, s73
    s_addc_u32 s75, s11, 0
    s_add_u32 m0, s72, 81920
    s_nop 0
    global_load_lds_dwordx4 v0, s[74:75]
    s_add_u32 m0, s72, 82944
    s_nop 0
    global_load_lds_dwordx4 v1, s[74:75]
    s_add_u32 m0, s72, 83968
    s_nop 0
    global_load_lds_dwordx4 v2, s[74:75]
    s_add_u32 m0, s72, 84992
    s_nop 0
    global_load_lds_dwordx4 v3, s[74:75]
    s_add_u32 s73, s70, 786432
    s_add_u32 s74, s10, s73
    s_addc_u32 s75, s11, 0
    s_add_u32 m0, s72, 98304
    s_nop 0
    global_load_lds_dwordx4 v0, s[74:75]
    s_add_u32 m0, s72, 99328
    s_nop 0
    global_load_lds_dwordx4 v1, s[74:75]
    s_add_u32 m0, s72, 100352
    s_nop 0
    global_load_lds_dwordx4 v2, s[74:75]
    s_add_u32 m0, s72, 101376
    s_nop 0
    global_load_lds_dwordx4 v3, s[74:75]
    s_add_u32 s73, s70, 917504
    s_add_u32 s74, s10, s73
    s_addc_u32 s75, s11, 0
    s_add_u32 m0, s72, 114688
    s_nop 0
    global_load_lds_dwordx4 v0, s[74:75]
    s_add_u32 m0, s72, 115712
    s_nop 0
    global_load_lds_dwordx4 v1, s[74:75]
    s_add_u32 m0, s72, 116736
    s_nop 0
    global_load_lds_dwordx4 v2, s[74:75]
    s_add_u32 m0, s72, 117760
    s_nop 0
    global_load_lds_dwordx4 v3, s[74:75]
    s_waitcnt vmcnt(16)
    s_barrier
    ds_read_b64_tr_b16 a[128:129], v22 offset:0
    ds_read_b64_tr_b16 a[130:131], v22 offset:512
    ds_read_b64_tr_b16 a[132:133], v22 offset:8192
    ds_read_b64_tr_b16 a[134:135], v22 offset:8704
    ds_read_b64_tr_b16 a[192:193], v25 offset:0
    ds_read_b64_tr_b16 a[194:195], v25 offset:512
    ds_read_b64_tr_b16 a[196:197], v25 offset:8192
    ds_read_b64_tr_b16 a[198:199], v25 offset:8704
    ds_read_b64_tr_b16 a[136:137], v22 offset:16384
    ds_read_b64_tr_b16 a[138:139], v22 offset:16896
    ds_read_b64_tr_b16 a[140:141], v22 offset:24576
    ds_read_b64_tr_b16 a[142:143], v22 offset:25088
    ds_read_b64_tr_b16 a[200:201], v25 offset:16384
    ds_read_b64_tr_b16 a[202:203], v25 offset:16896
    ds_read_b64_tr_b16 a[204:205], v25 offset:24576
    ds_read_b64_tr_b16 a[206:207], v25 offset:25088
    ds_read_b64_tr_b16 a[144:145], v22 offset:32768
    ds_read_b64_tr_b16 a[146:147], v22 offset:33280
    ds_read_b64_tr_b16 a[148:149], v22 offset:40960
    ds_read_b64_tr_b16 a[150:151], v22 offset:41472
    ds_read_b64_tr_b16 a[208:209], v25 offset:32768
    ds_read_b64_tr_b16 a[210:211], v25 offset:33280
    ds_read_b64_tr_b16 a[212:213], v25 offset:40960
    ds_read_b64_tr_b16 a[214:215], v25 offset:41472
    ds_read_b64_tr_b16 a[152:153], v22 offset:49152
    ds_read_b64_tr_b16 a[154:155], v22 offset:49664
    ds_read_b64_tr_b16 a[156:157], v22 offset:57344
    ds_read_b64_tr_b16 a[158:159], v22 offset:57856
    ds_read_b64_tr_b16 a[216:217], v25 offset:49152
    ds_read_b64_tr_b16 a[218:219], v25 offset:49664
    ds_read_b64_tr_b16 a[220:221], v25 offset:57344
    ds_read_b64_tr_b16 a[222:223], v25 offset:57856
    s_waitcnt lgkmcnt(0)
    s_barrier
    s_add_u32 s73, s71, 0
    s_add_u32 s74, s14, s73
    s_addc_u32 s75, s15, 0
    s_add_u32 m0, s72, 0
    s_nop 0
    global_load_lds_dwordx4 v4, s[74:75]
    s_add_u32 m0, s72, 1024
    s_nop 0
    global_load_lds_dwordx4 v5, s[74:75]
    s_add_u32 m0, s72, 2048
    s_nop 0
    global_load_lds_dwordx4 v6, s[74:75]
    s_add_u32 m0, s72, 3072
    s_nop 0
    global_load_lds_dwordx4 v7, s[74:75]
    s_add_u32 s73, s71, 256
    s_add_u32 s74, s14, s73
    s_addc_u32 s75, s15, 0
    s_add_u32 m0, s72, 16384
    s_nop 0
    global_load_lds_dwordx4 v4, s[74:75]
    s_add_u32 m0, s72, 17408
    s_nop 0
    global_load_lds_dwordx4 v5, s[74:75]
    s_add_u32 m0, s72, 18432
    s_nop 0
    global_load_lds_dwordx4 v6, s[74:75]
    s_add_u32 m0, s72, 19456
    s_nop 0
    global_load_lds_dwordx4 v7, s[74:75]
    s_add_u32 s73, s71, 512
    s_add_u32 s74, s14, s73
    s_addc_u32 s75, s15, 0
    s_add_u32 m0, s72, 32768
    s_nop 0
    global_load_lds_dwordx4 v4, s[74:75]
    s_add_u32 m0, s72, 33792
    s_nop 0
    global_load_lds_dwordx4 v5, s[74:75]
    s_add_u32 m0, s72, 34816
    s_nop 0
    global_load_lds_dwordx4 v6, s[74:75]
    s_add_u32 m0, s72, 35840
    s_nop 0
    global_load_lds_dwordx4 v7, s[74:75]
    s_add_u32 s73, s71, 768
    s_add_u32 s74, s14, s73
    s_addc_u32 s75, s15, 0
    s_add_u32 m0, s72, 49152
    s_nop 0
    global_load_lds_dwordx4 v4, s[74:75]
    s_add_u32 m0, s72, 50176
    s_nop 0
    global_load_lds_dwordx4 v5, s[74:75]
    s_add_u32 m0, s72, 51200
    s_nop 0
    global_load_lds_dwordx4 v6, s[74:75]
    s_add_u32 m0, s72, 52224
    s_nop 0
    global_load_lds_dwordx4 v7, s[74:75]
    s_waitcnt vmcnt(16)
    s_barrier
    ds_read_b64_tr_b16 a[160:161], v23 offset:0
    ds_read_b64_tr_b16 a[162:163], v23 offset:512
    ds_read_b64_tr_b16 a[164:165], v23 offset:8192
    ds_read_b64_tr_b16 a[166:167], v23 offset:8704
    ds_read_b64_tr_b16 a[224:225], v26 offset:0
    ds_read_b64_tr_b16 a[226:227], v26 offset:512
    ds_read_b64_tr_b16 a[228:229], v26 offset:8192
    ds_read_b64_tr_b16 a[230:231], v26 offset:8704
    ds_read_b64_tr_b16 a[168:169], v23 offset:16384
    ds_read_b64_tr_b16 a[170:171], v23 offset:16896
    ds_read_b64_tr_b16 a[172:173], v23 offset:24576
    ds_read_b64_tr_b16 a[174:175], v23 offset:25088
    ds_read_b64_tr_b16 a[232:233], v26 offset:16384
    ds_read_b64_tr_b16 a[234:235], v26 offset:16896
    ds_read_b64_tr_b16 a[236:237], v26 offset:24576
    ds_read_b64_tr_b16 a[238:239], v26 offset:25088
    ds_read_b64_tr_b16 a[176:177], v23 offset:32768
    ds_read_b64_tr_b16 a[178:179], v23 offset:33280
    ds_read_b64_tr_b16 a[180:181], v23 offset:40960
    ds_read_b64_tr_b16 a[182:183], v23 offset:41472
    ds_read_b64_tr_b16 a[240:241], v26 offset:32768
    ds_read_b64_tr_b16 a[242:243], v26 offset:33280
    ds_read_b64_tr_b16 a[244:245], v26 offset:40960
    ds_read_b64_tr_b16 a[246:247], v26 offset:41472
    ds_read_b64_tr_b16 a[184:185], v23 offset:49152
    ds_read_b64_tr_b16 a[186:187], v23 offset:49664
    ds_read_b64_tr_b16 a[188:189], v23 offset:57344
    ds_read_b64_tr_b16 a[190:191], v23 offset:57856
    ds_read_b64_tr_b16 a[248:249], v26 offset:49152
    ds_read_b64_tr_b16 a[250:251], v26 offset:49664
    ds_read_b64_tr_b16 a[252:253], v26 offset:57344
    ds_read_b64_tr_b16 a[254:255], v26 offset:57856
    s_waitcnt lgkmcnt(0)
    s_barrier
    s_add_u32 s73, s71, 65536
    s_add_u32 s74, s14, s73
    s_addc_u32 s75, s15, 0
    s_add_u32 m0, s72, 65536
    s_nop 0
    global_load_lds_dwordx4 v4, s[74:75]
    s_add_u32 m0, s72, 66560
    s_nop 0
    global_load_lds_dwordx4 v5, s[74:75]
    s_add_u32 m0, s72, 67584
    s_nop 0
    global_load_lds_dwordx4 v6, s[74:75]
    s_add_u32 m0, s72, 68608
    s_nop 0
    global_load_lds_dwordx4 v7, s[74:75]
    s_add_u32 s73, s71, 65792
    s_add_u32 s74, s14, s73
    s_addc_u32 s75, s15, 0
    s_add_u32 m0, s72, 81920
    s_nop 0
    global_load_lds_dwordx4 v4, s[74:75]
    s_add_u32 m0, s72, 82944
    s_nop 0
    global_load_lds_dwordx4 v5, s[74:75]
    s_add_u32 m0, s72, 83968
    s_nop 0
    global_load_lds_dwordx4 v6, s[74:75]
    s_add_u32 m0, s72, 84992
    s_nop 0
    global_load_lds_dwordx4 v7, s[74:75]
    s_add_u32 s73, s71, 66048
    s_add_u32 s74, s14, s73
    s_addc_u32 s75, s15, 0
    s_add_u32 m0, s72, 98304
    s_nop 0
    global_load_lds_dwordx4 v4, s[74:75]
    s_add_u32 m0, s72, 99328
    s_nop 0
    global_load_lds_dwordx4 v5, s[74:75]
    s_add_u32 m0, s72, 100352
    s_nop 0
    global_load_lds_dwordx4 v6, s[74:75]
    s_add_u32 m0, s72, 101376
    s_nop 0
    global_load_lds_dwordx4 v7, s[74:75]
    s_add_u32 s73, s71, 66304
    s_add_u32 s74, s14, s73
    s_addc_u32 s75, s15, 0
    s_add_u32 m0, s72, 114688
    s_nop 0
    global_load_lds_dwordx4 v4, s[74:75]
    s_add_u32 m0, s72, 115712
    s_nop 0
    global_load_lds_dwordx4 v5, s[74:75]
    s_add_u32 m0, s72, 116736
    s_nop 0
    global_load_lds_dwordx4 v6, s[74:75]
    s_add_u32 m0, s72, 117760
    s_nop 0
    global_load_lds_dwordx4 v7, s[74:75]
    s_waitcnt vmcnt(16)
    s_barrier
    s_lshl_b32 s73, s34, 14
    s_add_u32 s73, s73, 0
    v_xor_b32 v8, 0, v21
    v_lshl_add_u32 v8, v8, 5, v20
    v_add_u32 v8, s73, v8
    ds_read_b64_tr_b16 v[128:129], v8 offset:0
    ds_read_b64_tr_b16 v[130:131], v8 offset:512
    ds_read_b64_tr_b16 v[132:133], v8 offset:8192
    ds_read_b64_tr_b16 v[134:135], v8 offset:8704
    v_xor_b32 v8, 1, v21
    v_lshl_add_u32 v8, v8, 5, v20
    v_add_u32 v8, s73, v8
    ds_read_b64_tr_b16 v[144:145], v8 offset:0
    ds_read_b64_tr_b16 v[146:147], v8 offset:512
    ds_read_b64_tr_b16 v[148:149], v8 offset:8192
    ds_read_b64_tr_b16 v[150:151], v8 offset:8704
    v_xor_b32 v8, 2, v21
    v_lshl_add_u32 v8, v8, 5, v20
    v_add_u32 v8, s73, v8
    ds_read_b64_tr_b16 v[160:161], v8 offset:0
    ds_read_b64_tr_b16 v[162:163], v8 offset:512
    ds_read_b64_tr_b16 v[164:165], v8 offset:8192
    ds_read_b64_tr_b16 v[166:167], v8 offset:8704
    v_xor_b32 v8, 3, v21
    v_lshl_add_u32 v8, v8, 5, v20
    v_add_u32 v8, s73, v8
    ds_read_b64_tr_b16 v[176:177], v8 offset:0
    ds_read_b64_tr_b16 v[178:179], v8 offset:512
    ds_read_b64_tr_b16 v[180:181], v8 offset:8192
    ds_read_b64_tr_b16 v[182:183], v8 offset:8704
    v_xor_b32 v8, 4, v21
    v_lshl_add_u32 v8, v8, 5, v20
    v_add_u32 v8, s73, v8
    ds_read_b64_tr_b16 v[192:193], v8 offset:0
    ds_read_b64_tr_b16 v[194:195], v8 offset:512
    ds_read_b64_tr_b16 v[196:197], v8 offset:8192
    ds_read_b64_tr_b16 v[198:199], v8 offset:8704
    v_xor_b32 v8, 5, v21
    v_lshl_add_u32 v8, v8, 5, v20
    v_add_u32 v8, s73, v8
    ds_read_b64_tr_b16 v[208:209], v8 offset:0
    ds_read_b64_tr_b16 v[210:211], v8 offset:512
    ds_read_b64_tr_b16 v[212:213], v8 offset:8192
    ds_read_b64_tr_b16 v[214:215], v8 offset:8704
    v_xor_b32 v8, 6, v21
    v_lshl_add_u32 v8, v8, 5, v20
    v_add_u32 v8, s73, v8
    ds_read_b64_tr_b16 v[224:225], v8 offset:0
    ds_read_b64_tr_b16 v[226:227], v8 offset:512
    ds_read_b64_tr_b16 v[228:229], v8 offset:8192
    ds_read_b64_tr_b16 v[230:231], v8 offset:8704
    v_xor_b32 v8, 7, v21
    v_lshl_add_u32 v8, v8, 5, v20
    v_add_u32 v8, s73, v8
    ds_read_b64_tr_b16 v[240:241], v8 offset:0
    ds_read_b64_tr_b16 v[242:243], v8 offset:512
    ds_read_b64_tr_b16 v[244:245], v8 offset:8192
    ds_read_b64_tr_b16 v[246:247], v8 offset:8704
    s_waitcnt lgkmcnt(0)
    s_barrier
    s_waitcnt vmcnt(0)
    s_waitcnt vmcnt(16)
    s_barrier
    s_lshl_b32 s73, s34, 14
    s_add_u32 s73, s73, 65536
    v_xor_b32 v8, 0, v21
    v_lshl_add_u32 v8, v8, 5, v20
    v_add_u32 v8, s73, v8
    ds_read_b64_tr_b16 v[136:137], v8 offset:0
    ds_read_b64_tr_b16 v[138:139], v8 offset:512
    ds_read_b64_tr_b16 v[140:141], v8 offset:8192
    ds_read_b64_tr_b16 v[142:143], v8 offset:8704
    v_xor_b32 v8, 1, v21
    v_lshl_add_u32 v8, v8, 5, v20
    v_add_u32 v8, s73, v8
    ds_read_b64_tr_b16 v[152:153], v8 offset:0
    ds_read_b64_tr_b16 v[154:155], v8 offset:512
    ds_read_b64_tr_b16 v[156:157], v8 offset:8192
    ds_read_b64_tr_b16 v[158:159], v8 offset:8704
    v_xor_b32 v8, 2, v21
    v_lshl_add_u32 v8, v8, 5, v20
    v_add_u32 v8, s73, v8
    ds_read_b64_tr_b16 v[168:169], v8 offset:0
    ds_read_b64_tr_b16 v[170:171], v8 offset:512
    ds_read_b64_tr_b16 v[172:173], v8 offset:8192
    ds_read_b64_tr_b16 v[174:175], v8 offset:8704
    v_xor_b32 v8, 3, v21
    v_lshl_add_u32 v8, v8, 5, v20
    v_add_u32 v8, s73, v8
    ds_read_b64_tr_b16 v[184:185], v8 offset:0
    ds_read_b64_tr_b16 v[186:187], v8 offset:512
    ds_read_b64_tr_b16 v[188:189], v8 offset:8192
    ds_read_b64_tr_b16 v[190:191], v8 offset:8704
    v_xor_b32 v8, 4, v21
    v_lshl_add_u32 v8, v8, 5, v20
    v_add_u32 v8, s73, v8
    ds_read_b64_tr_b16 v[200:201], v8 offset:0
    ds_read_b64_tr_b16 v[202:203], v8 offset:512
    ds_read_b64_tr_b16 v[204:205], v8 offset:8192
    ds_read_b64_tr_b16 v[206:207], v8 offset:8704
    v_xor_b32 v8, 5, v21
    v_lshl_add_u32 v8, v8, 5, v20
    v_add_u32 v8, s73, v8
    ds_read_b64_tr_b16 v[216:217], v8 offset:0
    ds_read_b64_tr_b16 v[218:219], v8 offset:512
    ds_read_b64_tr_b16 v[220:221], v8 offset:8192
    ds_read_b64_tr_b16 v[222:223], v8 offset:8704
    v_xor_b32 v8, 6, v21
    v_lshl_add_u32 v8, v8, 5, v20
    v_add_u32 v8, s73, v8
    ds_read_b64_tr_b16 v[232:233], v8 offset:0
    ds_read_b64_tr_b16 v[234:235], v8 offset:512
    ds_read_b64_tr_b16 v[236:237], v8 offset:8192
    ds_read_b64_tr_b16 v[238:239], v8 offset:8704
    v_xor_b32 v8, 7, v21
    v_lshl_add_u32 v8, v8, 5, v20
    v_add_u32 v8, s73, v8
    ds_read_b64_tr_b16 v[248:249], v8 offset:0
    ds_read_b64_tr_b16 v[250:251], v8 offset:512
    ds_read_b64_tr_b16 v[252:253], v8 offset:8192
    ds_read_b64_tr_b16 v[254:255], v8 offset:8704
    s_waitcnt lgkmcnt(0)
    s_barrier
    s_add_u32 s73, s70, 0
    s_add_u32 s74, s12, s73
    s_addc_u32 s75, s13, 0
    s_add_u32 m0, s72, 16384
    s_nop 0
    global_load_lds_dwordx4 v0, s[74:75]
    s_add_u32 m0, s72, 17408
    s_nop 0
    global_load_lds_dwordx4 v1, s[74:75]
    s_add_u32 m0, s72, 18432
    s_nop 0
    global_load_lds_dwordx4 v2, s[74:75]
    s_add_u32 m0, s72, 19456
    s_nop 0
    global_load_lds_dwordx4 v3, s[74:75]
    s_add_u32 s73, s70, 131072
    s_add_u32 s74, s12, s73
    s_addc_u32 s75, s13, 0
    s_add_u32 m0, s72, 32768
    s_nop 0
    global_load_lds_dwordx4 v0, s[74:75]
    s_add_u32 m0, s72, 33792
    s_nop 0
    global_load_lds_dwordx4 v1, s[74:75]
    s_add_u32 m0, s72, 34816
    s_nop 0
    global_load_lds_dwordx4 v2, s[74:75]
    s_add_u32 m0, s72, 35840
    s_nop 0
    global_load_lds_dwordx4 v3, s[74:75]
    s_add_u32 s73, s70, 262144
    s_add_u32 s74, s12, s73
    s_addc_u32 s75, s13, 0
    s_add_u32 m0, s72, 49152
    s_nop 0
    global_load_lds_dwordx4 v0, s[74:75]
    s_add_u32 m0, s72, 50176
    s_nop 0
    global_load_lds_dwordx4 v1, s[74:75]
    s_add_u32 m0, s72, 51200
    s_nop 0
    global_load_lds_dwordx4 v2, s[74:75]
    s_add_u32 m0, s72, 52224
    s_nop 0
    global_load_lds_dwordx4 v3, s[74:75]
    s_add_u32 s73, s70, 393216
    s_add_u32 s74, s12, s73
    s_addc_u32 s75, s13, 0
    s_add_u32 m0, s72, 65536
    s_nop 0
    global_load_lds_dwordx4 v0, s[74:75]
    s_add_u32 m0, s72, 66560
    s_nop 0
    global_load_lds_dwordx4 v1, s[74:75]
    s_add_u32 m0, s72, 67584
    s_nop 0
    global_load_lds_dwordx4 v2, s[74:75]
    s_add_u32 m0, s72, 68608
    s_nop 0
    global_load_lds_dwordx4 v3, s[74:75]
    s_add_u32 s73, s70, 524288
    s_add_u32 s74, s12, s73
    s_addc_u32 s75, s13, 0
    s_add_u32 m0, s72, 81920
    s_nop 0
    global_load_lds_dwordx4 v0, s[74:75]
    s_add_u32 m0, s72, 82944
    s_nop 0
    global_load_lds_dwordx4 v1, s[74:75]
    s_add_u32 m0, s72, 83968
    s_nop 0
    global_load_lds_dwordx4 v2, s[74:75]
    s_add_u32 m0, s72, 84992
    s_nop 0
    global_load_lds_dwordx4 v3, s[74:75]
    s_add_u32 s73, s70, 655360
    s_add_u32 s74, s12, s73
    s_addc_u32 s75, s13, 0
    s_add_u32 m0, s72, 98304
    s_nop 0
    global_load_lds_dwordx4 v0, s[74:75]
    s_add_u32 m0, s72, 99328
    s_nop 0
    global_load_lds_dwordx4 v1, s[74:75]
    s_add_u32 m0, s72, 100352
    s_nop 0
    global_load_lds_dwordx4 v2, s[74:75]
    s_add_u32 m0, s72, 101376
    s_nop 0
    global_load_lds_dwordx4 v3, s[74:75]
    s_add_u32 s73, s70, 786432
    s_add_u32 s74, s12, s73
    s_addc_u32 s75, s13, 0
    s_add_u32 m0, s72, 114688
    s_nop 0
    global_load_lds_dwordx4 v0, s[74:75]
    s_add_u32 m0, s72, 115712
    s_nop 0
    global_load_lds_dwordx4 v1, s[74:75]
    s_add_u32 m0, s72, 116736
    s_nop 0
    global_load_lds_dwordx4 v2, s[74:75]
    s_add_u32 m0, s72, 117760
    s_nop 0
    global_load_lds_dwordx4 v3, s[74:75]
    s_add_u32 s73, s70, 917504
    s_add_u32 s74, s12, s73
    s_addc_u32 s75, s13, 0
    s_add_u32 m0, s72, 131072
    s_nop 0
    global_load_lds_dwordx4 v0, s[74:75]
    s_add_u32 m0, s72, 132096
    s_nop 0
    global_load_lds_dwordx4 v1, s[74:75]
    s_add_u32 m0, s72, 133120
    s_nop 0
    global_load_lds_dwordx4 v2, s[74:75]
    s_add_u32 m0, s72, 134144
    s_nop 0
    global_load_lds_dwordx4 v3, s[74:75]
    s_waitcnt vmcnt(28)
    s_barrier
    ds_read_b64_tr_b16 v[32:33], v22 offset:16384
    ds_read_b64_tr_b16 v[34:35], v22 offset:16896
    ds_read_b64_tr_b16 v[36:37], v22 offset:24576
    ds_read_b64_tr_b16 v[38:39], v22 offset:25088
    ds_read_b64_tr_b16 v[40:41], v25 offset:16384
    ds_read_b64_tr_b16 v[42:43], v25 offset:16896
    ds_read_b64_tr_b16 v[44:45], v25 offset:24576
    ds_read_b64_tr_b16 v[46:47], v25 offset:25088
    s_waitcnt lgkmcnt(0)
    ds_write_b128 v114, v[32:35] offset:0
    ds_write_b128 v114, v[36:39] offset:1024
    ds_write_b128 v114, v[40:43] offset:2048
    ds_write_b128 v114, v[44:47] offset:3072
    s_waitcnt lgkmcnt(0)
    s_waitcnt vmcnt(24)
    s_barrier
    ds_read_b64_tr_b16 v[32:33], v22 offset:32768
    ds_read_b64_tr_b16 v[34:35], v22 offset:33280
    ds_read_b64_tr_b16 v[36:37], v22 offset:40960
    ds_read_b64_tr_b16 v[38:39], v22 offset:41472
    ds_read_b64_tr_b16 v[40:41], v25 offset:32768
    ds_read_b64_tr_b16 v[42:43], v25 offset:33280
    ds_read_b64_tr_b16 v[44:45], v25 offset:40960
    ds_read_b64_tr_b16 v[46:47], v25 offset:41472
    s_waitcnt lgkmcnt(0)
    ds_write_b128 v114, v[32:35] offset:16384
    ds_write_b128 v114, v[36:39] offset:17408
    ds_write_b128 v114, v[40:43] offset:18432
    ds_write_b128 v114, v[44:47] offset:19456
    s_waitcnt lgkmcnt(0)
    s_waitcnt vmcnt(20)
    s_barrier
    ds_read_b64_tr_b16 v[32:33], v22 offset:49152
    ds_read_b64_tr_b16 v[34:35], v22 offset:49664
    ds_read_b64_tr_b16 v[36:37], v22 offset:57344
    ds_read_b64_tr_b16 v[38:39], v22 offset:57856
    ds_read_b64_tr_b16 v[40:41], v25 offset:49152
    ds_read_b64_tr_b16 v[42:43], v25 offset:49664
    ds_read_b64_tr_b16 v[44:45], v25 offset:57344
    ds_read_b64_tr_b16 v[46:47], v25 offset:57856
    s_waitcnt lgkmcnt(0)
    ds_write_b128 v114, v[32:35] offset:32768
    ds_write_b128 v114, v[36:39] offset:33792
    ds_write_b128 v114, v[40:43] offset:34816
    ds_write_b128 v114, v[44:47] offset:35840
    s_waitcnt lgkmcnt(0)
    s_waitcnt vmcnt(16)
    s_barrier
    ds_read_b64_tr_b16 v[32:33], v23 offset:0
    ds_read_b64_tr_b16 v[34:35], v23 offset:512
    ds_read_b64_tr_b16 v[36:37], v23 offset:8192
    ds_read_b64_tr_b16 v[38:39], v23 offset:8704
    ds_read_b64_tr_b16 v[40:41], v26 offset:0
    ds_read_b64_tr_b16 v[42:43], v26 offset:512
    ds_read_b64_tr_b16 v[44:45], v26 offset:8192
    ds_read_b64_tr_b16 v[46:47], v26 offset:8704
    s_waitcnt lgkmcnt(0)
    ds_write_b128 v114, v[32:35] offset:49152
    ds_write_b128 v114, v[36:39] offset:50176
    ds_write_b128 v114, v[40:43] offset:51200
    ds_write_b128 v114, v[44:47] offset:52224
    s_waitcnt lgkmcnt(0)
    s_waitcnt vmcnt(12)
    s_barrier
    ds_read_b64_tr_b16 v[32:33], v23 offset:16384
    ds_read_b64_tr_b16 v[34:35], v23 offset:16896
    ds_read_b64_tr_b16 v[36:37], v23 offset:24576
    ds_read_b64_tr_b16 v[38:39], v23 offset:25088
    ds_read_b64_tr_b16 v[40:41], v26 offset:16384
    ds_read_b64_tr_b16 v[42:43], v26 offset:16896
    ds_read_b64_tr_b16 v[44:45], v26 offset:24576
    ds_read_b64_tr_b16 v[46:47], v26 offset:25088
    s_waitcnt lgkmcnt(0)
    ds_write_b128 v115, v[32:35] offset:0
    ds_write_b128 v115, v[36:39] offset:1024
    ds_write_b128 v115, v[40:43] offset:2048
    ds_write_b128 v115, v[44:47] offset:3072
    s_waitcnt lgkmcnt(0)
    s_waitcnt vmcnt(8)
    s_barrier
    ds_read_b64_tr_b16 v[32:33], v23 offset:32768
    ds_read_b64_tr_b16 v[34:35], v23 offset:33280
    ds_read_b64_tr_b16 v[36:37], v23 offset:40960
    ds_read_b64_tr_b16 v[38:39], v23 offset:41472
    ds_read_b64_tr_b16 v[40:41], v26 offset:32768
    ds_read_b64_tr_b16 v[42:43], v26 offset:33280
    ds_read_b64_tr_b16 v[44:45], v26 offset:40960
    ds_read_b64_tr_b16 v[46:47], v26 offset:41472
    s_waitcnt lgkmcnt(0)
    ds_write_b128 v115, v[32:35] offset:16384
    ds_write_b128 v115, v[36:39] offset:17408
    ds_write_b128 v115, v[40:43] offset:18432
    ds_write_b128 v115, v[44:47] offset:19456
    s_waitcnt lgkmcnt(0)
    s_waitcnt vmcnt(4)
    s_barrier
    ds_read_b64_tr_b16 v[32:33], v23 offset:49152
    ds_read_b64_tr_b16 v[34:35], v23 offset:49664
    ds_read_b64_tr_b16 v[36:37], v23 offset:57344
    ds_read_b64_tr_b16 v[38:39], v23 offset:57856
    ds_read_b64_tr_b16 v[40:41], v26 offset:49152
    ds_read_b64_tr_b16 v[42:43], v26 offset:49664
    ds_read_b64_tr_b16 v[44:45], v26 offset:57344
    ds_read_b64_tr_b16 v[46:47], v26 offset:57856
    s_waitcnt lgkmcnt(0)
    ds_write_b128 v115, v[32:35] offset:32768
    ds_write_b128 v115, v[36:39] offset:33792
    ds_write_b128 v115, v[40:43] offset:34816
    ds_write_b128 v115, v[44:47] offset:35840
    s_waitcnt lgkmcnt(0)
    s_waitcnt vmcnt(0)
    s_barrier
    ds_read_b64_tr_b16 v[32:33], v24 offset:0
    ds_read_b64_tr_b16 v[34:35], v24 offset:512
    ds_read_b64_tr_b16 v[36:37], v24 offset:8192
    ds_read_b64_tr_b16 v[38:39], v24 offset:8704
    ds_read_b64_tr_b16 v[40:41], v27 offset:0
    ds_read_b64_tr_b16 v[42:43], v27 offset:512
    ds_read_b64_tr_b16 v[44:45], v27 offset:8192
    ds_read_b64_tr_b16 v[46:47], v27 offset:8704
    s_waitcnt lgkmcnt(0)
    ds_write_b128 v115, v[32:35] offset:49152
    ds_write_b128 v115, v[36:39] offset:50176
    ds_write_b128 v115, v[40:43] offset:51200
    ds_write_b128 v115, v[44:47] offset:52224
    s_waitcnt lgkmcnt(0)
    s_barrier
    s_cmp_lg_u32 s34, 0
    s_cbranch_scc1 polld_4
    v_mov_b32 v2, 8
    s_mov_b32 s79, 0
    s_mov_b64 exec, 1
poll_3:
    global_load_dword v3, v2, s[6:7] sc1
    s_add_u32 s79, s79, 1
    s_cmp_gt_u32 s79, 0x80000
    s_cbranch_scc1 L_fail
    s_waitcnt vmcnt(0)
    v_cmp_le_u32 vcc, 256, v3
    s_cbranch_vccnz polld_4
    s_sleep 4
    s_branch poll_3
polld_4:
    s_mov_b64 exec, -1
    s_barrier
    v_mov_b32 v1, 0
    global_load_dwordx2 v[4:5], v1, s[6:7] offset:128 sc1
    global_load_dword v6, v1, s[6:7] sc1
    s_waitcnt vmcnt(0)
    v_readfirstlane_b32 s78, v6
    v_xor_b32 v4, 0x20202000, v4
    v_xor_b32 v5, 0x20202020, v5
    v_xor_b32 v6, 32, v6
    v_or3_b32 v4, v4, v5, v6
    s_nop 0
    v_readfirstlane_b32 s37, v4
    s_nop 0
    s_cmp_lg_u32 s37, 0
    s_cselect_b32 s37, 1, 0
    s_cmp_eq_u32 s37, 0
    s_cbranch_scc1 L_chain0
    s_mov_b32 s88, 1040356334
    s_mov_b32 s89, 1040356334
    s_add_u32 s44, s4, 524288
    s_addc_u32 s45, s5, 0
    s_add_u32 s48, s4, 528384
    s_addc_u32 s49, s5, 0
    s_add_u32 s46, s4, 786432
    s_addc_u32 s47, s5, 0
    s_add_u32 s50, s4, 790528
    s_addc_u32 s51, s5, 0
    s_lshl_b32 s70, s36, 13
    s_mov_b32 s71, 50331648
    s_mov_b32 s82, 131072
    s_cmp_eq_u32 s34, 3
    s_cselect_b32 s71, 67108864, s71
    s_cselect_b32 s82, 139264, s82
    s_add_u32 s71, s71, s70
    s_add_u32 s80, s4, s71
    s_addc_u32 s81, s5, 0
    s_add_u32 s12, s80, 16777216
    s_addc_u32 s13, s81, 0
    s_lshl_b32 s70, s36, 12
    s_add_u32 s71, s70, 8257536
    s_add_u32 s84, s4, s71
    s_addc_u32 s85, s5, 0
    s_lshl_b32 s70, s36, 11
    s_add_u32 s71, s70, 16777216
    s_add_u32 s86, s4, s71
    s_addc_u32 s87, s5, 0
    s_lshl_b32 s100, s36, 7
    s_add_u32 s100, s100, 12288
    v_mov_b32 v114, v105
    v_add_u32 v115, 0x10000, v105
    v_lshrrev_b32 v121, 2, v105
    v_bfe_u32 v122, v105, 5, 3
    v_mul_u32_u24 v122, 288, v122
    v_lshrrev_b32 v123, 8, v105
    v_lshl_add_u32 v122, v123, 3, v122
    v_add_u32 v112, 160256, v122
    s_cmp_lg_u32 s34, 1
    s_cbranch_scc1 c_np_5
    v_mul_u32_u24 v122, 288, v123
    v_and_b32 v123, 0xff, v105
    v_add_u32 v122, v122, v123
    v_add_u32 v120, 157952, v122
c_np_5:
    s_lshl_b32 s70, s34, 8
    s_lshl_b32 s71, s36, 2
    s_add_u32 s70, s70, s71
    s_add_u32 s70, s70, 32768
    s_add_u32 s8, s4, s70
    s_addc_u32 s9, s5, 0
    s_lshr_b32 s70, s36, 2
    s_lshl_b32 s70, s70, 7
    s_add_u32 s70, s70, 32768
    s_add_u32 s10, s4, s70
    s_addc_u32 s11, s5, 0
    s_add_u32 s60, s4, 98304
    s_addc_u32 s61, s5, 0
    s_add_u32 s62, s4, 106496
    s_addc_u32 s63, s5, 0
    s_add_u32 s64, s4, 114688
    s_addc_u32 s65, s5, 0
    s_add_u32 s66, s4, 122880
    s_addc_u32 s67, s5, 0
    s_mov_b32 s69, 0
    s_mov_b32 s68, 0
    s_cmp_eq_u32 s34, 1
    s_cbranch_scc1 c_w1_7
    s_cmp_eq_u32 s34, 2
    s_cbranch_scc1 c_w2_8
    s_cmp_eq_u32 s34, 3
    s_cbranch_scc1 c_w3_9
    v_bfe_u32 v122, v108, 5, 3
    v_lshrrev_b32 v123, 8, v108
    v_lshlrev_b32 v122, 10, v122
    v_lshl_add_u32 v122, v123, 5, v122
    v_and_b32 v123, 31, v108
    v_add_u32 v122, v122, v123
    s_mov_b64 exec, s[42:43]
    global_load_dwordx2 v[124:125], v122, s[16:17]
    s_waitcnt vmcnt(0)
    v_min_u32 v124, -2, v124
    v_min_u32 v125, -2, v125
    global_store_dwordx2 v108, v[124:125], s[60:61] sc1
    s_mov_b64 exec, -1
    v_mov_b64 v[32:33], 0
    v_mov_b64 v[34:35], 0
    v_mov_b64 v[36:37], 0
    v_mov_b64 v[38:39], 0
    v_mov_b64 v[40:41], 0
    v_mov_b64 v[42:43], 0
    v_mov_b64 v[44:45], 0
    v_mov_b64 v[46:47], 0
    v_mov_b64 v[48:49], 0
    v_mov_b64 v[50:51], 0
    v_mov_b64 v[52:53], 0
    v_mov_b64 v[54:55], 0
    s_waitcnt lgkmcnt(0)
    global_load_dwordx4 v[0:3], v106, s[60:61] sc1
    global_load_dwordx4 v[16:19], v106, s[60:61] offset:1024 sc1
c_loop_11:
    s_branch c_chk0_12
c_pollm_13:
    global_load_dwordx4 v[0:3], v106, s[60:61] sc1
    global_load_dwordx4 v[16:19], v106, s[60:61] offset:1024 sc1
c_chk0_12:
    s_waitcnt vmcnt(1)
    v_max3_u32 v122, v0, v1, v2
    s_waitcnt vmcnt(0)
    v_max3_u32 v123, v3, v16, v17
    v_max3_u32 v122, v122, v18, v19
    v_max_u32 v122, v122, v123
    v_cmp_eq_u32 vcc, -1, v122
    ds_write_b128 v117, v[0:3]
    ds_write_b128 v117, v[16:19] offset:4096
    s_cbranch_vccnz c_retry_14
    v_smfmac_f32_16x16x64_bf16 v[32:35], v[0:3], a[0:7], v104
    v_smfmac_f32_16x16x64_bf16 v[36:39], v[0:3], a[64:71], v104
    v_smfmac_f32_16x16x64_bf16 v[32:35], v[16:19], a[32:39], v104
    s_waitcnt lgkmcnt(0)
    s_barrier
    ds_read_b128 v[4:7], v116 offset:17408
    ds_read_b128 v[8:11], v116 offset:18432
    v_smfmac_f32_16x16x64_bf16 v[36:39], v[16:19], a[96:103], v104
    ds_read_b128 v[12:15], v116 offset:19456
    v_smfmac_f32_16x16x64_bf16 v[40:43], v[0:3], a[128:135], v104
    ds_read_b128 v[20:23], v116 offset:21504
    v_smfmac_f32_16x16x64_bf16 v[44:47], v[0:3], a[192:199], v104
    ds_read_b128 v[24:27], v116 offset:22528
    v_smfmac_f32_16x16x64_bf16 v[40:43], v[16:19], a[160:167], v104
    ds_read_b128 v[28:31], v116 offset:23552
    s_waitcnt lgkmcnt(5)
    v_smfmac_f32_16x16x64_bf16 v[32:35], v[4:7], a[8:15], v104
    v_mov_b32 v124, 2139193217
    v_smfmac_f32_16x16x64_bf16 v[36:39], v[4:7], a[72:79], v104
    v_mov_b32 v125, 2139193217
    s_waitcnt lgkmcnt(4)
    v_smfmac_f32_16x16x64_bf16 v[32:35], v[8:11], a[16:23], v104
    v_mov_b32 v126, 2139193217
    v_smfmac_f32_16x16x64_bf16 v[36:39], v[8:11], a[80:87], v104
    v_mov_b32 v127, 2139193217
    s_waitcnt lgkmcnt(3)
    v_smfmac_f32_16x16x64_bf16 v[32:35], v[12:15], a[24:31], v104
    global_store_dwordx4 v118, v[124:127], s[46:47] sc1
    v_smfmac_f32_16x16x64_bf16 v[36:39], v[12:15], a[88:95], v104
    global_store_dwordx4 v118, v[124:127], s[50:51] sc1
    s_waitcnt lgkmcnt(2)
    v_smfmac_f32_16x16x64_bf16 v[32:35], v[20:23], a[40:47], v104
    v_add_u32 v122, 8192, v118
    v_smfmac_f32_16x16x64_bf16 v[36:39], v[20:23], a[104:111], v104
    global_store_dwordx4 v122, v[124:127], s[46:47] sc1
    s_waitcnt lgkmcnt(1)
    v_smfmac_f32_16x16x64_bf16 v[32:35], v[24:27], a[48:55], v104
    global_store_dwordx4 v122, v[124:127], s[50:51] sc1
    v_smfmac_f32_16x16x64_bf16 v[36:39], v[24:27], a[112:119], v104
    v_add_u32 v122, 16384, v118
    s_waitcnt lgkmcnt(0)
    v_smfmac_f32_16x16x64_bf16 v[32:35], v[28:31], a[56:63], v104
    global_store_dwordx4 v122, v[124:127], s[46:47] sc1
    v_smfmac_f32_16x16x64_bf16 v[36:39], v[28:31], a[120:127], v104
    global_store_dwordx4 v122, v[124:127], s[50:51] sc1
    v_add_u32 v122, 24576, v118
    global_store_dwordx4 v122, v[124:127], s[46:47] sc1
    global_store_dwordx4 v122, v[124:127], s[50:51] sc1
    v_smfmac_f32_16x16x64_bf16 v[44:47], v[16:19], a[224:231], v104
    v_smfmac_f32_16x16x64_bf16 v[40:43], v[4:7], a[136:143], v104
    v_smfmac_f32_16x16x64_bf16 v[44:47], v[4:7], a[200:207], v104
    v_add_f32 v32, v32, v34
    v_add_f32 v33, v33, v35
    v_smfmac_f32_16x16x64_bf16 v[40:43], v[8:11], a[144:151], v104
    v_add_f32 v36, v36, v38
    v_add_f32 v37, v37, v39
    v_smfmac_f32_16x16x64_bf16 v[44:47], v[8:11], a[208:215], v104
    v_cvt_pk_bf16_f32 v32, v32, v36
    v_cvt_pk_bf16_f32 v33, v33, v37
    v_smfmac_f32_16x16x64_bf16 v[40:43], v[12:15], a[152:159], v104
    ds_write2_b32 v109, v32, v33 offset0:0 offset1:72
    v_smfmac_f32_16x16x64_bf16 v[44:47], v[12:15], a[216:223], v104
    v_smfmac_f32_16x16x64_bf16 v[40:43], v[20:23], a[168:175], v104
    s_waitcnt lgkmcnt(0)
    s_barrier
    ds_read_b128 v[56:59], v110 offset:0
    ds_read_b128 v[72:75], v116 offset:0
    v_smfmac_f32_16x16x64_bf16 v[44:47], v[20:23], a[232:239], v104
    ds_read_b128 v[60:63], v110 offset:64
    ds_read_b128 v[76:79], v116 offset:1024
    v_smfmac_f32_16x16x64_bf16 v[40:43], v[24:27], a[176:183], v104
    ds_read_b128 v[64:67], v110 offset:128
    ds_read_b128 v[80:83], v116 offset:2048
    v_smfmac_f32_16x16x64_bf16 v[44:47], v[24:27], a[240:247], v104
    ds_read_b128 v[68:71], v110 offset:192
    ds_read_b128 v[84:87], v116 offset:3072
    v_smfmac_f32_16x16x64_bf16 v[40:43], v[28:31], a[184:191], v104
    ds_read_b128 v[88:91], v116 offset:4096
    ds_read_b128 v[92:95], v116 offset:5120
    v_smfmac_f32_16x16x64_bf16 v[44:47], v[28:31], a[248:255], v104
    ds_read_b128 v[96:99], v116 offset:6144
    ds_read_b128 v[100:103], v116 offset:7168
    s_waitcnt lgkmcnt(8)
    v_mfma_f32_16x16x32_bf16 v[32:35], v[72:75], v[56:59], 0
    v_mfma_f32_16x16x32_bf16 v[32:35], v[76:79], v[60:63], v[32:35]
    s_waitcnt lgkmcnt(4)
    v_mfma_f32_16x16x32_bf16 v[32:35], v[80:83], v[64:67], v[32:35]
    v_add_f32 v40, v40, v42
    v_add_f32 v41, v41, v43
    v_mfma_f32_16x16x32_bf16 v[32:35], v[84:87], v[68:71], v[32:35]
    v_add_f32 v44, v44, v46
    v_add_f32 v45, v45, v47
    s_waitcnt lgkmcnt(2)
    v_mfma_f32_16x16x32_bf16 v[36:39], v[88:91], v[56:59], 0
    v_cvt_pk_bf16_f32 v40, v40, v44
    v_cvt_pk_bf16_f32 v41, v41, v45
    v_mfma_f32_16x16x32_bf16 v[36:39], v[92:95], v[60:63], v[36:39]
    ds_write_b32 v109, v40 offset:2304
    ds_write_b32 v109, v41 offset:2592
    s_waitcnt lgkmcnt(2)
    v_mfma_f32_16x16x32_bf16 v[36:39], v[96:99], v[64:67], v[36:39]
    v_mfma_f32_16x16x32_bf16 v[36:39], v[100:103], v[68:71], v[36:39]
    s_waitcnt lgkmcnt(0)
    s_barrier
    ds_read_b128 v[72:75], v111 offset:0
    ds_read_b128 v[76:79], v111 offset:64
    ds_read_b128 v[80:83], v111 offset:128
    ds_read_b128 v[84:87], v111 offset:192
    v_max3_f32 v122, v32, v33, v34
    s_nop 0
    v_max3_f32 v122, v122, v35, v36
    v_max3_f32 v122, v122, v37, v38
    v_max_f32 v122, v122, v39
    v_mov_b32 v123, v122
    s_waitcnt lgkmcnt(2)
    v_mfma_f32_16x16x32_bf16 v[40:43], v[72:75], v[56:59], 0
    v_permlane32_swap_b32 v123, v122
    v_mfma_f32_16x16x32_bf16 v[40:43], v[76:79], v[60:63], v[40:43]
    v_max_f32 v122, v123, v122
    v_mov_b32 v123, v122
    s_waitcnt lgkmcnt(0)
    v_mfma_f32_16x16x32_bf16 v[40:43], v[80:83], v[64:67], v[40:43]
    v_permlane16_swap_b32 v123, v122
    v_mfma_f32_16x16x32_bf16 v[40:43], v[84:87], v[68:71], v[40:43]
    v_max_f32 v122, v123, v122
    v_mul_f32 v124, s88, v122
    v_pk_fma_f32 v[32:33], v[32:33], s[88:89], v[124:125] op_sel_hi:[1,1,0] neg_lo:[0,0,1] neg_hi:[0,0,1]
    v_pk_fma_f32 v[34:35], v[34:35], s[88:89], v[124:125] op_sel_hi:[1,1,0] neg_lo:[0,0,1] neg_hi:[0,0,1]
    v_pk_fma_f32 v[36:37], v[36:37], s[88:89], v[124:125] op_sel_hi:[1,1,0] neg_lo:[0,0,1] neg_hi:[0,0,1]
    v_pk_fma_f32 v[38:39], v[38:39], s[88:89], v[124:125] op_sel_hi:[1,1,0] neg_lo:[0,0,1] neg_hi:[0,0,1]
    s_nop 1
    v_pk_fma_f32 v[40:41], v[40:41], s[88:89], v[124:125] op_sel_hi:[1,1,0] neg_lo:[0,0,1] neg_hi:[0,0,1]
    v_max_f32 v123, v40, v41
    v_cmp_lt_f32 vcc, 0x42800000, v123
    v_exp_f32 v32, v32
    v_exp_f32 v33, v33
    v_exp_f32 v34, v34
    v_exp_f32 v35, v35
    v_exp_f32 v36, v36
    v_exp_f32 v37, v37
    v_exp_f32 v38, v38
    v_exp_f32 v39, v39
    s_cbranch_vccnz c_fb_15
c_fr_16:
    v_exp_f32 v40, v40
    v_exp_f32 v41, v41
    v_pk_add_f32 v[126:127], v[32:33], v[34:35]
    v_pk_add_f32 v[124:125], v[36:37], v[38:39]
    v_pk_add_f32 v[126:127], v[126:127], v[124:125]
    v_pk_add_f32 v[126:127], v[126:127], v[40:41]
    v_add_f32 v126, v126, v127
    v_mov_b32 v123, v126
    v_mov_b64 v[88:89], 0
    s_nop 0
    v_permlane32_swap_b32 v123, v126
    v_add_f32 v126, v123, v126
    v_mov_b32 v123, v126
    v_mov_b64 v[90:91], 0
    s_nop 0
    v_permlane16_swap_b32 v123, v126
    v_add_f32 v126, v123, v126
    v_rcp_f32 v126, v126
    s_nop 0
    v_pk_mul_f32 v[32:33], v[32:33], v[126:127] op_sel_hi:[1,0]
    v_pk_mul_f32 v[34:35], v[34:35], v[126:127] op_sel_hi:[1,0]
    v_pk_mul_f32 v[36:37], v[36:37], v[126:127] op_sel_hi:[1,0]
    v_pk_mul_f32 v[38:39], v[38:39], v[126:127] op_sel_hi:[1,0]
    v_pk_mul_f32 v[40:41], v[40:41], v[126:127] op_sel_hi:[1,0]
    v_cvt_pk_bf16_f32 v44, v32, v33
    v_cvt_pk_bf16_f32 v45, v34, v35
    v_cvt_pk_bf16_f32 v46, v36, v37
    v_cvt_pk_bf16_f32 v47, v38, v39
    ds_write_b128 v116, v[44:47] offset:16384
    v_cvt_pk_bf16_f32 v48, v40, v41
    ds_write_b64 v116, v[48:49] offset:17408
    s_waitcnt lgkmcnt(0)
    s_barrier
    v_mfma_f32_32x32x16_bf16 v[0:15], v[88:91], v[88:91], 0
    v_mfma_f32_32x32x16_bf16 v[16:31], v[88:91], v[88:91], 0
    v_add_u32 v122, 32768, v107
    s_add_u32 s76, s68, 1
    v_mov_b32 v123, 0
    v_mov_b32 v124, s76
    s_barrier
    ds_read_b128 v[40:43], v113 offset:0
    ds_read_b128 v[44:47], v113 offset:128
    s_waitcnt lgkmcnt(1)
    s_nop 0
    v_smfmac_f32_16x16x64_bf16 v[0:3], v[40:43], v[128:135], v104
    v_smfmac_f32_16x16x64_bf16 v[4:7], v[40:43], v[144:151], v104
    s_waitcnt lgkmcnt(0)
    v_smfmac_f32_16x16x64_bf16 v[0:3], v[44:47], v[136:143], v104
    v_smfmac_f32_16x16x64_bf16 v[4:7], v[44:47], v[152:159], v104
    v_smfmac_f32_16x16x64_bf16 v[8:11], v[40:43], v[160:167], v104
    v_smfmac_f32_16x16x64_bf16 v[12:15], v[40:43], v[176:183], v104
    s_nop 4
    v_add_f32 v0, v0, v2
    v_add_f32 v1, v1, v3
    v_smfmac_f32_16x16x64_bf16 v[8:11], v[44:47], v[168:175], v104
    v_cvt_pk_bf16_f32 v32, v0, v1
    v_add_f32 v4, v4, v6
    v_smfmac_f32_16x16x64_bf16 v[12:15], v[44:47], v[184:191], v104
    v_add_f32 v5, v5, v7
    v_cvt_pk_bf16_f32 v33, v4, v5
    v_smfmac_f32_16x16x64_bf16 v[16:19], v[40:43], v[192:199], v104
    v_smfmac_f32_16x16x64_bf16 v[20:23], v[40:43], v[208:215], v104
    s_nop 0
    v_add_f32 v8, v8, v10
    v_add_f32 v9, v9, v11
    v_smfmac_f32_16x16x64_bf16 v[16:19], v[44:47], v[200:207], v104
    v_cvt_pk_bf16_f32 v34, v8, v9
    v_add_f32 v12, v12, v14
    v_smfmac_f32_16x16x64_bf16 v[20:23], v[44:47], v[216:223], v104
    v_add_f32 v13, v13, v15
    v_cvt_pk_bf16_f32 v35, v12, v13
    v_smfmac_f32_16x16x64_bf16 v[24:27], v[40:43], v[224:231], v104
    global_store_dwordx4 v107, v[32:35], s[44:45] sc1
    global_store_dword v123, v124, s[8:9] sc1
    v_smfmac_f32_16x16x64_bf16 v[28:31], v[40:43], v[240:247], v104
    v_add_f32 v16, v16, v18
    v_add_f32 v17, v17, v19
    v_smfmac_f32_16x16x64_bf16 v[24:27], v[44:47], v[232:239], v104
    v_cvt_pk_bf16_f32 v36, v16, v17
    v_add_f32 v20, v20, v22
    v_smfmac_f32_16x16x64_bf16 v[28:31], v[44:47], v[248:255], v104
    v_add_f32 v21, v21, v23
    v_cvt_pk_bf16_f32 v37, v20, v21
    s_nop 2
    v_pk_add_f32 v[24:25], v[24:25], v[26:27]
    s_nop 1
    v_pk_add_f32 v[28:29], v[28:29], v[30:31]
    v_cvt_pk_bf16_f32 v38, v24, v25
    v_cvt_pk_bf16_f32 v39, v28, v29
    global_store_dwordx4 v122, v[36:39], s[44:45] sc1
    global_store_dword v123, v124, s[8:9] offset:128 sc1
    v_lshrrev_b32 v126, 2, v105
    v_and_b32 v126, 127, v126
    global_load_dword v127, v126, s[10:11] sc1
    v_cndmask_b32 v48, 0, v120, s[52:53]
    v_cndmask_b32 v49, 0, v120, s[54:55]
    v_cndmask_b32 v50, 0, v120, s[56:57]
    v_cndmask_b32 v51, 0, v120, s[58:59]
    v_add_u32 v123, 8192, v118
    v_add_u32 v124, 16384, v118
    v_add_u32 v125, 24576, v118
    v_mov_b64 v[32:33], 0
    v_mov_b64 v[34:35], 0
    v_mov_b64 v[36:37], 0
    v_mov_b64 v[38:39], 0
    v_mov_b64 v[52:53], 0
    v_mov_b64 v[54:55], 0
    s_mov_b64 s[70:71], s[60:61]
    s_mov_b64 s[60:61], s[62:63]
    s_mov_b64 s[62:63], s[64:65]
    s_mov_b64 s[64:65], s[66:67]
    s_mov_b64 s[66:67], s[70:71]
    s_add_u32 s86, s86, 65536
    s_addc_u32 s87, s87, 0
c_light_20:
    s_waitcnt vmcnt(0)
    v_cmp_eq_u32 vcc, s76, v127
    global_load_dword v127, v126, s[10:11] sc1
    s_bcnt1_i32_b32 s70, vcc_lo
    s_cmp_lt_u32 s70, 1
    s_cbranch_scc1 c_retry_22
c_pollp_17:
    global_load_dwordx4 v[0:3], v118, s[44:45] sc1
    global_load_dwordx4 v[4:7], v118, s[48:49] sc1
    global_load_dwordx4 v[8:11], v123, s[44:45] sc1
    global_load_dwordx4 v[12:15], v123, s[48:49] sc1
    global_load_dwordx4 v[16:19], v124, s[44:45] sc1
    global_load_dwordx4 v[20:23], v124, s[48:49] sc1
    global_load_dwordx4 v[24:27], v125, s[44:45] sc1
    global_load_dwordx4 v[28:31], v125, s[48:49] sc1
    s_waitcnt vmcnt(8)
    v_cmp_ne_u32 vcc, s76, v127
    s_cbranch_vccnz c_re_23
    s_waitcnt vmcnt(7)
    v_mfma_f32_16x16x32_bf16 v[40:43], v[0:3], v[48:51], 0
    s_waitcnt vmcnt(6)
    v_mfma_f32_16x16x32_bf16 v[40:43], v[4:7], v[48:51], v[40:43]
    s_waitcnt vmcnt(5)
    v_mfma_f32_16x16x32_bf16 v[40:43], v[8:11], v[48:51], v[40:43]
    s_waitcnt vmcnt(4)
    v_mfma_f32_16x16x32_bf16 v[40:43], v[12:15], v[48:51], v[40:43]
    s_waitcnt vmcnt(3)
    v_mfma_f32_16x16x32_bf16 v[40:43], v[16:19], v[48:51], v[40:43]
    s_waitcnt vmcnt(2)
    v_mfma_f32_16x16x32_bf16 v[40:43], v[20:23], v[48:51], v[40:43]
    s_waitcnt vmcnt(1)
    v_mfma_f32_16x16x32_bf16 v[40:43], v[24:27], v[48:51], v[40:43]
    s_waitcnt vmcnt(0)
    v_mfma_f32_16x16x32_bf16 v[40:43], v[28:31], v[48:51], v[40:43]
    s_mov_b64 exec, s[42:43]
    s_nop 6
    v_pk_add_f32 v[44:45], v[40:41], v[42:43]
    v_cmp_u_f32 vcc, v44, v45
    v_cvt_pk_bf16_f32 v40, v40, v41
    v_cvt_pk_bf16_f32 v41, v42, v43
    v_min_u32 v40, -2, v40
    v_min_u32 v41, -2, v41
    s_cbranch_vccnz c_slow_18
c_ok_19:
    global_store_dwordx2 v108, v[40:41], s[60:61] sc1
    s_barrier
    v_mov_b64 v[42:43], -1
    global_store_dwordx2 v108, v[42:43], s[64:65] sc1
    s_mov_b64 exec, -1
    global_load_dwordx4 v[0:3], v106, s[60:61] sc1
    global_load_dwordx4 v[16:19], v106, s[60:61] offset:1024 sc1
    v_mov_b64 v[40:41], 0
    v_mov_b64 v[42:43], 0
    v_mov_b64 v[44:45], 0
    v_mov_b64 v[46:47], 0
    v_mov_b64 v[48:49], 0
    v_mov_b64 v[50:51], 0
    s_add_u32 s68, s68, 1
    s_nop 0
c_chk1_25:
    s_waitcnt vmcnt(1)
    v_max3_u32 v122, v0, v1, v2
    s_waitcnt vmcnt(0)
    v_max3_u32 v123, v3, v16, v17
    v_max3_u32 v122, v122, v18, v19
    v_max_u32 v122, v122, v123
    v_cmp_eq_u32 vcc, -1, v122
    ds_write_b128 v117, v[0:3]
    ds_write_b128 v117, v[16:19] offset:4096
    s_cbranch_vccnz c_retry_26
    v_smfmac_f32_16x16x64_bf16 v[32:35], v[0:3], a[0:7], v104
    v_smfmac_f32_16x16x64_bf16 v[36:39], v[0:3], a[64:71], v104
    v_smfmac_f32_16x16x64_bf16 v[32:35], v[16:19], a[32:39], v104
    s_waitcnt lgkmcnt(0)
    s_barrier
    ds_read_b128 v[4:7], v116 offset:17408
    ds_read_b128 v[8:11], v116 offset:18432
    v_smfmac_f32_16x16x64_bf16 v[36:39], v[16:19], a[96:103], v104
    ds_read_b128 v[12:15], v116 offset:19456
    v_smfmac_f32_16x16x64_bf16 v[40:43], v[0:3], a[128:135], v104
    ds_read_b128 v[20:23], v116 offset:21504
    v_smfmac_f32_16x16x64_bf16 v[44:47], v[0:3], a[192:199], v104
    ds_read_b128 v[24:27], v116 offset:22528
    v_smfmac_f32_16x16x64_bf16 v[40:43], v[16:19], a[160:167], v104
    ds_read_b128 v[28:31], v116 offset:23552
    s_waitcnt lgkmcnt(5)
    v_smfmac_f32_16x16x64_bf16 v[32:35], v[4:7], a[8:15], v104
    v_mov_b32 v124, 2139193217
    v_smfmac_f32_16x16x64_bf16 v[36:39], v[4:7], a[72:79], v104
    v_mov_b32 v125, 2139193217
    s_waitcnt lgkmcnt(4)
    v_smfmac_f32_16x16x64_bf16 v[32:35], v[8:11], a[16:23], v104
    v_mov_b32 v126, 2139193217
    v_smfmac_f32_16x16x64_bf16 v[36:39], v[8:11], a[80:87], v104
    v_mov_b32 v127, 2139193217
    s_waitcnt lgkmcnt(3)
    v_smfmac_f32_16x16x64_bf16 v[32:35], v[12:15], a[24:31], v104
    global_store_dwordx4 v118, v[124:127], s[44:45] sc1
    v_smfmac_f32_16x16x64_bf16 v[36:39], v[12:15], a[88:95], v104
    global_store_dwordx4 v118, v[124:127], s[48:49] sc1
    s_waitcnt lgkmcnt(2)
    v_smfmac_f32_16x16x64_bf16 v[32:35], v[20:23], a[40:47], v104
    v_add_u32 v122, 8192, v118
    v_smfmac_f32_16x16x64_bf16 v[36:39], v[20:23], a[104:111], v104
    global_store_dwordx4 v122, v[124:127], s[44:45] sc1
    s_waitcnt lgkmcnt(1)
    v_smfmac_f32_16x16x64_bf16 v[32:35], v[24:27], a[48:55], v104
    global_store_dwordx4 v122, v[124:127], s[48:49] sc1
    v_smfmac_f32_16x16x64_bf16 v[36:39], v[24:27], a[112:119], v104
    v_add_u32 v122, 16384, v118
    s_waitcnt lgkmcnt(0)
    v_smfmac_f32_16x16x64_bf16 v[32:35], v[28:31], a[56:63], v104
    global_store_dwordx4 v122, v[124:127], s[44:45] sc1
    v_smfmac_f32_16x16x64_bf16 v[36:39], v[28:31], a[120:127], v104
    global_store_dwordx4 v122, v[124:127], s[48:49] sc1
    v_add_u32 v122, 24576, v118
    global_store_dwordx4 v122, v[124:127], s[44:45] sc1
    global_store_dwordx4 v122, v[124:127], s[48:49] sc1
    v_smfmac_f32_16x16x64_bf16 v[44:47], v[16:19], a[224:231], v104
    v_smfmac_f32_16x16x64_bf16 v[40:43], v[4:7], a[136:143], v104
    v_smfmac_f32_16x16x64_bf16 v[44:47], v[4:7], a[200:207], v104
    v_add_f32 v32, v32, v34
    v_add_f32 v33, v33, v35
    v_smfmac_f32_16x16x64_bf16 v[40:43], v[8:11], a[144:151], v104
    v_add_f32 v36, v36, v38
    v_add_f32 v37, v37, v39
    v_smfmac_f32_16x16x64_bf16 v[44:47], v[8:11], a[208:215], v104
    v_cvt_pk_bf16_f32 v32, v32, v36
    v_cvt_pk_bf16_f32 v33, v33, v37
    v_smfmac_f32_16x16x64_bf16 v[40:43], v[12:15], a[152:159], v104
    ds_write2_b32 v109, v32, v33 offset0:0 offset1:72
    v_smfmac_f32_16x16x64_bf16 v[44:47], v[12:15], a[216:223], v104
    v_smfmac_f32_16x16x64_bf16 v[40:43], v[20:23], a[168:175], v104
    s_waitcnt lgkmcnt(0)
    s_barrier
    ds_read_b128 v[56:59], v110 offset:0
    ds_read_b128 v[72:75], v116 offset:0
    v_smfmac_f32_16x16x64_bf16 v[44:47], v[20:23], a[232:239], v104
    ds_read_b128 v[60:63], v110 offset:64
    ds_read_b128 v[76:79], v116 offset:1024
    v_smfmac_f32_16x16x64_bf16 v[40:43], v[24:27], a[176:183], v104
    ds_read_b128 v[64:67], v110 offset:128
    ds_read_b128 v[80:83], v116 offset:2048
    v_smfmac_f32_16x16x64_bf16 v[44:47], v[24:27], a[240:247], v104
    ds_read_b128 v[68:71], v110 offset:192
    ds_read_b128 v[84:87], v116 offset:3072
    v_smfmac_f32_16x16x64_bf16 v[40:43], v[28:31], a[184:191], v104
    ds_read_b128 v[88:91], v116 offset:4096
    ds_read_b128 v[92:95], v116 offset:5120
    v_smfmac_f32_16x16x64_bf16 v[44:47], v[28:31], a[248:255], v104
    ds_read_b128 v[96:99], v116 offset:6144
    ds_read_b128 v[100:103], v116 offset:7168
    s_waitcnt lgkmcnt(8)
    v_mfma_f32_16x16x32_bf16 v[32:35], v[72:75], v[56:59], 0
    v_mfma_f32_16x16x32_bf16 v[32:35], v[76:79], v[60:63], v[32:35]
    s_waitcnt lgkmcnt(4)
    v_mfma_f32_16x16x32_bf16 v[32:35], v[80:83], v[64:67], v[32:35]
    v_add_f32 v40, v40, v42
    v_add_f32 v41, v41, v43
    v_mfma_f32_16x16x32_bf16 v[32:35], v[84:87], v[68:71], v[32:35]
    v_add_f32 v44, v44, v46
    v_add_f32 v45, v45, v47
    s_waitcnt lgkmcnt(2)
    v_mfma_f32_16x16x32_bf16 v[36:39], v[88:91], v[56:59], 0
    v_cvt_pk_bf16_f32 v40, v40, v44
    v_cvt_pk_bf16_f32 v41, v41, v45
    v_mfma_f32_16x16x32_bf16 v[36:39], v[92:95], v[60:63], v[36:39]
    ds_write_b32 v109, v40 offset:2304
    ds_write_b32 v109, v41 offset:2592
    s_waitcnt lgkmcnt(2)
    v_mfma_f32_16x16x32_bf16 v[36:39], v[96:99], v[64:67], v[36:39]
    v_mfma_f32_16x16x32_bf16 v[36:39], v[100:103], v[68:71], v[36:39]
    s_waitcnt lgkmcnt(0)
    s_barrier
    ds_read_b128 v[72:75], v111 offset:0
    ds_read_b128 v[76:79], v111 offset:64
    ds_read_b128 v[80:83], v111 offset:128
    ds_read_b128 v[84:87], v111 offset:192
    s_cmp_eq_u32 s68, 63
    s_cbranch_scc1 c_end_10
    v_max3_f32 v122, v32, v33, v34
    v_max3_f32 v122, v122, v35, v36
    v_max3_f32 v122, v122, v37, v38
    v_max_f32 v122, v122, v39
    v_mov_b32 v123, v122
    s_waitcnt lgkmcnt(2)
    v_mfma_f32_16x16x32_bf16 v[40:43], v[72:75], v[56:59], 0
    v_permlane32_swap_b32 v123, v122
    v_mfma_f32_16x16x32_bf16 v[40:43], v[76:79], v[60:63], v[40:43]
    v_max_f32 v122, v123, v122
    v_mov_b32 v123, v122
    s_waitcnt lgkmcnt(0)
    v_mfma_f32_16x16x32_bf16 v[40:43], v[80:83], v[64:67], v[40:43]
    v_permlane16_swap_b32 v123, v122
    v_mfma_f32_16x16x32_bf16 v[40:43], v[84:87], v[68:71], v[40:43]
    v_max_f32 v122, v123, v122
    v_mul_f32 v124, s88, v122
    v_pk_fma_f32 v[32:33], v[32:33], s[88:89], v[124:125] op_sel_hi:[1,1,0] neg_lo:[0,0,1] neg_hi:[0,0,1]
    v_pk_fma_f32 v[34:35], v[34:35], s[88:89], v[124:125] op_sel_hi:[1,1,0] neg_lo:[0,0,1] neg_hi:[0,0,1]
    v_pk_fma_f32 v[36:37], v[36:37], s[88:89], v[124:125] op_sel_hi:[1,1,0] neg_lo:[0,0,1] neg_hi:[0,0,1]
    v_pk_fma_f32 v[38:39], v[38:39], s[88:89], v[124:125] op_sel_hi:[1,1,0] neg_lo:[0,0,1] neg_hi:[0,0,1]
    s_nop 1
    v_pk_fma_f32 v[40:41], v[40:41], s[88:89], v[124:125] op_sel_hi:[1,1,0] neg_lo:[0,0,1] neg_hi:[0,0,1]
    v_max_f32 v123, v40, v41
    v_cmp_lt_f32 vcc, 0x42800000, v123
    v_exp_f32 v32, v32
    v_exp_f32 v33, v33
    v_exp_f32 v34, v34
    v_exp_f32 v35, v35
    v_exp_f32 v36, v36
    v_exp_f32 v37, v37
    v_exp_f32 v38, v38
    v_exp_f32 v39, v39
    s_cbranch_vccnz c_fb_27
c_fr_28:
    v_exp_f32 v40, v40
    v_exp_f32 v41, v41
    v_pk_add_f32 v[126:127], v[32:33], v[34:35]
    v_pk_add_f32 v[124:125], v[36:37], v[38:39]
    v_pk_add_f32 v[126:127], v[126:127], v[124:125]
    v_pk_add_f32 v[126:127], v[126:127], v[40:41]
    v_add_f32 v126, v126, v127
    v_mov_b32 v123, v126
    v_mov_b64 v[88:89], 0
    s_nop 0
    v_permlane32_swap_b32 v123, v126
    v_add_f32 v126, v123, v126
    v_mov_b32 v123, v126
    v_mov_b64 v[90:91], 0
    s_nop 0
    v_permlane16_swap_b32 v123, v126
    v_add_f32 v126, v123, v126
    v_rcp_f32 v126, v126
    s_nop 0
    v_pk_mul_f32 v[32:33], v[32:33], v[126:127] op_sel_hi:[1,0]
    v_pk_mul_f32 v[34:35], v[34:35], v[126:127] op_sel_hi:[1,0]
    v_pk_mul_f32 v[36:37], v[36:37], v[126:127] op_sel_hi:[1,0]
    v_pk_mul_f32 v[38:39], v[38:39], v[126:127] op_sel_hi:[1,0]
    v_pk_mul_f32 v[40:41], v[40:41], v[126:127] op_sel_hi:[1,0]
    v_cvt_pk_bf16_f32 v44, v32, v33
    v_cvt_pk_bf16_f32 v45, v34, v35
    v_cvt_pk_bf16_f32 v46, v36, v37
    v_cvt_pk_bf16_f32 v47, v38, v39
    ds_write_b128 v116, v[44:47] offset:16384
    v_cvt_pk_bf16_f32 v48, v40, v41
    ds_write_b64 v116, v[48:49] offset:17408
    s_waitcnt lgkmcnt(0)
    s_barrier
    v_mfma_f32_32x32x16_bf16 v[0:15], v[88:91], v[88:91], 0
    v_mfma_f32_32x32x16_bf16 v[16:31], v[88:91], v[88:91], 0
    v_add_u32 v122, 32768, v107
    s_add_u32 s76, s68, 1
    v_mov_b32 v123, 0
    v_mov_b32 v124, s76
    s_barrier
    ds_read_b128 v[40:43], v113 offset:0
    ds_read_b128 v[44:47], v113 offset:128
    s_waitcnt lgkmcnt(1)
    s_nop 0
    v_smfmac_f32_16x16x64_bf16 v[0:3], v[40:43], v[128:135], v104
    v_smfmac_f32_16x16x64_bf16 v[4:7], v[40:43], v[144:151], v104
    s_waitcnt lgkmcnt(0)
    v_smfmac_f32_16x16x64_bf16 v[0:3], v[44:47], v[136:143], v104
    v_smfmac_f32_16x16x64_bf16 v[4:7], v[44:47], v[152:159], v104
    v_smfmac_f32_16x16x64_bf16 v[8:11], v[40:43], v[160:167], v104
    v_smfmac_f32_16x16x64_bf16 v[12:15], v[40:43], v[176:183], v104
    s_nop 4
    v_add_f32 v0, v0, v2
    v_add_f32 v1, v1, v3
    v_smfmac_f32_16x16x64_bf16 v[8:11], v[44:47], v[168:175], v104
    v_cvt_pk_bf16_f32 v32, v0, v1
    v_add_f32 v4, v4, v6
    v_smfmac_f32_16x16x64_bf16 v[12:15], v[44:47], v[184:191], v104
    v_add_f32 v5, v5, v7
    v_cvt_pk_bf16_f32 v33, v4, v5
    v_smfmac_f32_16x16x64_bf16 v[16:19], v[40:43], v[192:199], v104
    v_smfmac_f32_16x16x64_bf16 v[20:23], v[40:43], v[208:215], v104
    s_nop 0
    v_add_f32 v8, v8, v10
    v_add_f32 v9, v9, v11
    v_smfmac_f32_16x16x64_bf16 v[16:19], v[44:47], v[200:207], v104
    v_cvt_pk_bf16_f32 v34, v8, v9
    v_add_f32 v12, v12, v14
    v_smfmac_f32_16x16x64_bf16 v[20:23], v[44:47], v[216:223], v104
    v_add_f32 v13, v13, v15
    v_cvt_pk_bf16_f32 v35, v12, v13
    v_smfmac_f32_16x16x64_bf16 v[24:27], v[40:43], v[224:231], v104
    global_store_dwordx4 v107, v[32:35], s[46:47] sc1
    global_store_dword v123, v124, s[8:9] sc1
    v_smfmac_f32_16x16x64_bf16 v[28:31], v[40:43], v[240:247], v104
    v_add_f32 v16, v16, v18
    v_add_f32 v17, v17, v19
    v_smfmac_f32_16x16x64_bf16 v[24:27], v[44:47], v[232:239], v104
    v_cvt_pk_bf16_f32 v36, v16, v17
    v_add_f32 v20, v20, v22
    v_smfmac_f32_16x16x64_bf16 v[28:31], v[44:47], v[248:255], v104
    v_add_f32 v21, v21, v23
    v_cvt_pk_bf16_f32 v37, v20, v21
    s_nop 2
    v_pk_add_f32 v[24:25], v[24:25], v[26:27]
    s_nop 1
    v_pk_add_f32 v[28:29], v[28:29], v[30:31]
    v_cvt_pk_bf16_f32 v38, v24, v25
    v_cvt_pk_bf16_f32 v39, v28, v29
    global_store_dwordx4 v122, v[36:39], s[46:47] sc1
    global_store_dword v123, v124, s[8:9] offset:128 sc1
    v_lshrrev_b32 v126, 2, v105
    v_and_b32 v126, 127, v126
    global_load_dword v127, v126, s[10:11] sc1
    v_cndmask_b32 v48, 0, v120, s[52:53]
    v_cndmask_b32 v49, 0, v120, s[54:55]
    v_cndmask_b32 v50, 0, v120, s[56:57]
    v_cndmask_b32 v51, 0, v120, s[58:59]
    v_add_u32 v123, 8192, v118
    v_add_u32 v124, 16384, v118
    v_add_u32 v125, 24576, v118
    v_mov_b64 v[32:33], 0
    v_mov_b64 v[34:35], 0
    v_mov_b64 v[36:37], 0
    v_mov_b64 v[38:39], 0
    v_mov_b64 v[52:53], 0
    v_mov_b64 v[54:55], 0
    s_mov_b64 s[70:71], s[60:61]
    s_mov_b64 s[60:61], s[62:63]
    s_mov_b64 s[62:63], s[64:65]
    s_mov_b64 s[64:65], s[66:67]
    s_mov_b64 s[66:67], s[70:71]
    s_add_u32 s86, s86, 65536
    s_addc_u32 s87, s87, 0
c_light_32:
    s_waitcnt vmcnt(0)
    v_cmp_eq_u32 vcc, s76, v127
    global_load_dword v127, v126, s[10:11] sc1
    s_bcnt1_i32_b32 s70, vcc_lo
    s_cmp_lt_u32 s70, 1
    s_cbranch_scc1 c_retry_34
c_pollp_29:
    global_load_dwordx4 v[0:3], v118, s[46:47] sc1
    global_load_dwordx4 v[4:7], v118, s[50:51] sc1
    global_load_dwordx4 v[8:11], v123, s[46:47] sc1
    global_load_dwordx4 v[12:15], v123, s[50:51] sc1
    global_load_dwordx4 v[16:19], v124, s[46:47] sc1
    global_load_dwordx4 v[20:23], v124, s[50:51] sc1
    global_load_dwordx4 v[24:27], v125, s[46:47] sc1
    global_load_dwordx4 v[28:31], v125, s[50:51] sc1
    s_waitcnt vmcnt(8)
    v_cmp_ne_u32 vcc, s76, v127
    s_cbranch_vccnz c_re_35
    s_waitcnt vmcnt(7)
    v_mfma_f32_16x16x32_bf16 v[40:43], v[0:3], v[48:51], 0
    s_waitcnt vmcnt(6)
    v_mfma_f32_16x16x32_bf16 v[40:43], v[4:7], v[48:51], v[40:43]
    s_waitcnt vmcnt(5)
    v_mfma_f32_16x16x32_bf16 v[40:43], v[8:11], v[48:51], v[40:43]
    s_waitcnt vmcnt(4)
    v_mfma_f32_16x16x32_bf16 v[40:43], v[12:15], v[48:51], v[40:43]
    s_waitcnt vmcnt(3)
    v_mfma_f32_16x16x32_bf16 v[40:43], v[16:19], v[48:51], v[40:43]
    s_waitcnt vmcnt(2)
    v_mfma_f32_16x16x32_bf16 v[40:43], v[20:23], v[48:51], v[40:43]
    s_waitcnt vmcnt(1)
    v_mfma_f32_16x16x32_bf16 v[40:43], v[24:27], v[48:51], v[40:43]
    s_waitcnt vmcnt(0)
    v_mfma_f32_16x16x32_bf16 v[40:43], v[28:31], v[48:51], v[40:43]
    s_mov_b64 exec, s[42:43]
    s_nop 6
    v_pk_add_f32 v[44:45], v[40:41], v[42:43]
    v_cmp_u_f32 vcc, v44, v45
    v_cvt_pk_bf16_f32 v40, v40, v41
    v_cvt_pk_bf16_f32 v41, v42, v43
    v_min_u32 v40, -2, v40
    v_min_u32 v41, -2, v41
    s_cbranch_vccnz c_slow_30
c_ok_31:
    global_store_dwordx2 v108, v[40:41], s[60:61] sc1
    s_barrier
    v_mov_b64 v[42:43], -1
    global_store_dwordx2 v108, v[42:43], s[64:65] sc1
    s_mov_b64 exec, -1
    global_load_dwordx4 v[0:3], v106, s[60:61] sc1
    global_load_dwordx4 v[16:19], v106, s[60:61] offset:1024 sc1
    v_mov_b64 v[40:41], 0
    v_mov_b64 v[42:43], 0
    v_mov_b64 v[44:45], 0
    v_mov_b64 v[46:47], 0
    v_mov_b64 v[48:49], 0
    v_mov_b64 v[50:51], 0
    s_add_u32 s68, s68, 1
    s_nop 0
    s_branch c_chk0_12
c_w1_7:
    v_mov_b64 v[32:33], 0
    v_mov_b64 v[34:35], 0
    v_mov_b64 v[36:37], 0
    v_mov_b64 v[38:39], 0
    v_mov_b64 v[40:41], 0
    v_mov_b64 v[42:43], 0
    v_mov_b64 v[44:45], 0
    v_mov_b64 v[46:47], 0
    v_mov_b64 v[48:49], 0
    v_mov_b64 v[50:51], 0
    v_mov_b64 v[52:53], 0
    v_mov_b64 v[54:55], 0
    ds_read_b128 v[56:59], v114 offset:16384
    ds_read_b128 v[60:63], v114 offset:17408
    ds_read_b128 v[64:67], v114 offset:18432
    ds_read_b128 v[68:71], v114 offset:19456
    ds_read_b128 v[72:75], v114 offset:20480
    ds_read_b128 v[76:79], v114 offset:21504
    ds_read_b128 v[80:83], v115 offset:16384
    ds_read_b128 v[84:87], v115 offset:17408
    ds_read_b128 v[88:91], v115 offset:18432
    ds_read_b128 v[92:95], v115 offset:19456
    v_mov_b64 v[100:101], 0
    v_mov_b64 v[102:103], 0
    s_waitcnt lgkmcnt(0)
    global_load_dwordx4 v[4:7], v106, s[60:61] sc1
    global_load_dwordx4 v[20:23], v106, s[60:61] offset:1024 sc1
c_loop_36:
    s_branch c_chk0_37
c_pollm_38:
    global_load_dwordx4 v[4:7], v106, s[60:61] sc1
    global_load_dwordx4 v[20:23], v106, s[60:61] offset:1024 sc1
c_chk0_37:
    s_waitcnt vmcnt(1)
    v_max3_u32 v122, v4, v5, v6
    s_waitcnt vmcnt(0)
    v_max3_u32 v123, v7, v20, v21
    v_max3_u32 v122, v122, v22, v23
    v_max_u32 v122, v122, v123
    v_cmp_eq_u32 vcc, -1, v122
    ds_write_b128 v117, v[4:7]
    ds_write_b128 v117, v[20:23] offset:4096
    s_cbranch_vccnz c_retry_39
    v_smfmac_f32_16x16x64_bf16 v[32:35], v[4:7], a[8:15], v104
    v_smfmac_f32_16x16x64_bf16 v[36:39], v[4:7], a[72:79], v104
    v_smfmac_f32_16x16x64_bf16 v[32:35], v[20:23], a[40:47], v104
    s_waitcnt lgkmcnt(0)
    s_barrier
    ds_read_b128 v[0:3], v116 offset:16384
    ds_read_b128 v[8:11], v116 offset:18432
    v_smfmac_f32_16x16x64_bf16 v[36:39], v[20:23], a[104:111], v104
    ds_read_b128 v[12:15], v116 offset:19456
    v_smfmac_f32_16x16x64_bf16 v[40:43], v[4:7], a[136:143], v104
    ds_read_b128 v[16:19], v116 offset:20480
    global_store_dwordx4 v105, v[24:27], s[84:85] sc1
    global_store_dwordx4 v105, v[28:31], s[84:85] offset:1024 sc1
    v_smfmac_f32_16x16x64_bf16 v[44:47], v[4:7], a[200:207], v104
    ds_read_b128 v[24:27], v116 offset:22528
    v_smfmac_f32_16x16x64_bf16 v[40:43], v[20:23], a[168:175], v104
    ds_read_b128 v[28:31], v116 offset:23552
    s_waitcnt lgkmcnt(5)
    v_smfmac_f32_16x16x64_bf16 v[32:35], v[0:3], a[0:7], v104
    global_store_dword v121, v110, s[86:87] offset:0 sc1
    v_smfmac_f32_16x16x64_bf16 v[36:39], v[0:3], a[64:71], v104
    global_store_dword v121, v111, s[86:87] offset:256 sc1
    s_waitcnt lgkmcnt(4)
    v_smfmac_f32_16x16x64_bf16 v[32:35], v[8:11], a[16:23], v104
    global_store_dword v121, v119, s[86:87] offset:512 sc1
    v_smfmac_f32_16x16x64_bf16 v[36:39], v[8:11], a[80:87], v104
    s_sub_u32 s70, s68, 1
    s_waitcnt lgkmcnt(3)
    v_smfmac_f32_16x16x64_bf16 v[32:35], v[12:15], a[24:31], v104
    s_max_i32 s70, s70, 0
    v_smfmac_f32_16x16x64_bf16 v[36:39], v[12:15], a[88:95], v104
    v_mov_b32 v122, s100
    s_waitcnt lgkmcnt(2)
    v_smfmac_f32_16x16x64_bf16 v[32:35], v[16:19], a[32:39], v104
    v_mov_b32 v123, s70
    v_smfmac_f32_16x16x64_bf16 v[36:39], v[16:19], a[96:103], v104
    global_store_dword v122, v123, s[4:5] sc1
    s_waitcnt lgkmcnt(1)
    v_smfmac_f32_16x16x64_bf16 v[32:35], v[24:27], a[48:55], v104
    v_smfmac_f32_16x16x64_bf16 v[36:39], v[24:27], a[112:119], v104
    s_waitcnt lgkmcnt(0)
    v_smfmac_f32_16x16x64_bf16 v[32:35], v[28:31], a[56:63], v104
    v_smfmac_f32_16x16x64_bf16 v[36:39], v[28:31], a[120:127], v104
    v_smfmac_f32_16x16x64_bf16 v[44:47], v[20:23], a[232:239], v104
    v_smfmac_f32_16x16x64_bf16 v[40:43], v[0:3], a[128:135], v104
    v_smfmac_f32_16x16x64_bf16 v[44:47], v[0:3], a[192:199], v104
    s_nop 3
    v_add_f32 v32, v32, v34
    v_add_f32 v33, v33, v35
    v_smfmac_f32_16x16x64_bf16 v[40:43], v[8:11], a[144:151], v104
    v_add_f32 v36, v36, v38
    v_add_f32 v37, v37, v39
    v_smfmac_f32_16x16x64_bf16 v[44:47], v[8:11], a[208:215], v104
    v_cvt_pk_bf16_f32 v32, v32, v36
    v_cvt_pk_bf16_f32 v33, v33, v37
    v_smfmac_f32_16x16x64_bf16 v[40:43], v[12:15], a[152:159], v104
    ds_write2_b32 v109, v32, v33 offset0:0 offset1:72
    v_smfmac_f32_16x16x64_bf16 v[44:47], v[12:15], a[216:223], v104
    v_smfmac_f32_16x16x64_bf16 v[40:43], v[16:19], a[160:167], v104
    s_waitcnt lgkmcnt(0)
    s_barrier
    v_smfmac_f32_16x16x64_bf16 v[44:47], v[16:19], a[224:231], v104
    ds_read_b128 v[32:35], v116 offset:8192
    v_smfmac_f32_16x16x64_bf16 v[40:43], v[24:27], a[176:183], v104
    ds_read_b128 v[36:39], v116 offset:9216
    v_smfmac_f32_16x16x64_bf16 v[44:47], v[24:27], a[240:247], v104
    ds_read_b128 v[96:99], v116 offset:10240
    v_smfmac_f32_16x16x64_bf16 v[40:43], v[28:31], a[184:191], v104
    v_smfmac_f32_16x16x64_bf16 v[44:47], v[28:31], a[248:255], v104
    v_smfmac_f32_16x16x64_bf16 v[48:51], v[4:7], v[56:63], v104
    ds_read_b128 v[56:59], v115 offset:20480
    ds_read_b128 v[60:63], v115 offset:21504
    v_smfmac_f32_16x16x64_bf16 v[52:55], v[4:7], v[64:71], v104
    ds_read_b128 v[64:67], v114 offset:0
    ds_read_b128 v[68:71], v114 offset:1024
    s_nop 0
    v_add_f32 v40, v40, v42
    v_add_f32 v41, v41, v43
    v_add_f32 v44, v44, v46
    v_add_f32 v45, v45, v47
    v_cvt_pk_bf16_f32 v40, v40, v44
    v_cvt_pk_bf16_f32 v41, v41, v45
    ds_write_b32 v109, v40 offset:2304
    ds_write_b32 v109, v41 offset:2592
    v_smfmac_f32_16x16x64_bf16 v[100:103], v[4:7], v[72:79], v104
    ds_read_b128 v[72:75], v114 offset:2048
    ds_read_b128 v[76:79], v114 offset:3072
    v_smfmac_f32_16x16x64_bf16 v[48:51], v[20:23], v[80:87], v104
    ds_read_b128 v[80:83], v114 offset:4096
    ds_read_b128 v[84:87], v114 offset:5120
    v_smfmac_f32_16x16x64_bf16 v[52:55], v[20:23], v[88:95], v104
    ds_read_b128 v[88:91], v114 offset:32768
    ds_read_b128 v[92:95], v114 offset:33792
    s_waitcnt lgkmcnt(6)
    s_barrier
    v_smfmac_f32_16x16x64_bf16 v[100:103], v[20:23], v[56:63], v104
    ds_read_b128 v[56:59], v114 offset:34816
    ds_read_b128 v[60:63], v114 offset:35840
    v_smfmac_f32_16x16x64_bf16 v[48:51], v[0:3], v[64:71], v104
    ds_read_b128 v[64:67], v114 offset:36864
    ds_read_b128 v[68:71], v114 offset:37888
    s_waitcnt lgkmcnt(8)
    v_smfmac_f32_16x16x64_bf16 v[52:55], v[0:3], v[72:79], v104
    ds_read_b128 v[72:75], v114 offset:49152
    ds_read_b128 v[76:79], v114 offset:50176
    s_waitcnt lgkmcnt(8)
    v_smfmac_f32_16x16x64_bf16 v[100:103], v[0:3], v[80:87], v104
    ds_read_b128 v[80:83], v114 offset:51200
    ds_read_b128 v[84:87], v114 offset:52224
    s_waitcnt lgkmcnt(8)
    v_smfmac_f32_16x16x64_bf16 v[48:51], v[8:11], v[88:95], v104
    ds_read_b128 v[88:91], v114 offset:53248
    ds_read_b128 v[92:95], v114 offset:54272
    s_waitcnt lgkmcnt(8)
    v_smfmac_f32_16x16x64_bf16 v[52:55], v[8:11], v[56:63], v104
    ds_read_b128 v[56:59], v115 offset:0
    ds_read_b128 v[60:63], v115 offset:1024
    s_waitcnt lgkmcnt(8)
    v_smfmac_f32_16x16x64_bf16 v[100:103], v[8:11], v[64:71], v104
    ds_read_b128 v[64:67], v115 offset:2048
    ds_read_b128 v[68:71], v115 offset:3072
    s_waitcnt lgkmcnt(8)
    v_smfmac_f32_16x16x64_bf16 v[48:51], v[12:15], v[72:79], v104
    ds_read_b128 v[72:75], v115 offset:4096
    ds_read_b128 v[76:79], v115 offset:5120
    s_waitcnt lgkmcnt(8)
    v_smfmac_f32_16x16x64_bf16 v[52:55], v[12:15], v[80:87], v104
    ds_read_b128 v[80:83], v115 offset:32768
    ds_read_b128 v[84:87], v115 offset:33792
    s_waitcnt lgkmcnt(8)
    v_smfmac_f32_16x16x64_bf16 v[100:103], v[12:15], v[88:95], v104
    ds_read_b128 v[88:91], v115 offset:34816
    ds_read_b128 v[92:95], v115 offset:35840
    s_waitcnt lgkmcnt(8)
    v_smfmac_f32_16x16x64_bf16 v[48:51], v[16:19], v[56:63], v104
    ds_read_b128 v[56:59], v115 offset:36864
    ds_read_b128 v[60:63], v115 offset:37888
    s_waitcnt lgkmcnt(8)
    v_smfmac_f32_16x16x64_bf16 v[52:55], v[16:19], v[64:71], v104
    ds_read_b128 v[64:67], v115 offset:49152
    ds_read_b128 v[68:71], v115 offset:50176
    s_waitcnt lgkmcnt(8)
    v_smfmac_f32_16x16x64_bf16 v[100:103], v[16:19], v[72:79], v104
    ds_read_b128 v[72:75], v115 offset:51200
    ds_read_b128 v[76:79], v115 offset:52224
    s_waitcnt lgkmcnt(8)
    v_smfmac_f32_16x16x64_bf16 v[48:51], v[24:27], v[80:87], v104
    ds_read_b128 v[80:83], v115 offset:53248
    ds_read_b128 v[84:87], v115 offset:54272
    s_waitcnt lgkmcnt(8)
    v_smfmac_f32_16x16x64_bf16 v[52:55], v[24:27], v[88:95], v104
    s_waitcnt lgkmcnt(6)
    v_smfmac_f32_16x16x64_bf16 v[100:103], v[24:27], v[56:63], v104
    s_waitcnt lgkmcnt(4)
    v_smfmac_f32_16x16x64_bf16 v[48:51], v[28:31], v[64:71], v104
    s_waitcnt lgkmcnt(2)
    v_smfmac_f32_16x16x64_bf16 v[52:55], v[28:31], v[72:79], v104
    s_waitcnt lgkmcnt(0)
    v_smfmac_f32_16x16x64_bf16 v[100:103], v[28:31], v[80:87], v104
    v_mov_b64 v[72:73], 0
    v_mov_b64 v[74:75], 0
    s_nop 1
    v_pk_add_f32 v[48:49], v[48:49], v[50:51]
    v_cvt_pk_bf16_f32 v48, v48, v49
    v_mov_b32 v49, 0
    v_pk_add_f32 v[52:53], v[52:53], v[54:55]
    v_cvt_pk_bf16_f32 v52, v52, v53
    v_mov_b32 v53, 0
    v_pk_add_f32 v[100:101], v[100:101], v[102:103]
    v_cvt_pk_bf16_f32 v100, v100, v101
    v_mov_b32 v101, 0
    v_mfma_f32_32x32x16_bf16 v[0:15], v[72:75], v[72:75], 0
    v_mfma_f32_32x32x16_bf16 v[16:31], v[72:75], v[72:75], 0
    v_mov_b32 v110, v48
    v_mov_b32 v111, v52
    v_mov_b32 v119, v100
    s_waitcnt lgkmcnt(0)
    s_barrier
    ds_read_b128 v[44:47], v116 offset:16384
    ds_read_b64 v[126:127], v116 offset:17408
    v_add_u32 v122, 32768, v107
    s_add_u32 s76, s68, 1
    v_mov_b32 v123, 0
    v_mov_b32 v124, s76
    s_waitcnt lgkmcnt(1)
    v_mfma_f32_16x16x32_bf16 v[56:59], v[32:35], v[44:47], 0
    v_mfma_f32_16x16x32_bf16 v[60:63], v[36:39], v[44:47], 0
    v_mfma_f32_16x16x32_bf16 v[64:67], v[96:99], v[44:47], 0
    s_waitcnt lgkmcnt(0)
    s_nop 2
    v_mfma_f32_16x16x16_bf16 v[56:59], v[48:49], v[126:127], v[56:59]
    v_mfma_f32_16x16x16_bf16 v[60:63], v[52:53], v[126:127], v[60:63]
    v_mfma_f32_16x16x16_bf16 v[64:67], v[100:101], v[126:127], v[64:67]
    s_nop 5
    v_cvt_pk_bf16_f32 v56, v56, v57
    v_cvt_pk_bf16_f32 v57, v58, v59
    ds_write_b64 v112, v[56:57] offset:0
    v_cvt_pk_bf16_f32 v60, v60, v61
    v_cvt_pk_bf16_f32 v61, v62, v63
    ds_write_b64 v112, v[60:61] offset:32
    v_cvt_pk_bf16_f32 v64, v64, v65
    v_cvt_pk_bf16_f32 v65, v66, v67
    ds_write_b64 v112, v[64:65] offset:64
    s_waitcnt lgkmcnt(0)
    s_barrier
    ds_read_b128 v[40:43], v113 offset:0
    ds_read_b128 v[44:47], v113 offset:128
    s_waitcnt lgkmcnt(1)
    v_smfmac_f32_16x16x64_bf16 v[0:3], v[40:43], v[128:135], v104
    v_smfmac_f32_16x16x64_bf16 v[4:7], v[40:43], v[144:151], v104
    s_waitcnt lgkmcnt(0)
    v_smfmac_f32_16x16x64_bf16 v[0:3], v[44:47], v[136:143], v104
    v_smfmac_f32_16x16x64_bf16 v[4:7], v[44:47], v[152:159], v104
    v_smfmac_f32_16x16x64_bf16 v[8:11], v[40:43], v[160:167], v104
    v_smfmac_f32_16x16x64_bf16 v[12:15], v[40:43], v[176:183], v104
    s_nop 4
    v_add_f32 v0, v0, v2
    v_add_f32 v1, v1, v3
    v_smfmac_f32_16x16x64_bf16 v[8:11], v[44:47], v[168:175], v104
    v_cvt_pk_bf16_f32 v32, v0, v1
    v_add_f32 v4, v4, v6
    v_smfmac_f32_16x16x64_bf16 v[12:15], v[44:47], v[184:191], v104
    v_add_f32 v5, v5, v7
    v_cvt_pk_bf16_f32 v33, v4, v5
    v_smfmac_f32_16x16x64_bf16 v[16:19], v[40:43], v[192:199], v104
    v_smfmac_f32_16x16x64_bf16 v[20:23], v[40:43], v[208:215], v104
    s_nop 0
    v_add_f32 v8, v8, v10
    v_add_f32 v9, v9, v11
    v_smfmac_f32_16x16x64_bf16 v[16:19], v[44:47], v[200:207], v104
    v_cvt_pk_bf16_f32 v34, v8, v9
    v_add_f32 v12, v12, v14
    v_smfmac_f32_16x16x64_bf16 v[20:23], v[44:47], v[216:223], v104
    v_add_f32 v13, v13, v15
    v_cvt_pk_bf16_f32 v35, v12, v13
    v_smfmac_f32_16x16x64_bf16 v[24:27], v[40:43], v[224:231], v104
    global_store_dwordx4 v107, v[32:35], s[44:45] sc1
    global_store_dword v123, v124, s[8:9] sc1
    v_smfmac_f32_16x16x64_bf16 v[28:31], v[40:43], v[240:247], v104
    v_add_f32 v16, v16, v18
    v_add_f32 v17, v17, v19
    v_smfmac_f32_16x16x64_bf16 v[24:27], v[44:47], v[232:239], v104
    v_cvt_pk_bf16_f32 v36, v16, v17
    v_add_f32 v20, v20, v22
    v_smfmac_f32_16x16x64_bf16 v[28:31], v[44:47], v[248:255], v104
    v_add_f32 v21, v21, v23
    v_cvt_pk_bf16_f32 v37, v20, v21
    s_nop 2
    v_pk_add_f32 v[24:25], v[24:25], v[26:27]
    s_nop 1
    v_pk_add_f32 v[28:29], v[28:29], v[30:31]
    v_cvt_pk_bf16_f32 v38, v24, v25
    v_cvt_pk_bf16_f32 v39, v28, v29
    global_store_dwordx4 v122, v[36:39], s[44:45] sc1
    global_store_dword v123, v124, s[8:9] offset:128 sc1
    s_add_u32 s84, s84, 131072
    s_addc_u32 s85, s85, 0
    s_add_u32 s86, s86, 65536
    s_addc_u32 s87, s87, 0
    s_mov_b64 s[70:71], s[60:61]
    s_mov_b64 s[60:61], s[62:63]
    s_mov_b64 s[62:63], s[64:65]
    s_mov_b64 s[64:65], s[66:67]
    s_mov_b64 s[66:67], s[70:71]
    s_add_u32 s68, s68, 1
    v_mfma_f32_32x32x16_bf16 v[32:47], v[72:75], v[72:75], 0
    v_mfma_f32_16x16x32_bf16 v[48:51], v[72:75], v[72:75], 0
    v_mfma_f32_16x16x32_bf16 v[52:55], v[72:75], v[72:75], 0
    v_mfma_f32_16x16x32_bf16 v[100:103], v[72:75], v[72:75], 0
    ds_read_b128 v[56:59], v114 offset:16384
    ds_read_b128 v[60:63], v114 offset:17408
    ds_read_b128 v[64:67], v114 offset:18432
    ds_read_b128 v[68:71], v114 offset:19456
    ds_read_b128 v[72:75], v114 offset:20480
    ds_read_b128 v[76:79], v114 offset:21504
    ds_read_b128 v[80:83], v115 offset:16384
    ds_read_b128 v[84:87], v115 offset:17408
    ds_read_b128 v[88:91], v115 offset:18432
    ds_read_b128 v[92:95], v115 offset:19456
    ds_read_b128 v[24:27], v120
    ds_read_b128 v[28:31], v120 offset:1152
    s_waitcnt lgkmcnt(0)
    s_barrier
    global_load_dwordx4 v[4:7], v106, s[60:61] sc1
    global_load_dwordx4 v[20:23], v106, s[60:61] offset:1024 sc1
c_chk1_41:
    s_waitcnt vmcnt(1)
    v_max3_u32 v122, v4, v5, v6
    s_waitcnt vmcnt(0)
    v_max3_u32 v123, v7, v20, v21
    v_max3_u32 v122, v122, v22, v23
    v_max_u32 v122, v122, v123
    v_cmp_eq_u32 vcc, -1, v122
    ds_write_b128 v117, v[4:7]
    ds_write_b128 v117, v[20:23] offset:4096
    s_cbranch_vccnz c_retry_42
    v_smfmac_f32_16x16x64_bf16 v[32:35], v[4:7], a[8:15], v104
    v_smfmac_f32_16x16x64_bf16 v[36:39], v[4:7], a[72:79], v104
    v_smfmac_f32_16x16x64_bf16 v[32:35], v[20:23], a[40:47], v104
    s_waitcnt lgkmcnt(0)
    s_barrier
    ds_read_b128 v[0:3], v116 offset:16384
    ds_read_b128 v[8:11], v116 offset:18432
    v_smfmac_f32_16x16x64_bf16 v[36:39], v[20:23], a[104:111], v104
    ds_read_b128 v[12:15], v116 offset:19456
    v_smfmac_f32_16x16x64_bf16 v[40:43], v[4:7], a[136:143], v104
    ds_read_b128 v[16:19], v116 offset:20480
    global_store_dwordx4 v105, v[24:27], s[84:85] sc1
    global_store_dwordx4 v105, v[28:31], s[84:85] offset:1024 sc1
    v_smfmac_f32_16x16x64_bf16 v[44:47], v[4:7], a[200:207], v104
    ds_read_b128 v[24:27], v116 offset:22528
    v_smfmac_f32_16x16x64_bf16 v[40:43], v[20:23], a[168:175], v104
    ds_read_b128 v[28:31], v116 offset:23552
    s_waitcnt lgkmcnt(5)
    v_smfmac_f32_16x16x64_bf16 v[32:35], v[0:3], a[0:7], v104
    global_store_dword v121, v110, s[86:87] offset:0 sc1
    v_smfmac_f32_16x16x64_bf16 v[36:39], v[0:3], a[64:71], v104
    global_store_dword v121, v111, s[86:87] offset:256 sc1
    s_waitcnt lgkmcnt(4)
    v_smfmac_f32_16x16x64_bf16 v[32:35], v[8:11], a[16:23], v104
    global_store_dword v121, v119, s[86:87] offset:512 sc1
    v_smfmac_f32_16x16x64_bf16 v[36:39], v[8:11], a[80:87], v104
    s_sub_u32 s70, s68, 1
    s_waitcnt lgkmcnt(3)
    v_smfmac_f32_16x16x64_bf16 v[32:35], v[12:15], a[24:31], v104
    s_max_i32 s70, s70, 0
    v_smfmac_f32_16x16x64_bf16 v[36:39], v[12:15], a[88:95], v104
    v_mov_b32 v122, s100
    s_waitcnt lgkmcnt(2)
    v_smfmac_f32_16x16x64_bf16 v[32:35], v[16:19], a[32:39], v104
    v_mov_b32 v123, s70
    v_smfmac_f32_16x16x64_bf16 v[36:39], v[16:19], a[96:103], v104
    global_store_dword v122, v123, s[4:5] sc1
    s_waitcnt lgkmcnt(1)
    v_smfmac_f32_16x16x64_bf16 v[32:35], v[24:27], a[48:55], v104
    v_smfmac_f32_16x16x64_bf16 v[36:39], v[24:27], a[112:119], v104
    s_waitcnt lgkmcnt(0)
    v_smfmac_f32_16x16x64_bf16 v[32:35], v[28:31], a[56:63], v104
    v_smfmac_f32_16x16x64_bf16 v[36:39], v[28:31], a[120:127], v104
    v_smfmac_f32_16x16x64_bf16 v[44:47], v[20:23], a[232:239], v104
    v_smfmac_f32_16x16x64_bf16 v[40:43], v[0:3], a[128:135], v104
    v_smfmac_f32_16x16x64_bf16 v[44:47], v[0:3], a[192:199], v104
    s_nop 3
    v_add_f32 v32, v32, v34
    v_add_f32 v33, v33, v35
    v_smfmac_f32_16x16x64_bf16 v[40:43], v[8:11], a[144:151], v104
    v_add_f32 v36, v36, v38
    v_add_f32 v37, v37, v39
    v_smfmac_f32_16x16x64_bf16 v[44:47], v[8:11], a[208:215], v104
    v_cvt_pk_bf16_f32 v32, v32, v36
    v_cvt_pk_bf16_f32 v33, v33, v37
    v_smfmac_f32_16x16x64_bf16 v[40:43], v[12:15], a[152:159], v104
    ds_write2_b32 v109, v32, v33 offset0:0 offset1:72
    v_smfmac_f32_16x16x64_bf16 v[44:47], v[12:15], a[216:223], v104
    v_smfmac_f32_16x16x64_bf16 v[40:43], v[16:19], a[160:167], v104
    s_waitcnt lgkmcnt(0)
    s_barrier
    v_smfmac_f32_16x16x64_bf16 v[44:47], v[16:19], a[224:231], v104
    ds_read_b128 v[32:35], v116 offset:8192
    v_smfmac_f32_16x16x64_bf16 v[40:43], v[24:27], a[176:183], v104
    ds_read_b128 v[36:39], v116 offset:9216
    v_smfmac_f32_16x16x64_bf16 v[44:47], v[24:27], a[240:247], v104
    ds_read_b128 v[96:99], v116 offset:10240
    v_smfmac_f32_16x16x64_bf16 v[40:43], v[28:31], a[184:191], v104
    v_smfmac_f32_16x16x64_bf16 v[44:47], v[28:31], a[248:255], v104
    v_smfmac_f32_16x16x64_bf16 v[48:51], v[4:7], v[56:63], v104
    ds_read_b128 v[56:59], v115 offset:20480
    ds_read_b128 v[60:63], v115 offset:21504
    v_smfmac_f32_16x16x64_bf16 v[52:55], v[4:7], v[64:71], v104
    ds_read_b128 v[64:67], v114 offset:0
    ds_read_b128 v[68:71], v114 offset:1024
    s_nop 0
    v_add_f32 v40, v40, v42
    v_add_f32 v41, v41, v43
    v_add_f32 v44, v44, v46
    v_add_f32 v45, v45, v47
    v_cvt_pk_bf16_f32 v40, v40, v44
    v_cvt_pk_bf16_f32 v41, v41, v45
    ds_write_b32 v109, v40 offset:2304
    ds_write_b32 v109, v41 offset:2592
    v_smfmac_f32_16x16x64_bf16 v[100:103], v[4:7], v[72:79], v104
    ds_read_b128 v[72:75], v114 offset:2048
    ds_read_b128 v[76:79], v114 offset:3072
    v_smfmac_f32_16x16x64_bf16 v[48:51], v[20:23], v[80:87], v104
    ds_read_b128 v[80:83], v114 offset:4096
    ds_read_b128 v[84:87], v114 offset:5120
    v_smfmac_f32_16x16x64_bf16 v[52:55], v[20:23], v[88:95], v104
    ds_read_b128 v[88:91], v114 offset:32768
    ds_read_b128 v[92:95], v114 offset:33792
    s_waitcnt lgkmcnt(6)
    s_barrier
    v_smfmac_f32_16x16x64_bf16 v[100:103], v[20:23], v[56:63], v104
    ds_read_b128 v[56:59], v114 offset:34816
    ds_read_b128 v[60:63], v114 offset:35840
    v_smfmac_f32_16x16x64_bf16 v[48:51], v[0:3], v[64:71], v104
    ds_read_b128 v[64:67], v114 offset:36864
    ds_read_b128 v[68:71], v114 offset:37888
    s_waitcnt lgkmcnt(8)
    v_smfmac_f32_16x16x64_bf16 v[52:55], v[0:3], v[72:79], v104
    ds_read_b128 v[72:75], v114 offset:49152
    ds_read_b128 v[76:79], v114 offset:50176
    s_waitcnt lgkmcnt(8)
    v_smfmac_f32_16x16x64_bf16 v[100:103], v[0:3], v[80:87], v104
    ds_read_b128 v[80:83], v114 offset:51200
    ds_read_b128 v[84:87], v114 offset:52224
    s_waitcnt lgkmcnt(8)
    v_smfmac_f32_16x16x64_bf16 v[48:51], v[8:11], v[88:95], v104
    ds_read_b128 v[88:91], v114 offset:53248
    ds_read_b128 v[92:95], v114 offset:54272
    s_waitcnt lgkmcnt(8)
    v_smfmac_f32_16x16x64_bf16 v[52:55], v[8:11], v[56:63], v104
    ds_read_b128 v[56:59], v115 offset:0
    ds_read_b128 v[60:63], v115 offset:1024
    s_waitcnt lgkmcnt(8)
    v_smfmac_f32_16x16x64_bf16 v[100:103], v[8:11], v[64:71], v104
    ds_read_b128 v[64:67], v115 offset:2048
    ds_read_b128 v[68:71], v115 offset:3072
    s_waitcnt lgkmcnt(8)
    v_smfmac_f32_16x16x64_bf16 v[48:51], v[12:15], v[72:79], v104
    ds_read_b128 v[72:75], v115 offset:4096
    ds_read_b128 v[76:79], v115 offset:5120
    s_waitcnt lgkmcnt(8)
    v_smfmac_f32_16x16x64_bf16 v[52:55], v[12:15], v[80:87], v104
    ds_read_b128 v[80:83], v115 offset:32768
    ds_read_b128 v[84:87], v115 offset:33792
    s_waitcnt lgkmcnt(8)
    v_smfmac_f32_16x16x64_bf16 v[100:103], v[12:15], v[88:95], v104
    ds_read_b128 v[88:91], v115 offset:34816
    ds_read_b128 v[92:95], v115 offset:35840
    s_waitcnt lgkmcnt(8)
    v_smfmac_f32_16x16x64_bf16 v[48:51], v[16:19], v[56:63], v104
    ds_read_b128 v[56:59], v115 offset:36864
    ds_read_b128 v[60:63], v115 offset:37888
    s_waitcnt lgkmcnt(8)
    v_smfmac_f32_16x16x64_bf16 v[52:55], v[16:19], v[64:71], v104
    ds_read_b128 v[64:67], v115 offset:49152
    ds_read_b128 v[68:71], v115 offset:50176
    s_waitcnt lgkmcnt(8)
    v_smfmac_f32_16x16x64_bf16 v[100:103], v[16:19], v[72:79], v104
    ds_read_b128 v[72:75], v115 offset:51200
    ds_read_b128 v[76:79], v115 offset:52224
    s_waitcnt lgkmcnt(8)
    v_smfmac_f32_16x16x64_bf16 v[48:51], v[24:27], v[80:87], v104
    ds_read_b128 v[80:83], v115 offset:53248
    ds_read_b128 v[84:87], v115 offset:54272
    s_waitcnt lgkmcnt(8)
    v_smfmac_f32_16x16x64_bf16 v[52:55], v[24:27], v[88:95], v104
    s_waitcnt lgkmcnt(6)
    v_smfmac_f32_16x16x64_bf16 v[100:103], v[24:27], v[56:63], v104
    s_waitcnt lgkmcnt(4)
    v_smfmac_f32_16x16x64_bf16 v[48:51], v[28:31], v[64:71], v104
    s_waitcnt lgkmcnt(2)
    v_smfmac_f32_16x16x64_bf16 v[52:55], v[28:31], v[72:79], v104
    s_waitcnt lgkmcnt(0)
    v_smfmac_f32_16x16x64_bf16 v[100:103], v[28:31], v[80:87], v104
    v_mov_b64 v[72:73], 0
    v_mov_b64 v[74:75], 0
    s_nop 1
    v_pk_add_f32 v[48:49], v[48:49], v[50:51]
    v_cvt_pk_bf16_f32 v48, v48, v49
    v_mov_b32 v49, 0
    v_pk_add_f32 v[52:53], v[52:53], v[54:55]
    v_cvt_pk_bf16_f32 v52, v52, v53
    v_mov_b32 v53, 0
    v_pk_add_f32 v[100:101], v[100:101], v[102:103]
    v_cvt_pk_bf16_f32 v100, v100, v101
    v_mov_b32 v101, 0
    v_mfma_f32_32x32x16_bf16 v[0:15], v[72:75], v[72:75], 0
    v_mfma_f32_32x32x16_bf16 v[16:31], v[72:75], v[72:75], 0
    v_mov_b32 v110, v48
    v_mov_b32 v111, v52
    v_mov_b32 v119, v100
    s_cmp_eq_u32 s68, 63
    s_cbranch_scc1 c_end_10
    s_waitcnt lgkmcnt(0)
    s_barrier
    ds_read_b128 v[44:47], v116 offset:16384
    ds_read_b64 v[126:127], v116 offset:17408
    v_add_u32 v122, 32768, v107
    s_add_u32 s76, s68, 1
    v_mov_b32 v123, 0
    v_mov_b32 v124, s76
    s_waitcnt lgkmcnt(1)
    v_mfma_f32_16x16x32_bf16 v[56:59], v[32:35], v[44:47], 0
    v_mfma_f32_16x16x32_bf16 v[60:63], v[36:39], v[44:47], 0
    v_mfma_f32_16x16x32_bf16 v[64:67], v[96:99], v[44:47], 0
    s_waitcnt lgkmcnt(0)
    s_nop 2
    v_mfma_f32_16x16x16_bf16 v[56:59], v[48:49], v[126:127], v[56:59]
    v_mfma_f32_16x16x16_bf16 v[60:63], v[52:53], v[126:127], v[60:63]
    v_mfma_f32_16x16x16_bf16 v[64:67], v[100:101], v[126:127], v[64:67]
    s_nop 5
    v_cvt_pk_bf16_f32 v56, v56, v57
    v_cvt_pk_bf16_f32 v57, v58, v59
    ds_write_b64 v112, v[56:57] offset:0
    v_cvt_pk_bf16_f32 v60, v60, v61
    v_cvt_pk_bf16_f32 v61, v62, v63
    ds_write_b64 v112, v[60:61] offset:32
    v_cvt_pk_bf16_f32 v64, v64, v65
    v_cvt_pk_bf16_f32 v65, v66, v67
    ds_write_b64 v112, v[64:65] offset:64
    s_waitcnt lgkmcnt(0)
    s_barrier
    ds_read_b128 v[40:43], v113 offset:0
    ds_read_b128 v[44:47], v113 offset:128
    s_waitcnt lgkmcnt(1)
    v_smfmac_f32_16x16x64_bf16 v[0:3], v[40:43], v[128:135], v104
    v_smfmac_f32_16x16x64_bf16 v[4:7], v[40:43], v[144:151], v104
    s_waitcnt lgkmcnt(0)
    v_smfmac_f32_16x16x64_bf16 v[0:3], v[44:47], v[136:143], v104
    v_smfmac_f32_16x16x64_bf16 v[4:7], v[44:47], v[152:159], v104
    v_smfmac_f32_16x16x64_bf16 v[8:11], v[40:43], v[160:167], v104
    v_smfmac_f32_16x16x64_bf16 v[12:15], v[40:43], v[176:183], v104
    s_nop 4
    v_add_f32 v0, v0, v2
    v_add_f32 v1, v1, v3
    v_smfmac_f32_16x16x64_bf16 v[8:11], v[44:47], v[168:175], v104
    v_cvt_pk_bf16_f32 v32, v0, v1
    v_add_f32 v4, v4, v6
    v_smfmac_f32_16x16x64_bf16 v[12:15], v[44:47], v[184:191], v104
    v_add_f32 v5, v5, v7
    v_cvt_pk_bf16_f32 v33, v4, v5
    v_smfmac_f32_16x16x64_bf16 v[16:19], v[40:43], v[192:199], v104
    v_smfmac_f32_16x16x64_bf16 v[20:23], v[40:43], v[208:215], v104
    s_nop 0
    v_add_f32 v8, v8, v10
    v_add_f32 v9, v9, v11
    v_smfmac_f32_16x16x64_bf16 v[16:19], v[44:47], v[200:207], v104
    v_cvt_pk_bf16_f32 v34, v8, v9
    v_add_f32 v12, v12, v14
    v_smfmac_f32_16x16x64_bf16 v[20:23], v[44:47], v[216:223], v104
    v_add_f32 v13, v13, v15
    v_cvt_pk_bf16_f32 v35, v12, v13
    v_smfmac_f32_16x16x64_bf16 v[24:27], v[40:43], v[224:231], v104
    global_store_dwordx4 v107, v[32:35], s[46:47] sc1
    global_store_dword v123, v124, s[8:9] sc1
    v_smfmac_f32_16x16x64_bf16 v[28:31], v[40:43], v[240:247], v104
    v_add_f32 v16, v16, v18
    v_add_f32 v17, v17, v19
    v_smfmac_f32_16x16x64_bf16 v[24:27], v[44:47], v[232:239], v104
    v_cvt_pk_bf16_f32 v36, v16, v17
    v_add_f32 v20, v20, v22
    v_smfmac_f32_16x16x64_bf16 v[28:31], v[44:47], v[248:255], v104
    v_add_f32 v21, v21, v23
    v_cvt_pk_bf16_f32 v37, v20, v21
    s_nop 2
    v_pk_add_f32 v[24:25], v[24:25], v[26:27]
    s_nop 1
    v_pk_add_f32 v[28:29], v[28:29], v[30:31]
    v_cvt_pk_bf16_f32 v38, v24, v25
    v_cvt_pk_bf16_f32 v39, v28, v29
    global_store_dwordx4 v122, v[36:39], s[46:47] sc1
    global_store_dword v123, v124, s[8:9] offset:128 sc1
    s_add_u32 s84, s84, 131072
    s_addc_u32 s85, s85, 0
    s_add_u32 s86, s86, 65536
    s_addc_u32 s87, s87, 0
    s_mov_b64 s[70:71], s[60:61]
    s_mov_b64 s[60:61], s[62:63]
    s_mov_b64 s[62:63], s[64:65]
    s_mov_b64 s[64:65], s[66:67]
    s_mov_b64 s[66:67], s[70:71]
    s_add_u32 s68, s68, 1
    v_mfma_f32_32x32x16_bf16 v[32:47], v[72:75], v[72:75], 0
    v_mfma_f32_16x16x32_bf16 v[48:51], v[72:75], v[72:75], 0
    v_mfma_f32_16x16x32_bf16 v[52:55], v[72:75], v[72:75], 0
    v_mfma_f32_16x16x32_bf16 v[100:103], v[72:75], v[72:75], 0
    ds_read_b128 v[56:59], v114 offset:16384
    ds_read_b128 v[60:63], v114 offset:17408
    ds_read_b128 v[64:67], v114 offset:18432
    ds_read_b128 v[68:71], v114 offset:19456
    ds_read_b128 v[72:75], v114 offset:20480
    ds_read_b128 v[76:79], v114 offset:21504
    ds_read_b128 v[80:83], v115 offset:16384
    ds_read_b128 v[84:87], v115 offset:17408
    ds_read_b128 v[88:91], v115 offset:18432
    ds_read_b128 v[92:95], v115 offset:19456
    ds_read_b128 v[24:27], v120
    ds_read_b128 v[28:31], v120 offset:1152
    s_waitcnt lgkmcnt(0)
    s_barrier
    global_load_dwordx4 v[4:7], v106, s[60:61] sc1
    global_load_dwordx4 v[20:23], v106, s[60:61] offset:1024 sc1
    s_branch c_chk0_37
c_w2_8:
    s_mov_b32 s101, 0
    v_mov_b32 v122, s101
c_fl_43:
    global_load_dword v120, v122, s[4:5] sc1
    s_add_u32 s69, s69, 1
    s_cmp_gt_u32 s69, 0x80000
    s_cbranch_scc1 L_fail
    s_waitcnt vmcnt(0)
    v_cmp_gt_u32 vcc, 64, v120
    s_cbranch_vccnz c_fl_43
    s_mov_b32 m0, 162560
    v_lshlrev_b32 v122, 3, v105
    global_load_lds_dword v122, s[80:81] sc1
    v_add_u32 v122, 0x40000, v122
    global_load_lds_dword v122, s[80:81] sc1
    v_lshlrev_b32 v127, 3, v105
    s_mov_b32 s101, 128
    v_mov_b32 v122, s101
c_fl_44:
    global_load_dword v120, v122, s[4:5] sc1
    s_add_u32 s69, s69, 1
    s_cmp_gt_u32 s69, 0x80000
    s_cbranch_scc1 L_fail
    s_waitcnt vmcnt(0)
    v_cmp_gt_u32 vcc, 64, v120
    s_cbranch_vccnz c_fl_44
    s_mov_b32 s101, 256
    v_mov_b64 v[32:33], 0
    v_mov_b64 v[34:35], 0
    v_mov_b64 v[36:37], 0
    v_mov_b64 v[38:39], 0
    v_mov_b64 v[40:41], 0
    v_mov_b64 v[42:43], 0
    v_mov_b64 v[44:45], 0
    v_mov_b64 v[46:47], 0
    v_mov_b64 v[48:49], 0
    v_mov_b64 v[50:51], 0
    v_mov_b64 v[52:53], 0
    v_mov_b64 v[54:55], 0
    ds_read_b128 v[56:59], v114 offset:38912
    ds_read_b128 v[60:63], v114 offset:39936
    ds_read_b128 v[64:67], v114 offset:40960
    ds_read_b128 v[68:71], v114 offset:41984
    ds_read_b128 v[72:75], v114 offset:43008
    ds_read_b128 v[76:79], v114 offset:44032
    ds_read_b128 v[80:83], v115 offset:38912
    ds_read_b128 v[84:87], v115 offset:39936
    ds_read_b128 v[88:91], v115 offset:40960
    ds_read_b128 v[92:95], v115 offset:41984
    v_mov_b64 v[100:101], 0
    v_mov_b64 v[102:103], 0
    s_waitcnt lgkmcnt(0)
    s_mov_b32 m0, 131072
    s_nop 0
    global_load_lds_dwordx4 v105, s[80:81] offset:0
    global_load_lds_dwordx4 v105, s[80:81] offset:1024
    global_load_lds_dwordx4 v105, s[80:81] offset:2048
    global_load_lds_dwordx4 v105, s[80:81] offset:3072
    v_add_u32 v122, 4096, v105
    s_mov_b32 m0, 135168
    s_nop 0
    global_load_lds_dwordx4 v122, s[80:81] offset:0
    global_load_lds_dwordx4 v122, s[80:81] offset:1024
    global_load_lds_dwordx4 v122, s[80:81] offset:2048
    global_load_lds_dwordx4 v122, s[80:81] offset:3072
    s_add_u32 s80, s80, 262144
    s_addc_u32 s81, s81, 0
    global_load_dwordx4 v[8:11], v106, s[60:61] sc1
    global_load_dwordx4 v[24:27], v106, s[60:61] offset:1024 sc1
c_loop_45:
    s_branch c_chk0_46
c_pollm_47:
    global_load_dwordx4 v[8:11], v106, s[60:61] sc1
    global_load_dwordx4 v[24:27], v106, s[60:61] offset:1024 sc1
c_chk0_46:
    s_waitcnt vmcnt(1)
    v_max3_u32 v122, v8, v9, v10
    s_waitcnt vmcnt(0)
    v_max3_u32 v123, v11, v24, v25
    v_max3_u32 v122, v122, v26, v27
    v_max_u32 v122, v122, v123
    v_cmp_eq_u32 vcc, -1, v122
    ds_write_b128 v117, v[8:11]
    ds_write_b128 v117, v[24:27] offset:4096
    s_cbranch_vccnz c_retry_48
    v_smfmac_f32_16x16x64_bf16 v[32:35], v[8:11], a[16:23], v104
    v_smfmac_f32_16x16x64_bf16 v[36:39], v[8:11], a[80:87], v104
    v_smfmac_f32_16x16x64_bf16 v[32:35], v[24:27], a[48:55], v104
    s_waitcnt lgkmcnt(0)
    s_barrier
    ds_read_b128 v[0:3], v116 offset:16384
    ds_read_b128 v[4:7], v116 offset:17408
    v_smfmac_f32_16x16x64_bf16 v[36:39], v[24:27], a[112:119], v104
    ds_read_b128 v[12:15], v116 offset:19456
    v_smfmac_f32_16x16x64_bf16 v[40:43], v[8:11], a[144:151], v104
    ds_read_b128 v[16:19], v116 offset:20480
    v_smfmac_f32_16x16x64_bf16 v[44:47], v[8:11], a[208:215], v104
    ds_read_b128 v[20:23], v116 offset:21504
    v_smfmac_f32_16x16x64_bf16 v[40:43], v[24:27], a[176:183], v104
    ds_read_b128 v[28:31], v116 offset:23552
    s_waitcnt lgkmcnt(5)
    v_smfmac_f32_16x16x64_bf16 v[32:35], v[0:3], a[0:7], v104
    global_store_dword v121, v110, s[86:87] offset:768 sc1
    v_smfmac_f32_16x16x64_bf16 v[36:39], v[0:3], a[64:71], v104
    global_store_dword v121, v111, s[86:87] offset:1024 sc1
    s_waitcnt lgkmcnt(4)
    v_smfmac_f32_16x16x64_bf16 v[32:35], v[4:7], a[8:15], v104
    global_store_dword v121, v119, s[86:87] offset:1280 sc1
    v_smfmac_f32_16x16x64_bf16 v[36:39], v[4:7], a[72:79], v104
    s_mov_b32 m0, 162560
    s_waitcnt lgkmcnt(3)
    v_smfmac_f32_16x16x64_bf16 v[32:35], v[12:15], a[24:31], v104
    global_load_lds_dword v127, s[80:81]
    v_smfmac_f32_16x16x64_bf16 v[36:39], v[12:15], a[88:95], v104
    v_mov_b32 v122, s101
    s_waitcnt lgkmcnt(2)
    v_smfmac_f32_16x16x64_bf16 v[32:35], v[16:19], a[32:39], v104
    global_load_dword v120, v122, s[4:5] sc1
    v_smfmac_f32_16x16x64_bf16 v[36:39], v[16:19], a[96:103], v104
    s_waitcnt lgkmcnt(1)
    v_smfmac_f32_16x16x64_bf16 v[32:35], v[20:23], a[40:47], v104
    v_smfmac_f32_16x16x64_bf16 v[36:39], v[20:23], a[104:111], v104
    s_waitcnt lgkmcnt(0)
    v_smfmac_f32_16x16x64_bf16 v[32:35], v[28:31], a[56:63], v104
    v_smfmac_f32_16x16x64_bf16 v[36:39], v[28:31], a[120:127], v104
    v_smfmac_f32_16x16x64_bf16 v[44:47], v[24:27], a[240:247], v104
    v_smfmac_f32_16x16x64_bf16 v[40:43], v[0:3], a[128:135], v104
    v_smfmac_f32_16x16x64_bf16 v[44:47], v[0:3], a[192:199], v104
    s_nop 3
    v_add_f32 v32, v32, v34
    v_add_f32 v33, v33, v35
    v_smfmac_f32_16x16x64_bf16 v[40:43], v[4:7], a[136:143], v104
    v_add_f32 v36, v36, v38
    v_add_f32 v37, v37, v39
    v_smfmac_f32_16x16x64_bf16 v[44:47], v[4:7], a[200:207], v104
    v_cvt_pk_bf16_f32 v32, v32, v36
    v_cvt_pk_bf16_f32 v33, v33, v37
    v_smfmac_f32_16x16x64_bf16 v[40:43], v[12:15], a[152:159], v104
    ds_write2_b32 v109, v32, v33 offset0:0 offset1:72
    v_smfmac_f32_16x16x64_bf16 v[44:47], v[12:15], a[216:223], v104
    v_smfmac_f32_16x16x64_bf16 v[40:43], v[16:19], a[160:167], v104
    s_waitcnt lgkmcnt(0)
    s_barrier
    v_smfmac_f32_16x16x64_bf16 v[44:47], v[16:19], a[224:231], v104
    ds_read_b128 v[32:35], v116 offset:11264
    v_smfmac_f32_16x16x64_bf16 v[40:43], v[20:23], a[168:175], v104
    ds_read_b128 v[36:39], v116 offset:12288
    v_smfmac_f32_16x16x64_bf16 v[44:47], v[20:23], a[232:239], v104
    ds_read_b128 v[96:99], v116 offset:13312
    v_smfmac_f32_16x16x64_bf16 v[40:43], v[28:31], a[184:191], v104
    v_smfmac_f32_16x16x64_bf16 v[44:47], v[28:31], a[248:255], v104
    v_smfmac_f32_16x16x64_bf16 v[48:51], v[8:11], v[56:63], v104
    ds_read_b128 v[56:59], v115 offset:43008
    ds_read_b128 v[60:63], v115 offset:44032
    v_smfmac_f32_16x16x64_bf16 v[52:55], v[8:11], v[64:71], v104
    ds_read_b128 v[64:67], v114 offset:6144
    ds_read_b128 v[68:71], v114 offset:7168
    s_nop 0
    v_add_f32 v40, v40, v42
    v_add_f32 v41, v41, v43
    v_add_f32 v44, v44, v46
    v_add_f32 v45, v45, v47
    v_cvt_pk_bf16_f32 v40, v40, v44
    v_cvt_pk_bf16_f32 v41, v41, v45
    ds_write_b32 v109, v40 offset:2304
    ds_write_b32 v109, v41 offset:2592
    v_smfmac_f32_16x16x64_bf16 v[100:103], v[8:11], v[72:79], v104
    ds_read_b128 v[72:75], v114 offset:8192
    ds_read_b128 v[76:79], v114 offset:9216
    v_smfmac_f32_16x16x64_bf16 v[48:51], v[24:27], v[80:87], v104
    ds_read_b128 v[80:83], v114 offset:10240
    ds_read_b128 v[84:87], v114 offset:11264
    v_smfmac_f32_16x16x64_bf16 v[52:55], v[24:27], v[88:95], v104
    ds_read_b128 v[88:91], v114 offset:22528
    ds_read_b128 v[92:95], v114 offset:23552
    s_waitcnt lgkmcnt(6)
    s_barrier
    v_smfmac_f32_16x16x64_bf16 v[100:103], v[24:27], v[56:63], v104
    ds_read_b128 v[56:59], v114 offset:24576
    ds_read_b128 v[60:63], v114 offset:25600
    s_mov_b32 m0, 131072
    v_smfmac_f32_16x16x64_bf16 v[48:51], v[0:3], v[64:71], v104
    ds_read_b128 v[64:67], v114 offset:26624
    ds_read_b128 v[68:71], v114 offset:27648
    global_load_lds_dwordx4 v105, s[80:81] offset:0
    s_waitcnt lgkmcnt(8)
    v_smfmac_f32_16x16x64_bf16 v[52:55], v[0:3], v[72:79], v104
    ds_read_b128 v[72:75], v114 offset:55296
    ds_read_b128 v[76:79], v114 offset:56320
    global_load_lds_dwordx4 v105, s[80:81] offset:1024
    s_waitcnt lgkmcnt(8)
    v_smfmac_f32_16x16x64_bf16 v[100:103], v[0:3], v[80:87], v104
    ds_read_b128 v[80:83], v114 offset:57344
    ds_read_b128 v[84:87], v114 offset:58368
    global_load_lds_dwordx4 v105, s[80:81] offset:2048
    s_waitcnt lgkmcnt(8)
    v_smfmac_f32_16x16x64_bf16 v[48:51], v[4:7], v[88:95], v104
    ds_read_b128 v[88:91], v114 offset:59392
    ds_read_b128 v[92:95], v114 offset:60416
    global_load_lds_dwordx4 v105, s[80:81] offset:3072
    s_waitcnt lgkmcnt(8)
    v_smfmac_f32_16x16x64_bf16 v[52:55], v[4:7], v[56:63], v104
    ds_read_b128 v[56:59], v115 offset:6144
    ds_read_b128 v[60:63], v115 offset:7168
    v_add_u32 v122, 4096, v105
    s_waitcnt lgkmcnt(8)
    v_smfmac_f32_16x16x64_bf16 v[100:103], v[4:7], v[64:71], v104
    ds_read_b128 v[64:67], v115 offset:8192
    ds_read_b128 v[68:71], v115 offset:9216
    s_mov_b32 m0, 135168
    s_waitcnt lgkmcnt(8)
    v_smfmac_f32_16x16x64_bf16 v[48:51], v[12:15], v[72:79], v104
    ds_read_b128 v[72:75], v115 offset:10240
    ds_read_b128 v[76:79], v115 offset:11264
    global_load_lds_dwordx4 v122, s[80:81] offset:0
    s_waitcnt lgkmcnt(8)
    v_smfmac_f32_16x16x64_bf16 v[52:55], v[12:15], v[80:87], v104
    ds_read_b128 v[80:83], v115 offset:22528
    ds_read_b128 v[84:87], v115 offset:23552
    global_load_lds_dwordx4 v122, s[80:81] offset:1024
    s_waitcnt lgkmcnt(8)
    v_smfmac_f32_16x16x64_bf16 v[100:103], v[12:15], v[88:95], v104
    ds_read_b128 v[88:91], v115 offset:24576
    ds_read_b128 v[92:95], v115 offset:25600
    global_load_lds_dwordx4 v122, s[80:81] offset:2048
    s_waitcnt lgkmcnt(8)
    v_smfmac_f32_16x16x64_bf16 v[48:51], v[16:19], v[56:63], v104
    ds_read_b128 v[56:59], v115 offset:26624
    ds_read_b128 v[60:63], v115 offset:27648
    global_load_lds_dwordx4 v122, s[80:81] offset:3072
    s_waitcnt lgkmcnt(8)
    v_smfmac_f32_16x16x64_bf16 v[52:55], v[16:19], v[64:71], v104
    ds_read_b128 v[64:67], v115 offset:55296
    ds_read_b128 v[68:71], v115 offset:56320
    s_waitcnt lgkmcnt(8)
    v_smfmac_f32_16x16x64_bf16 v[100:103], v[16:19], v[72:79], v104
    ds_read_b128 v[72:75], v115 offset:57344
    ds_read_b128 v[76:79], v115 offset:58368
    s_waitcnt lgkmcnt(8)
    v_smfmac_f32_16x16x64_bf16 v[48:51], v[20:23], v[80:87], v104
    ds_read_b128 v[80:83], v115 offset:59392
    ds_read_b128 v[84:87], v115 offset:60416
    s_waitcnt lgkmcnt(8)
    v_smfmac_f32_16x16x64_bf16 v[52:55], v[20:23], v[88:95], v104
    s_waitcnt lgkmcnt(6)
    v_smfmac_f32_16x16x64_bf16 v[100:103], v[20:23], v[56:63], v104
    s_waitcnt lgkmcnt(4)
    v_smfmac_f32_16x16x64_bf16 v[48:51], v[28:31], v[64:71], v104
    s_waitcnt lgkmcnt(2)
    v_smfmac_f32_16x16x64_bf16 v[52:55], v[28:31], v[72:79], v104
    s_waitcnt lgkmcnt(0)
    v_smfmac_f32_16x16x64_bf16 v[100:103], v[28:31], v[80:87], v104
    v_mov_b64 v[72:73], 0
    v_mov_b64 v[74:75], 0
    s_nop 1
    v_pk_add_f32 v[48:49], v[48:49], v[50:51]
    v_cvt_pk_bf16_f32 v48, v48, v49
    v_mov_b32 v49, 0
    v_pk_add_f32 v[52:53], v[52:53], v[54:55]
    v_cvt_pk_bf16_f32 v52, v52, v53
    v_mov_b32 v53, 0
    v_pk_add_f32 v[100:101], v[100:101], v[102:103]
    v_cvt_pk_bf16_f32 v100, v100, v101
    v_mov_b32 v101, 0
    v_mfma_f32_32x32x16_bf16 v[0:15], v[72:75], v[72:75], 0
    v_mfma_f32_32x32x16_bf16 v[16:31], v[72:75], v[72:75], 0
    v_mov_b32 v110, v48
    v_mov_b32 v111, v52
    v_mov_b32 v119, v100
    s_waitcnt lgkmcnt(0)
    s_barrier
    ds_read_b128 v[44:47], v116 offset:16384
    ds_read_b64 v[126:127], v116 offset:17408
    v_add_u32 v122, 32768, v107
    s_add_u32 s76, s68, 1
    v_mov_b32 v123, 0
    v_mov_b32 v124, s76
    s_waitcnt lgkmcnt(1)
    v_mfma_f32_16x16x32_bf16 v[56:59], v[32:35], v[44:47], 0
    v_mfma_f32_16x16x32_bf16 v[60:63], v[36:39], v[44:47], 0
    v_mfma_f32_16x16x32_bf16 v[64:67], v[96:99], v[44:47], 0
    s_waitcnt lgkmcnt(0)
    s_nop 2
    v_mfma_f32_16x16x16_bf16 v[56:59], v[48:49], v[126:127], v[56:59]
    v_mfma_f32_16x16x16_bf16 v[60:63], v[52:53], v[126:127], v[60:63]
    v_mfma_f32_16x16x16_bf16 v[64:67], v[100:101], v[126:127], v[64:67]
    s_nop 5
    v_cvt_pk_bf16_f32 v56, v56, v57
    v_cvt_pk_bf16_f32 v57, v58, v59
    ds_write_b64 v112, v[56:57] offset:96
    v_cvt_pk_bf16_f32 v60, v60, v61
    v_cvt_pk_bf16_f32 v61, v62, v63
    ds_write_b64 v112, v[60:61] offset:128
    v_cvt_pk_bf16_f32 v64, v64, v65
    v_cvt_pk_bf16_f32 v65, v66, v67
    ds_write_b64 v112, v[64:65] offset:160
    s_waitcnt lgkmcnt(0)
    s_barrier
    ds_read_b128 v[40:43], v113 offset:0
    ds_read_b128 v[44:47], v113 offset:128
    s_waitcnt lgkmcnt(1)
    v_smfmac_f32_16x16x64_bf16 v[0:3], v[40:43], v[128:135], v104
    v_smfmac_f32_16x16x64_bf16 v[4:7], v[40:43], v[144:151], v104
    s_waitcnt lgkmcnt(0)
    v_smfmac_f32_16x16x64_bf16 v[0:3], v[44:47], v[136:143], v104
    v_smfmac_f32_16x16x64_bf16 v[4:7], v[44:47], v[152:159], v104
    v_smfmac_f32_16x16x64_bf16 v[8:11], v[40:43], v[160:167], v104
    v_smfmac_f32_16x16x64_bf16 v[12:15], v[40:43], v[176:183], v104
    s_nop 4
    v_add_f32 v0, v0, v2
    v_add_f32 v1, v1, v3
    v_smfmac_f32_16x16x64_bf16 v[8:11], v[44:47], v[168:175], v104
    v_cvt_pk_bf16_f32 v32, v0, v1
    v_add_f32 v4, v4, v6
    v_smfmac_f32_16x16x64_bf16 v[12:15], v[44:47], v[184:191], v104
    v_add_f32 v5, v5, v7
    v_cvt_pk_bf16_f32 v33, v4, v5
    v_smfmac_f32_16x16x64_bf16 v[16:19], v[40:43], v[192:199], v104
    v_smfmac_f32_16x16x64_bf16 v[20:23], v[40:43], v[208:215], v104
    s_nop 0
    v_add_f32 v8, v8, v10
    v_add_f32 v9, v9, v11
    v_smfmac_f32_16x16x64_bf16 v[16:19], v[44:47], v[200:207], v104
    v_cvt_pk_bf16_f32 v34, v8, v9
    v_add_f32 v12, v12, v14
    v_smfmac_f32_16x16x64_bf16 v[20:23], v[44:47], v[216:223], v104
    v_add_f32 v13, v13, v15
    v_cvt_pk_bf16_f32 v35, v12, v13
    v_smfmac_f32_16x16x64_bf16 v[24:27], v[40:43], v[224:231], v104
    global_store_dwordx4 v107, v[32:35], s[44:45] sc1
    global_store_dword v123, v124, s[8:9] sc1
    v_smfmac_f32_16x16x64_bf16 v[28:31], v[40:43], v[240:247], v104
    v_add_f32 v16, v16, v18
    v_add_f32 v17, v17, v19
    v_smfmac_f32_16x16x64_bf16 v[24:27], v[44:47], v[232:239], v104
    v_cvt_pk_bf16_f32 v36, v16, v17
    v_add_f32 v20, v20, v22
    v_smfmac_f32_16x16x64_bf16 v[28:31], v[44:47], v[248:255], v104
    v_add_f32 v21, v21, v23
    v_cvt_pk_bf16_f32 v37, v20, v21
    s_nop 2
    v_pk_add_f32 v[24:25], v[24:25], v[26:27]
    s_nop 1
    v_pk_add_f32 v[28:29], v[28:29], v[30:31]
    v_cvt_pk_bf16_f32 v38, v24, v25
    v_cvt_pk_bf16_f32 v39, v28, v29
    global_store_dwordx4 v122, v[36:39], s[44:45] sc1
    global_store_dword v123, v124, s[8:9] offset:128 sc1
    s_add_u32 s80, s80, 262144
    s_addc_u32 s81, s81, 0
    v_lshlrev_b32 v127, 3, v105
    s_add_u32 s86, s86, 65536
    s_addc_u32 s87, s87, 0
    s_mov_b64 s[70:71], s[60:61]
    s_mov_b64 s[60:61], s[62:63]
    s_mov_b64 s[62:63], s[64:65]
    s_mov_b64 s[64:65], s[66:67]
    s_mov_b64 s[66:67], s[70:71]
    s_add_u32 s68, s68, 1
    v_mfma_f32_32x32x16_bf16 v[32:47], v[72:75], v[72:75], 0
    v_mfma_f32_16x16x32_bf16 v[48:51], v[72:75], v[72:75], 0
    v_mfma_f32_16x16x32_bf16 v[52:55], v[72:75], v[72:75], 0
    v_mfma_f32_16x16x32_bf16 v[100:103], v[72:75], v[72:75], 0
    ds_read_b128 v[56:59], v114 offset:38912
    ds_read_b128 v[60:63], v114 offset:39936
    ds_read_b128 v[64:67], v114 offset:40960
    ds_read_b128 v[68:71], v114 offset:41984
    ds_read_b128 v[72:75], v114 offset:43008
    ds_read_b128 v[76:79], v114 offset:44032
    ds_read_b128 v[80:83], v115 offset:38912
    ds_read_b128 v[84:87], v115 offset:39936
    ds_read_b128 v[88:91], v115 offset:40960
    ds_read_b128 v[92:95], v115 offset:41984
    s_barrier
    global_load_dwordx4 v[8:11], v106, s[60:61] sc1
    global_load_dwordx4 v[24:27], v106, s[60:61] offset:1024 sc1
c_chk1_50:
    s_waitcnt vmcnt(1)
    v_max3_u32 v122, v8, v9, v10
    s_waitcnt vmcnt(0)
    v_max3_u32 v123, v11, v24, v25
    v_max3_u32 v122, v122, v26, v27
    v_max_u32 v122, v122, v123
    v_cmp_eq_u32 vcc, -1, v122
    ds_write_b128 v117, v[8:11]
    ds_write_b128 v117, v[24:27] offset:4096
    s_cbranch_vccnz c_retry_51
    v_smfmac_f32_16x16x64_bf16 v[32:35], v[8:11], a[16:23], v104
    v_smfmac_f32_16x16x64_bf16 v[36:39], v[8:11], a[80:87], v104
    v_smfmac_f32_16x16x64_bf16 v[32:35], v[24:27], a[48:55], v104
    s_waitcnt lgkmcnt(0)
    s_barrier
    ds_read_b128 v[0:3], v116 offset:16384
    ds_read_b128 v[4:7], v116 offset:17408
    v_smfmac_f32_16x16x64_bf16 v[36:39], v[24:27], a[112:119], v104
    ds_read_b128 v[12:15], v116 offset:19456
    v_smfmac_f32_16x16x64_bf16 v[40:43], v[8:11], a[144:151], v104
    ds_read_b128 v[16:19], v116 offset:20480
    v_smfmac_f32_16x16x64_bf16 v[44:47], v[8:11], a[208:215], v104
    ds_read_b128 v[20:23], v116 offset:21504
    v_smfmac_f32_16x16x64_bf16 v[40:43], v[24:27], a[176:183], v104
    ds_read_b128 v[28:31], v116 offset:23552
    s_waitcnt lgkmcnt(5)
    v_smfmac_f32_16x16x64_bf16 v[32:35], v[0:3], a[0:7], v104
    global_store_dword v121, v110, s[86:87] offset:768 sc1
    v_smfmac_f32_16x16x64_bf16 v[36:39], v[0:3], a[64:71], v104
    global_store_dword v121, v111, s[86:87] offset:1024 sc1
    s_waitcnt lgkmcnt(4)
    v_smfmac_f32_16x16x64_bf16 v[32:35], v[4:7], a[8:15], v104
    global_store_dword v121, v119, s[86:87] offset:1280 sc1
    v_smfmac_f32_16x16x64_bf16 v[36:39], v[4:7], a[72:79], v104
    s_mov_b32 m0, 162560
    s_waitcnt lgkmcnt(3)
    v_smfmac_f32_16x16x64_bf16 v[32:35], v[12:15], a[24:31], v104
    global_load_lds_dword v127, s[80:81]
    v_smfmac_f32_16x16x64_bf16 v[36:39], v[12:15], a[88:95], v104
    s_waitcnt lgkmcnt(2)
    v_smfmac_f32_16x16x64_bf16 v[32:35], v[16:19], a[32:39], v104
    v_smfmac_f32_16x16x64_bf16 v[36:39], v[16:19], a[96:103], v104
    s_waitcnt lgkmcnt(1)
    v_smfmac_f32_16x16x64_bf16 v[32:35], v[20:23], a[40:47], v104
    v_smfmac_f32_16x16x64_bf16 v[36:39], v[20:23], a[104:111], v104
    s_waitcnt lgkmcnt(0)
    v_smfmac_f32_16x16x64_bf16 v[32:35], v[28:31], a[56:63], v104
    v_smfmac_f32_16x16x64_bf16 v[36:39], v[28:31], a[120:127], v104
    v_smfmac_f32_16x16x64_bf16 v[44:47], v[24:27], a[240:247], v104
    v_smfmac_f32_16x16x64_bf16 v[40:43], v[0:3], a[128:135], v104
    v_smfmac_f32_16x16x64_bf16 v[44:47], v[0:3], a[192:199], v104
    s_nop 3
    v_add_f32 v32, v32, v34
    v_add_f32 v33, v33, v35
    v_smfmac_f32_16x16x64_bf16 v[40:43], v[4:7], a[136:143], v104
    v_add_f32 v36, v36, v38
    v_add_f32 v37, v37, v39
    v_smfmac_f32_16x16x64_bf16 v[44:47], v[4:7], a[200:207], v104
    v_cvt_pk_bf16_f32 v32, v32, v36
    v_cvt_pk_bf16_f32 v33, v33, v37
    v_smfmac_f32_16x16x64_bf16 v[40:43], v[12:15], a[152:159], v104
    ds_write2_b32 v109, v32, v33 offset0:0 offset1:72
    v_smfmac_f32_16x16x64_bf16 v[44:47], v[12:15], a[216:223], v104
    v_smfmac_f32_16x16x64_bf16 v[40:43], v[16:19], a[160:167], v104
    s_waitcnt lgkmcnt(0)
    s_barrier
    v_smfmac_f32_16x16x64_bf16 v[44:47], v[16:19], a[224:231], v104
    ds_read_b128 v[32:35], v116 offset:11264
    v_smfmac_f32_16x16x64_bf16 v[40:43], v[20:23], a[168:175], v104
    ds_read_b128 v[36:39], v116 offset:12288
    v_smfmac_f32_16x16x64_bf16 v[44:47], v[20:23], a[232:239], v104
    ds_read_b128 v[96:99], v116 offset:13312
    v_smfmac_f32_16x16x64_bf16 v[40:43], v[28:31], a[184:191], v104
    v_smfmac_f32_16x16x64_bf16 v[44:47], v[28:31], a[248:255], v104
    v_smfmac_f32_16x16x64_bf16 v[48:51], v[8:11], v[56:63], v104
    ds_read_b128 v[56:59], v115 offset:43008
    ds_read_b128 v[60:63], v115 offset:44032
    v_smfmac_f32_16x16x64_bf16 v[52:55], v[8:11], v[64:71], v104
    ds_read_b128 v[64:67], v114 offset:6144
    ds_read_b128 v[68:71], v114 offset:7168
    s_nop 0
    v_add_f32 v40, v40, v42
    v_add_f32 v41, v41, v43
    v_add_f32 v44, v44, v46
    v_add_f32 v45, v45, v47
    v_cvt_pk_bf16_f32 v40, v40, v44
    v_cvt_pk_bf16_f32 v41, v41, v45
    ds_write_b32 v109, v40 offset:2304
    ds_write_b32 v109, v41 offset:2592
    v_smfmac_f32_16x16x64_bf16 v[100:103], v[8:11], v[72:79], v104
    ds_read_b128 v[72:75], v114 offset:8192
    ds_read_b128 v[76:79], v114 offset:9216
    v_smfmac_f32_16x16x64_bf16 v[48:51], v[24:27], v[80:87], v104
    ds_read_b128 v[80:83], v114 offset:10240
    ds_read_b128 v[84:87], v114 offset:11264
    v_smfmac_f32_16x16x64_bf16 v[52:55], v[24:27], v[88:95], v104
    ds_read_b128 v[88:91], v114 offset:22528
    ds_read_b128 v[92:95], v114 offset:23552
    s_waitcnt lgkmcnt(6)
    s_barrier
    v_smfmac_f32_16x16x64_bf16 v[100:103], v[24:27], v[56:63], v104
    ds_read_b128 v[56:59], v114 offset:24576
    ds_read_b128 v[60:63], v114 offset:25600
    s_mov_b32 m0, 131072
    v_smfmac_f32_16x16x64_bf16 v[48:51], v[0:3], v[64:71], v104
    ds_read_b128 v[64:67], v114 offset:26624
    ds_read_b128 v[68:71], v114 offset:27648
    global_load_lds_dwordx4 v105, s[80:81] offset:0
    s_waitcnt lgkmcnt(8)
    v_smfmac_f32_16x16x64_bf16 v[52:55], v[0:3], v[72:79], v104
    ds_read_b128 v[72:75], v114 offset:55296
    ds_read_b128 v[76:79], v114 offset:56320
    global_load_lds_dwordx4 v105, s[80:81] offset:1024
    s_waitcnt lgkmcnt(8)
    v_smfmac_f32_16x16x64_bf16 v[100:103], v[0:3], v[80:87], v104
    ds_read_b128 v[80:83], v114 offset:57344
    ds_read_b128 v[84:87], v114 offset:58368
    global_load_lds_dwordx4 v105, s[80:81] offset:2048
    s_waitcnt lgkmcnt(8)
    v_smfmac_f32_16x16x64_bf16 v[48:51], v[4:7], v[88:95], v104
    ds_read_b128 v[88:91], v114 offset:59392
    ds_read_b128 v[92:95], v114 offset:60416
    global_load_lds_dwordx4 v105, s[80:81] offset:3072
    s_waitcnt lgkmcnt(8)
    v_smfmac_f32_16x16x64_bf16 v[52:55], v[4:7], v[56:63], v104
    ds_read_b128 v[56:59], v115 offset:6144
    ds_read_b128 v[60:63], v115 offset:7168
    v_add_u32 v122, 4096, v105
    s_waitcnt lgkmcnt(8)
    v_smfmac_f32_16x16x64_bf16 v[100:103], v[4:7], v[64:71], v104
    ds_read_b128 v[64:67], v115 offset:8192
    ds_read_b128 v[68:71], v115 offset:9216
    s_mov_b32 m0, 135168
    s_waitcnt lgkmcnt(8)
    v_smfmac_f32_16x16x64_bf16 v[48:51], v[12:15], v[72:79], v104
    ds_read_b128 v[72:75], v115 offset:10240
    ds_read_b128 v[76:79], v115 offset:11264
    global_load_lds_dwordx4 v122, s[80:81] offset:0
    s_waitcnt lgkmcnt(8)
    v_smfmac_f32_16x16x64_bf16 v[52:55], v[12:15], v[80:87], v104
    ds_read_b128 v[80:83], v115 offset:22528
    ds_read_b128 v[84:87], v115 offset:23552
    global_load_lds_dwordx4 v122, s[80:81] offset:1024
    s_waitcnt lgkmcnt(8)
    v_smfmac_f32_16x16x64_bf16 v[100:103], v[12:15], v[88:95], v104
    ds_read_b128 v[88:91], v115 offset:24576
    ds_read_b128 v[92:95], v115 offset:25600
    global_load_lds_dwordx4 v122, s[80:81] offset:2048
    s_waitcnt lgkmcnt(8)
    v_smfmac_f32_16x16x64_bf16 v[48:51], v[16:19], v[56:63], v104
    ds_read_b128 v[56:59], v115 offset:26624
    ds_read_b128 v[60:63], v115 offset:27648
    global_load_lds_dwordx4 v122, s[80:81] offset:3072
    s_waitcnt lgkmcnt(8)
    v_smfmac_f32_16x16x64_bf16 v[52:55], v[16:19], v[64:71], v104
    ds_read_b128 v[64:67], v115 offset:55296
    ds_read_b128 v[68:71], v115 offset:56320
    s_waitcnt lgkmcnt(8)
    v_smfmac_f32_16x16x64_bf16 v[100:103], v[16:19], v[72:79], v104
    ds_read_b128 v[72:75], v115 offset:57344
    ds_read_b128 v[76:79], v115 offset:58368
    s_waitcnt lgkmcnt(8)
    v_smfmac_f32_16x16x64_bf16 v[48:51], v[20:23], v[80:87], v104
    ds_read_b128 v[80:83], v115 offset:59392
    ds_read_b128 v[84:87], v115 offset:60416
    s_waitcnt lgkmcnt(8)
    v_smfmac_f32_16x16x64_bf16 v[52:55], v[20:23], v[88:95], v104
    s_waitcnt lgkmcnt(6)
    v_smfmac_f32_16x16x64_bf16 v[100:103], v[20:23], v[56:63], v104
    s_waitcnt lgkmcnt(4)
    v_smfmac_f32_16x16x64_bf16 v[48:51], v[28:31], v[64:71], v104
    s_waitcnt lgkmcnt(2)
    v_smfmac_f32_16x16x64_bf16 v[52:55], v[28:31], v[72:79], v104
    s_waitcnt lgkmcnt(0)
    v_smfmac_f32_16x16x64_bf16 v[100:103], v[28:31], v[80:87], v104
    v_mov_b64 v[72:73], 0
    v_mov_b64 v[74:75], 0
    s_nop 1
    v_pk_add_f32 v[48:49], v[48:49], v[50:51]
    v_cvt_pk_bf16_f32 v48, v48, v49
    v_mov_b32 v49, 0
    v_pk_add_f32 v[52:53], v[52:53], v[54:55]
    v_cvt_pk_bf16_f32 v52, v52, v53
    v_mov_b32 v53, 0
    v_pk_add_f32 v[100:101], v[100:101], v[102:103]
    v_cvt_pk_bf16_f32 v100, v100, v101
    v_mov_b32 v101, 0
    v_mfma_f32_32x32x16_bf16 v[0:15], v[72:75], v[72:75], 0
    v_mfma_f32_32x32x16_bf16 v[16:31], v[72:75], v[72:75], 0
    v_mov_b32 v110, v48
    v_mov_b32 v111, v52
    v_mov_b32 v119, v100
    s_cmp_eq_u32 s68, 63
    s_cbranch_scc1 c_end_10
    s_waitcnt lgkmcnt(0)
    s_barrier
    ds_read_b128 v[44:47], v116 offset:16384
    ds_read_b64 v[126:127], v116 offset:17408
    v_add_u32 v122, 32768, v107
    s_add_u32 s76, s68, 1
    v_mov_b32 v123, 0
    v_mov_b32 v124, s76
    s_waitcnt lgkmcnt(1)
    v_mfma_f32_16x16x32_bf16 v[56:59], v[32:35], v[44:47], 0
    v_mfma_f32_16x16x32_bf16 v[60:63], v[36:39], v[44:47], 0
    v_mfma_f32_16x16x32_bf16 v[64:67], v[96:99], v[44:47], 0
    s_waitcnt lgkmcnt(0)
    s_nop 2
    v_mfma_f32_16x16x16_bf16 v[56:59], v[48:49], v[126:127], v[56:59]
    v_mfma_f32_16x16x16_bf16 v[60:63], v[52:53], v[126:127], v[60:63]
    v_mfma_f32_16x16x16_bf16 v[64:67], v[100:101], v[126:127], v[64:67]
    s_nop 5
    v_cvt_pk_bf16_f32 v56, v56, v57
    v_cvt_pk_bf16_f32 v57, v58, v59
    ds_write_b64 v112, v[56:57] offset:96
    v_cvt_pk_bf16_f32 v60, v60, v61
    v_cvt_pk_bf16_f32 v61, v62, v63
    ds_write_b64 v112, v[60:61] offset:128
    v_cvt_pk_bf16_f32 v64, v64, v65
    v_cvt_pk_bf16_f32 v65, v66, v67
    ds_write_b64 v112, v[64:65] offset:160
    s_waitcnt lgkmcnt(0)
    s_barrier
    ds_read_b128 v[40:43], v113 offset:0
    ds_read_b128 v[44:47], v113 offset:128
    s_waitcnt lgkmcnt(1)
    v_smfmac_f32_16x16x64_bf16 v[0:3], v[40:43], v[128:135], v104
    v_smfmac_f32_16x16x64_bf16 v[4:7], v[40:43], v[144:151], v104
    s_waitcnt lgkmcnt(0)
    v_smfmac_f32_16x16x64_bf16 v[0:3], v[44:47], v[136:143], v104
    v_smfmac_f32_16x16x64_bf16 v[4:7], v[44:47], v[152:159], v104
    v_smfmac_f32_16x16x64_bf16 v[8:11], v[40:43], v[160:167], v104
    v_smfmac_f32_16x16x64_bf16 v[12:15], v[40:43], v[176:183], v104
    s_nop 4
    v_add_f32 v0, v0, v2
    v_add_f32 v1, v1, v3
    v_smfmac_f32_16x16x64_bf16 v[8:11], v[44:47], v[168:175], v104
    v_cvt_pk_bf16_f32 v32, v0, v1
    v_add_f32 v4, v4, v6
    v_smfmac_f32_16x16x64_bf16 v[12:15], v[44:47], v[184:191], v104
    v_add_f32 v5, v5, v7
    v_cvt_pk_bf16_f32 v33, v4, v5
    v_smfmac_f32_16x16x64_bf16 v[16:19], v[40:43], v[192:199], v104
    v_smfmac_f32_16x16x64_bf16 v[20:23], v[40:43], v[208:215], v104
    s_nop 0
    v_add_f32 v8, v8, v10
    v_add_f32 v9, v9, v11
    v_smfmac_f32_16x16x64_bf16 v[16:19], v[44:47], v[200:207], v104
    v_cvt_pk_bf16_f32 v34, v8, v9
    v_add_f32 v12, v12, v14
    v_smfmac_f32_16x16x64_bf16 v[20:23], v[44:47], v[216:223], v104
    v_add_f32 v13, v13, v15
    v_cvt_pk_bf16_f32 v35, v12, v13
    v_smfmac_f32_16x16x64_bf16 v[24:27], v[40:43], v[224:231], v104
    global_store_dwordx4 v107, v[32:35], s[46:47] sc1
    global_store_dword v123, v124, s[8:9] sc1
    v_smfmac_f32_16x16x64_bf16 v[28:31], v[40:43], v[240:247], v104
    v_add_f32 v16, v16, v18
    v_add_f32 v17, v17, v19
    v_smfmac_f32_16x16x64_bf16 v[24:27], v[44:47], v[232:239], v104
    v_cvt_pk_bf16_f32 v36, v16, v17
    v_add_f32 v20, v20, v22
    v_smfmac_f32_16x16x64_bf16 v[28:31], v[44:47], v[248:255], v104
    v_add_f32 v21, v21, v23
    v_cvt_pk_bf16_f32 v37, v20, v21
    s_nop 2
    v_pk_add_f32 v[24:25], v[24:25], v[26:27]
    s_nop 1
    v_pk_add_f32 v[28:29], v[28:29], v[30:31]
    v_cvt_pk_bf16_f32 v38, v24, v25
    v_cvt_pk_bf16_f32 v39, v28, v29
    global_store_dwordx4 v122, v[36:39], s[46:47] sc1
    global_store_dword v123, v124, s[8:9] offset:128 sc1
    s_add_u32 s80, s80, 262144
    s_addc_u32 s81, s81, 0
    v_lshlrev_b32 v127, 3, v105
    v_cmp_le_u32 vcc, 64, v120
    s_cbranch_vccnz c_fok_52
    v_mov_b32 v122, s101
c_fl_53:
    global_load_dword v120, v122, s[4:5] sc1
    s_add_u32 s69, s69, 1
    s_cmp_gt_u32 s69, 0x80000
    s_cbranch_scc1 L_fail
    s_waitcnt vmcnt(0)
    v_cmp_gt_u32 vcc, 64, v120
    s_cbranch_vccnz c_fl_53
c_fok_52:
    s_add_u32 s101, s101, 128
    s_min_u32 s101, s101, 3968
    s_add_u32 s86, s86, 65536
    s_addc_u32 s87, s87, 0
    s_mov_b64 s[70:71], s[60:61]
    s_mov_b64 s[60:61], s[62:63]
    s_mov_b64 s[62:63], s[64:65]
    s_mov_b64 s[64:65], s[66:67]
    s_mov_b64 s[66:67], s[70:71]
    s_add_u32 s68, s68, 1
    v_mfma_f32_32x32x16_bf16 v[32:47], v[72:75], v[72:75], 0
    v_mfma_f32_16x16x32_bf16 v[48:51], v[72:75], v[72:75], 0
    v_mfma_f32_16x16x32_bf16 v[52:55], v[72:75], v[72:75], 0
    v_mfma_f32_16x16x32_bf16 v[100:103], v[72:75], v[72:75], 0
    ds_read_b128 v[56:59], v114 offset:38912
    ds_read_b128 v[60:63], v114 offset:39936
    ds_read_b128 v[64:67], v114 offset:40960
    ds_read_b128 v[68:71], v114 offset:41984
    ds_read_b128 v[72:75], v114 offset:43008
    ds_read_b128 v[76:79], v114 offset:44032
    ds_read_b128 v[80:83], v115 offset:38912
    ds_read_b128 v[84:87], v115 offset:39936
    ds_read_b128 v[88:91], v115 offset:40960
    ds_read_b128 v[92:95], v115 offset:41984
    s_barrier
    global_load_dwordx4 v[8:11], v106, s[60:61] sc1
    global_load_dwordx4 v[24:27], v106, s[60:61] offset:1024 sc1
    s_branch c_chk0_46
c_w3_9:
    s_mov_b32 s101, 0
    v_mov_b32 v122, s101
c_fl_54:
    global_load_dword v120, v122, s[4:5] sc1
    s_add_u32 s69, s69, 1
    s_cmp_gt_u32 s69, 0x80000
    s_cbranch_scc1 L_fail
    s_waitcnt vmcnt(0)
    v_cmp_gt_u32 vcc, 64, v120
    s_cbranch_vccnz c_fl_54
    s_mov_b32 m0, 162560
    v_lshlrev_b32 v122, 3, v105
    global_load_lds_dword v122, s[80:81] sc1
    v_add_u32 v122, 0x40000, v122
    global_load_lds_dword v122, s[80:81] sc1
    v_lshlrev_b32 v127, 3, v105
    s_mov_b32 s101, 128
    v_mov_b32 v122, s101
c_fl_55:
    global_load_dword v120, v122, s[4:5] sc1
    s_add_u32 s69, s69, 1
    s_cmp_gt_u32 s69, 0x80000
    s_cbranch_scc1 L_fail
    s_waitcnt vmcnt(0)
    v_cmp_gt_u32 vcc, 64, v120
    s_cbranch_vccnz c_fl_55
    s_mov_b32 s101, 256
    v_mov_b64 v[32:33], 0
    v_mov_b64 v[34:35], 0
    v_mov_b64 v[36:37], 0
    v_mov_b64 v[38:39], 0
    v_mov_b64 v[40:41], 0
    v_mov_b64 v[42:43], 0
    v_mov_b64 v[44:45], 0
    v_mov_b64 v[46:47], 0
    v_mov_b64 v[48:49], 0
    v_mov_b64 v[50:51], 0
    v_mov_b64 v[52:53], 0
    v_mov_b64 v[54:55], 0
    ds_read_b128 v[56:59], v114 offset:61440
    ds_read_b128 v[60:63], v114 offset:62464
    ds_read_b128 v[64:67], v114 offset:63488
    ds_read_b128 v[68:71], v114 offset:64512
    ds_read_b128 v[72:75], v115 offset:61440
    ds_read_b128 v[76:79], v115 offset:62464
    ds_read_b128 v[80:83], v115 offset:63488
    ds_read_b128 v[84:87], v115 offset:64512
    ds_read_b128 v[88:91], v114 offset:12288
    ds_read_b128 v[92:95], v114 offset:13312
    v_mov_b64 v[100:101], 0
    v_mov_b64 v[102:103], 0
    s_waitcnt lgkmcnt(0)
    s_mov_b32 m0, 139264
    s_nop 0
    global_load_lds_dwordx4 v105, s[80:81] offset:0
    global_load_lds_dwordx4 v105, s[80:81] offset:1024
    global_load_lds_dwordx4 v105, s[80:81] offset:2048
    global_load_lds_dwordx4 v105, s[80:81] offset:3072
    v_add_u32 v122, 4096, v105
    s_mov_b32 m0, 143360
    s_nop 0
    global_load_lds_dwordx4 v122, s[80:81] offset:0
    global_load_lds_dwordx4 v122, s[80:81] offset:1024
    global_load_lds_dwordx4 v122, s[80:81] offset:2048
    global_load_lds_dwordx4 v122, s[80:81] offset:3072
    s_add_u32 s80, s80, 262144
    s_addc_u32 s81, s81, 0
    global_load_dwordx4 v[12:15], v106, s[60:61] sc1
    global_load_dwordx4 v[28:31], v106, s[60:61] offset:1024 sc1
c_loop_56:
    s_branch c_chk0_57
c_pollm_58:
    global_load_dwordx4 v[12:15], v106, s[60:61] sc1
    global_load_dwordx4 v[28:31], v106, s[60:61] offset:1024 sc1
c_chk0_57:
    s_waitcnt vmcnt(1)
    v_max3_u32 v122, v12, v13, v14
    s_waitcnt vmcnt(0)
    v_max3_u32 v123, v15, v28, v29
    v_max3_u32 v122, v122, v30, v31
    v_max_u32 v122, v122, v123
    v_cmp_eq_u32 vcc, -1, v122
    ds_write_b128 v117, v[12:15]
    ds_write_b128 v117, v[28:31] offset:4096
    s_cbranch_vccnz c_retry_59
    v_smfmac_f32_16x16x64_bf16 v[32:35], v[12:15], a[24:31], v104
    v_smfmac_f32_16x16x64_bf16 v[36:39], v[12:15], a[88:95], v104
    v_smfmac_f32_16x16x64_bf16 v[32:35], v[28:31], a[56:63], v104
    s_waitcnt lgkmcnt(0)
    s_barrier
    ds_read_b128 v[0:3], v116 offset:16384
    ds_read_b128 v[4:7], v116 offset:17408
    v_smfmac_f32_16x16x64_bf16 v[36:39], v[28:31], a[120:127], v104
    ds_read_b128 v[8:11], v116 offset:18432
    v_smfmac_f32_16x16x64_bf16 v[40:43], v[12:15], a[152:159], v104
    ds_read_b128 v[16:19], v116 offset:20480
    v_smfmac_f32_16x16x64_bf16 v[44:47], v[12:15], a[216:223], v104
    ds_read_b128 v[20:23], v116 offset:21504
    v_smfmac_f32_16x16x64_bf16 v[40:43], v[28:31], a[184:191], v104
    ds_read_b128 v[24:27], v116 offset:22528
    s_waitcnt lgkmcnt(5)
    v_smfmac_f32_16x16x64_bf16 v[32:35], v[0:3], a[0:7], v104
    global_store_dword v121, v110, s[86:87] offset:1536 sc1
    v_smfmac_f32_16x16x64_bf16 v[36:39], v[0:3], a[64:71], v104
    global_store_dword v121, v111, s[86:87] offset:1792 sc1
    s_waitcnt lgkmcnt(4)
    v_smfmac_f32_16x16x64_bf16 v[32:35], v[4:7], a[8:15], v104
    s_mov_b32 m0, 162560
    v_smfmac_f32_16x16x64_bf16 v[36:39], v[4:7], a[72:79], v104
    global_load_lds_dword v127, s[80:81]
    s_waitcnt lgkmcnt(3)
    v_smfmac_f32_16x16x64_bf16 v[32:35], v[8:11], a[16:23], v104
    v_mov_b32 v122, s101
    v_smfmac_f32_16x16x64_bf16 v[36:39], v[8:11], a[80:87], v104
    global_load_dword v120, v122, s[4:5] sc1
    s_waitcnt lgkmcnt(2)
    v_smfmac_f32_16x16x64_bf16 v[32:35], v[16:19], a[32:39], v104
    v_smfmac_f32_16x16x64_bf16 v[36:39], v[16:19], a[96:103], v104
    s_waitcnt lgkmcnt(1)
    v_smfmac_f32_16x16x64_bf16 v[32:35], v[20:23], a[40:47], v104
    v_smfmac_f32_16x16x64_bf16 v[36:39], v[20:23], a[104:111], v104
    s_waitcnt lgkmcnt(0)
    v_smfmac_f32_16x16x64_bf16 v[32:35], v[24:27], a[48:55], v104
    v_smfmac_f32_16x16x64_bf16 v[36:39], v[24:27], a[112:119], v104
    v_smfmac_f32_16x16x64_bf16 v[44:47], v[28:31], a[248:255], v104
    v_smfmac_f32_16x16x64_bf16 v[40:43], v[0:3], a[128:135], v104
    v_smfmac_f32_16x16x64_bf16 v[44:47], v[0:3], a[192:199], v104
    s_nop 3
    v_add_f32 v32, v32, v34
    v_add_f32 v33, v33, v35
    v_smfmac_f32_16x16x64_bf16 v[40:43], v[4:7], a[136:143], v104
    v_add_f32 v36, v36, v38
    v_add_f32 v37, v37, v39
    v_smfmac_f32_16x16x64_bf16 v[44:47], v[4:7], a[200:207], v104
    v_cvt_pk_bf16_f32 v32, v32, v36
    v_cvt_pk_bf16_f32 v33, v33, v37
    v_smfmac_f32_16x16x64_bf16 v[40:43], v[8:11], a[144:151], v104
    ds_write2_b32 v109, v32, v33 offset0:0 offset1:72
    v_smfmac_f32_16x16x64_bf16 v[44:47], v[8:11], a[208:215], v104
    v_smfmac_f32_16x16x64_bf16 v[40:43], v[16:19], a[160:167], v104
    s_waitcnt lgkmcnt(0)
    s_barrier
    v_smfmac_f32_16x16x64_bf16 v[44:47], v[16:19], a[224:231], v104
    ds_read_b128 v[32:35], v116 offset:14336
    v_smfmac_f32_16x16x64_bf16 v[40:43], v[20:23], a[168:175], v104
    ds_read_b128 v[36:39], v116 offset:15360
    v_smfmac_f32_16x16x64_bf16 v[44:47], v[20:23], a[232:239], v104
    v_smfmac_f32_16x16x64_bf16 v[40:43], v[24:27], a[176:183], v104
    v_smfmac_f32_16x16x64_bf16 v[44:47], v[24:27], a[240:247], v104
    v_smfmac_f32_16x16x64_bf16 v[48:51], v[12:15], v[56:63], v104
    ds_read_b128 v[56:59], v114 offset:14336
    ds_read_b128 v[60:63], v114 offset:15360
    v_smfmac_f32_16x16x64_bf16 v[52:55], v[12:15], v[64:71], v104
    ds_read_b128 v[64:67], v114 offset:28672
    ds_read_b128 v[68:71], v114 offset:29696
    s_nop 0
    v_add_f32 v40, v40, v42
    v_add_f32 v41, v41, v43
    v_add_f32 v44, v44, v46
    v_add_f32 v45, v45, v47
    v_cvt_pk_bf16_f32 v40, v40, v44
    v_cvt_pk_bf16_f32 v41, v41, v45
    ds_write_b32 v109, v40 offset:2304
    ds_write_b32 v109, v41 offset:2592
    v_smfmac_f32_16x16x64_bf16 v[48:51], v[28:31], v[72:79], v104
    ds_read_b128 v[72:75], v114 offset:30720
    ds_read_b128 v[76:79], v114 offset:31744
    v_smfmac_f32_16x16x64_bf16 v[52:55], v[28:31], v[80:87], v104
    ds_read_b128 v[80:83], v114 offset:45056
    ds_read_b128 v[84:87], v114 offset:46080
    v_smfmac_f32_16x16x64_bf16 v[48:51], v[0:3], v[88:95], v104
    ds_read_b128 v[88:91], v114 offset:47104
    ds_read_b128 v[92:95], v114 offset:48128
    s_waitcnt lgkmcnt(6)
    s_barrier
    v_smfmac_f32_16x16x64_bf16 v[52:55], v[0:3], v[56:63], v104
    ds_read_b128 v[56:59], v115 offset:12288
    ds_read_b128 v[60:63], v115 offset:13312
    s_mov_b32 m0, 139264
    v_smfmac_f32_16x16x64_bf16 v[48:51], v[4:7], v[64:71], v104
    ds_read_b128 v[64:67], v115 offset:14336
    ds_read_b128 v[68:71], v115 offset:15360
    global_load_lds_dwordx4 v105, s[80:81] offset:0
    s_waitcnt lgkmcnt(8)
    v_smfmac_f32_16x16x64_bf16 v[52:55], v[4:7], v[72:79], v104
    ds_read_b128 v[72:75], v115 offset:28672
    ds_read_b128 v[76:79], v115 offset:29696
    global_load_lds_dwordx4 v105, s[80:81] offset:1024
    s_waitcnt lgkmcnt(8)
    v_smfmac_f32_16x16x64_bf16 v[48:51], v[8:11], v[80:87], v104
    ds_read_b128 v[80:83], v115 offset:30720
    ds_read_b128 v[84:87], v115 offset:31744
    global_load_lds_dwordx4 v105, s[80:81] offset:2048
    s_waitcnt lgkmcnt(8)
    v_smfmac_f32_16x16x64_bf16 v[52:55], v[8:11], v[88:95], v104
    ds_read_b128 v[88:91], v115 offset:45056
    ds_read_b128 v[92:95], v115 offset:46080
    global_load_lds_dwordx4 v105, s[80:81] offset:3072
    s_waitcnt lgkmcnt(8)
    v_smfmac_f32_16x16x64_bf16 v[48:51], v[16:19], v[56:63], v104
    ds_read_b128 v[56:59], v115 offset:47104
    ds_read_b128 v[60:63], v115 offset:48128
    v_add_u32 v122, 4096, v105
    s_waitcnt lgkmcnt(8)
    v_smfmac_f32_16x16x64_bf16 v[52:55], v[16:19], v[64:71], v104
    s_mov_b32 m0, 143360
    s_waitcnt lgkmcnt(6)
    v_smfmac_f32_16x16x64_bf16 v[48:51], v[20:23], v[72:79], v104
    global_load_lds_dwordx4 v122, s[80:81] offset:0
    s_waitcnt lgkmcnt(4)
    v_smfmac_f32_16x16x64_bf16 v[52:55], v[20:23], v[80:87], v104
    global_load_lds_dwordx4 v122, s[80:81] offset:1024
    s_waitcnt lgkmcnt(2)
    v_smfmac_f32_16x16x64_bf16 v[48:51], v[24:27], v[88:95], v104
    global_load_lds_dwordx4 v122, s[80:81] offset:2048
    s_waitcnt lgkmcnt(0)
    v_smfmac_f32_16x16x64_bf16 v[52:55], v[24:27], v[56:63], v104
    global_load_lds_dwordx4 v122, s[80:81] offset:3072
    v_mov_b64 v[72:73], 0
    v_mov_b64 v[74:75], 0
    s_nop 1
    v_pk_add_f32 v[48:49], v[48:49], v[50:51]
    v_cvt_pk_bf16_f32 v48, v48, v49
    v_mov_b32 v49, 0
    v_pk_add_f32 v[52:53], v[52:53], v[54:55]
    v_cvt_pk_bf16_f32 v52, v52, v53
    v_mov_b32 v53, 0
    v_mfma_f32_32x32x16_bf16 v[0:15], v[72:75], v[72:75], 0
    v_mfma_f32_32x32x16_bf16 v[16:31], v[72:75], v[72:75], 0
    v_mov_b32 v110, v48
    v_mov_b32 v111, v52
    s_waitcnt lgkmcnt(0)
    s_barrier
    ds_read_b128 v[44:47], v116 offset:16384
    ds_read_b64 v[126:127], v116 offset:17408
    v_add_u32 v122, 32768, v107
    s_add_u32 s76, s68, 1
    v_mov_b32 v123, 0
    v_mov_b32 v124, s76
    s_waitcnt lgkmcnt(1)
    v_mfma_f32_16x16x32_bf16 v[56:59], v[32:35], v[44:47], 0
    v_mfma_f32_16x16x32_bf16 v[60:63], v[36:39], v[44:47], 0
    s_waitcnt lgkmcnt(0)
    s_nop 3
    v_mfma_f32_16x16x16_bf16 v[56:59], v[48:49], v[126:127], v[56:59]
    v_mfma_f32_16x16x16_bf16 v[60:63], v[52:53], v[126:127], v[60:63]
    s_nop 6
    v_cvt_pk_bf16_f32 v56, v56, v57
    v_cvt_pk_bf16_f32 v57, v58, v59
    ds_write_b64 v112, v[56:57] offset:192
    v_cvt_pk_bf16_f32 v60, v60, v61
    v_cvt_pk_bf16_f32 v61, v62, v63
    ds_write_b64 v112, v[60:61] offset:224
    s_waitcnt lgkmcnt(0)
    s_barrier
    ds_read_b128 v[40:43], v113 offset:0
    ds_read_b128 v[44:47], v113 offset:128
    s_waitcnt lgkmcnt(1)
    v_smfmac_f32_16x16x64_bf16 v[0:3], v[40:43], v[128:135], v104
    v_smfmac_f32_16x16x64_bf16 v[4:7], v[40:43], v[144:151], v104
    s_waitcnt lgkmcnt(0)
    v_smfmac_f32_16x16x64_bf16 v[0:3], v[44:47], v[136:143], v104
    v_smfmac_f32_16x16x64_bf16 v[4:7], v[44:47], v[152:159], v104
    v_smfmac_f32_16x16x64_bf16 v[8:11], v[40:43], v[160:167], v104
    v_smfmac_f32_16x16x64_bf16 v[12:15], v[40:43], v[176:183], v104
    s_nop 4
    v_add_f32 v0, v0, v2
    v_add_f32 v1, v1, v3
    v_smfmac_f32_16x16x64_bf16 v[8:11], v[44:47], v[168:175], v104
    v_cvt_pk_bf16_f32 v32, v0, v1
    v_add_f32 v4, v4, v6
    v_smfmac_f32_16x16x64_bf16 v[12:15], v[44:47], v[184:191], v104
    v_add_f32 v5, v5, v7
    v_cvt_pk_bf16_f32 v33, v4, v5
    v_smfmac_f32_16x16x64_bf16 v[16:19], v[40:43], v[192:199], v104
    v_smfmac_f32_16x16x64_bf16 v[20:23], v[40:43], v[208:215], v104
    s_nop 0
    v_add_f32 v8, v8, v10
    v_add_f32 v9, v9, v11
    v_smfmac_f32_16x16x64_bf16 v[16:19], v[44:47], v[200:207], v104
    v_cvt_pk_bf16_f32 v34, v8, v9
    v_add_f32 v12, v12, v14
    v_smfmac_f32_16x16x64_bf16 v[20:23], v[44:47], v[216:223], v104
    v_add_f32 v13, v13, v15
    v_cvt_pk_bf16_f32 v35, v12, v13
    v_smfmac_f32_16x16x64_bf16 v[24:27], v[40:43], v[224:231], v104
    global_store_dwordx4 v107, v[32:35], s[44:45] sc1
    global_store_dword v123, v124, s[8:9] sc1
    v_smfmac_f32_16x16x64_bf16 v[28:31], v[40:43], v[240:247], v104
    v_add_f32 v16, v16, v18
    v_add_f32 v17, v17, v19
    v_smfmac_f32_16x16x64_bf16 v[24:27], v[44:47], v[232:239], v104
    v_cvt_pk_bf16_f32 v36, v16, v17
    v_add_f32 v20, v20, v22
    v_smfmac_f32_16x16x64_bf16 v[28:31], v[44:47], v[248:255], v104
    v_add_f32 v21, v21, v23
    v_cvt_pk_bf16_f32 v37, v20, v21
    s_nop 2
    v_pk_add_f32 v[24:25], v[24:25], v[26:27]
    s_nop 1
    v_pk_add_f32 v[28:29], v[28:29], v[30:31]
    v_cvt_pk_bf16_f32 v38, v24, v25
    v_cvt_pk_bf16_f32 v39, v28, v29
    global_store_dwordx4 v122, v[36:39], s[44:45] sc1
    global_store_dword v123, v124, s[8:9] offset:128 sc1
    s_add_u32 s80, s80, 262144
    s_addc_u32 s81, s81, 0
    v_lshlrev_b32 v127, 3, v105
    s_add_u32 s86, s86, 65536
    s_addc_u32 s87, s87, 0
    s_mov_b64 s[70:71], s[60:61]
    s_mov_b64 s[60:61], s[62:63]
    s_mov_b64 s[62:63], s[64:65]
    s_mov_b64 s[64:65], s[66:67]
    s_mov_b64 s[66:67], s[70:71]
    s_add_u32 s68, s68, 1
    v_mfma_f32_32x32x16_bf16 v[32:47], v[72:75], v[72:75], 0
    v_mfma_f32_16x16x32_bf16 v[48:51], v[72:75], v[72:75], 0
    v_mfma_f32_16x16x32_bf16 v[52:55], v[72:75], v[72:75], 0
    v_mfma_f32_16x16x32_bf16 v[100:103], v[72:75], v[72:75], 0
    ds_read_b128 v[56:59], v114 offset:61440
    ds_read_b128 v[60:63], v114 offset:62464
    ds_read_b128 v[64:67], v114 offset:63488
    ds_read_b128 v[68:71], v114 offset:64512
    ds_read_b128 v[72:75], v115 offset:61440
    ds_read_b128 v[76:79], v115 offset:62464
    ds_read_b128 v[80:83], v115 offset:63488
    ds_read_b128 v[84:87], v115 offset:64512
    ds_read_b128 v[88:91], v114 offset:12288
    ds_read_b128 v[92:95], v114 offset:13312
    s_barrier
    global_load_dwordx4 v[12:15], v106, s[60:61] sc1
    global_load_dwordx4 v[28:31], v106, s[60:61] offset:1024 sc1
c_chk1_61:
    s_waitcnt vmcnt(1)
    v_max3_u32 v122, v12, v13, v14
    s_waitcnt vmcnt(0)
    v_max3_u32 v123, v15, v28, v29
    v_max3_u32 v122, v122, v30, v31
    v_max_u32 v122, v122, v123
    v_cmp_eq_u32 vcc, -1, v122
    ds_write_b128 v117, v[12:15]
    ds_write_b128 v117, v[28:31] offset:4096
    s_cbranch_vccnz c_retry_62
    v_smfmac_f32_16x16x64_bf16 v[32:35], v[12:15], a[24:31], v104
    v_smfmac_f32_16x16x64_bf16 v[36:39], v[12:15], a[88:95], v104
    v_smfmac_f32_16x16x64_bf16 v[32:35], v[28:31], a[56:63], v104
    s_waitcnt lgkmcnt(0)
    s_barrier
    ds_read_b128 v[0:3], v116 offset:16384
    ds_read_b128 v[4:7], v116 offset:17408
    v_smfmac_f32_16x16x64_bf16 v[36:39], v[28:31], a[120:127], v104
    ds_read_b128 v[8:11], v116 offset:18432
    v_smfmac_f32_16x16x64_bf16 v[40:43], v[12:15], a[152:159], v104
    ds_read_b128 v[16:19], v116 offset:20480
    v_smfmac_f32_16x16x64_bf16 v[44:47], v[12:15], a[216:223], v104
    ds_read_b128 v[20:23], v116 offset:21504
    v_smfmac_f32_16x16x64_bf16 v[40:43], v[28:31], a[184:191], v104
    ds_read_b128 v[24:27], v116 offset:22528
    s_waitcnt lgkmcnt(5)
    v_smfmac_f32_16x16x64_bf16 v[32:35], v[0:3], a[0:7], v104
    global_store_dword v121, v110, s[86:87] offset:1536 sc1
    v_smfmac_f32_16x16x64_bf16 v[36:39], v[0:3], a[64:71], v104
    global_store_dword v121, v111, s[86:87] offset:1792 sc1
    s_waitcnt lgkmcnt(4)
    v_smfmac_f32_16x16x64_bf16 v[32:35], v[4:7], a[8:15], v104
    s_mov_b32 m0, 162560
    v_smfmac_f32_16x16x64_bf16 v[36:39], v[4:7], a[72:79], v104
    global_load_lds_dword v127, s[80:81]
    s_waitcnt lgkmcnt(3)
    v_smfmac_f32_16x16x64_bf16 v[32:35], v[8:11], a[16:23], v104
    v_smfmac_f32_16x16x64_bf16 v[36:39], v[8:11], a[80:87], v104
    s_waitcnt lgkmcnt(2)
    v_smfmac_f32_16x16x64_bf16 v[32:35], v[16:19], a[32:39], v104
    v_smfmac_f32_16x16x64_bf16 v[36:39], v[16:19], a[96:103], v104
    s_waitcnt lgkmcnt(1)
    v_smfmac_f32_16x16x64_bf16 v[32:35], v[20:23], a[40:47], v104
    v_smfmac_f32_16x16x64_bf16 v[36:39], v[20:23], a[104:111], v104
    s_waitcnt lgkmcnt(0)
    v_smfmac_f32_16x16x64_bf16 v[32:35], v[24:27], a[48:55], v104
    v_smfmac_f32_16x16x64_bf16 v[36:39], v[24:27], a[112:119], v104
    v_smfmac_f32_16x16x64_bf16 v[44:47], v[28:31], a[248:255], v104
    v_smfmac_f32_16x16x64_bf16 v[40:43], v[0:3], a[128:135], v104
    v_smfmac_f32_16x16x64_bf16 v[44:47], v[0:3], a[192:199], v104
    s_nop 3
    v_add_f32 v32, v32, v34
    v_add_f32 v33, v33, v35
    v_smfmac_f32_16x16x64_bf16 v[40:43], v[4:7], a[136:143], v104
    v_add_f32 v36, v36, v38
    v_add_f32 v37, v37, v39
    v_smfmac_f32_16x16x64_bf16 v[44:47], v[4:7], a[200:207], v104
    v_cvt_pk_bf16_f32 v32, v32, v36
    v_cvt_pk_bf16_f32 v33, v33, v37
    v_smfmac_f32_16x16x64_bf16 v[40:43], v[8:11], a[144:151], v104
    ds_write2_b32 v109, v32, v33 offset0:0 offset1:72
    v_smfmac_f32_16x16x64_bf16 v[44:47], v[8:11], a[208:215], v104
    v_smfmac_f32_16x16x64_bf16 v[40:43], v[16:19], a[160:167], v104
    s_waitcnt lgkmcnt(0)
    s_barrier
    v_smfmac_f32_16x16x64_bf16 v[44:47], v[16:19], a[224:231], v104
    ds_read_b128 v[32:35], v116 offset:14336
    v_smfmac_f32_16x16x64_bf16 v[40:43], v[20:23], a[168:175], v104
    ds_read_b128 v[36:39], v116 offset:15360
    v_smfmac_f32_16x16x64_bf16 v[44:47], v[20:23], a[232:239], v104
    v_smfmac_f32_16x16x64_bf16 v[40:43], v[24:27], a[176:183], v104
    v_smfmac_f32_16x16x64_bf16 v[44:47], v[24:27], a[240:247], v104
    v_smfmac_f32_16x16x64_bf16 v[48:51], v[12:15], v[56:63], v104
    ds_read_b128 v[56:59], v114 offset:14336
    ds_read_b128 v[60:63], v114 offset:15360
    v_smfmac_f32_16x16x64_bf16 v[52:55], v[12:15], v[64:71], v104
    ds_read_b128 v[64:67], v114 offset:28672
    ds_read_b128 v[68:71], v114 offset:29696
    s_nop 0
    v_add_f32 v40, v40, v42
    v_add_f32 v41, v41, v43
    v_add_f32 v44, v44, v46
    v_add_f32 v45, v45, v47
    v_cvt_pk_bf16_f32 v40, v40, v44
    v_cvt_pk_bf16_f32 v41, v41, v45
    ds_write_b32 v109, v40 offset:2304
    ds_write_b32 v109, v41 offset:2592
    v_smfmac_f32_16x16x64_bf16 v[48:51], v[28:31], v[72:79], v104
    ds_read_b128 v[72:75], v114 offset:30720
    ds_read_b128 v[76:79], v114 offset:31744
    v_smfmac_f32_16x16x64_bf16 v[52:55], v[28:31], v[80:87], v104
    ds_read_b128 v[80:83], v114 offset:45056
    ds_read_b128 v[84:87], v114 offset:46080
    v_smfmac_f32_16x16x64_bf16 v[48:51], v[0:3], v[88:95], v104
    ds_read_b128 v[88:91], v114 offset:47104
    ds_read_b128 v[92:95], v114 offset:48128
    s_waitcnt lgkmcnt(6)
    s_barrier
    v_smfmac_f32_16x16x64_bf16 v[52:55], v[0:3], v[56:63], v104
    ds_read_b128 v[56:59], v115 offset:12288
    ds_read_b128 v[60:63], v115 offset:13312
    s_mov_b32 m0, 139264
    v_smfmac_f32_16x16x64_bf16 v[48:51], v[4:7], v[64:71], v104
    ds_read_b128 v[64:67], v115 offset:14336
    ds_read_b128 v[68:71], v115 offset:15360
    global_load_lds_dwordx4 v105, s[80:81] offset:0
    s_waitcnt lgkmcnt(8)
    v_smfmac_f32_16x16x64_bf16 v[52:55], v[4:7], v[72:79], v104
    ds_read_b128 v[72:75], v115 offset:28672
    ds_read_b128 v[76:79], v115 offset:29696
    global_load_lds_dwordx4 v105, s[80:81] offset:1024
    s_waitcnt lgkmcnt(8)
    v_smfmac_f32_16x16x64_bf16 v[48:51], v[8:11], v[80:87], v104
    ds_read_b128 v[80:83], v115 offset:30720
    ds_read_b128 v[84:87], v115 offset:31744
    global_load_lds_dwordx4 v105, s[80:81] offset:2048
    s_waitcnt lgkmcnt(8)
    v_smfmac_f32_16x16x64_bf16 v[52:55], v[8:11], v[88:95], v104
    ds_read_b128 v[88:91], v115 offset:45056
    ds_read_b128 v[92:95], v115 offset:46080
    global_load_lds_dwordx4 v105, s[80:81] offset:3072
    s_waitcnt lgkmcnt(8)
    v_smfmac_f32_16x16x64_bf16 v[48:51], v[16:19], v[56:63], v104
    ds_read_b128 v[56:59], v115 offset:47104
    ds_read_b128 v[60:63], v115 offset:48128
    v_add_u32 v122, 4096, v105
    s_waitcnt lgkmcnt(8)
    v_smfmac_f32_16x16x64_bf16 v[52:55], v[16:19], v[64:71], v104
    s_mov_b32 m0, 143360
    s_waitcnt lgkmcnt(6)
    v_smfmac_f32_16x16x64_bf16 v[48:51], v[20:23], v[72:79], v104
    global_load_lds_dwordx4 v122, s[80:81] offset:0
    s_waitcnt lgkmcnt(4)
    v_smfmac_f32_16x16x64_bf16 v[52:55], v[20:23], v[80:87], v104
    global_load_lds_dwordx4 v122, s[80:81] offset:1024
    s_waitcnt lgkmcnt(2)
    v_smfmac_f32_16x16x64_bf16 v[48:51], v[24:27], v[88:95], v104
    global_load_lds_dwordx4 v122, s[80:81] offset:2048
    s_waitcnt lgkmcnt(0)
    v_smfmac_f32_16x16x64_bf16 v[52:55], v[24:27], v[56:63], v104
    global_load_lds_dwordx4 v122, s[80:81] offset:3072
    v_mov_b64 v[72:73], 0
    v_mov_b64 v[74:75], 0
    s_nop 1
    v_pk_add_f32 v[48:49], v[48:49], v[50:51]
    v_cvt_pk_bf16_f32 v48, v48, v49
    v_mov_b32 v49, 0
    v_pk_add_f32 v[52:53], v[52:53], v[54:55]
    v_cvt_pk_bf16_f32 v52, v52, v53
    v_mov_b32 v53, 0
    v_mfma_f32_32x32x16_bf16 v[0:15], v[72:75], v[72:75], 0
    v_mfma_f32_32x32x16_bf16 v[16:31], v[72:75], v[72:75], 0
    v_mov_b32 v110, v48
    v_mov_b32 v111, v52
    s_cmp_eq_u32 s68, 63
    s_cbranch_scc1 c_end_10
    s_waitcnt lgkmcnt(0)
    s_barrier
    ds_read_b128 v[44:47], v116 offset:16384
    ds_read_b64 v[126:127], v116 offset:17408
    v_add_u32 v122, 32768, v107
    s_add_u32 s76, s68, 1
    v_mov_b32 v123, 0
    v_mov_b32 v124, s76
    s_waitcnt lgkmcnt(1)
    v_mfma_f32_16x16x32_bf16 v[56:59], v[32:35], v[44:47], 0
    v_mfma_f32_16x16x32_bf16 v[60:63], v[36:39], v[44:47], 0
    s_waitcnt lgkmcnt(0)
    s_nop 3
    v_mfma_f32_16x16x16_bf16 v[56:59], v[48:49], v[126:127], v[56:59]
    v_mfma_f32_16x16x16_bf16 v[60:63], v[52:53], v[126:127], v[60:63]
    s_nop 6
    v_cvt_pk_bf16_f32 v56, v56, v57
    v_cvt_pk_bf16_f32 v57, v58, v59
    ds_write_b64 v112, v[56:57] offset:192
    v_cvt_pk_bf16_f32 v60, v60, v61
    v_cvt_pk_bf16_f32 v61, v62, v63
    ds_write_b64 v112, v[60:61] offset:224
    s_waitcnt lgkmcnt(0)
    s_barrier
    ds_read_b128 v[40:43], v113 offset:0
    ds_read_b128 v[44:47], v113 offset:128
    s_waitcnt lgkmcnt(1)
    v_smfmac_f32_16x16x64_bf16 v[0:3], v[40:43], v[128:135], v104
    v_smfmac_f32_16x16x64_bf16 v[4:7], v[40:43], v[144:151], v104
    s_waitcnt lgkmcnt(0)
    v_smfmac_f32_16x16x64_bf16 v[0:3], v[44:47], v[136:143], v104
    v_smfmac_f32_16x16x64_bf16 v[4:7], v[44:47], v[152:159], v104
    v_smfmac_f32_16x16x64_bf16 v[8:11], v[40:43], v[160:167], v104
    v_smfmac_f32_16x16x64_bf16 v[12:15], v[40:43], v[176:183], v104
    s_nop 4
    v_add_f32 v0, v0, v2
    v_add_f32 v1, v1, v3
    v_smfmac_f32_16x16x64_bf16 v[8:11], v[44:47], v[168:175], v104
    v_cvt_pk_bf16_f32 v32, v0, v1
    v_add_f32 v4, v4, v6
    v_smfmac_f32_16x16x64_bf16 v[12:15], v[44:47], v[184:191], v104
    v_add_f32 v5, v5, v7
    v_cvt_pk_bf16_f32 v33, v4, v5
    v_smfmac_f32_16x16x64_bf16 v[16:19], v[40:43], v[192:199], v104
    v_smfmac_f32_16x16x64_bf16 v[20:23], v[40:43], v[208:215], v104
    s_nop 0
    v_add_f32 v8, v8, v10
    v_add_f32 v9, v9, v11
    v_smfmac_f32_16x16x64_bf16 v[16:19], v[44:47], v[200:207], v104
    v_cvt_pk_bf16_f32 v34, v8, v9
    v_add_f32 v12, v12, v14
    v_smfmac_f32_16x16x64_bf16 v[20:23], v[44:47], v[216:223], v104
    v_add_f32 v13, v13, v15
    v_cvt_pk_bf16_f32 v35, v12, v13
    v_smfmac_f32_16x16x64_bf16 v[24:27], v[40:43], v[224:231], v104
    global_store_dwordx4 v107, v[32:35], s[46:47] sc1
    global_store_dword v123, v124, s[8:9] sc1
    v_smfmac_f32_16x16x64_bf16 v[28:31], v[40:43], v[240:247], v104
    v_add_f32 v16, v16, v18
    v_add_f32 v17, v17, v19
    v_smfmac_f32_16x16x64_bf16 v[24:27], v[44:47], v[232:239], v104
    v_cvt_pk_bf16_f32 v36, v16, v17
    v_add_f32 v20, v20, v22
    v_smfmac_f32_16x16x64_bf16 v[28:31], v[44:47], v[248:255], v104
    v_add_f32 v21, v21, v23
    v_cvt_pk_bf16_f32 v37, v20, v21
    s_nop 2
    v_pk_add_f32 v[24:25], v[24:25], v[26:27]
    s_nop 1
    v_pk_add_f32 v[28:29], v[28:29], v[30:31]
    v_cvt_pk_bf16_f32 v38, v24, v25
    v_cvt_pk_bf16_f32 v39, v28, v29
    global_store_dwordx4 v122, v[36:39], s[46:47] sc1
    global_store_dword v123, v124, s[8:9] offset:128 sc1
    s_add_u32 s80, s80, 262144
    s_addc_u32 s81, s81, 0
    v_lshlrev_b32 v127, 3, v105
    v_cmp_le_u32 vcc, 64, v120
    s_cbranch_vccnz c_fok_63
    v_mov_b32 v122, s101
c_fl_64:
    global_load_dword v120, v122, s[4:5] sc1
    s_add_u32 s69, s69, 1
    s_cmp_gt_u32 s69, 0x80000
    s_cbranch_scc1 L_fail
    s_waitcnt vmcnt(0)
    v_cmp_gt_u32 vcc, 64, v120
    s_cbranch_vccnz c_fl_64
c_fok_63:
    s_add_u32 s101, s101, 128
    s_min_u32 s101, s101, 3968
    s_add_u32 s86, s86, 65536
    s_addc_u32 s87, s87, 0
    s_mov_b64 s[70:71], s[60:61]
    s_mov_b64 s[60:61], s[62:63]
    s_mov_b64 s[62:63], s[64:65]
    s_mov_b64 s[64:65], s[66:67]
    s_mov_b64 s[66:67], s[70:71]
    s_add_u32 s68, s68, 1
    v_mfma_f32_32x32x16_bf16 v[32:47], v[72:75], v[72:75], 0
    v_mfma_f32_16x16x32_bf16 v[48:51], v[72:75], v[72:75], 0
    v_mfma_f32_16x16x32_bf16 v[52:55], v[72:75], v[72:75], 0
    v_mfma_f32_16x16x32_bf16 v[100:103], v[72:75], v[72:75], 0
    ds_read_b128 v[56:59], v114 offset:61440
    ds_read_b128 v[60:63], v114 offset:62464
    ds_read_b128 v[64:67], v114 offset:63488
    ds_read_b128 v[68:71], v114 offset:64512
    ds_read_b128 v[72:75], v115 offset:61440
    ds_read_b128 v[76:79], v115 offset:62464
    ds_read_b128 v[80:83], v115 offset:63488
    ds_read_b128 v[84:87], v115 offset:64512
    ds_read_b128 v[88:91], v114 offset:12288
    ds_read_b128 v[92:95], v114 offset:13312
    s_barrier
    global_load_dwordx4 v[12:15], v106, s[60:61] sc1
    global_load_dwordx4 v[28:31], v106, s[60:61] offset:1024 sc1
    s_branch c_chk0_57
c_pollm_24:
    global_load_dwordx4 v[0:3], v106, s[60:61] sc1
    global_load_dwordx4 v[16:19], v106, s[60:61] offset:1024 sc1
    s_branch c_chk1_25
c_pollm_40:
    global_load_dwordx4 v[4:7], v106, s[60:61] sc1
    global_load_dwordx4 v[20:23], v106, s[60:61] offset:1024 sc1
    s_branch c_chk1_41
c_pollm_49:
    global_load_dwordx4 v[8:11], v106, s[60:61] sc1
    global_load_dwordx4 v[24:27], v106, s[60:61] offset:1024 sc1
    s_branch c_chk1_50
c_pollm_60:
    global_load_dwordx4 v[12:15], v106, s[60:61] sc1
    global_load_dwordx4 v[28:31], v106, s[60:61] offset:1024 sc1
    s_branch c_chk1_61
c_retry_14:
    s_add_u32 s69, s69, 1
    s_cmp_lt_u32 s69, 0x80000
    s_cbranch_scc1 c_pollm_13
    s_branch L_fail
c_retry_22:
    s_add_u32 s69, s69, 1
    s_cmp_lt_u32 s69, 0x80000
    s_cbranch_scc1 c_light_20
    s_branch L_fail
c_retry_26:
    s_add_u32 s69, s69, 1
    s_cmp_lt_u32 s69, 0x80000
    s_cbranch_scc1 c_pollm_24
    s_branch L_fail
c_retry_34:
    s_add_u32 s69, s69, 1
    s_cmp_lt_u32 s69, 0x80000
    s_cbranch_scc1 c_light_32
    s_branch L_fail
c_retry_39:
    s_add_u32 s69, s69, 1
    s_cmp_lt_u32 s69, 0x80000
    s_cbranch_scc1 c_pollm_38
    s_branch L_fail
c_retry_42:
    s_add_u32 s69, s69, 1
    s_cmp_lt_u32 s69, 0x80000
    s_cbranch_scc1 c_pollm_40
    s_branch L_fail
c_retry_48:
    s_add_u32 s69, s69, 1
    s_cmp_lt_u32 s69, 0x80000
    s_cbranch_scc1 c_pollm_47
    s_branch L_fail
c_retry_51:
    s_add_u32 s69, s69, 1
    s_cmp_lt_u32 s69, 0x80000
    s_cbranch_scc1 c_pollm_49
    s_branch L_fail
c_retry_59:
    s_add_u32 s69, s69, 1
    s_cmp_lt_u32 s69, 0x80000
    s_cbranch_scc1 c_pollm_58
    s_branch L_fail
c_retry_62:
    s_add_u32 s69, s69, 1
    s_cmp_lt_u32 s69, 0x80000
    s_cbranch_scc1 c_pollm_60
    s_branch L_fail
c_re_23:
    global_load_dword v127, v126, s[10:11] sc1
    s_add_u32 s69, s69, 1
    s_cmp_lt_u32 s69, 0x80000
    s_cbranch_scc1 c_pollp_17
    s_branch L_fail
c_re_35:
    global_load_dword v127, v126, s[10:11] sc1
    s_add_u32 s69, s69, 1
    s_cmp_lt_u32 s69, 0x80000
    s_cbranch_scc1 c_pollp_29
    s_branch L_fail
c_slow_18:
    s_mov_b64 exec, -1
    s_add_u32 s69, s69, 1
    s_cmp_gt_u32 s69, 0x80000
    s_cbranch_scc1 L_fail
    s_and_b32 s70, s69, 31
    s_cmp_lg_u32 s70, 0
    s_cbranch_scc1 c_pollp_17
    s_mov_b32 s70, 2139193217
    s_mov_b64 s[72:73], 0
    v_cmp_eq_u32 vcc, s70, v0
    s_nop 0
    s_or_b64 s[72:73], s[72:73], vcc
    v_cmp_eq_u32 vcc, s70, v1
    s_nop 0
    s_or_b64 s[72:73], s[72:73], vcc
    v_cmp_eq_u32 vcc, s70, v2
    s_nop 0
    s_or_b64 s[72:73], s[72:73], vcc
    v_cmp_eq_u32 vcc, s70, v3
    s_nop 0
    s_or_b64 s[72:73], s[72:73], vcc
    v_cmp_eq_u32 vcc, s70, v4
    s_nop 0
    s_or_b64 s[72:73], s[72:73], vcc
    v_cmp_eq_u32 vcc, s70, v5
    s_nop 0
    s_or_b64 s[72:73], s[72:73], vcc
    v_cmp_eq_u32 vcc, s70, v6
    s_nop 0
    s_or_b64 s[72:73], s[72:73], vcc
    v_cmp_eq_u32 vcc, s70, v7
    s_nop 0
    s_or_b64 s[72:73], s[72:73], vcc
    v_cmp_eq_u32 vcc, s70, v8
    s_nop 0
    s_or_b64 s[72:73], s[72:73], vcc
    v_cmp_eq_u32 vcc, s70, v9
    s_nop 0
    s_or_b64 s[72:73], s[72:73], vcc
    v_cmp_eq_u32 vcc, s70, v10
    s_nop 0
    s_or_b64 s[72:73], s[72:73], vcc
    v_cmp_eq_u32 vcc, s70, v11
    s_nop 0
    s_or_b64 s[72:73], s[72:73], vcc
    v_cmp_eq_u32 vcc, s70, v12
    s_nop 0
    s_or_b64 s[72:73], s[72:73], vcc
    v_cmp_eq_u32 vcc, s70, v13
    s_nop 0
    s_or_b64 s[72:73], s[72:73], vcc
    v_cmp_eq_u32 vcc, s70, v14
    s_nop 0
    s_or_b64 s[72:73], s[72:73], vcc
    v_cmp_eq_u32 vcc, s70, v15
    s_nop 0
    s_or_b64 s[72:73], s[72:73], vcc
    v_cmp_eq_u32 vcc, s70, v16
    s_nop 0
    s_or_b64 s[72:73], s[72:73], vcc
    v_cmp_eq_u32 vcc, s70, v17
    s_nop 0
    s_or_b64 s[72:73], s[72:73], vcc
    v_cmp_eq_u32 vcc, s70, v18
    s_nop 0
    s_or_b64 s[72:73], s[72:73], vcc
    v_cmp_eq_u32 vcc, s70, v19
    s_nop 0
    s_or_b64 s[72:73], s[72:73], vcc
    v_cmp_eq_u32 vcc, s70, v20
    s_nop 0
    s_or_b64 s[72:73], s[72:73], vcc
    v_cmp_eq_u32 vcc, s70, v21
    s_nop 0
    s_or_b64 s[72:73], s[72:73], vcc
    v_cmp_eq_u32 vcc, s70, v22
    s_nop 0
    s_or_b64 s[72:73], s[72:73], vcc
    v_cmp_eq_u32 vcc, s70, v23
    s_nop 0
    s_or_b64 s[72:73], s[72:73], vcc
    v_cmp_eq_u32 vcc, s70, v24
    s_nop 0
    s_or_b64 s[72:73], s[72:73], vcc
    v_cmp_eq_u32 vcc, s70, v25
    s_nop 0
    s_or_b64 s[72:73], s[72:73], vcc
    v_cmp_eq_u32 vcc, s70, v26
    s_nop 0
    s_or_b64 s[72:73], s[72:73], vcc
    v_cmp_eq_u32 vcc, s70, v27
    s_nop 0
    s_or_b64 s[72:73], s[72:73], vcc
    v_cmp_eq_u32 vcc, s70, v28
    s_nop 0
    s_or_b64 s[72:73], s[72:73], vcc
    v_cmp_eq_u32 vcc, s70, v29
    s_nop 0
    s_or_b64 s[72:73], s[72:73], vcc
    v_cmp_eq_u32 vcc, s70, v30
    s_nop 0
    s_or_b64 s[72:73], s[72:73], vcc
    v_cmp_eq_u32 vcc, s70, v31
    s_nop 0
    s_or_b64 s[72:73], s[72:73], vcc
    s_cmp_lg_u64 s[72:73], 0
    s_cbranch_scc1 c_pollp_17
    s_mov_b64 exec, s[42:43]
    s_branch c_ok_19
c_slow_30:
    s_mov_b64 exec, -1
    s_add_u32 s69, s69, 1
    s_cmp_gt_u32 s69, 0x80000
    s_cbranch_scc1 L_fail
    s_and_b32 s70, s69, 31
    s_cmp_lg_u32 s70, 0
    s_cbranch_scc1 c_pollp_29
    s_mov_b32 s70, 2139193217
    s_mov_b64 s[72:73], 0
    v_cmp_eq_u32 vcc, s70, v0
    s_nop 0
    s_or_b64 s[72:73], s[72:73], vcc
    v_cmp_eq_u32 vcc, s70, v1
    s_nop 0
    s_or_b64 s[72:73], s[72:73], vcc
    v_cmp_eq_u32 vcc, s70, v2
    s_nop 0
    s_or_b64 s[72:73], s[72:73], vcc
    v_cmp_eq_u32 vcc, s70, v3
    s_nop 0
    s_or_b64 s[72:73], s[72:73], vcc
    v_cmp_eq_u32 vcc, s70, v4
    s_nop 0
    s_or_b64 s[72:73], s[72:73], vcc
    v_cmp_eq_u32 vcc, s70, v5
    s_nop 0
    s_or_b64 s[72:73], s[72:73], vcc
    v_cmp_eq_u32 vcc, s70, v6
    s_nop 0
    s_or_b64 s[72:73], s[72:73], vcc
    v_cmp_eq_u32 vcc, s70, v7
    s_nop 0
    s_or_b64 s[72:73], s[72:73], vcc
    v_cmp_eq_u32 vcc, s70, v8
    s_nop 0
    s_or_b64 s[72:73], s[72:73], vcc
    v_cmp_eq_u32 vcc, s70, v9
    s_nop 0
    s_or_b64 s[72:73], s[72:73], vcc
    v_cmp_eq_u32 vcc, s70, v10
    s_nop 0
    s_or_b64 s[72:73], s[72:73], vcc
    v_cmp_eq_u32 vcc, s70, v11
    s_nop 0
    s_or_b64 s[72:73], s[72:73], vcc
    v_cmp_eq_u32 vcc, s70, v12
    s_nop 0
    s_or_b64 s[72:73], s[72:73], vcc
    v_cmp_eq_u32 vcc, s70, v13
    s_nop 0
    s_or_b64 s[72:73], s[72:73], vcc
    v_cmp_eq_u32 vcc, s70, v14
    s_nop 0
    s_or_b64 s[72:73], s[72:73], vcc
    v_cmp_eq_u32 vcc, s70, v15
    s_nop 0
    s_or_b64 s[72:73], s[72:73], vcc
    v_cmp_eq_u32 vcc, s70, v16
    s_nop 0
    s_or_b64 s[72:73], s[72:73], vcc
    v_cmp_eq_u32 vcc, s70, v17
    s_nop 0
    s_or_b64 s[72:73], s[72:73], vcc
    v_cmp_eq_u32 vcc, s70, v18
    s_nop 0
    s_or_b64 s[72:73], s[72:73], vcc
    v_cmp_eq_u32 vcc, s70, v19
    s_nop 0
    s_or_b64 s[72:73], s[72:73], vcc
    v_cmp_eq_u32 vcc, s70, v20
    s_nop 0
    s_or_b64 s[72:73], s[72:73], vcc
    v_cmp_eq_u32 vcc, s70, v21
    s_nop 0
    s_or_b64 s[72:73], s[72:73], vcc
    v_cmp_eq_u32 vcc, s70, v22
    s_nop 0
    s_or_b64 s[72:73], s[72:73], vcc
    v_cmp_eq_u32 vcc, s70, v23
    s_nop 0
    s_or_b64 s[72:73], s[72:73], vcc
    v_cmp_eq_u32 vcc, s70, v24
    s_nop 0
    s_or_b64 s[72:73], s[72:73], vcc
    v_cmp_eq_u32 vcc, s70, v25
    s_nop 0
    s_or_b64 s[72:73], s[72:73], vcc
    v_cmp_eq_u32 vcc, s70, v26
    s_nop 0
    s_or_b64 s[72:73], s[72:73], vcc
    v_cmp_eq_u32 vcc, s70, v27
    s_nop 0
    s_or_b64 s[72:73], s[72:73], vcc
    v_cmp_eq_u32 vcc, s70, v28
    s_nop 0
    s_or_b64 s[72:73], s[72:73], vcc
    v_cmp_eq_u32 vcc, s70, v29
    s_nop 0
    s_or_b64 s[72:73], s[72:73], vcc
    v_cmp_eq_u32 vcc, s70, v30
    s_nop 0
    s_or_b64 s[72:73], s[72:73], vcc
    v_cmp_eq_u32 vcc, s70, v31
    s_nop 0
    s_or_b64 s[72:73], s[72:73], vcc
    s_cmp_lg_u64 s[72:73], 0
    s_cbranch_scc1 c_pollp_29
    s_mov_b64 exec, s[42:43]
    s_branch c_ok_31
c_fb_15:
    s_nop 7
    v_max_f32 v122, v40, v41
    v_mov_b32 v123, v122
    s_nop 1
    v_permlane32_swap_b32 v123, v122
    v_max_f32 v122, v123, v122
    v_mov_b32 v123, v122
    s_nop 1
    v_permlane16_swap_b32 v123, v122
    v_max_f32 v122, v123, v122
    v_max_f32 v122, 0, v122
    v_sub_f32 v40, v40, v122
    v_sub_f32 v41, v41, v122
    v_sub_f32 v122, 0, v122
    v_exp_f32 v122, v122
    s_nop 0
    v_mul_f32 v32, v32, v122
    v_mul_f32 v33, v33, v122
    v_mul_f32 v34, v34, v122
    v_mul_f32 v35, v35, v122
    v_mul_f32 v36, v36, v122
    v_mul_f32 v37, v37, v122
    v_mul_f32 v38, v38, v122
    v_mul_f32 v39, v39, v122
    s_branch c_fr_16
c_fb_27:
    s_nop 7
    v_max_f32 v122, v40, v41
    v_mov_b32 v123, v122
    s_nop 1
    v_permlane32_swap_b32 v123, v122
    v_max_f32 v122, v123, v122
    v_mov_b32 v123, v122
    s_nop 1
    v_permlane16_swap_b32 v123, v122
    v_max_f32 v122, v123, v122
    v_max_f32 v122, 0, v122
    v_sub_f32 v40, v40, v122
    v_sub_f32 v41, v41, v122
    v_sub_f32 v122, 0, v122
    v_exp_f32 v122, v122
    s_nop 0
    v_mul_f32 v32, v32, v122
    v_mul_f32 v33, v33, v122
    v_mul_f32 v34, v34, v122
    v_mul_f32 v35, v35, v122
    v_mul_f32 v36, v36, v122
    v_mul_f32 v37, v37, v122
    v_mul_f32 v38, v38, v122
    v_mul_f32 v39, v39, v122
    s_branch c_fr_28
c_end_10:
    s_nop 0
    s_add_u32 s86, s86, 65536
    s_addc_u32 s87, s87, 0
    s_cmp_lg_u32 s34, 1
    s_cbranch_scc1 c_fv_66
    s_add_u32 s84, s84, 131072
    s_addc_u32 s85, s85, 0
    ds_read_b128 v[0:3], v120
    ds_read_b128 v[4:7], v120 offset:1152
    s_waitcnt lgkmcnt(0)
    global_store_dwordx4 v105, v[0:3], s[84:85] sc1
    global_store_dwordx4 v105, v[4:7], s[84:85] offset:1024 sc1
    global_store_dword v121, v110, s[86:87] offset:0 sc1
    global_store_dword v121, v111, s[86:87] offset:256 sc1
    global_store_dword v121, v119, s[86:87] offset:512 sc1
c_fv_66:
    s_cmp_lg_u32 s34, 2
    s_cbranch_scc1 c_fv_67
    global_store_dword v121, v110, s[86:87] offset:768 sc1
    global_store_dword v121, v111, s[86:87] offset:1024 sc1
    global_store_dword v121, v119, s[86:87] offset:1280 sc1
c_fv_67:
    s_cmp_lg_u32 s34, 3
    s_cbranch_scc1 c_fv_68
    global_store_dword v121, v110, s[86:87] offset:1536 sc1
    global_store_dword v121, v111, s[86:87] offset:1792 sc1
c_fv_68:
    s_waitcnt vmcnt(0) lgkmcnt(0)
    s_barrier
    s_cmp_lg_u32 s34, 1
    s_cbranch_scc1 c_fin_65
    v_mov_b32 v122, s100
    v_mov_b32 v124, 64
    global_store_dword v122, v124, s[4:5] sc1
c_fin_65:
    s_waitcnt lgkmcnt(0) vmcnt(0)
    s_endpgm
L_chain0:
    s_mov_b32 s88, 1040356334
    s_mov_b32 s89, 1040356334
    s_add_u32 s44, s4, 524288
    s_addc_u32 s45, s5, 0
    s_add_u32 s48, s4, 528384
    s_addc_u32 s49, s5, 0
    s_add_u32 s46, s4, 786432
    s_addc_u32 s47, s5, 0
    s_add_u32 s50, s4, 790528
    s_addc_u32 s51, s5, 0
    s_lshl_b32 s70, s36, 13
    s_mov_b32 s71, 50331648
    s_mov_b32 s82, 131072
    s_cmp_eq_u32 s34, 3
    s_cselect_b32 s71, 67108864, s71
    s_cselect_b32 s82, 139264, s82
    s_add_u32 s71, s71, s70
    s_add_u32 s80, s4, s71
    s_addc_u32 s81, s5, 0
    s_add_u32 s12, s80, 16777216
    s_addc_u32 s13, s81, 0
    s_lshl_b32 s70, s36, 12
    s_add_u32 s71, s70, 8257536
    s_add_u32 s84, s4, s71
    s_addc_u32 s85, s5, 0
    s_lshl_b32 s70, s36, 11
    s_add_u32 s71, s70, 16777216
    s_add_u32 s86, s4, s71
    s_addc_u32 s87, s5, 0
    s_lshl_b32 s100, s36, 7
    s_add_u32 s100, s100, 12288
    v_mov_b32 v114, v105
    v_add_u32 v115, 0x10000, v105
    v_lshrrev_b32 v121, 2, v105
    v_bfe_u32 v122, v105, 5, 3
    v_mul_u32_u24 v122, 288, v122
    v_lshrrev_b32 v123, 8, v105
    v_lshl_add_u32 v122, v123, 3, v122
    v_add_u32 v112, 160256, v122
    s_cmp_lg_u32 s34, 1
    s_cbranch_scc1 c_np_69
    v_mul_u32_u24 v122, 288, v123
    v_and_b32 v123, 0xff, v105
    v_add_u32 v122, v122, v123
    v_add_u32 v120, 157952, v122
c_np_69:
    s_lshl_b32 s70, s34, 8
    s_lshl_b32 s71, s36, 2
    s_add_u32 s70, s70, s71
    s_add_u32 s70, s70, 32768
    s_add_u32 s8, s4, s70
    s_addc_u32 s9, s5, 0
    s_lshr_b32 s70, s36, 2
    s_lshl_b32 s70, s70, 7
    s_add_u32 s70, s70, 32768
    s_add_u32 s10, s4, s70
    s_addc_u32 s11, s5, 0
    s_add_u32 s60, s4, 98304
    s_addc_u32 s61, s5, 0
    s_add_u32 s62, s4, 106496
    s_addc_u32 s63, s5, 0
    s_add_u32 s64, s4, 114688
    s_addc_u32 s65, s5, 0
    s_add_u32 s66, s4, 122880
    s_addc_u32 s67, s5, 0
    s_mov_b32 s69, 0
    s_mov_b32 s68, 0
    s_cmp_eq_u32 s34, 1
    s_cbranch_scc1 c_w1_71
    s_cmp_eq_u32 s34, 2
    s_cbranch_scc1 c_w2_72
    s_cmp_eq_u32 s34, 3
    s_cbranch_scc1 c_w3_73
    v_bfe_u32 v122, v108, 5, 3
    v_lshrrev_b32 v123, 8, v108
    v_lshlrev_b32 v122, 10, v122
    v_lshl_add_u32 v122, v123, 5, v122
    v_and_b32 v123, 31, v108
    v_add_u32 v122, v122, v123
    s_mov_b64 exec, s[42:43]
    global_load_dwordx2 v[124:125], v122, s[16:17]
    s_waitcnt vmcnt(0)
    v_min_u32 v124, -2, v124
    v_min_u32 v125, -2, v125
    global_store_dwordx2 v108, v[124:125], s[60:61]
    s_mov_b64 exec, -1
    v_mov_b64 v[32:33], 0
    v_mov_b64 v[34:35], 0
    v_mov_b64 v[36:37], 0
    v_mov_b64 v[38:39], 0
    v_mov_b64 v[40:41], 0
    v_mov_b64 v[42:43], 0
    v_mov_b64 v[44:45], 0
    v_mov_b64 v[46:47], 0
    v_mov_b64 v[48:49], 0
    v_mov_b64 v[50:51], 0
    v_mov_b64 v[52:53], 0
    v_mov_b64 v[54:55], 0
    s_waitcnt lgkmcnt(0)
    global_load_dwordx4 v[0:3], v106, s[60:61] sc1
    global_load_dwordx4 v[16:19], v106, s[60:61] offset:1024 sc1
c_loop_75:
    s_branch c_chk0_76
c_pollm_77:
    global_load_dwordx4 v[0:3], v106, s[60:61] sc1
    global_load_dwordx4 v[16:19], v106, s[60:61] offset:1024 sc1
c_chk0_76:
    s_waitcnt vmcnt(1)
    v_max3_u32 v122, v0, v1, v2
    s_waitcnt vmcnt(0)
    v_max3_u32 v123, v3, v16, v17
    v_max3_u32 v122, v122, v18, v19
    v_max_u32 v122, v122, v123
    v_cmp_eq_u32 vcc, -1, v122
    ds_write_b128 v117, v[0:3]
    ds_write_b128 v117, v[16:19] offset:4096
    s_cbranch_vccnz c_retry_78
    v_smfmac_f32_16x16x64_bf16 v[32:35], v[0:3], a[0:7], v104
    v_smfmac_f32_16x16x64_bf16 v[36:39], v[0:3], a[64:71], v104
    v_smfmac_f32_16x16x64_bf16 v[32:35], v[16:19], a[32:39], v104
    s_waitcnt lgkmcnt(0)
    s_barrier
    ds_read_b128 v[4:7], v116 offset:17408
    ds_read_b128 v[8:11], v116 offset:18432
    v_smfmac_f32_16x16x64_bf16 v[36:39], v[16:19], a[96:103], v104
    ds_read_b128 v[12:15], v116 offset:19456
    v_smfmac_f32_16x16x64_bf16 v[40:43], v[0:3], a[128:135], v104
    ds_read_b128 v[20:23], v116 offset:21504
    v_smfmac_f32_16x16x64_bf16 v[44:47], v[0:3], a[192:199], v104
    ds_read_b128 v[24:27], v116 offset:22528
    v_smfmac_f32_16x16x64_bf16 v[40:43], v[16:19], a[160:167], v104
    ds_read_b128 v[28:31], v116 offset:23552
    s_waitcnt lgkmcnt(5)
    v_smfmac_f32_16x16x64_bf16 v[32:35], v[4:7], a[8:15], v104
    v_mov_b32 v124, 2139193217
    v_smfmac_f32_16x16x64_bf16 v[36:39], v[4:7], a[72:79], v104
    v_mov_b32 v125, 2139193217
    s_waitcnt lgkmcnt(4)
    v_smfmac_f32_16x16x64_bf16 v[32:35], v[8:11], a[16:23], v104
    v_mov_b32 v126, 2139193217
    v_smfmac_f32_16x16x64_bf16 v[36:39], v[8:11], a[80:87], v104
    v_mov_b32 v127, 2139193217
    s_waitcnt lgkmcnt(3)
    v_smfmac_f32_16x16x64_bf16 v[32:35], v[12:15], a[24:31], v104
    global_store_dwordx4 v118, v[124:127], s[46:47]
    v_smfmac_f32_16x16x64_bf16 v[36:39], v[12:15], a[88:95], v104
    global_store_dwordx4 v118, v[124:127], s[50:51]
    s_waitcnt lgkmcnt(2)
    v_smfmac_f32_16x16x64_bf16 v[32:35], v[20:23], a[40:47], v104
    v_add_u32 v122, 8192, v118
    v_smfmac_f32_16x16x64_bf16 v[36:39], v[20:23], a[104:111], v104
    global_store_dwordx4 v122, v[124:127], s[46:47]
    s_waitcnt lgkmcnt(1)
    v_smfmac_f32_16x16x64_bf16 v[32:35], v[24:27], a[48:55], v104
    global_store_dwordx4 v122, v[124:127], s[50:51]
    v_smfmac_f32_16x16x64_bf16 v[36:39], v[24:27], a[112:119], v104
    v_add_u32 v122, 16384, v118
    s_waitcnt lgkmcnt(0)
    v_smfmac_f32_16x16x64_bf16 v[32:35], v[28:31], a[56:63], v104
    global_store_dwordx4 v122, v[124:127], s[46:47]
    v_smfmac_f32_16x16x64_bf16 v[36:39], v[28:31], a[120:127], v104
    global_store_dwordx4 v122, v[124:127], s[50:51]
    v_add_u32 v122, 24576, v118
    global_store_dwordx4 v122, v[124:127], s[46:47]
    global_store_dwordx4 v122, v[124:127], s[50:51]
    v_smfmac_f32_16x16x64_bf16 v[44:47], v[16:19], a[224:231], v104
    v_smfmac_f32_16x16x64_bf16 v[40:43], v[4:7], a[136:143], v104
    v_smfmac_f32_16x16x64_bf16 v[44:47], v[4:7], a[200:207], v104
    v_add_f32 v32, v32, v34
    v_add_f32 v33, v33, v35
    v_smfmac_f32_16x16x64_bf16 v[40:43], v[8:11], a[144:151], v104
    v_add_f32 v36, v36, v38
    v_add_f32 v37, v37, v39
    v_smfmac_f32_16x16x64_bf16 v[44:47], v[8:11], a[208:215], v104
    v_cvt_pk_bf16_f32 v32, v32, v36
    v_cvt_pk_bf16_f32 v33, v33, v37
    v_smfmac_f32_16x16x64_bf16 v[40:43], v[12:15], a[152:159], v104
    ds_write2_b32 v109, v32, v33 offset0:0 offset1:72
    v_smfmac_f32_16x16x64_bf16 v[44:47], v[12:15], a[216:223], v104
    v_smfmac_f32_16x16x64_bf16 v[40:43], v[20:23], a[168:175], v104
    s_waitcnt lgkmcnt(0)
    s_barrier
    ds_read_b128 v[56:59], v110 offset:0
    ds_read_b128 v[72:75], v116 offset:0
    v_smfmac_f32_16x16x64_bf16 v[44:47], v[20:23], a[232:239], v104
    ds_read_b128 v[60:63], v110 offset:64
    ds_read_b128 v[76:79], v116 offset:1024
    v_smfmac_f32_16x16x64_bf16 v[40:43], v[24:27], a[176:183], v104
    ds_read_b128 v[64:67], v110 offset:128
    ds_read_b128 v[80:83], v116 offset:2048
    v_smfmac_f32_16x16x64_bf16 v[44:47], v[24:27], a[240:247], v104
    ds_read_b128 v[68:71], v110 offset:192
    ds_read_b128 v[84:87], v116 offset:3072
    v_smfmac_f32_16x16x64_bf16 v[40:43], v[28:31], a[184:191], v104
    ds_read_b128 v[88:91], v116 offset:4096
    ds_read_b128 v[92:95], v116 offset:5120
    v_smfmac_f32_16x16x64_bf16 v[44:47], v[28:31], a[248:255], v104
    ds_read_b128 v[96:99], v116 offset:6144
    ds_read_b128 v[100:103], v116 offset:7168
    s_waitcnt lgkmcnt(8)
    v_mfma_f32_16x16x32_bf16 v[32:35], v[72:75], v[56:59], 0
    v_mfma_f32_16x16x32_bf16 v[32:35], v[76:79], v[60:63], v[32:35]
    s_waitcnt lgkmcnt(4)
    v_mfma_f32_16x16x32_bf16 v[32:35], v[80:83], v[64:67], v[32:35]
    v_add_f32 v40, v40, v42
    v_add_f32 v41, v41, v43
    v_mfma_f32_16x16x32_bf16 v[32:35], v[84:87], v[68:71], v[32:35]
    v_add_f32 v44, v44, v46
    v_add_f32 v45, v45, v47
    s_waitcnt lgkmcnt(2)
    v_mfma_f32_16x16x32_bf16 v[36:39], v[88:91], v[56:59], 0
    v_cvt_pk_bf16_f32 v40, v40, v44
    v_cvt_pk_bf16_f32 v41, v41, v45
    v_mfma_f32_16x16x32_bf16 v[36:39], v[92:95], v[60:63], v[36:39]
    ds_write_b32 v109, v40 offset:2304
    ds_write_b32 v109, v41 offset:2592
    s_waitcnt lgkmcnt(2)
    v_mfma_f32_16x16x32_bf16 v[36:39], v[96:99], v[64:67], v[36:39]
    v_mfma_f32_16x16x32_bf16 v[36:39], v[100:103], v[68:71], v[36:39]
    s_waitcnt lgkmcnt(0)
    s_barrier
    ds_read_b128 v[72:75], v111 offset:0
    ds_read_b128 v[76:79], v111 offset:64
    ds_read_b128 v[80:83], v111 offset:128
    ds_read_b128 v[84:87], v111 offset:192
    v_max3_f32 v122, v32, v33, v34
    s_nop 0
    v_max3_f32 v122, v122, v35, v36
    v_max3_f32 v122, v122, v37, v38
    v_max_f32 v122, v122, v39
    v_mov_b32 v123, v122
    s_waitcnt lgkmcnt(2)
    v_mfma_f32_16x16x32_bf16 v[40:43], v[72:75], v[56:59], 0
    v_permlane32_swap_b32 v123, v122
    v_mfma_f32_16x16x32_bf16 v[40:43], v[76:79], v[60:63], v[40:43]
    v_max_f32 v122, v123, v122
    v_mov_b32 v123, v122
    s_waitcnt lgkmcnt(0)
    v_mfma_f32_16x16x32_bf16 v[40:43], v[80:83], v[64:67], v[40:43]
    v_permlane16_swap_b32 v123, v122
    v_mfma_f32_16x16x32_bf16 v[40:43], v[84:87], v[68:71], v[40:43]
    v_max_f32 v122, v123, v122
    v_mul_f32 v124, s88, v122
    v_pk_fma_f32 v[32:33], v[32:33], s[88:89], v[124:125] op_sel_hi:[1,1,0] neg_lo:[0,0,1] neg_hi:[0,0,1]
    v_pk_fma_f32 v[34:35], v[34:35], s[88:89], v[124:125] op_sel_hi:[1,1,0] neg_lo:[0,0,1] neg_hi:[0,0,1]
    v_pk_fma_f32 v[36:37], v[36:37], s[88:89], v[124:125] op_sel_hi:[1,1,0] neg_lo:[0,0,1] neg_hi:[0,0,1]
    v_pk_fma_f32 v[38:39], v[38:39], s[88:89], v[124:125] op_sel_hi:[1,1,0] neg_lo:[0,0,1] neg_hi:[0,0,1]
    s_nop 1
    v_pk_fma_f32 v[40:41], v[40:41], s[88:89], v[124:125] op_sel_hi:[1,1,0] neg_lo:[0,0,1] neg_hi:[0,0,1]
    v_max_f32 v123, v40, v41
    v_cmp_lt_f32 vcc, 0x42800000, v123
    v_exp_f32 v32, v32
    v_exp_f32 v33, v33
    v_exp_f32 v34, v34
    v_exp_f32 v35, v35
    v_exp_f32 v36, v36
    v_exp_f32 v37, v37
    v_exp_f32 v38, v38
    v_exp_f32 v39, v39
    s_cbranch_vccnz c_fb_79
c_fr_80:
    v_exp_f32 v40, v40
    v_exp_f32 v41, v41
    v_pk_add_f32 v[126:127], v[32:33], v[34:35]
    v_pk_add_f32 v[124:125], v[36:37], v[38:39]
    v_pk_add_f32 v[126:127], v[126:127], v[124:125]
    v_pk_add_f32 v[126:127], v[126:127], v[40:41]
    v_add_f32 v126, v126, v127
    v_mov_b32 v123, v126
    v_mov_b64 v[88:89], 0
    s_nop 0
    v_permlane32_swap_b32 v123, v126
    v_add_f32 v126, v123, v126
    v_mov_b32 v123, v126
    v_mov_b64 v[90:91], 0
    s_nop 0
    v_permlane16_swap_b32 v123, v126
    v_add_f32 v126, v123, v126
    v_rcp_f32 v126, v126
    s_nop 0
    v_pk_mul_f32 v[32:33], v[32:33], v[126:127] op_sel_hi:[1,0]
    v_pk_mul_f32 v[34:35], v[34:35], v[126:127] op_sel_hi:[1,0]
    v_pk_mul_f32 v[36:37], v[36:37], v[126:127] op_sel_hi:[1,0]
    v_pk_mul_f32 v[38:39], v[38:39], v[126:127] op_sel_hi:[1,0]
    v_pk_mul_f32 v[40:41], v[40:41], v[126:127] op_sel_hi:[1,0]
    v_cvt_pk_bf16_f32 v44, v32, v33
    v_cvt_pk_bf16_f32 v45, v34, v35
    v_cvt_pk_bf16_f32 v46, v36, v37
    v_cvt_pk_bf16_f32 v47, v38, v39
    ds_write_b128 v116, v[44:47] offset:16384
    v_cvt_pk_bf16_f32 v48, v40, v41
    ds_write_b64 v116, v[48:49] offset:17408
    s_waitcnt lgkmcnt(0)
    s_barrier
    v_mfma_f32_32x32x16_bf16 v[0:15], v[88:91], v[88:91], 0
    v_mfma_f32_32x32x16_bf16 v[16:31], v[88:91], v[88:91], 0
    v_add_u32 v122, 32768, v107
    s_add_u32 s76, s68, 1
    v_mov_b32 v123, 0
    v_mov_b32 v124, s76
    s_barrier
    ds_read_b128 v[40:43], v113 offset:0
    ds_read_b128 v[44:47], v113 offset:128
    s_waitcnt lgkmcnt(1)
    s_nop 0
    v_smfmac_f32_16x16x64_bf16 v[0:3], v[40:43], v[128:135], v104
    v_smfmac_f32_16x16x64_bf16 v[4:7], v[40:43], v[144:151], v104
    s_waitcnt lgkmcnt(0)
    v_smfmac_f32_16x16x64_bf16 v[0:3], v[44:47], v[136:143], v104
    v_smfmac_f32_16x16x64_bf16 v[4:7], v[44:47], v[152:159], v104
    v_smfmac_f32_16x16x64_bf16 v[8:11], v[40:43], v[160:167], v104
    v_smfmac_f32_16x16x64_bf16 v[12:15], v[40:43], v[176:183], v104
    s_nop 4
    v_add_f32 v0, v0, v2
    v_add_f32 v1, v1, v3
    v_smfmac_f32_16x16x64_bf16 v[8:11], v[44:47], v[168:175], v104
    v_cvt_pk_bf16_f32 v32, v0, v1
    v_add_f32 v4, v4, v6
    v_smfmac_f32_16x16x64_bf16 v[12:15], v[44:47], v[184:191], v104
    v_add_f32 v5, v5, v7
    v_cvt_pk_bf16_f32 v33, v4, v5
    v_smfmac_f32_16x16x64_bf16 v[16:19], v[40:43], v[192:199], v104
    v_smfmac_f32_16x16x64_bf16 v[20:23], v[40:43], v[208:215], v104
    s_nop 0
    v_add_f32 v8, v8, v10
    v_add_f32 v9, v9, v11
    v_smfmac_f32_16x16x64_bf16 v[16:19], v[44:47], v[200:207], v104
    v_cvt_pk_bf16_f32 v34, v8, v9
    v_add_f32 v12, v12, v14
    v_smfmac_f32_16x16x64_bf16 v[20:23], v[44:47], v[216:223], v104
    v_add_f32 v13, v13, v15
    v_cvt_pk_bf16_f32 v35, v12, v13
    v_smfmac_f32_16x16x64_bf16 v[24:27], v[40:43], v[224:231], v104
    global_store_dwordx4 v107, v[32:35], s[44:45]
    global_store_dword v123, v124, s[8:9]
    v_smfmac_f32_16x16x64_bf16 v[28:31], v[40:43], v[240:247], v104
    v_add_f32 v16, v16, v18
    v_add_f32 v17, v17, v19
    v_smfmac_f32_16x16x64_bf16 v[24:27], v[44:47], v[232:239], v104
    v_cvt_pk_bf16_f32 v36, v16, v17
    v_add_f32 v20, v20, v22
    v_smfmac_f32_16x16x64_bf16 v[28:31], v[44:47], v[248:255], v104
    v_add_f32 v21, v21, v23
    v_cvt_pk_bf16_f32 v37, v20, v21
    s_nop 2
    v_pk_add_f32 v[24:25], v[24:25], v[26:27]
    s_nop 1
    v_pk_add_f32 v[28:29], v[28:29], v[30:31]
    v_cvt_pk_bf16_f32 v38, v24, v25
    v_cvt_pk_bf16_f32 v39, v28, v29
    global_store_dwordx4 v122, v[36:39], s[44:45]
    global_store_dword v123, v124, s[8:9] offset:128
    v_lshrrev_b32 v126, 2, v105
    v_and_b32 v126, 127, v126
    global_load_dword v127, v126, s[10:11] sc1
    v_cndmask_b32 v48, 0, v120, s[52:53]
    v_cndmask_b32 v49, 0, v120, s[54:55]
    v_cndmask_b32 v50, 0, v120, s[56:57]
    v_cndmask_b32 v51, 0, v120, s[58:59]
    v_add_u32 v123, 8192, v118
    v_add_u32 v124, 16384, v118
    v_add_u32 v125, 24576, v118
    v_mov_b64 v[32:33], 0
    v_mov_b64 v[34:35], 0
    v_mov_b64 v[36:37], 0
    v_mov_b64 v[38:39], 0
    v_mov_b64 v[52:53], 0
    v_mov_b64 v[54:55], 0
    s_mov_b64 s[70:71], s[60:61]
    s_mov_b64 s[60:61], s[62:63]
    s_mov_b64 s[62:63], s[64:65]
    s_mov_b64 s[64:65], s[66:67]
    s_mov_b64 s[66:67], s[70:71]
    s_add_u32 s86, s86, 65536
    s_addc_u32 s87, s87, 0
c_light_84:
    s_waitcnt vmcnt(0)
    v_cmp_eq_u32 vcc, s76, v127
    global_load_dword v127, v126, s[10:11] sc1
    s_bcnt1_i32_b32 s70, vcc_lo
    s_cmp_lt_u32 s70, 1
    s_cbranch_scc1 c_retry_86
c_pollp_81:
    global_load_dwordx4 v[0:3], v118, s[44:45] sc1
    global_load_dwordx4 v[4:7], v118, s[48:49] sc1
    global_load_dwordx4 v[8:11], v123, s[44:45] sc1
    global_load_dwordx4 v[12:15], v123, s[48:49] sc1
    global_load_dwordx4 v[16:19], v124, s[44:45] sc1
    global_load_dwordx4 v[20:23], v124, s[48:49] sc1
    global_load_dwordx4 v[24:27], v125, s[44:45] sc1
    global_load_dwordx4 v[28:31], v125, s[48:49] sc1
    s_waitcnt vmcnt(8)
    v_cmp_ne_u32 vcc, s76, v127
    s_cbranch_vccnz c_re_87
    s_waitcnt vmcnt(7)
    v_mfma_f32_16x16x32_bf16 v[40:43], v[0:3], v[48:51], 0
    s_waitcnt vmcnt(6)
    v_mfma_f32_16x16x32_bf16 v[40:43], v[4:7], v[48:51], v[40:43]
    s_waitcnt vmcnt(5)
    v_mfma_f32_16x16x32_bf16 v[40:43], v[8:11], v[48:51], v[40:43]
    s_waitcnt vmcnt(4)
    v_mfma_f32_16x16x32_bf16 v[40:43], v[12:15], v[48:51], v[40:43]
    s_waitcnt vmcnt(3)
    v_mfma_f32_16x16x32_bf16 v[40:43], v[16:19], v[48:51], v[40:43]
    s_waitcnt vmcnt(2)
    v_mfma_f32_16x16x32_bf16 v[40:43], v[20:23], v[48:51], v[40:43]
    s_waitcnt vmcnt(1)
    v_mfma_f32_16x16x32_bf16 v[40:43], v[24:27], v[48:51], v[40:43]
    s_waitcnt vmcnt(0)
    v_mfma_f32_16x16x32_bf16 v[40:43], v[28:31], v[48:51], v[40:43]
    s_mov_b64 exec, s[42:43]
    s_nop 6
    v_pk_add_f32 v[44:45], v[40:41], v[42:43]
    v_cmp_u_f32 vcc, v44, v45
    v_cvt_pk_bf16_f32 v40, v40, v41
    v_cvt_pk_bf16_f32 v41, v42, v43
    v_min_u32 v40, -2, v40
    v_min_u32 v41, -2, v41
    s_cbranch_vccnz c_slow_82
c_ok_83:
    global_store_dwordx2 v108, v[40:41], s[60:61]
    s_barrier
    v_mov_b64 v[42:43], -1
    global_store_dwordx2 v108, v[42:43], s[64:65]
    s_mov_b64 exec, -1
    global_load_dwordx4 v[0:3], v106, s[60:61] sc1
    global_load_dwordx4 v[16:19], v106, s[60:61] offset:1024 sc1
    v_mov_b64 v[40:41], 0
    v_mov_b64 v[42:43], 0
    v_mov_b64 v[44:45], 0
    v_mov_b64 v[46:47], 0
    v_mov_b64 v[48:49], 0
    v_mov_b64 v[50:51], 0
    s_add_u32 s68, s68, 1
    s_nop 0
c_chk1_89:
    s_waitcnt vmcnt(1)
    v_max3_u32 v122, v0, v1, v2
    s_waitcnt vmcnt(0)
    v_max3_u32 v123, v3, v16, v17
    v_max3_u32 v122, v122, v18, v19
    v_max_u32 v122, v122, v123
    v_cmp_eq_u32 vcc, -1, v122
    ds_write_b128 v117, v[0:3]
    ds_write_b128 v117, v[16:19] offset:4096
    s_cbranch_vccnz c_retry_90
    v_smfmac_f32_16x16x64_bf16 v[32:35], v[0:3], a[0:7], v104
    v_smfmac_f32_16x16x64_bf16 v[36:39], v[0:3], a[64:71], v104
    v_smfmac_f32_16x16x64_bf16 v[32:35], v[16:19], a[32:39], v104
    s_waitcnt lgkmcnt(0)
    s_barrier
    ds_read_b128 v[4:7], v116 offset:17408
    ds_read_b128 v[8:11], v116 offset:18432
    v_smfmac_f32_16x16x64_bf16 v[36:39], v[16:19], a[96:103], v104
    ds_read_b128 v[12:15], v116 offset:19456
    v_smfmac_f32_16x16x64_bf16 v[40:43], v[0:3], a[128:135], v104
    ds_read_b128 v[20:23], v116 offset:21504
    v_smfmac_f32_16x16x64_bf16 v[44:47], v[0:3], a[192:199], v104
    ds_read_b128 v[24:27], v116 offset:22528
    v_smfmac_f32_16x16x64_bf16 v[40:43], v[16:19], a[160:167], v104
    ds_read_b128 v[28:31], v116 offset:23552
    s_waitcnt lgkmcnt(5)
    v_smfmac_f32_16x16x64_bf16 v[32:35], v[4:7], a[8:15], v104
    v_mov_b32 v124, 2139193217
    v_smfmac_f32_16x16x64_bf16 v[36:39], v[4:7], a[72:79], v104
    v_mov_b32 v125, 2139193217
    s_waitcnt lgkmcnt(4)
    v_smfmac_f32_16x16x64_bf16 v[32:35], v[8:11], a[16:23], v104
    v_mov_b32 v126, 2139193217
    v_smfmac_f32_16x16x64_bf16 v[36:39], v[8:11], a[80:87], v104
    v_mov_b32 v127, 2139193217
    s_waitcnt lgkmcnt(3)
    v_smfmac_f32_16x16x64_bf16 v[32:35], v[12:15], a[24:31], v104
    global_store_dwordx4 v118, v[124:127], s[44:45]
    v_smfmac_f32_16x16x64_bf16 v[36:39], v[12:15], a[88:95], v104
    global_store_dwordx4 v118, v[124:127], s[48:49]
    s_waitcnt lgkmcnt(2)
    v_smfmac_f32_16x16x64_bf16 v[32:35], v[20:23], a[40:47], v104
    v_add_u32 v122, 8192, v118
    v_smfmac_f32_16x16x64_bf16 v[36:39], v[20:23], a[104:111], v104
    global_store_dwordx4 v122, v[124:127], s[44:45]
    s_waitcnt lgkmcnt(1)
    v_smfmac_f32_16x16x64_bf16 v[32:35], v[24:27], a[48:55], v104
    global_store_dwordx4 v122, v[124:127], s[48:49]
    v_smfmac_f32_16x16x64_bf16 v[36:39], v[24:27], a[112:119], v104
    v_add_u32 v122, 16384, v118
    s_waitcnt lgkmcnt(0)
    v_smfmac_f32_16x16x64_bf16 v[32:35], v[28:31], a[56:63], v104
    global_store_dwordx4 v122, v[124:127], s[44:45]
    v_smfmac_f32_16x16x64_bf16 v[36:39], v[28:31], a[120:127], v104
    global_store_dwordx4 v122, v[124:127], s[48:49]
    v_add_u32 v122, 24576, v118
    global_store_dwordx4 v122, v[124:127], s[44:45]
    global_store_dwordx4 v122, v[124:127], s[48:49]
    v_smfmac_f32_16x16x64_bf16 v[44:47], v[16:19], a[224:231], v104
    v_smfmac_f32_16x16x64_bf16 v[40:43], v[4:7], a[136:143], v104
    v_smfmac_f32_16x16x64_bf16 v[44:47], v[4:7], a[200:207], v104
    v_add_f32 v32, v32, v34
    v_add_f32 v33, v33, v35
    v_smfmac_f32_16x16x64_bf16 v[40:43], v[8:11], a[144:151], v104
    v_add_f32 v36, v36, v38
    v_add_f32 v37, v37, v39
    v_smfmac_f32_16x16x64_bf16 v[44:47], v[8:11], a[208:215], v104
    v_cvt_pk_bf16_f32 v32, v32, v36
    v_cvt_pk_bf16_f32 v33, v33, v37
    v_smfmac_f32_16x16x64_bf16 v[40:43], v[12:15], a[152:159], v104
    ds_write2_b32 v109, v32, v33 offset0:0 offset1:72
    v_smfmac_f32_16x16x64_bf16 v[44:47], v[12:15], a[216:223], v104
    v_smfmac_f32_16x16x64_bf16 v[40:43], v[20:23], a[168:175], v104
    s_waitcnt lgkmcnt(0)
    s_barrier
    ds_read_b128 v[56:59], v110 offset:0
    ds_read_b128 v[72:75], v116 offset:0
    v_smfmac_f32_16x16x64_bf16 v[44:47], v[20:23], a[232:239], v104
    ds_read_b128 v[60:63], v110 offset:64
    ds_read_b128 v[76:79], v116 offset:1024
    v_smfmac_f32_16x16x64_bf16 v[40:43], v[24:27], a[176:183], v104
    ds_read_b128 v[64:67], v110 offset:128
    ds_read_b128 v[80:83], v116 offset:2048
    v_smfmac_f32_16x16x64_bf16 v[44:47], v[24:27], a[240:247], v104
    ds_read_b128 v[68:71], v110 offset:192
    ds_read_b128 v[84:87], v116 offset:3072
    v_smfmac_f32_16x16x64_bf16 v[40:43], v[28:31], a[184:191], v104
    ds_read_b128 v[88:91], v116 offset:4096
    ds_read_b128 v[92:95], v116 offset:5120
    v_smfmac_f32_16x16x64_bf16 v[44:47], v[28:31], a[248:255], v104
    ds_read_b128 v[96:99], v116 offset:6144
    ds_read_b128 v[100:103], v116 offset:7168
    s_waitcnt lgkmcnt(8)
    v_mfma_f32_16x16x32_bf16 v[32:35], v[72:75], v[56:59], 0
    v_mfma_f32_16x16x32_bf16 v[32:35], v[76:79], v[60:63], v[32:35]
    s_waitcnt lgkmcnt(4)
    v_mfma_f32_16x16x32_bf16 v[32:35], v[80:83], v[64:67], v[32:35]
    v_add_f32 v40, v40, v42
    v_add_f32 v41, v41, v43
    v_mfma_f32_16x16x32_bf16 v[32:35], v[84:87], v[68:71], v[32:35]
    v_add_f32 v44, v44, v46
    v_add_f32 v45, v45, v47
    s_waitcnt lgkmcnt(2)
    v_mfma_f32_16x16x32_bf16 v[36:39], v[88:91], v[56:59], 0
    v_cvt_pk_bf16_f32 v40, v40, v44
    v_cvt_pk_bf16_f32 v41, v41, v45
    v_mfma_f32_16x16x32_bf16 v[36:39], v[92:95], v[60:63], v[36:39]
    ds_write_b32 v109, v40 offset:2304
    ds_write_b32 v109, v41 offset:2592
    s_waitcnt lgkmcnt(2)
    v_mfma_f32_16x16x32_bf16 v[36:39], v[96:99], v[64:67], v[36:39]
    v_mfma_f32_16x16x32_bf16 v[36:39], v[100:103], v[68:71], v[36:39]
    s_waitcnt lgkmcnt(0)
    s_barrier
    ds_read_b128 v[72:75], v111 offset:0
    ds_read_b128 v[76:79], v111 offset:64
    ds_read_b128 v[80:83], v111 offset:128
    ds_read_b128 v[84:87], v111 offset:192
    s_cmp_eq_u32 s68, 63
    s_cbranch_scc1 c_end_74
    v_max3_f32 v122, v32, v33, v34
    v_max3_f32 v122, v122, v35, v36
    v_max3_f32 v122, v122, v37, v38
    v_max_f32 v122, v122, v39
    v_mov_b32 v123, v122
    s_waitcnt lgkmcnt(2)
    v_mfma_f32_16x16x32_bf16 v[40:43], v[72:75], v[56:59], 0
    v_permlane32_swap_b32 v123, v122
    v_mfma_f32_16x16x32_bf16 v[40:43], v[76:79], v[60:63], v[40:43]
    v_max_f32 v122, v123, v122
    v_mov_b32 v123, v122
    s_waitcnt lgkmcnt(0)
    v_mfma_f32_16x16x32_bf16 v[40:43], v[80:83], v[64:67], v[40:43]
    v_permlane16_swap_b32 v123, v122
    v_mfma_f32_16x16x32_bf16 v[40:43], v[84:87], v[68:71], v[40:43]
    v_max_f32 v122, v123, v122
    v_mul_f32 v124, s88, v122
    v_pk_fma_f32 v[32:33], v[32:33], s[88:89], v[124:125] op_sel_hi:[1,1,0] neg_lo:[0,0,1] neg_hi:[0,0,1]
    v_pk_fma_f32 v[34:35], v[34:35], s[88:89], v[124:125] op_sel_hi:[1,1,0] neg_lo:[0,0,1] neg_hi:[0,0,1]
    v_pk_fma_f32 v[36:37], v[36:37], s[88:89], v[124:125] op_sel_hi:[1,1,0] neg_lo:[0,0,1] neg_hi:[0,0,1]
    v_pk_fma_f32 v[38:39], v[38:39], s[88:89], v[124:125] op_sel_hi:[1,1,0] neg_lo:[0,0,1] neg_hi:[0,0,1]
    s_nop 1
    v_pk_fma_f32 v[40:41], v[40:41], s[88:89], v[124:125] op_sel_hi:[1,1,0] neg_lo:[0,0,1] neg_hi:[0,0,1]
    v_max_f32 v123, v40, v41
    v_cmp_lt_f32 vcc, 0x42800000, v123
    v_exp_f32 v32, v32
    v_exp_f32 v33, v33
    v_exp_f32 v34, v34
    v_exp_f32 v35, v35
    v_exp_f32 v36, v36
    v_exp_f32 v37, v37
    v_exp_f32 v38, v38
    v_exp_f32 v39, v39
    s_cbranch_vccnz c_fb_91
c_fr_92:
    v_exp_f32 v40, v40
    v_exp_f32 v41, v41
    v_pk_add_f32 v[126:127], v[32:33], v[34:35]
    v_pk_add_f32 v[124:125], v[36:37], v[38:39]
    v_pk_add_f32 v[126:127], v[126:127], v[124:125]
    v_pk_add_f32 v[126:127], v[126:127], v[40:41]
    v_add_f32 v126, v126, v127
    v_mov_b32 v123, v126
    v_mov_b64 v[88:89], 0
    s_nop 0
    v_permlane32_swap_b32 v123, v126
    v_add_f32 v126, v123, v126
    v_mov_b32 v123, v126
    v_mov_b64 v[90:91], 0
    s_nop 0
    v_permlane16_swap_b32 v123, v126
    v_add_f32 v126, v123, v126
    v_rcp_f32 v126, v126
    s_nop 0
    v_pk_mul_f32 v[32:33], v[32:33], v[126:127] op_sel_hi:[1,0]
    v_pk_mul_f32 v[34:35], v[34:35], v[126:127] op_sel_hi:[1,0]
    v_pk_mul_f32 v[36:37], v[36:37], v[126:127] op_sel_hi:[1,0]
    v_pk_mul_f32 v[38:39], v[38:39], v[126:127] op_sel_hi:[1,0]
    v_pk_mul_f32 v[40:41], v[40:41], v[126:127] op_sel_hi:[1,0]
    v_cvt_pk_bf16_f32 v44, v32, v33
    v_cvt_pk_bf16_f32 v45, v34, v35
    v_cvt_pk_bf16_f32 v46, v36, v37
    v_cvt_pk_bf16_f32 v47, v38, v39
    ds_write_b128 v116, v[44:47] offset:16384
    v_cvt_pk_bf16_f32 v48, v40, v41
    ds_write_b64 v116, v[48:49] offset:17408
    s_waitcnt lgkmcnt(0)
    s_barrier
    v_mfma_f32_32x32x16_bf16 v[0:15], v[88:91], v[88:91], 0
    v_mfma_f32_32x32x16_bf16 v[16:31], v[88:91], v[88:91], 0
    v_add_u32 v122, 32768, v107
    s_add_u32 s76, s68, 1
    v_mov_b32 v123, 0
    v_mov_b32 v124, s76
    s_barrier
    ds_read_b128 v[40:43], v113 offset:0
    ds_read_b128 v[44:47], v113 offset:128
    s_waitcnt lgkmcnt(1)
    s_nop 0
    v_smfmac_f32_16x16x64_bf16 v[0:3], v[40:43], v[128:135], v104
    v_smfmac_f32_16x16x64_bf16 v[4:7], v[40:43], v[144:151], v104
    s_waitcnt lgkmcnt(0)
    v_smfmac_f32_16x16x64_bf16 v[0:3], v[44:47], v[136:143], v104
    v_smfmac_f32_16x16x64_bf16 v[4:7], v[44:47], v[152:159], v104
    v_smfmac_f32_16x16x64_bf16 v[8:11], v[40:43], v[160:167], v104
    v_smfmac_f32_16x16x64_bf16 v[12:15], v[40:43], v[176:183], v104
    s_nop 4
    v_add_f32 v0, v0, v2
    v_add_f32 v1, v1, v3
    v_smfmac_f32_16x16x64_bf16 v[8:11], v[44:47], v[168:175], v104
    v_cvt_pk_bf16_f32 v32, v0, v1
    v_add_f32 v4, v4, v6
    v_smfmac_f32_16x16x64_bf16 v[12:15], v[44:47], v[184:191], v104
    v_add_f32 v5, v5, v7
    v_cvt_pk_bf16_f32 v33, v4, v5
    v_smfmac_f32_16x16x64_bf16 v[16:19], v[40:43], v[192:199], v104
    v_smfmac_f32_16x16x64_bf16 v[20:23], v[40:43], v[208:215], v104
    s_nop 0
    v_add_f32 v8, v8, v10
    v_add_f32 v9, v9, v11
    v_smfmac_f32_16x16x64_bf16 v[16:19], v[44:47], v[200:207], v104
    v_cvt_pk_bf16_f32 v34, v8, v9
    v_add_f32 v12, v12, v14
    v_smfmac_f32_16x16x64_bf16 v[20:23], v[44:47], v[216:223], v104
    v_add_f32 v13, v13, v15
    v_cvt_pk_bf16_f32 v35, v12, v13
    v_smfmac_f32_16x16x64_bf16 v[24:27], v[40:43], v[224:231], v104
    global_store_dwordx4 v107, v[32:35], s[46:47]
    global_store_dword v123, v124, s[8:9]
    v_smfmac_f32_16x16x64_bf16 v[28:31], v[40:43], v[240:247], v104
    v_add_f32 v16, v16, v18
    v_add_f32 v17, v17, v19
    v_smfmac_f32_16x16x64_bf16 v[24:27], v[44:47], v[232:239], v104
    v_cvt_pk_bf16_f32 v36, v16, v17
    v_add_f32 v20, v20, v22
    v_smfmac_f32_16x16x64_bf16 v[28:31], v[44:47], v[248:255], v104
    v_add_f32 v21, v21, v23
    v_cvt_pk_bf16_f32 v37, v20, v21
    s_nop 2
    v_pk_add_f32 v[24:25], v[24:25], v[26:27]
    s_nop 1
    v_pk_add_f32 v[28:29], v[28:29], v[30:31]
    v_cvt_pk_bf16_f32 v38, v24, v25
    v_cvt_pk_bf16_f32 v39, v28, v29
    global_store_dwordx4 v122, v[36:39], s[46:47]
    global_store_dword v123, v124, s[8:9] offset:128
    v_lshrrev_b32 v126, 2, v105
    v_and_b32 v126, 127, v126
    global_load_dword v127, v126, s[10:11] sc1
    v_cndmask_b32 v48, 0, v120, s[52:53]
    v_cndmask_b32 v49, 0, v120, s[54:55]
    v_cndmask_b32 v50, 0, v120, s[56:57]
    v_cndmask_b32 v51, 0, v120, s[58:59]
    v_add_u32 v123, 8192, v118
    v_add_u32 v124, 16384, v118
    v_add_u32 v125, 24576, v118
    v_mov_b64 v[32:33], 0
    v_mov_b64 v[34:35], 0
    v_mov_b64 v[36:37], 0
    v_mov_b64 v[38:39], 0
    v_mov_b64 v[52:53], 0
    v_mov_b64 v[54:55], 0
    s_mov_b64 s[70:71], s[60:61]
    s_mov_b64 s[60:61], s[62:63]
    s_mov_b64 s[62:63], s[64:65]
    s_mov_b64 s[64:65], s[66:67]
    s_mov_b64 s[66:67], s[70:71]
    s_add_u32 s86, s86, 65536
    s_addc_u32 s87, s87, 0
c_light_96:
    s_waitcnt vmcnt(0)
    v_cmp_eq_u32 vcc, s76, v127
    global_load_dword v127, v126, s[10:11] sc1
    s_bcnt1_i32_b32 s70, vcc_lo
    s_cmp_lt_u32 s70, 1
    s_cbranch_scc1 c_retry_98
c_pollp_93:
    global_load_dwordx4 v[0:3], v118, s[46:47] sc1
    global_load_dwordx4 v[4:7], v118, s[50:51] sc1
    global_load_dwordx4 v[8:11], v123, s[46:47] sc1
    global_load_dwordx4 v[12:15], v123, s[50:51] sc1
    global_load_dwordx4 v[16:19], v124, s[46:47] sc1
    global_load_dwordx4 v[20:23], v124, s[50:51] sc1
    global_load_dwordx4 v[24:27], v125, s[46:47] sc1
    global_load_dwordx4 v[28:31], v125, s[50:51] sc1
    s_waitcnt vmcnt(8)
    v_cmp_ne_u32 vcc, s76, v127
    s_cbranch_vccnz c_re_99
    s_waitcnt vmcnt(7)
    v_mfma_f32_16x16x32_bf16 v[40:43], v[0:3], v[48:51], 0
    s_waitcnt vmcnt(6)
    v_mfma_f32_16x16x32_bf16 v[40:43], v[4:7], v[48:51], v[40:43]
    s_waitcnt vmcnt(5)
    v_mfma_f32_16x16x32_bf16 v[40:43], v[8:11], v[48:51], v[40:43]
    s_waitcnt vmcnt(4)
    v_mfma_f32_16x16x32_bf16 v[40:43], v[12:15], v[48:51], v[40:43]
    s_waitcnt vmcnt(3)
    v_mfma_f32_16x16x32_bf16 v[40:43], v[16:19], v[48:51], v[40:43]
    s_waitcnt vmcnt(2)
    v_mfma_f32_16x16x32_bf16 v[40:43], v[20:23], v[48:51], v[40:43]
    s_waitcnt vmcnt(1)
    v_mfma_f32_16x16x32_bf16 v[40:43], v[24:27], v[48:51], v[40:43]
    s_waitcnt vmcnt(0)
    v_mfma_f32_16x16x32_bf16 v[40:43], v[28:31], v[48:51], v[40:43]
    s_mov_b64 exec, s[42:43]
    s_nop 6
    v_pk_add_f32 v[44:45], v[40:41], v[42:43]
    v_cmp_u_f32 vcc, v44, v45
    v_cvt_pk_bf16_f32 v40, v40, v41
    v_cvt_pk_bf16_f32 v41, v42, v43
    v_min_u32 v40, -2, v40
    v_min_u32 v41, -2, v41
    s_cbranch_vccnz c_slow_94
c_ok_95:
    global_store_dwordx2 v108, v[40:41], s[60:61]
    s_barrier
    v_mov_b64 v[42:43], -1
    global_store_dwordx2 v108, v[42:43], s[64:65]
    s_mov_b64 exec, -1
    global_load_dwordx4 v[0:3], v106, s[60:61] sc1
    global_load_dwordx4 v[16:19], v106, s[60:61] offset:1024 sc1
    v_mov_b64 v[40:41], 0
    v_mov_b64 v[42:43], 0
    v_mov_b64 v[44:45], 0
    v_mov_b64 v[46:47], 0
    v_mov_b64 v[48:49], 0
    v_mov_b64 v[50:51], 0
    s_add_u32 s68, s68, 1
    s_nop 0
    s_branch c_chk0_76
c_w1_71:
    v_mov_b64 v[32:33], 0
    v_mov_b64 v[34:35], 0
    v_mov_b64 v[36:37], 0
    v_mov_b64 v[38:39], 0
    v_mov_b64 v[40:41], 0
    v_mov_b64 v[42:43], 0
    v_mov_b64 v[44:45], 0
    v_mov_b64 v[46:47], 0
    v_mov_b64 v[48:49], 0
    v_mov_b64 v[50:51], 0
    v_mov_b64 v[52:53], 0
    v_mov_b64 v[54:55], 0
    ds_read_b128 v[56:59], v114 offset:16384
    ds_read_b128 v[60:63], v114 offset:17408
    ds_read_b128 v[64:67], v114 offset:18432
    ds_read_b128 v[68:71], v114 offset:19456
    ds_read_b128 v[72:75], v114 offset:20480
    ds_read_b128 v[76:79], v114 offset:21504
    ds_read_b128 v[80:83], v115 offset:16384
    ds_read_b128 v[84:87], v115 offset:17408
    ds_read_b128 v[88:91], v115 offset:18432
    ds_read_b128 v[92:95], v115 offset:19456
    v_mov_b64 v[100:101], 0
    v_mov_b64 v[102:103], 0
    s_waitcnt lgkmcnt(0)
    global_load_dwordx4 v[4:7], v106, s[60:61] sc1
    global_load_dwordx4 v[20:23], v106, s[60:61] offset:1024 sc1
c_loop_100:
    s_branch c_chk0_101
c_pollm_102:
    global_load_dwordx4 v[4:7], v106, s[60:61] sc1
    global_load_dwordx4 v[20:23], v106, s[60:61] offset:1024 sc1
c_chk0_101:
    s_waitcnt vmcnt(1)
    v_max3_u32 v122, v4, v5, v6
    s_waitcnt vmcnt(0)
    v_max3_u32 v123, v7, v20, v21
    v_max3_u32 v122, v122, v22, v23
    v_max_u32 v122, v122, v123
    v_cmp_eq_u32 vcc, -1, v122
    ds_write_b128 v117, v[4:7]
    ds_write_b128 v117, v[20:23] offset:4096
    s_cbranch_vccnz c_retry_103
    v_smfmac_f32_16x16x64_bf16 v[32:35], v[4:7], a[8:15], v104
    v_smfmac_f32_16x16x64_bf16 v[36:39], v[4:7], a[72:79], v104
    v_smfmac_f32_16x16x64_bf16 v[32:35], v[20:23], a[40:47], v104
    s_waitcnt lgkmcnt(0)
    s_barrier
    ds_read_b128 v[0:3], v116 offset:16384
    ds_read_b128 v[8:11], v116 offset:18432
    v_smfmac_f32_16x16x64_bf16 v[36:39], v[20:23], a[104:111], v104
    ds_read_b128 v[12:15], v116 offset:19456
    v_smfmac_f32_16x16x64_bf16 v[40:43], v[4:7], a[136:143], v104
    ds_read_b128 v[16:19], v116 offset:20480
    global_store_dwordx4 v105, v[24:27], s[84:85] sc1
    global_store_dwordx4 v105, v[28:31], s[84:85] offset:1024 sc1
    v_smfmac_f32_16x16x64_bf16 v[44:47], v[4:7], a[200:207], v104
    ds_read_b128 v[24:27], v116 offset:22528
    v_smfmac_f32_16x16x64_bf16 v[40:43], v[20:23], a[168:175], v104
    ds_read_b128 v[28:31], v116 offset:23552
    s_waitcnt lgkmcnt(5)
    v_smfmac_f32_16x16x64_bf16 v[32:35], v[0:3], a[0:7], v104
    global_store_dword v121, v110, s[86:87] offset:0 sc1
    v_smfmac_f32_16x16x64_bf16 v[36:39], v[0:3], a[64:71], v104
    global_store_dword v121, v111, s[86:87] offset:256 sc1
    s_waitcnt lgkmcnt(4)
    v_smfmac_f32_16x16x64_bf16 v[32:35], v[8:11], a[16:23], v104
    global_store_dword v121, v119, s[86:87] offset:512 sc1
    v_smfmac_f32_16x16x64_bf16 v[36:39], v[8:11], a[80:87], v104
    s_sub_u32 s70, s68, 1
    s_waitcnt lgkmcnt(3)
    v_smfmac_f32_16x16x64_bf16 v[32:35], v[12:15], a[24:31], v104
    s_max_i32 s70, s70, 0
    v_smfmac_f32_16x16x64_bf16 v[36:39], v[12:15], a[88:95], v104
    v_mov_b32 v122, s100
    s_waitcnt lgkmcnt(2)
    v_smfmac_f32_16x16x64_bf16 v[32:35], v[16:19], a[32:39], v104
    v_mov_b32 v123, s70
    v_smfmac_f32_16x16x64_bf16 v[36:39], v[16:19], a[96:103], v104
    global_store_dword v122, v123, s[4:5] sc1
    s_waitcnt lgkmcnt(1)
    v_smfmac_f32_16x16x64_bf16 v[32:35], v[24:27], a[48:55], v104
    v_smfmac_f32_16x16x64_bf16 v[36:39], v[24:27], a[112:119], v104
    s_waitcnt lgkmcnt(0)
    v_smfmac_f32_16x16x64_bf16 v[32:35], v[28:31], a[56:63], v104
    v_smfmac_f32_16x16x64_bf16 v[36:39], v[28:31], a[120:127], v104
    v_smfmac_f32_16x16x64_bf16 v[44:47], v[20:23], a[232:239], v104
    v_smfmac_f32_16x16x64_bf16 v[40:43], v[0:3], a[128:135], v104
    v_smfmac_f32_16x16x64_bf16 v[44:47], v[0:3], a[192:199], v104
    s_nop 3
    v_add_f32 v32, v32, v34
    v_add_f32 v33, v33, v35
    v_smfmac_f32_16x16x64_bf16 v[40:43], v[8:11], a[144:151], v104
    v_add_f32 v36, v36, v38
    v_add_f32 v37, v37, v39
    v_smfmac_f32_16x16x64_bf16 v[44:47], v[8:11], a[208:215], v104
    v_cvt_pk_bf16_f32 v32, v32, v36
    v_cvt_pk_bf16_f32 v33, v33, v37
    v_smfmac_f32_16x16x64_bf16 v[40:43], v[12:15], a[152:159], v104
    ds_write2_b32 v109, v32, v33 offset0:0 offset1:72
    v_smfmac_f32_16x16x64_bf16 v[44:47], v[12:15], a[216:223], v104
    v_smfmac_f32_16x16x64_bf16 v[40:43], v[16:19], a[160:167], v104
    s_waitcnt lgkmcnt(0)
    s_barrier
    v_smfmac_f32_16x16x64_bf16 v[44:47], v[16:19], a[224:231], v104
    ds_read_b128 v[32:35], v116 offset:8192
    v_smfmac_f32_16x16x64_bf16 v[40:43], v[24:27], a[176:183], v104
    ds_read_b128 v[36:39], v116 offset:9216
    v_smfmac_f32_16x16x64_bf16 v[44:47], v[24:27], a[240:247], v104
    ds_read_b128 v[96:99], v116 offset:10240
    v_smfmac_f32_16x16x64_bf16 v[40:43], v[28:31], a[184:191], v104
    v_smfmac_f32_16x16x64_bf16 v[44:47], v[28:31], a[248:255], v104
    v_smfmac_f32_16x16x64_bf16 v[48:51], v[4:7], v[56:63], v104
    ds_read_b128 v[56:59], v115 offset:20480
    ds_read_b128 v[60:63], v115 offset:21504
    v_smfmac_f32_16x16x64_bf16 v[52:55], v[4:7], v[64:71], v104
    ds_read_b128 v[64:67], v114 offset:0
    ds_read_b128 v[68:71], v114 offset:1024
    s_nop 0
    v_add_f32 v40, v40, v42
    v_add_f32 v41, v41, v43
    v_add_f32 v44, v44, v46
    v_add_f32 v45, v45, v47
    v_cvt_pk_bf16_f32 v40, v40, v44
    v_cvt_pk_bf16_f32 v41, v41, v45
    ds_write_b32 v109, v40 offset:2304
    ds_write_b32 v109, v41 offset:2592
    v_smfmac_f32_16x16x64_bf16 v[100:103], v[4:7], v[72:79], v104
    ds_read_b128 v[72:75], v114 offset:2048
    ds_read_b128 v[76:79], v114 offset:3072
    v_smfmac_f32_16x16x64_bf16 v[48:51], v[20:23], v[80:87], v104
    ds_read_b128 v[80:83], v114 offset:4096
    ds_read_b128 v[84:87], v114 offset:5120
    v_smfmac_f32_16x16x64_bf16 v[52:55], v[20:23], v[88:95], v104
    ds_read_b128 v[88:91], v114 offset:32768
    ds_read_b128 v[92:95], v114 offset:33792
    s_waitcnt lgkmcnt(6)
    s_barrier
    v_smfmac_f32_16x16x64_bf16 v[100:103], v[20:23], v[56:63], v104
    ds_read_b128 v[56:59], v114 offset:34816
    ds_read_b128 v[60:63], v114 offset:35840
    v_smfmac_f32_16x16x64_bf16 v[48:51], v[0:3], v[64:71], v104
    ds_read_b128 v[64:67], v114 offset:36864
    ds_read_b128 v[68:71], v114 offset:37888
    s_waitcnt lgkmcnt(8)
    v_smfmac_f32_16x16x64_bf16 v[52:55], v[0:3], v[72:79], v104
    ds_read_b128 v[72:75], v114 offset:49152
    ds_read_b128 v[76:79], v114 offset:50176
    s_waitcnt lgkmcnt(8)
    v_smfmac_f32_16x16x64_bf16 v[100:103], v[0:3], v[80:87], v104
    ds_read_b128 v[80:83], v114 offset:51200
    ds_read_b128 v[84:87], v114 offset:52224
    s_waitcnt lgkmcnt(8)
    v_smfmac_f32_16x16x64_bf16 v[48:51], v[8:11], v[88:95], v104
    ds_read_b128 v[88:91], v114 offset:53248
    ds_read_b128 v[92:95], v114 offset:54272
    s_waitcnt lgkmcnt(8)
    v_smfmac_f32_16x16x64_bf16 v[52:55], v[8:11], v[56:63], v104
    ds_read_b128 v[56:59], v115 offset:0
    ds_read_b128 v[60:63], v115 offset:1024
    s_waitcnt lgkmcnt(8)
    v_smfmac_f32_16x16x64_bf16 v[100:103], v[8:11], v[64:71], v104
    ds_read_b128 v[64:67], v115 offset:2048
    ds_read_b128 v[68:71], v115 offset:3072
    s_waitcnt lgkmcnt(8)
    v_smfmac_f32_16x16x64_bf16 v[48:51], v[12:15], v[72:79], v104
    ds_read_b128 v[72:75], v115 offset:4096
    ds_read_b128 v[76:79], v115 offset:5120
    s_waitcnt lgkmcnt(8)
    v_smfmac_f32_16x16x64_bf16 v[52:55], v[12:15], v[80:87], v104
    ds_read_b128 v[80:83], v115 offset:32768
    ds_read_b128 v[84:87], v115 offset:33792
    s_waitcnt lgkmcnt(8)
    v_smfmac_f32_16x16x64_bf16 v[100:103], v[12:15], v[88:95], v104
    ds_read_b128 v[88:91], v115 offset:34816
    ds_read_b128 v[92:95], v115 offset:35840
    s_waitcnt lgkmcnt(8)
    v_smfmac_f32_16x16x64_bf16 v[48:51], v[16:19], v[56:63], v104
    ds_read_b128 v[56:59], v115 offset:36864
    ds_read_b128 v[60:63], v115 offset:37888
    s_waitcnt lgkmcnt(8)
    v_smfmac_f32_16x16x64_bf16 v[52:55], v[16:19], v[64:71], v104
    ds_read_b128 v[64:67], v115 offset:49152
    ds_read_b128 v[68:71], v115 offset:50176
    s_waitcnt lgkmcnt(8)
    v_smfmac_f32_16x16x64_bf16 v[100:103], v[16:19], v[72:79], v104
    ds_read_b128 v[72:75], v115 offset:51200
    ds_read_b128 v[76:79], v115 offset:52224
    s_waitcnt lgkmcnt(8)
    v_smfmac_f32_16x16x64_bf16 v[48:51], v[24:27], v[80:87], v104
    ds_read_b128 v[80:83], v115 offset:53248
    ds_read_b128 v[84:87], v115 offset:54272
    s_waitcnt lgkmcnt(8)
    v_smfmac_f32_16x16x64_bf16 v[52:55], v[24:27], v[88:95], v104
    s_waitcnt lgkmcnt(6)
    v_smfmac_f32_16x16x64_bf16 v[100:103], v[24:27], v[56:63], v104
    s_waitcnt lgkmcnt(4)
    v_smfmac_f32_16x16x64_bf16 v[48:51], v[28:31], v[64:71], v104
    s_waitcnt lgkmcnt(2)
    v_smfmac_f32_16x16x64_bf16 v[52:55], v[28:31], v[72:79], v104
    s_waitcnt lgkmcnt(0)
    v_smfmac_f32_16x16x64_bf16 v[100:103], v[28:31], v[80:87], v104
    v_mov_b64 v[72:73], 0
    v_mov_b64 v[74:75], 0
    s_nop 1
    v_pk_add_f32 v[48:49], v[48:49], v[50:51]
    v_cvt_pk_bf16_f32 v48, v48, v49
    v_mov_b32 v49, 0
    v_pk_add_f32 v[52:53], v[52:53], v[54:55]
    v_cvt_pk_bf16_f32 v52, v52, v53
    v_mov_b32 v53, 0
    v_pk_add_f32 v[100:101], v[100:101], v[102:103]
    v_cvt_pk_bf16_f32 v100, v100, v101
    v_mov_b32 v101, 0
    v_mfma_f32_32x32x16_bf16 v[0:15], v[72:75], v[72:75], 0
    v_mfma_f32_32x32x16_bf16 v[16:31], v[72:75], v[72:75], 0
    v_mov_b32 v110, v48
    v_mov_b32 v111, v52
    v_mov_b32 v119, v100
    s_waitcnt lgkmcnt(0)
    s_barrier
    ds_read_b128 v[44:47], v116 offset:16384
    ds_read_b64 v[126:127], v116 offset:17408
    v_add_u32 v122, 32768, v107
    s_add_u32 s76, s68, 1
    v_mov_b32 v123, 0
    v_mov_b32 v124, s76
    s_waitcnt lgkmcnt(1)
    v_mfma_f32_16x16x32_bf16 v[56:59], v[32:35], v[44:47], 0
    v_mfma_f32_16x16x32_bf16 v[60:63], v[36:39], v[44:47], 0
    v_mfma_f32_16x16x32_bf16 v[64:67], v[96:99], v[44:47], 0
    s_waitcnt lgkmcnt(0)
    s_nop 2
    v_mfma_f32_16x16x16_bf16 v[56:59], v[48:49], v[126:127], v[56:59]
    v_mfma_f32_16x16x16_bf16 v[60:63], v[52:53], v[126:127], v[60:63]
    v_mfma_f32_16x16x16_bf16 v[64:67], v[100:101], v[126:127], v[64:67]
    s_nop 5
    v_cvt_pk_bf16_f32 v56, v56, v57
    v_cvt_pk_bf16_f32 v57, v58, v59
    ds_write_b64 v112, v[56:57] offset:0
    v_cvt_pk_bf16_f32 v60, v60, v61
    v_cvt_pk_bf16_f32 v61, v62, v63
    ds_write_b64 v112, v[60:61] offset:32
    v_cvt_pk_bf16_f32 v64, v64, v65
    v_cvt_pk_bf16_f32 v65, v66, v67
    ds_write_b64 v112, v[64:65] offset:64
    s_waitcnt lgkmcnt(0)
    s_barrier
    ds_read_b128 v[40:43], v113 offset:0
    ds_read_b128 v[44:47], v113 offset:128
    s_waitcnt lgkmcnt(1)
    v_smfmac_f32_16x16x64_bf16 v[0:3], v[40:43], v[128:135], v104
    v_smfmac_f32_16x16x64_bf16 v[4:7], v[40:43], v[144:151], v104
    s_waitcnt lgkmcnt(0)
    v_smfmac_f32_16x16x64_bf16 v[0:3], v[44:47], v[136:143], v104
    v_smfmac_f32_16x16x64_bf16 v[4:7], v[44:47], v[152:159], v104
    v_smfmac_f32_16x16x64_bf16 v[8:11], v[40:43], v[160:167], v104
    v_smfmac_f32_16x16x64_bf16 v[12:15], v[40:43], v[176:183], v104
    s_nop 4
    v_add_f32 v0, v0, v2
    v_add_f32 v1, v1, v3
    v_smfmac_f32_16x16x64_bf16 v[8:11], v[44:47], v[168:175], v104
    v_cvt_pk_bf16_f32 v32, v0, v1
    v_add_f32 v4, v4, v6
    v_smfmac_f32_16x16x64_bf16 v[12:15], v[44:47], v[184:191], v104
    v_add_f32 v5, v5, v7
    v_cvt_pk_bf16_f32 v33, v4, v5
    v_smfmac_f32_16x16x64_bf16 v[16:19], v[40:43], v[192:199], v104
    v_smfmac_f32_16x16x64_bf16 v[20:23], v[40:43], v[208:215], v104
    s_nop 0
    v_add_f32 v8, v8, v10
    v_add_f32 v9, v9, v11
    v_smfmac_f32_16x16x64_bf16 v[16:19], v[44:47], v[200:207], v104
    v_cvt_pk_bf16_f32 v34, v8, v9
    v_add_f32 v12, v12, v14
    v_smfmac_f32_16x16x64_bf16 v[20:23], v[44:47], v[216:223], v104
    v_add_f32 v13, v13, v15
    v_cvt_pk_bf16_f32 v35, v12, v13
    v_smfmac_f32_16x16x64_bf16 v[24:27], v[40:43], v[224:231], v104
    global_store_dwordx4 v107, v[32:35], s[44:45]
    global_store_dword v123, v124, s[8:9]
    v_smfmac_f32_16x16x64_bf16 v[28:31], v[40:43], v[240:247], v104
    v_add_f32 v16, v16, v18
    v_add_f32 v17, v17, v19
    v_smfmac_f32_16x16x64_bf16 v[24:27], v[44:47], v[232:239], v104
    v_cvt_pk_bf16_f32 v36, v16, v17
    v_add_f32 v20, v20, v22
    v_smfmac_f32_16x16x64_bf16 v[28:31], v[44:47], v[248:255], v104
    v_add_f32 v21, v21, v23
    v_cvt_pk_bf16_f32 v37, v20, v21
    s_nop 2
    v_pk_add_f32 v[24:25], v[24:25], v[26:27]
    s_nop 1
    v_pk_add_f32 v[28:29], v[28:29], v[30:31]
    v_cvt_pk_bf16_f32 v38, v24, v25
    v_cvt_pk_bf16_f32 v39, v28, v29
    global_store_dwordx4 v122, v[36:39], s[44:45]
    global_store_dword v123, v124, s[8:9] offset:128
    s_add_u32 s84, s84, 131072
    s_addc_u32 s85, s85, 0
    s_add_u32 s86, s86, 65536
    s_addc_u32 s87, s87, 0
    s_mov_b64 s[70:71], s[60:61]
    s_mov_b64 s[60:61], s[62:63]
    s_mov_b64 s[62:63], s[64:65]
    s_mov_b64 s[64:65], s[66:67]
    s_mov_b64 s[66:67], s[70:71]
    s_add_u32 s68, s68, 1
    v_mfma_f32_32x32x16_bf16 v[32:47], v[72:75], v[72:75], 0
    v_mfma_f32_16x16x32_bf16 v[48:51], v[72:75], v[72:75], 0
    v_mfma_f32_16x16x32_bf16 v[52:55], v[72:75], v[72:75], 0
    v_mfma_f32_16x16x32_bf16 v[100:103], v[72:75], v[72:75], 0
    ds_read_b128 v[56:59], v114 offset:16384
    ds_read_b128 v[60:63], v114 offset:17408
    ds_read_b128 v[64:67], v114 offset:18432
    ds_read_b128 v[68:71], v114 offset:19456
    ds_read_b128 v[72:75], v114 offset:20480
    ds_read_b128 v[76:79], v114 offset:21504
    ds_read_b128 v[80:83], v115 offset:16384
    ds_read_b128 v[84:87], v115 offset:17408
    ds_read_b128 v[88:91], v115 offset:18432
    ds_read_b128 v[92:95], v115 offset:19456
    ds_read_b128 v[24:27], v120
    ds_read_b128 v[28:31], v120 offset:1152
    s_waitcnt lgkmcnt(0)
    s_barrier
    global_load_dwordx4 v[4:7], v106, s[60:61] sc1
    global_load_dwordx4 v[20:23], v106, s[60:61] offset:1024 sc1
c_chk1_105:
    s_waitcnt vmcnt(1)
    v_max3_u32 v122, v4, v5, v6
    s_waitcnt vmcnt(0)
    v_max3_u32 v123, v7, v20, v21
    v_max3_u32 v122, v122, v22, v23
    v_max_u32 v122, v122, v123
    v_cmp_eq_u32 vcc, -1, v122
    ds_write_b128 v117, v[4:7]
    ds_write_b128 v117, v[20:23] offset:4096
    s_cbranch_vccnz c_retry_106
    v_smfmac_f32_16x16x64_bf16 v[32:35], v[4:7], a[8:15], v104
    v_smfmac_f32_16x16x64_bf16 v[36:39], v[4:7], a[72:79], v104
    v_smfmac_f32_16x16x64_bf16 v[32:35], v[20:23], a[40:47], v104
    s_waitcnt lgkmcnt(0)
    s_barrier
    ds_read_b128 v[0:3], v116 offset:16384
    ds_read_b128 v[8:11], v116 offset:18432
    v_smfmac_f32_16x16x64_bf16 v[36:39], v[20:23], a[104:111], v104
    ds_read_b128 v[12:15], v116 offset:19456
    v_smfmac_f32_16x16x64_bf16 v[40:43], v[4:7], a[136:143], v104
    ds_read_b128 v[16:19], v116 offset:20480
    global_store_dwordx4 v105, v[24:27], s[84:85] sc1
    global_store_dwordx4 v105, v[28:31], s[84:85] offset:1024 sc1
    v_smfmac_f32_16x16x64_bf16 v[44:47], v[4:7], a[200:207], v104
    ds_read_b128 v[24:27], v116 offset:22528
    v_smfmac_f32_16x16x64_bf16 v[40:43], v[20:23], a[168:175], v104
    ds_read_b128 v[28:31], v116 offset:23552
    s_waitcnt lgkmcnt(5)
    v_smfmac_f32_16x16x64_bf16 v[32:35], v[0:3], a[0:7], v104
    global_store_dword v121, v110, s[86:87] offset:0 sc1
    v_smfmac_f32_16x16x64_bf16 v[36:39], v[0:3], a[64:71], v104
    global_store_dword v121, v111, s[86:87] offset:256 sc1
    s_waitcnt lgkmcnt(4)
    v_smfmac_f32_16x16x64_bf16 v[32:35], v[8:11], a[16:23], v104
    global_store_dword v121, v119, s[86:87] offset:512 sc1
    v_smfmac_f32_16x16x64_bf16 v[36:39], v[8:11], a[80:87], v104
    s_sub_u32 s70, s68, 1
    s_waitcnt lgkmcnt(3)
    v_smfmac_f32_16x16x64_bf16 v[32:35], v[12:15], a[24:31], v104
    s_max_i32 s70, s70, 0
    v_smfmac_f32_16x16x64_bf16 v[36:39], v[12:15], a[88:95], v104
    v_mov_b32 v122, s100
    s_waitcnt lgkmcnt(2)
    v_smfmac_f32_16x16x64_bf16 v[32:35], v[16:19], a[32:39], v104
    v_mov_b32 v123, s70
    v_smfmac_f32_16x16x64_bf16 v[36:39], v[16:19], a[96:103], v104
    global_store_dword v122, v123, s[4:5] sc1
    s_waitcnt lgkmcnt(1)
    v_smfmac_f32_16x16x64_bf16 v[32:35], v[24:27], a[48:55], v104
    v_smfmac_f32_16x16x64_bf16 v[36:39], v[24:27], a[112:119], v104
    s_waitcnt lgkmcnt(0)
    v_smfmac_f32_16x16x64_bf16 v[32:35], v[28:31], a[56:63], v104
    v_smfmac_f32_16x16x64_bf16 v[36:39], v[28:31], a[120:127], v104
    v_smfmac_f32_16x16x64_bf16 v[44:47], v[20:23], a[232:239], v104
    v_smfmac_f32_16x16x64_bf16 v[40:43], v[0:3], a[128:135], v104
    v_smfmac_f32_16x16x64_bf16 v[44:47], v[0:3], a[192:199], v104
    s_nop 3
    v_add_f32 v32, v32, v34
    v_add_f32 v33, v33, v35
    v_smfmac_f32_16x16x64_bf16 v[40:43], v[8:11], a[144:151], v104
    v_add_f32 v36, v36, v38
    v_add_f32 v37, v37, v39
    v_smfmac_f32_16x16x64_bf16 v[44:47], v[8:11], a[208:215], v104
    v_cvt_pk_bf16_f32 v32, v32, v36
    v_cvt_pk_bf16_f32 v33, v33, v37
    v_smfmac_f32_16x16x64_bf16 v[40:43], v[12:15], a[152:159], v104
    ds_write2_b32 v109, v32, v33 offset0:0 offset1:72
    v_smfmac_f32_16x16x64_bf16 v[44:47], v[12:15], a[216:223], v104
    v_smfmac_f32_16x16x64_bf16 v[40:43], v[16:19], a[160:167], v104
    s_waitcnt lgkmcnt(0)
    s_barrier
    v_smfmac_f32_16x16x64_bf16 v[44:47], v[16:19], a[224:231], v104
    ds_read_b128 v[32:35], v116 offset:8192
    v_smfmac_f32_16x16x64_bf16 v[40:43], v[24:27], a[176:183], v104
    ds_read_b128 v[36:39], v116 offset:9216
    v_smfmac_f32_16x16x64_bf16 v[44:47], v[24:27], a[240:247], v104
    ds_read_b128 v[96:99], v116 offset:10240
    v_smfmac_f32_16x16x64_bf16 v[40:43], v[28:31], a[184:191], v104
    v_smfmac_f32_16x16x64_bf16 v[44:47], v[28:31], a[248:255], v104
    v_smfmac_f32_16x16x64_bf16 v[48:51], v[4:7], v[56:63], v104
    ds_read_b128 v[56:59], v115 offset:20480
    ds_read_b128 v[60:63], v115 offset:21504
    v_smfmac_f32_16x16x64_bf16 v[52:55], v[4:7], v[64:71], v104
    ds_read_b128 v[64:67], v114 offset:0
    ds_read_b128 v[68:71], v114 offset:1024
    s_nop 0
    v_add_f32 v40, v40, v42
    v_add_f32 v41, v41, v43
    v_add_f32 v44, v44, v46
    v_add_f32 v45, v45, v47
    v_cvt_pk_bf16_f32 v40, v40, v44
    v_cvt_pk_bf16_f32 v41, v41, v45
    ds_write_b32 v109, v40 offset:2304
    ds_write_b32 v109, v41 offset:2592
    v_smfmac_f32_16x16x64_bf16 v[100:103], v[4:7], v[72:79], v104
    ds_read_b128 v[72:75], v114 offset:2048
    ds_read_b128 v[76:79], v114 offset:3072
    v_smfmac_f32_16x16x64_bf16 v[48:51], v[20:23], v[80:87], v104
    ds_read_b128 v[80:83], v114 offset:4096
    ds_read_b128 v[84:87], v114 offset:5120
    v_smfmac_f32_16x16x64_bf16 v[52:55], v[20:23], v[88:95], v104
    ds_read_b128 v[88:91], v114 offset:32768
    ds_read_b128 v[92:95], v114 offset:33792
    s_waitcnt lgkmcnt(6)
    s_barrier
    v_smfmac_f32_16x16x64_bf16 v[100:103], v[20:23], v[56:63], v104
    ds_read_b128 v[56:59], v114 offset:34816
    ds_read_b128 v[60:63], v114 offset:35840
    v_smfmac_f32_16x16x64_bf16 v[48:51], v[0:3], v[64:71], v104
    ds_read_b128 v[64:67], v114 offset:36864
    ds_read_b128 v[68:71], v114 offset:37888
    s_waitcnt lgkmcnt(8)
    v_smfmac_f32_16x16x64_bf16 v[52:55], v[0:3], v[72:79], v104
    ds_read_b128 v[72:75], v114 offset:49152
    ds_read_b128 v[76:79], v114 offset:50176
    s_waitcnt lgkmcnt(8)
    v_smfmac_f32_16x16x64_bf16 v[100:103], v[0:3], v[80:87], v104
    ds_read_b128 v[80:83], v114 offset:51200
    ds_read_b128 v[84:87], v114 offset:52224
    s_waitcnt lgkmcnt(8)
    v_smfmac_f32_16x16x64_bf16 v[48:51], v[8:11], v[88:95], v104
    ds_read_b128 v[88:91], v114 offset:53248
    ds_read_b128 v[92:95], v114 offset:54272
    s_waitcnt lgkmcnt(8)
    v_smfmac_f32_16x16x64_bf16 v[52:55], v[8:11], v[56:63], v104
    ds_read_b128 v[56:59], v115 offset:0
    ds_read_b128 v[60:63], v115 offset:1024
    s_waitcnt lgkmcnt(8)
    v_smfmac_f32_16x16x64_bf16 v[100:103], v[8:11], v[64:71], v104
    ds_read_b128 v[64:67], v115 offset:2048
    ds_read_b128 v[68:71], v115 offset:3072
    s_waitcnt lgkmcnt(8)
    v_smfmac_f32_16x16x64_bf16 v[48:51], v[12:15], v[72:79], v104
    ds_read_b128 v[72:75], v115 offset:4096
    ds_read_b128 v[76:79], v115 offset:5120
    s_waitcnt lgkmcnt(8)
    v_smfmac_f32_16x16x64_bf16 v[52:55], v[12:15], v[80:87], v104
    ds_read_b128 v[80:83], v115 offset:32768
    ds_read_b128 v[84:87], v115 offset:33792
    s_waitcnt lgkmcnt(8)
    v_smfmac_f32_16x16x64_bf16 v[100:103], v[12:15], v[88:95], v104
    ds_read_b128 v[88:91], v115 offset:34816
    ds_read_b128 v[92:95], v115 offset:35840
    s_waitcnt lgkmcnt(8)
    v_smfmac_f32_16x16x64_bf16 v[48:51], v[16:19], v[56:63], v104
    ds_read_b128 v[56:59], v115 offset:36864
    ds_read_b128 v[60:63], v115 offset:37888
    s_waitcnt lgkmcnt(8)
    v_smfmac_f32_16x16x64_bf16 v[52:55], v[16:19], v[64:71], v104
    ds_read_b128 v[64:67], v115 offset:49152
    ds_read_b128 v[68:71], v115 offset:50176
    s_waitcnt lgkmcnt(8)
    v_smfmac_f32_16x16x64_bf16 v[100:103], v[16:19], v[72:79], v104
    ds_read_b128 v[72:75], v115 offset:51200
    ds_read_b128 v[76:79], v115 offset:52224
    s_waitcnt lgkmcnt(8)
    v_smfmac_f32_16x16x64_bf16 v[48:51], v[24:27], v[80:87], v104
    ds_read_b128 v[80:83], v115 offset:53248
    ds_read_b128 v[84:87], v115 offset:54272
    s_waitcnt lgkmcnt(8)
    v_smfmac_f32_16x16x64_bf16 v[52:55], v[24:27], v[88:95], v104
    s_waitcnt lgkmcnt(6)
    v_smfmac_f32_16x16x64_bf16 v[100:103], v[24:27], v[56:63], v104
    s_waitcnt lgkmcnt(4)
    v_smfmac_f32_16x16x64_bf16 v[48:51], v[28:31], v[64:71], v104
    s_waitcnt lgkmcnt(2)
    v_smfmac_f32_16x16x64_bf16 v[52:55], v[28:31], v[72:79], v104
    s_waitcnt lgkmcnt(0)
    v_smfmac_f32_16x16x64_bf16 v[100:103], v[28:31], v[80:87], v104
    v_mov_b64 v[72:73], 0
    v_mov_b64 v[74:75], 0
    s_nop 1
    v_pk_add_f32 v[48:49], v[48:49], v[50:51]
    v_cvt_pk_bf16_f32 v48, v48, v49
    v_mov_b32 v49, 0
    v_pk_add_f32 v[52:53], v[52:53], v[54:55]
    v_cvt_pk_bf16_f32 v52, v52, v53
    v_mov_b32 v53, 0
    v_pk_add_f32 v[100:101], v[100:101], v[102:103]
    v_cvt_pk_bf16_f32 v100, v100, v101
    v_mov_b32 v101, 0
    v_mfma_f32_32x32x16_bf16 v[0:15], v[72:75], v[72:75], 0
    v_mfma_f32_32x32x16_bf16 v[16:31], v[72:75], v[72:75], 0
    v_mov_b32 v110, v48
    v_mov_b32 v111, v52
    v_mov_b32 v119, v100
    s_cmp_eq_u32 s68, 63
    s_cbranch_scc1 c_end_74
    s_waitcnt lgkmcnt(0)
    s_barrier
    ds_read_b128 v[44:47], v116 offset:16384
    ds_read_b64 v[126:127], v116 offset:17408
    v_add_u32 v122, 32768, v107
    s_add_u32 s76, s68, 1
    v_mov_b32 v123, 0
    v_mov_b32 v124, s76
    s_waitcnt lgkmcnt(1)
    v_mfma_f32_16x16x32_bf16 v[56:59], v[32:35], v[44:47], 0
    v_mfma_f32_16x16x32_bf16 v[60:63], v[36:39], v[44:47], 0
    v_mfma_f32_16x16x32_bf16 v[64:67], v[96:99], v[44:47], 0
    s_waitcnt lgkmcnt(0)
    s_nop 2
    v_mfma_f32_16x16x16_bf16 v[56:59], v[48:49], v[126:127], v[56:59]
    v_mfma_f32_16x16x16_bf16 v[60:63], v[52:53], v[126:127], v[60:63]
    v_mfma_f32_16x16x16_bf16 v[64:67], v[100:101], v[126:127], v[64:67]
    s_nop 5
    v_cvt_pk_bf16_f32 v56, v56, v57
    v_cvt_pk_bf16_f32 v57, v58, v59
    ds_write_b64 v112, v[56:57] offset:0
    v_cvt_pk_bf16_f32 v60, v60, v61
    v_cvt_pk_bf16_f32 v61, v62, v63
    ds_write_b64 v112, v[60:61] offset:32
    v_cvt_pk_bf16_f32 v64, v64, v65
    v_cvt_pk_bf16_f32 v65, v66, v67
    ds_write_b64 v112, v[64:65] offset:64
    s_waitcnt lgkmcnt(0)
    s_barrier
    ds_read_b128 v[40:43], v113 offset:0
    ds_read_b128 v[44:47], v113 offset:128
    s_waitcnt lgkmcnt(1)
    v_smfmac_f32_16x16x64_bf16 v[0:3], v[40:43], v[128:135], v104
    v_smfmac_f32_16x16x64_bf16 v[4:7], v[40:43], v[144:151], v104
    s_waitcnt lgkmcnt(0)
    v_smfmac_f32_16x16x64_bf16 v[0:3], v[44:47], v[136:143], v104
    v_smfmac_f32_16x16x64_bf16 v[4:7], v[44:47], v[152:159], v104
    v_smfmac_f32_16x16x64_bf16 v[8:11], v[40:43], v[160:167], v104
    v_smfmac_f32_16x16x64_bf16 v[12:15], v[40:43], v[176:183], v104
    s_nop 4
    v_add_f32 v0, v0, v2
    v_add_f32 v1, v1, v3
    v_smfmac_f32_16x16x64_bf16 v[8:11], v[44:47], v[168:175], v104
    v_cvt_pk_bf16_f32 v32, v0, v1
    v_add_f32 v4, v4, v6
    v_smfmac_f32_16x16x64_bf16 v[12:15], v[44:47], v[184:191], v104
    v_add_f32 v5, v5, v7
    v_cvt_pk_bf16_f32 v33, v4, v5
    v_smfmac_f32_16x16x64_bf16 v[16:19], v[40:43], v[192:199], v104
    v_smfmac_f32_16x16x64_bf16 v[20:23], v[40:43], v[208:215], v104
    s_nop 0
    v_add_f32 v8, v8, v10
    v_add_f32 v9, v9, v11
    v_smfmac_f32_16x16x64_bf16 v[16:19], v[44:47], v[200:207], v104
    v_cvt_pk_bf16_f32 v34, v8, v9
    v_add_f32 v12, v12, v14
    v_smfmac_f32_16x16x64_bf16 v[20:23], v[44:47], v[216:223], v104
    v_add_f32 v13, v13, v15
    v_cvt_pk_bf16_f32 v35, v12, v13
    v_smfmac_f32_16x16x64_bf16 v[24:27], v[40:43], v[224:231], v104
    global_store_dwordx4 v107, v[32:35], s[46:47]
    global_store_dword v123, v124, s[8:9]
    v_smfmac_f32_16x16x64_bf16 v[28:31], v[40:43], v[240:247], v104
    v_add_f32 v16, v16, v18
    v_add_f32 v17, v17, v19
    v_smfmac_f32_16x16x64_bf16 v[24:27], v[44:47], v[232:239], v104
    v_cvt_pk_bf16_f32 v36, v16, v17
    v_add_f32 v20, v20, v22
    v_smfmac_f32_16x16x64_bf16 v[28:31], v[44:47], v[248:255], v104
    v_add_f32 v21, v21, v23
    v_cvt_pk_bf16_f32 v37, v20, v21
    s_nop 2
    v_pk_add_f32 v[24:25], v[24:25], v[26:27]
    s_nop 1
    v_pk_add_f32 v[28:29], v[28:29], v[30:31]
    v_cvt_pk_bf16_f32 v38, v24, v25
    v_cvt_pk_bf16_f32 v39, v28, v29
    global_store_dwordx4 v122, v[36:39], s[46:47]
    global_store_dword v123, v124, s[8:9] offset:128
    s_add_u32 s84, s84, 131072
    s_addc_u32 s85, s85, 0
    s_add_u32 s86, s86, 65536
    s_addc_u32 s87, s87, 0
    s_mov_b64 s[70:71], s[60:61]
    s_mov_b64 s[60:61], s[62:63]
    s_mov_b64 s[62:63], s[64:65]
    s_mov_b64 s[64:65], s[66:67]
    s_mov_b64 s[66:67], s[70:71]
    s_add_u32 s68, s68, 1
    v_mfma_f32_32x32x16_bf16 v[32:47], v[72:75], v[72:75], 0
    v_mfma_f32_16x16x32_bf16 v[48:51], v[72:75], v[72:75], 0
    v_mfma_f32_16x16x32_bf16 v[52:55], v[72:75], v[72:75], 0
    v_mfma_f32_16x16x32_bf16 v[100:103], v[72:75], v[72:75], 0
    ds_read_b128 v[56:59], v114 offset:16384
    ds_read_b128 v[60:63], v114 offset:17408
    ds_read_b128 v[64:67], v114 offset:18432
    ds_read_b128 v[68:71], v114 offset:19456
    ds_read_b128 v[72:75], v114 offset:20480
    ds_read_b128 v[76:79], v114 offset:21504
    ds_read_b128 v[80:83], v115 offset:16384
    ds_read_b128 v[84:87], v115 offset:17408
    ds_read_b128 v[88:91], v115 offset:18432
    ds_read_b128 v[92:95], v115 offset:19456
    ds_read_b128 v[24:27], v120
    ds_read_b128 v[28:31], v120 offset:1152
    s_waitcnt lgkmcnt(0)
    s_barrier
    global_load_dwordx4 v[4:7], v106, s[60:61] sc1
    global_load_dwordx4 v[20:23], v106, s[60:61] offset:1024 sc1
    s_branch c_chk0_101
c_w2_72:
    s_mov_b32 s101, 0
    v_mov_b32 v122, s101
c_fl_107:
    global_load_dword v120, v122, s[4:5] sc1
    s_add_u32 s69, s69, 1
    s_cmp_gt_u32 s69, 0x80000
    s_cbranch_scc1 L_fail
    s_waitcnt vmcnt(0)
    v_cmp_gt_u32 vcc, 64, v120
    s_cbranch_vccnz c_fl_107
    s_mov_b32 m0, 162560
    v_lshlrev_b32 v122, 3, v105
    global_load_lds_dword v122, s[80:81] sc1
    v_add_u32 v122, 0x40000, v122
    global_load_lds_dword v122, s[80:81] sc1
    v_lshlrev_b32 v127, 3, v105
    s_mov_b32 s101, 128
    v_mov_b32 v122, s101
c_fl_108:
    global_load_dword v120, v122, s[4:5] sc1
    s_add_u32 s69, s69, 1
    s_cmp_gt_u32 s69, 0x80000
    s_cbranch_scc1 L_fail
    s_waitcnt vmcnt(0)
    v_cmp_gt_u32 vcc, 64, v120
    s_cbranch_vccnz c_fl_108
    s_mov_b32 s101, 256
    v_mov_b64 v[32:33], 0
    v_mov_b64 v[34:35], 0
    v_mov_b64 v[36:37], 0
    v_mov_b64 v[38:39], 0
    v_mov_b64 v[40:41], 0
    v_mov_b64 v[42:43], 0
    v_mov_b64 v[44:45], 0
    v_mov_b64 v[46:47], 0
    v_mov_b64 v[48:49], 0
    v_mov_b64 v[50:51], 0
    v_mov_b64 v[52:53], 0
    v_mov_b64 v[54:55], 0
    ds_read_b128 v[56:59], v114 offset:38912
    ds_read_b128 v[60:63], v114 offset:39936
    ds_read_b128 v[64:67], v114 offset:40960
    ds_read_b128 v[68:71], v114 offset:41984
    ds_read_b128 v[72:75], v114 offset:43008
    ds_read_b128 v[76:79], v114 offset:44032
    ds_read_b128 v[80:83], v115 offset:38912
    ds_read_b128 v[84:87], v115 offset:39936
    ds_read_b128 v[88:91], v115 offset:40960
    ds_read_b128 v[92:95], v115 offset:41984
    v_mov_b64 v[100:101], 0
    v_mov_b64 v[102:103], 0
    s_waitcnt lgkmcnt(0)
    s_mov_b32 m0, 131072
    s_nop 0
    global_load_lds_dwordx4 v105, s[80:81] offset:0
    global_load_lds_dwordx4 v105, s[80:81] offset:1024
    global_load_lds_dwordx4 v105, s[80:81] offset:2048
    global_load_lds_dwordx4 v105, s[80:81] offset:3072
    v_add_u32 v122, 4096, v105
    s_mov_b32 m0, 135168
    s_nop 0
    global_load_lds_dwordx4 v122, s[80:81] offset:0
    global_load_lds_dwordx4 v122, s[80:81] offset:1024
    global_load_lds_dwordx4 v122, s[80:81] offset:2048
    global_load_lds_dwordx4 v122, s[80:81] offset:3072
    s_add_u32 s80, s80, 262144
    s_addc_u32 s81, s81, 0
    global_load_dwordx4 v[8:11], v106, s[60:61] sc1
    global_load_dwordx4 v[24:27], v106, s[60:61] offset:1024 sc1
c_loop_109:
    s_branch c_chk0_110
c_pollm_111:
    global_load_dwordx4 v[8:11], v106, s[60:61] sc1
    global_load_dwordx4 v[24:27], v106, s[60:61] offset:1024 sc1
c_chk0_110:
    s_waitcnt vmcnt(1)
    v_max3_u32 v122, v8, v9, v10
    s_waitcnt vmcnt(0)
    v_max3_u32 v123, v11, v24, v25
    v_max3_u32 v122, v122, v26, v27
    v_max_u32 v122, v122, v123
    v_cmp_eq_u32 vcc, -1, v122
    ds_write_b128 v117, v[8:11]
    ds_write_b128 v117, v[24:27] offset:4096
    s_cbranch_vccnz c_retry_112
    v_smfmac_f32_16x16x64_bf16 v[32:35], v[8:11], a[16:23], v104
    v_smfmac_f32_16x16x64_bf16 v[36:39], v[8:11], a[80:87], v104
    v_smfmac_f32_16x16x64_bf16 v[32:35], v[24:27], a[48:55], v104
    s_waitcnt lgkmcnt(0)
    s_barrier
    ds_read_b128 v[0:3], v116 offset:16384
    ds_read_b128 v[4:7], v116 offset:17408
    v_smfmac_f32_16x16x64_bf16 v[36:39], v[24:27], a[112:119], v104
    ds_read_b128 v[12:15], v116 offset:19456
    v_smfmac_f32_16x16x64_bf16 v[40:43], v[8:11], a[144:151], v104
    ds_read_b128 v[16:19], v116 offset:20480
    v_smfmac_f32_16x16x64_bf16 v[44:47], v[8:11], a[208:215], v104
    ds_read_b128 v[20:23], v116 offset:21504
    v_smfmac_f32_16x16x64_bf16 v[40:43], v[24:27], a[176:183], v104
    ds_read_b128 v[28:31], v116 offset:23552
    s_waitcnt lgkmcnt(5)
    v_smfmac_f32_16x16x64_bf16 v[32:35], v[0:3], a[0:7], v104
    global_store_dword v121, v110, s[86:87] offset:768 sc1
    v_smfmac_f32_16x16x64_bf16 v[36:39], v[0:3], a[64:71], v104
    global_store_dword v121, v111, s[86:87] offset:1024 sc1
    s_waitcnt lgkmcnt(4)
    v_smfmac_f32_16x16x64_bf16 v[32:35], v[4:7], a[8:15], v104
    global_store_dword v121, v119, s[86:87] offset:1280 sc1
    v_smfmac_f32_16x16x64_bf16 v[36:39], v[4:7], a[72:79], v104
    s_mov_b32 m0, 162560
    s_waitcnt lgkmcnt(3)
    v_smfmac_f32_16x16x64_bf16 v[32:35], v[12:15], a[24:31], v104
    global_load_lds_dword v127, s[80:81]
    v_smfmac_f32_16x16x64_bf16 v[36:39], v[12:15], a[88:95], v104
    v_mov_b32 v122, s101
    s_waitcnt lgkmcnt(2)
    v_smfmac_f32_16x16x64_bf16 v[32:35], v[16:19], a[32:39], v104
    global_load_dword v120, v122, s[4:5] sc1
    v_smfmac_f32_16x16x64_bf16 v[36:39], v[16:19], a[96:103], v104
    s_waitcnt lgkmcnt(1)
    v_smfmac_f32_16x16x64_bf16 v[32:35], v[20:23], a[40:47], v104
    v_smfmac_f32_16x16x64_bf16 v[36:39], v[20:23], a[104:111], v104
    s_waitcnt lgkmcnt(0)
    v_smfmac_f32_16x16x64_bf16 v[32:35], v[28:31], a[56:63], v104
    v_smfmac_f32_16x16x64_bf16 v[36:39], v[28:31], a[120:127], v104
    v_smfmac_f32_16x16x64_bf16 v[44:47], v[24:27], a[240:247], v104
    v_smfmac_f32_16x16x64_bf16 v[40:43], v[0:3], a[128:135], v104
    v_smfmac_f32_16x16x64_bf16 v[44:47], v[0:3], a[192:199], v104
    s_nop 3
    v_add_f32 v32, v32, v34
    v_add_f32 v33, v33, v35
    v_smfmac_f32_16x16x64_bf16 v[40:43], v[4:7], a[136:143], v104
    v_add_f32 v36, v36, v38
    v_add_f32 v37, v37, v39
    v_smfmac_f32_16x16x64_bf16 v[44:47], v[4:7], a[200:207], v104
    v_cvt_pk_bf16_f32 v32, v32, v36
    v_cvt_pk_bf16_f32 v33, v33, v37
    v_smfmac_f32_16x16x64_bf16 v[40:43], v[12:15], a[152:159], v104
    ds_write2_b32 v109, v32, v33 offset0:0 offset1:72
    v_smfmac_f32_16x16x64_bf16 v[44:47], v[12:15], a[216:223], v104
    v_smfmac_f32_16x16x64_bf16 v[40:43], v[16:19], a[160:167], v104
    s_waitcnt lgkmcnt(0)
    s_barrier
    v_smfmac_f32_16x16x64_bf16 v[44:47], v[16:19], a[224:231], v104
    ds_read_b128 v[32:35], v116 offset:11264
    v_smfmac_f32_16x16x64_bf16 v[40:43], v[20:23], a[168:175], v104
    ds_read_b128 v[36:39], v116 offset:12288
    v_smfmac_f32_16x16x64_bf16 v[44:47], v[20:23], a[232:239], v104
    ds_read_b128 v[96:99], v116 offset:13312
    v_smfmac_f32_16x16x64_bf16 v[40:43], v[28:31], a[184:191], v104
    v_smfmac_f32_16x16x64_bf16 v[44:47], v[28:31], a[248:255], v104
    v_smfmac_f32_16x16x64_bf16 v[48:51], v[8:11], v[56:63], v104
    ds_read_b128 v[56:59], v115 offset:43008
    ds_read_b128 v[60:63], v115 offset:44032
    v_smfmac_f32_16x16x64_bf16 v[52:55], v[8:11], v[64:71], v104
    ds_read_b128 v[64:67], v114 offset:6144
    ds_read_b128 v[68:71], v114 offset:7168
    s_nop 0
    v_add_f32 v40, v40, v42
    v_add_f32 v41, v41, v43
    v_add_f32 v44, v44, v46
    v_add_f32 v45, v45, v47
    v_cvt_pk_bf16_f32 v40, v40, v44
    v_cvt_pk_bf16_f32 v41, v41, v45
    ds_write_b32 v109, v40 offset:2304
    ds_write_b32 v109, v41 offset:2592
    v_smfmac_f32_16x16x64_bf16 v[100:103], v[8:11], v[72:79], v104
    ds_read_b128 v[72:75], v114 offset:8192
    ds_read_b128 v[76:79], v114 offset:9216
    v_smfmac_f32_16x16x64_bf16 v[48:51], v[24:27], v[80:87], v104
    ds_read_b128 v[80:83], v114 offset:10240
    ds_read_b128 v[84:87], v114 offset:11264
    v_smfmac_f32_16x16x64_bf16 v[52:55], v[24:27], v[88:95], v104
    ds_read_b128 v[88:91], v114 offset:22528
    ds_read_b128 v[92:95], v114 offset:23552
    s_waitcnt lgkmcnt(6)
    s_barrier
    v_smfmac_f32_16x16x64_bf16 v[100:103], v[24:27], v[56:63], v104
    ds_read_b128 v[56:59], v114 offset:24576
    ds_read_b128 v[60:63], v114 offset:25600
    s_mov_b32 m0, 131072
    v_smfmac_f32_16x16x64_bf16 v[48:51], v[0:3], v[64:71], v104
    ds_read_b128 v[64:67], v114 offset:26624
    ds_read_b128 v[68:71], v114 offset:27648
    global_load_lds_dwordx4 v105, s[80:81] offset:0
    s_waitcnt lgkmcnt(8)
    v_smfmac_f32_16x16x64_bf16 v[52:55], v[0:3], v[72:79], v104
    ds_read_b128 v[72:75], v114 offset:55296
    ds_read_b128 v[76:79], v114 offset:56320
    global_load_lds_dwordx4 v105, s[80:81] offset:1024
    s_waitcnt lgkmcnt(8)
    v_smfmac_f32_16x16x64_bf16 v[100:103], v[0:3], v[80:87], v104
    ds_read_b128 v[80:83], v114 offset:57344
    ds_read_b128 v[84:87], v114 offset:58368
    global_load_lds_dwordx4 v105, s[80:81] offset:2048
    s_waitcnt lgkmcnt(8)
    v_smfmac_f32_16x16x64_bf16 v[48:51], v[4:7], v[88:95], v104
    ds_read_b128 v[88:91], v114 offset:59392
    ds_read_b128 v[92:95], v114 offset:60416
    global_load_lds_dwordx4 v105, s[80:81] offset:3072
    s_waitcnt lgkmcnt(8)
    v_smfmac_f32_16x16x64_bf16 v[52:55], v[4:7], v[56:63], v104
    ds_read_b128 v[56:59], v115 offset:6144
    ds_read_b128 v[60:63], v115 offset:7168
    v_add_u32 v122, 4096, v105
    s_waitcnt lgkmcnt(8)
    v_smfmac_f32_16x16x64_bf16 v[100:103], v[4:7], v[64:71], v104
    ds_read_b128 v[64:67], v115 offset:8192
    ds_read_b128 v[68:71], v115 offset:9216
    s_mov_b32 m0, 135168
    s_waitcnt lgkmcnt(8)
    v_smfmac_f32_16x16x64_bf16 v[48:51], v[12:15], v[72:79], v104
    ds_read_b128 v[72:75], v115 offset:10240
    ds_read_b128 v[76:79], v115 offset:11264
    global_load_lds_dwordx4 v122, s[80:81] offset:0
    s_waitcnt lgkmcnt(8)
    v_smfmac_f32_16x16x64_bf16 v[52:55], v[12:15], v[80:87], v104
    ds_read_b128 v[80:83], v115 offset:22528
    ds_read_b128 v[84:87], v115 offset:23552
    global_load_lds_dwordx4 v122, s[80:81] offset:1024
    s_waitcnt lgkmcnt(8)
    v_smfmac_f32_16x16x64_bf16 v[100:103], v[12:15], v[88:95], v104
    ds_read_b128 v[88:91], v115 offset:24576
    ds_read_b128 v[92:95], v115 offset:25600
    global_load_lds_dwordx4 v122, s[80:81] offset:2048
    s_waitcnt lgkmcnt(8)
    v_smfmac_f32_16x16x64_bf16 v[48:51], v[16:19], v[56:63], v104
    ds_read_b128 v[56:59], v115 offset:26624
    ds_read_b128 v[60:63], v115 offset:27648
    global_load_lds_dwordx4 v122, s[80:81] offset:3072
    s_waitcnt lgkmcnt(8)
    v_smfmac_f32_16x16x64_bf16 v[52:55], v[16:19], v[64:71], v104
    ds_read_b128 v[64:67], v115 offset:55296
    ds_read_b128 v[68:71], v115 offset:56320
    s_waitcnt lgkmcnt(8)
    v_smfmac_f32_16x16x64_bf16 v[100:103], v[16:19], v[72:79], v104
    ds_read_b128 v[72:75], v115 offset:57344
    ds_read_b128 v[76:79], v115 offset:58368
    s_waitcnt lgkmcnt(8)
    v_smfmac_f32_16x16x64_bf16 v[48:51], v[20:23], v[80:87], v104
    ds_read_b128 v[80:83], v115 offset:59392
    ds_read_b128 v[84:87], v115 offset:60416
    s_waitcnt lgkmcnt(8)
    v_smfmac_f32_16x16x64_bf16 v[52:55], v[20:23], v[88:95], v104
    s_waitcnt lgkmcnt(6)
    v_smfmac_f32_16x16x64_bf16 v[100:103], v[20:23], v[56:63], v104
    s_waitcnt lgkmcnt(4)
    v_smfmac_f32_16x16x64_bf16 v[48:51], v[28:31], v[64:71], v104
    s_waitcnt lgkmcnt(2)
    v_smfmac_f32_16x16x64_bf16 v[52:55], v[28:31], v[72:79], v104
    s_waitcnt lgkmcnt(0)
    v_smfmac_f32_16x16x64_bf16 v[100:103], v[28:31], v[80:87], v104
    v_mov_b64 v[72:73], 0
    v_mov_b64 v[74:75], 0
    s_nop 1
    v_pk_add_f32 v[48:49], v[48:49], v[50:51]
    v_cvt_pk_bf16_f32 v48, v48, v49
    v_mov_b32 v49, 0
    v_pk_add_f32 v[52:53], v[52:53], v[54:55]
    v_cvt_pk_bf16_f32 v52, v52, v53
    v_mov_b32 v53, 0
    v_pk_add_f32 v[100:101], v[100:101], v[102:103]
    v_cvt_pk_bf16_f32 v100, v100, v101
    v_mov_b32 v101, 0
    v_mfma_f32_32x32x16_bf16 v[0:15], v[72:75], v[72:75], 0
    v_mfma_f32_32x32x16_bf16 v[16:31], v[72:75], v[72:75], 0
    v_mov_b32 v110, v48
    v_mov_b32 v111, v52
    v_mov_b32 v119, v100
    s_waitcnt lgkmcnt(0)
    s_barrier
    ds_read_b128 v[44:47], v116 offset:16384
    ds_read_b64 v[126:127], v116 offset:17408
    v_add_u32 v122, 32768, v107
    s_add_u32 s76, s68, 1
    v_mov_b32 v123, 0
    v_mov_b32 v124, s76
    s_waitcnt lgkmcnt(1)
    v_mfma_f32_16x16x32_bf16 v[56:59], v[32:35], v[44:47], 0
    v_mfma_f32_16x16x32_bf16 v[60:63], v[36:39], v[44:47], 0
    v_mfma_f32_16x16x32_bf16 v[64:67], v[96:99], v[44:47], 0
    s_waitcnt lgkmcnt(0)
    s_nop 2
    v_mfma_f32_16x16x16_bf16 v[56:59], v[48:49], v[126:127], v[56:59]
    v_mfma_f32_16x16x16_bf16 v[60:63], v[52:53], v[126:127], v[60:63]
    v_mfma_f32_16x16x16_bf16 v[64:67], v[100:101], v[126:127], v[64:67]
    s_nop 5
    v_cvt_pk_bf16_f32 v56, v56, v57
    v_cvt_pk_bf16_f32 v57, v58, v59
    ds_write_b64 v112, v[56:57] offset:96
    v_cvt_pk_bf16_f32 v60, v60, v61
    v_cvt_pk_bf16_f32 v61, v62, v63
    ds_write_b64 v112, v[60:61] offset:128
    v_cvt_pk_bf16_f32 v64, v64, v65
    v_cvt_pk_bf16_f32 v65, v66, v67
    ds_write_b64 v112, v[64:65] offset:160
    s_waitcnt lgkmcnt(0)
    s_barrier
    ds_read_b128 v[40:43], v113 offset:0
    ds_read_b128 v[44:47], v113 offset:128
    s_waitcnt lgkmcnt(1)
    v_smfmac_f32_16x16x64_bf16 v[0:3], v[40:43], v[128:135], v104
    v_smfmac_f32_16x16x64_bf16 v[4:7], v[40:43], v[144:151], v104
    s_waitcnt lgkmcnt(0)
    v_smfmac_f32_16x16x64_bf16 v[0:3], v[44:47], v[136:143], v104
    v_smfmac_f32_16x16x64_bf16 v[4:7], v[44:47], v[152:159], v104
    v_smfmac_f32_16x16x64_bf16 v[8:11], v[40:43], v[160:167], v104
    v_smfmac_f32_16x16x64_bf16 v[12:15], v[40:43], v[176:183], v104
    s_nop 4
    v_add_f32 v0, v0, v2
    v_add_f32 v1, v1, v3
    v_smfmac_f32_16x16x64_bf16 v[8:11], v[44:47], v[168:175], v104
    v_cvt_pk_bf16_f32 v32, v0, v1
    v_add_f32 v4, v4, v6
    v_smfmac_f32_16x16x64_bf16 v[12:15], v[44:47], v[184:191], v104
    v_add_f32 v5, v5, v7
    v_cvt_pk_bf16_f32 v33, v4, v5
    v_smfmac_f32_16x16x64_bf16 v[16:19], v[40:43], v[192:199], v104
    v_smfmac_f32_16x16x64_bf16 v[20:23], v[40:43], v[208:215], v104
    s_nop 0
    v_add_f32 v8, v8, v10
    v_add_f32 v9, v9, v11
    v_smfmac_f32_16x16x64_bf16 v[16:19], v[44:47], v[200:207], v104
    v_cvt_pk_bf16_f32 v34, v8, v9
    v_add_f32 v12, v12, v14
    v_smfmac_f32_16x16x64_bf16 v[20:23], v[44:47], v[216:223], v104
    v_add_f32 v13, v13, v15
    v_cvt_pk_bf16_f32 v35, v12, v13
    v_smfmac_f32_16x16x64_bf16 v[24:27], v[40:43], v[224:231], v104
    global_store_dwordx4 v107, v[32:35], s[44:45]
    global_store_dword v123, v124, s[8:9]
    v_smfmac_f32_16x16x64_bf16 v[28:31], v[40:43], v[240:247], v104
    v_add_f32 v16, v16, v18
    v_add_f32 v17, v17, v19
    v_smfmac_f32_16x16x64_bf16 v[24:27], v[44:47], v[232:239], v104
    v_cvt_pk_bf16_f32 v36, v16, v17
    v_add_f32 v20, v20, v22
    v_smfmac_f32_16x16x64_bf16 v[28:31], v[44:47], v[248:255], v104
    v_add_f32 v21, v21, v23
    v_cvt_pk_bf16_f32 v37, v20, v21
    s_nop 2
    v_pk_add_f32 v[24:25], v[24:25], v[26:27]
    s_nop 1
    v_pk_add_f32 v[28:29], v[28:29], v[30:31]
    v_cvt_pk_bf16_f32 v38, v24, v25
    v_cvt_pk_bf16_f32 v39, v28, v29
    global_store_dwordx4 v122, v[36:39], s[44:45]
    global_store_dword v123, v124, s[8:9] offset:128
    s_add_u32 s80, s80, 262144
    s_addc_u32 s81, s81, 0
    v_lshlrev_b32 v127, 3, v105
    s_add_u32 s86, s86, 65536
    s_addc_u32 s87, s87, 0
    s_mov_b64 s[70:71], s[60:61]
    s_mov_b64 s[60:61], s[62:63]
    s_mov_b64 s[62:63], s[64:65]
    s_mov_b64 s[64:65], s[66:67]
    s_mov_b64 s[66:67], s[70:71]
    s_add_u32 s68, s68, 1
    v_mfma_f32_32x32x16_bf16 v[32:47], v[72:75], v[72:75], 0
    v_mfma_f32_16x16x32_bf16 v[48:51], v[72:75], v[72:75], 0
    v_mfma_f32_16x16x32_bf16 v[52:55], v[72:75], v[72:75], 0
    v_mfma_f32_16x16x32_bf16 v[100:103], v[72:75], v[72:75], 0
    ds_read_b128 v[56:59], v114 offset:38912
    ds_read_b128 v[60:63], v114 offset:39936
    ds_read_b128 v[64:67], v114 offset:40960
    ds_read_b128 v[68:71], v114 offset:41984
    ds_read_b128 v[72:75], v114 offset:43008
    ds_read_b128 v[76:79], v114 offset:44032
    ds_read_b128 v[80:83], v115 offset:38912
    ds_read_b128 v[84:87], v115 offset:39936
    ds_read_b128 v[88:91], v115 offset:40960
    ds_read_b128 v[92:95], v115 offset:41984
    s_barrier
    global_load_dwordx4 v[8:11], v106, s[60:61] sc1
    global_load_dwordx4 v[24:27], v106, s[60:61] offset:1024 sc1
c_chk1_114:
    s_waitcnt vmcnt(1)
    v_max3_u32 v122, v8, v9, v10
    s_waitcnt vmcnt(0)
    v_max3_u32 v123, v11, v24, v25
    v_max3_u32 v122, v122, v26, v27
    v_max_u32 v122, v122, v123
    v_cmp_eq_u32 vcc, -1, v122
    ds_write_b128 v117, v[8:11]
    ds_write_b128 v117, v[24:27] offset:4096
    s_cbranch_vccnz c_retry_115
    v_smfmac_f32_16x16x64_bf16 v[32:35], v[8:11], a[16:23], v104
    v_smfmac_f32_16x16x64_bf16 v[36:39], v[8:11], a[80:87], v104
    v_smfmac_f32_16x16x64_bf16 v[32:35], v[24:27], a[48:55], v104
    s_waitcnt lgkmcnt(0)
    s_barrier
    ds_read_b128 v[0:3], v116 offset:16384
    ds_read_b128 v[4:7], v116 offset:17408
    v_smfmac_f32_16x16x64_bf16 v[36:39], v[24:27], a[112:119], v104
    ds_read_b128 v[12:15], v116 offset:19456
    v_smfmac_f32_16x16x64_bf16 v[40:43], v[8:11], a[144:151], v104
    ds_read_b128 v[16:19], v116 offset:20480
    v_smfmac_f32_16x16x64_bf16 v[44:47], v[8:11], a[208:215], v104
    ds_read_b128 v[20:23], v116 offset:21504
    v_smfmac_f32_16x16x64_bf16 v[40:43], v[24:27], a[176:183], v104
    ds_read_b128 v[28:31], v116 offset:23552
    s_waitcnt lgkmcnt(5)
    v_smfmac_f32_16x16x64_bf16 v[32:35], v[0:3], a[0:7], v104
    global_store_dword v121, v110, s[86:87] offset:768 sc1
    v_smfmac_f32_16x16x64_bf16 v[36:39], v[0:3], a[64:71], v104
    global_store_dword v121, v111, s[86:87] offset:1024 sc1
    s_waitcnt lgkmcnt(4)
    v_smfmac_f32_16x16x64_bf16 v[32:35], v[4:7], a[8:15], v104
    global_store_dword v121, v119, s[86:87] offset:1280 sc1
    v_smfmac_f32_16x16x64_bf16 v[36:39], v[4:7], a[72:79], v104
    s_mov_b32 m0, 162560
    s_waitcnt lgkmcnt(3)
    v_smfmac_f32_16x16x64_bf16 v[32:35], v[12:15], a[24:31], v104
    global_load_lds_dword v127, s[80:81]
    v_smfmac_f32_16x16x64_bf16 v[36:39], v[12:15], a[88:95], v104
    s_waitcnt lgkmcnt(2)
    v_smfmac_f32_16x16x64_bf16 v[32:35], v[16:19], a[32:39], v104
    v_smfmac_f32_16x16x64_bf16 v[36:39], v[16:19], a[96:103], v104
    s_waitcnt lgkmcnt(1)
    v_smfmac_f32_16x16x64_bf16 v[32:35], v[20:23], a[40:47], v104
    v_smfmac_f32_16x16x64_bf16 v[36:39], v[20:23], a[104:111], v104
    s_waitcnt lgkmcnt(0)
    v_smfmac_f32_16x16x64_bf16 v[32:35], v[28:31], a[56:63], v104
    v_smfmac_f32_16x16x64_bf16 v[36:39], v[28:31], a[120:127], v104
    v_smfmac_f32_16x16x64_bf16 v[44:47], v[24:27], a[240:247], v104
    v_smfmac_f32_16x16x64_bf16 v[40:43], v[0:3], a[128:135], v104
    v_smfmac_f32_16x16x64_bf16 v[44:47], v[0:3], a[192:199], v104
    s_nop 3
    v_add_f32 v32, v32, v34
    v_add_f32 v33, v33, v35
    v_smfmac_f32_16x16x64_bf16 v[40:43], v[4:7], a[136:143], v104
    v_add_f32 v36, v36, v38
    v_add_f32 v37, v37, v39
    v_smfmac_f32_16x16x64_bf16 v[44:47], v[4:7], a[200:207], v104
    v_cvt_pk_bf16_f32 v32, v32, v36
    v_cvt_pk_bf16_f32 v33, v33, v37
    v_smfmac_f32_16x16x64_bf16 v[40:43], v[12:15], a[152:159], v104
    ds_write2_b32 v109, v32, v33 offset0:0 offset1:72
    v_smfmac_f32_16x16x64_bf16 v[44:47], v[12:15], a[216:223], v104
    v_smfmac_f32_16x16x64_bf16 v[40:43], v[16:19], a[160:167], v104
    s_waitcnt lgkmcnt(0)
    s_barrier
    v_smfmac_f32_16x16x64_bf16 v[44:47], v[16:19], a[224:231], v104
    ds_read_b128 v[32:35], v116 offset:11264
    v_smfmac_f32_16x16x64_bf16 v[40:43], v[20:23], a[168:175], v104
    ds_read_b128 v[36:39], v116 offset:12288
    v_smfmac_f32_16x16x64_bf16 v[44:47], v[20:23], a[232:239], v104
    ds_read_b128 v[96:99], v116 offset:13312
    v_smfmac_f32_16x16x64_bf16 v[40:43], v[28:31], a[184:191], v104
    v_smfmac_f32_16x16x64_bf16 v[44:47], v[28:31], a[248:255], v104
    v_smfmac_f32_16x16x64_bf16 v[48:51], v[8:11], v[56:63], v104
    ds_read_b128 v[56:59], v115 offset:43008
    ds_read_b128 v[60:63], v115 offset:44032
    v_smfmac_f32_16x16x64_bf16 v[52:55], v[8:11], v[64:71], v104
    ds_read_b128 v[64:67], v114 offset:6144
    ds_read_b128 v[68:71], v114 offset:7168
    s_nop 0
    v_add_f32 v40, v40, v42
    v_add_f32 v41, v41, v43
    v_add_f32 v44, v44, v46
    v_add_f32 v45, v45, v47
    v_cvt_pk_bf16_f32 v40, v40, v44
    v_cvt_pk_bf16_f32 v41, v41, v45
    ds_write_b32 v109, v40 offset:2304
    ds_write_b32 v109, v41 offset:2592
    v_smfmac_f32_16x16x64_bf16 v[100:103], v[8:11], v[72:79], v104
    ds_read_b128 v[72:75], v114 offset:8192
    ds_read_b128 v[76:79], v114 offset:9216
    v_smfmac_f32_16x16x64_bf16 v[48:51], v[24:27], v[80:87], v104
    ds_read_b128 v[80:83], v114 offset:10240
    ds_read_b128 v[84:87], v114 offset:11264
    v_smfmac_f32_16x16x64_bf16 v[52:55], v[24:27], v[88:95], v104
    ds_read_b128 v[88:91], v114 offset:22528
    ds_read_b128 v[92:95], v114 offset:23552
    s_waitcnt lgkmcnt(6)
    s_barrier
    v_smfmac_f32_16x16x64_bf16 v[100:103], v[24:27], v[56:63], v104
    ds_read_b128 v[56:59], v114 offset:24576
    ds_read_b128 v[60:63], v114 offset:25600
    s_mov_b32 m0, 131072
    v_smfmac_f32_16x16x64_bf16 v[48:51], v[0:3], v[64:71], v104
    ds_read_b128 v[64:67], v114 offset:26624
    ds_read_b128 v[68:71], v114 offset:27648
    global_load_lds_dwordx4 v105, s[80:81] offset:0
    s_waitcnt lgkmcnt(8)
    v_smfmac_f32_16x16x64_bf16 v[52:55], v[0:3], v[72:79], v104
    ds_read_b128 v[72:75], v114 offset:55296
    ds_read_b128 v[76:79], v114 offset:56320
    global_load_lds_dwordx4 v105, s[80:81] offset:1024
    s_waitcnt lgkmcnt(8)
    v_smfmac_f32_16x16x64_bf16 v[100:103], v[0:3], v[80:87], v104
    ds_read_b128 v[80:83], v114 offset:57344
    ds_read_b128 v[84:87], v114 offset:58368
    global_load_lds_dwordx4 v105, s[80:81] offset:2048
    s_waitcnt lgkmcnt(8)
    v_smfmac_f32_16x16x64_bf16 v[48:51], v[4:7], v[88:95], v104
    ds_read_b128 v[88:91], v114 offset:59392
    ds_read_b128 v[92:95], v114 offset:60416
    global_load_lds_dwordx4 v105, s[80:81] offset:3072
    s_waitcnt lgkmcnt(8)
    v_smfmac_f32_16x16x64_bf16 v[52:55], v[4:7], v[56:63], v104
    ds_read_b128 v[56:59], v115 offset:6144
    ds_read_b128 v[60:63], v115 offset:7168
    v_add_u32 v122, 4096, v105
    s_waitcnt lgkmcnt(8)
    v_smfmac_f32_16x16x64_bf16 v[100:103], v[4:7], v[64:71], v104
    ds_read_b128 v[64:67], v115 offset:8192
    ds_read_b128 v[68:71], v115 offset:9216
    s_mov_b32 m0, 135168
    s_waitcnt lgkmcnt(8)
    v_smfmac_f32_16x16x64_bf16 v[48:51], v[12:15], v[72:79], v104
    ds_read_b128 v[72:75], v115 offset:10240
    ds_read_b128 v[76:79], v115 offset:11264
    global_load_lds_dwordx4 v122, s[80:81] offset:0
    s_waitcnt lgkmcnt(8)
    v_smfmac_f32_16x16x64_bf16 v[52:55], v[12:15], v[80:87], v104
    ds_read_b128 v[80:83], v115 offset:22528
    ds_read_b128 v[84:87], v115 offset:23552
    global_load_lds_dwordx4 v122, s[80:81] offset:1024
    s_waitcnt lgkmcnt(8)
    v_smfmac_f32_16x16x64_bf16 v[100:103], v[12:15], v[88:95], v104
    ds_read_b128 v[88:91], v115 offset:24576
    ds_read_b128 v[92:95], v115 offset:25600
    global_load_lds_dwordx4 v122, s[80:81] offset:2048
    s_waitcnt lgkmcnt(8)
    v_smfmac_f32_16x16x64_bf16 v[48:51], v[16:19], v[56:63], v104
    ds_read_b128 v[56:59], v115 offset:26624
    ds_read_b128 v[60:63], v115 offset:27648
    global_load_lds_dwordx4 v122, s[80:81] offset:3072
    s_waitcnt lgkmcnt(8)
    v_smfmac_f32_16x16x64_bf16 v[52:55], v[16:19], v[64:71], v104
    ds_read_b128 v[64:67], v115 offset:55296
    ds_read_b128 v[68:71], v115 offset:56320
    s_waitcnt lgkmcnt(8)
    v_smfmac_f32_16x16x64_bf16 v[100:103], v[16:19], v[72:79], v104
    ds_read_b128 v[72:75], v115 offset:57344
    ds_read_b128 v[76:79], v115 offset:58368
    s_waitcnt lgkmcnt(8)
    v_smfmac_f32_16x16x64_bf16 v[48:51], v[20:23], v[80:87], v104
    ds_read_b128 v[80:83], v115 offset:59392
    ds_read_b128 v[84:87], v115 offset:60416
    s_waitcnt lgkmcnt(8)
    v_smfmac_f32_16x16x64_bf16 v[52:55], v[20:23], v[88:95], v104
    s_waitcnt lgkmcnt(6)
    v_smfmac_f32_16x16x64_bf16 v[100:103], v[20:23], v[56:63], v104
    s_waitcnt lgkmcnt(4)
    v_smfmac_f32_16x16x64_bf16 v[48:51], v[28:31], v[64:71], v104
    s_waitcnt lgkmcnt(2)
    v_smfmac_f32_16x16x64_bf16 v[52:55], v[28:31], v[72:79], v104
    s_waitcnt lgkmcnt(0)
    v_smfmac_f32_16x16x64_bf16 v[100:103], v[28:31], v[80:87], v104
    v_mov_b64 v[72:73], 0
    v_mov_b64 v[74:75], 0
    s_nop 1
    v_pk_add_f32 v[48:49], v[48:49], v[50:51]
    v_cvt_pk_bf16_f32 v48, v48, v49
    v_mov_b32 v49, 0
    v_pk_add_f32 v[52:53], v[52:53], v[54:55]
    v_cvt_pk_bf16_f32 v52, v52, v53
    v_mov_b32 v53, 0
    v_pk_add_f32 v[100:101], v[100:101], v[102:103]
    v_cvt_pk_bf16_f32 v100, v100, v101
    v_mov_b32 v101, 0
    v_mfma_f32_32x32x16_bf16 v[0:15], v[72:75], v[72:75], 0
    v_mfma_f32_32x32x16_bf16 v[16:31], v[72:75], v[72:75], 0
    v_mov_b32 v110, v48
    v_mov_b32 v111, v52
    v_mov_b32 v119, v100
    s_cmp_eq_u32 s68, 63
    s_cbranch_scc1 c_end_74
    s_waitcnt lgkmcnt(0)
    s_barrier
    ds_read_b128 v[44:47], v116 offset:16384
    ds_read_b64 v[126:127], v116 offset:17408
    v_add_u32 v122, 32768, v107
    s_add_u32 s76, s68, 1
    v_mov_b32 v123, 0
    v_mov_b32 v124, s76
    s_waitcnt lgkmcnt(1)
    v_mfma_f32_16x16x32_bf16 v[56:59], v[32:35], v[44:47], 0
    v_mfma_f32_16x16x32_bf16 v[60:63], v[36:39], v[44:47], 0
    v_mfma_f32_16x16x32_bf16 v[64:67], v[96:99], v[44:47], 0
    s_waitcnt lgkmcnt(0)
    s_nop 2
    v_mfma_f32_16x16x16_bf16 v[56:59], v[48:49], v[126:127], v[56:59]
    v_mfma_f32_16x16x16_bf16 v[60:63], v[52:53], v[126:127], v[60:63]
    v_mfma_f32_16x16x16_bf16 v[64:67], v[100:101], v[126:127], v[64:67]
    s_nop 5
    v_cvt_pk_bf16_f32 v56, v56, v57
    v_cvt_pk_bf16_f32 v57, v58, v59
    ds_write_b64 v112, v[56:57] offset:96
    v_cvt_pk_bf16_f32 v60, v60, v61
    v_cvt_pk_bf16_f32 v61, v62, v63
    ds_write_b64 v112, v[60:61] offset:128
    v_cvt_pk_bf16_f32 v64, v64, v65
    v_cvt_pk_bf16_f32 v65, v66, v67
    ds_write_b64 v112, v[64:65] offset:160
    s_waitcnt lgkmcnt(0)
    s_barrier
    ds_read_b128 v[40:43], v113 offset:0
    ds_read_b128 v[44:47], v113 offset:128
    s_waitcnt lgkmcnt(1)
    v_smfmac_f32_16x16x64_bf16 v[0:3], v[40:43], v[128:135], v104
    v_smfmac_f32_16x16x64_bf16 v[4:7], v[40:43], v[144:151], v104
    s_waitcnt lgkmcnt(0)
    v_smfmac_f32_16x16x64_bf16 v[0:3], v[44:47], v[136:143], v104
    v_smfmac_f32_16x16x64_bf16 v[4:7], v[44:47], v[152:159], v104
    v_smfmac_f32_16x16x64_bf16 v[8:11], v[40:43], v[160:167], v104
    v_smfmac_f32_16x16x64_bf16 v[12:15], v[40:43], v[176:183], v104
    s_nop 4
    v_add_f32 v0, v0, v2
    v_add_f32 v1, v1, v3
    v_smfmac_f32_16x16x64_bf16 v[8:11], v[44:47], v[168:175], v104
    v_cvt_pk_bf16_f32 v32, v0, v1
    v_add_f32 v4, v4, v6
    v_smfmac_f32_16x16x64_bf16 v[12:15], v[44:47], v[184:191], v104
    v_add_f32 v5, v5, v7
    v_cvt_pk_bf16_f32 v33, v4, v5
    v_smfmac_f32_16x16x64_bf16 v[16:19], v[40:43], v[192:199], v104
    v_smfmac_f32_16x16x64_bf16 v[20:23], v[40:43], v[208:215], v104
    s_nop 0
    v_add_f32 v8, v8, v10
    v_add_f32 v9, v9, v11
    v_smfmac_f32_16x16x64_bf16 v[16:19], v[44:47], v[200:207], v104
    v_cvt_pk_bf16_f32 v34, v8, v9
    v_add_f32 v12, v12, v14
    v_smfmac_f32_16x16x64_bf16 v[20:23], v[44:47], v[216:223], v104
    v_add_f32 v13, v13, v15
    v_cvt_pk_bf16_f32 v35, v12, v13
    v_smfmac_f32_16x16x64_bf16 v[24:27], v[40:43], v[224:231], v104
    global_store_dwordx4 v107, v[32:35], s[46:47]
    global_store_dword v123, v124, s[8:9]
    v_smfmac_f32_16x16x64_bf16 v[28:31], v[40:43], v[240:247], v104
    v_add_f32 v16, v16, v18
    v_add_f32 v17, v17, v19
    v_smfmac_f32_16x16x64_bf16 v[24:27], v[44:47], v[232:239], v104
    v_cvt_pk_bf16_f32 v36, v16, v17
    v_add_f32 v20, v20, v22
    v_smfmac_f32_16x16x64_bf16 v[28:31], v[44:47], v[248:255], v104
    v_add_f32 v21, v21, v23
    v_cvt_pk_bf16_f32 v37, v20, v21
    s_nop 2
    v_pk_add_f32 v[24:25], v[24:25], v[26:27]
    s_nop 1
    v_pk_add_f32 v[28:29], v[28:29], v[30:31]
    v_cvt_pk_bf16_f32 v38, v24, v25
    v_cvt_pk_bf16_f32 v39, v28, v29
    global_store_dwordx4 v122, v[36:39], s[46:47]
    global_store_dword v123, v124, s[8:9] offset:128
    s_add_u32 s80, s80, 262144
    s_addc_u32 s81, s81, 0
    v_lshlrev_b32 v127, 3, v105
    v_cmp_le_u32 vcc, 64, v120
    s_cbranch_vccnz c_fok_116
    v_mov_b32 v122, s101
c_fl_117:
    global_load_dword v120, v122, s[4:5] sc1
    s_add_u32 s69, s69, 1
    s_cmp_gt_u32 s69, 0x80000
    s_cbranch_scc1 L_fail
    s_waitcnt vmcnt(0)
    v_cmp_gt_u32 vcc, 64, v120
    s_cbranch_vccnz c_fl_117
c_fok_116:
    s_add_u32 s101, s101, 128
    s_min_u32 s101, s101, 3968
    s_add_u32 s86, s86, 65536
    s_addc_u32 s87, s87, 0
    s_mov_b64 s[70:71], s[60:61]
    s_mov_b64 s[60:61], s[62:63]
    s_mov_b64 s[62:63], s[64:65]
    s_mov_b64 s[64:65], s[66:67]
    s_mov_b64 s[66:67], s[70:71]
    s_add_u32 s68, s68, 1
    v_mfma_f32_32x32x16_bf16 v[32:47], v[72:75], v[72:75], 0
    v_mfma_f32_16x16x32_bf16 v[48:51], v[72:75], v[72:75], 0
    v_mfma_f32_16x16x32_bf16 v[52:55], v[72:75], v[72:75], 0
    v_mfma_f32_16x16x32_bf16 v[100:103], v[72:75], v[72:75], 0
    ds_read_b128 v[56:59], v114 offset:38912
    ds_read_b128 v[60:63], v114 offset:39936
    ds_read_b128 v[64:67], v114 offset:40960
    ds_read_b128 v[68:71], v114 offset:41984
    ds_read_b128 v[72:75], v114 offset:43008
    ds_read_b128 v[76:79], v114 offset:44032
    ds_read_b128 v[80:83], v115 offset:38912
    ds_read_b128 v[84:87], v115 offset:39936
    ds_read_b128 v[88:91], v115 offset:40960
    ds_read_b128 v[92:95], v115 offset:41984
    s_barrier
    global_load_dwordx4 v[8:11], v106, s[60:61] sc1
    global_load_dwordx4 v[24:27], v106, s[60:61] offset:1024 sc1
    s_branch c_chk0_110
c_w3_73:
    s_mov_b32 s101, 0
    v_mov_b32 v122, s101
c_fl_118:
    global_load_dword v120, v122, s[4:5] sc1
    s_add_u32 s69, s69, 1
    s_cmp_gt_u32 s69, 0x80000
    s_cbranch_scc1 L_fail
    s_waitcnt vmcnt(0)
    v_cmp_gt_u32 vcc, 64, v120
    s_cbranch_vccnz c_fl_118
    s_mov_b32 m0, 162560
    v_lshlrev_b32 v122, 3, v105
    global_load_lds_dword v122, s[80:81] sc1
    v_add_u32 v122, 0x40000, v122
    global_load_lds_dword v122, s[80:81] sc1
    v_lshlrev_b32 v127, 3, v105
    s_mov_b32 s101, 128
    v_mov_b32 v122, s101
c_fl_119:
    global_load_dword v120, v122, s[4:5] sc1
    s_add_u32 s69, s69, 1
    s_cmp_gt_u32 s69, 0x80000
    s_cbranch_scc1 L_fail
    s_waitcnt vmcnt(0)
    v_cmp_gt_u32 vcc, 64, v120
    s_cbranch_vccnz c_fl_119
    s_mov_b32 s101, 256
    v_mov_b64 v[32:33], 0
    v_mov_b64 v[34:35], 0
    v_mov_b64 v[36:37], 0
    v_mov_b64 v[38:39], 0
    v_mov_b64 v[40:41], 0
    v_mov_b64 v[42:43], 0
    v_mov_b64 v[44:45], 0
    v_mov_b64 v[46:47], 0
    v_mov_b64 v[48:49], 0
    v_mov_b64 v[50:51], 0
    v_mov_b64 v[52:53], 0
    v_mov_b64 v[54:55], 0
    ds_read_b128 v[56:59], v114 offset:61440
    ds_read_b128 v[60:63], v114 offset:62464
    ds_read_b128 v[64:67], v114 offset:63488
    ds_read_b128 v[68:71], v114 offset:64512
    ds_read_b128 v[72:75], v115 offset:61440
    ds_read_b128 v[76:79], v115 offset:62464
    ds_read_b128 v[80:83], v115 offset:63488
    ds_read_b128 v[84:87], v115 offset:64512
    ds_read_b128 v[88:91], v114 offset:12288
    ds_read_b128 v[92:95], v114 offset:13312
    v_mov_b64 v[100:101], 0
    v_mov_b64 v[102:103], 0
    s_waitcnt lgkmcnt(0)
    s_mov_b32 m0, 139264
    s_nop 0
    global_load_lds_dwordx4 v105, s[80:81] offset:0
    global_load_lds_dwordx4 v105, s[80:81] offset:1024
    global_load_lds_dwordx4 v105, s[80:81] offset:2048
    global_load_lds_dwordx4 v105, s[80:81] offset:3072
    v_add_u32 v122, 4096, v105
    s_mov_b32 m0, 143360
    s_nop 0
    global_load_lds_dwordx4 v122, s[80:81] offset:0
    global_load_lds_dwordx4 v122, s[80:81] offset:1024
    global_load_lds_dwordx4 v122, s[80:81] offset:2048
    global_load_lds_dwordx4 v122, s[80:81] offset:3072
    s_add_u32 s80, s80, 262144
    s_addc_u32 s81, s81, 0
    global_load_dwordx4 v[12:15], v106, s[60:61] sc1
    global_load_dwordx4 v[28:31], v106, s[60:61] offset:1024 sc1
c_loop_120:
    s_branch c_chk0_121
c_pollm_122:
    global_load_dwordx4 v[12:15], v106, s[60:61] sc1
    global_load_dwordx4 v[28:31], v106, s[60:61] offset:1024 sc1
c_chk0_121:
    s_waitcnt vmcnt(1)
    v_max3_u32 v122, v12, v13, v14
    s_waitcnt vmcnt(0)
    v_max3_u32 v123, v15, v28, v29
    v_max3_u32 v122, v122, v30, v31
    v_max_u32 v122, v122, v123
    v_cmp_eq_u32 vcc, -1, v122
    ds_write_b128 v117, v[12:15]
    ds_write_b128 v117, v[28:31] offset:4096
    s_cbranch_vccnz c_retry_123
    v_smfmac_f32_16x16x64_bf16 v[32:35], v[12:15], a[24:31], v104
    v_smfmac_f32_16x16x64_bf16 v[36:39], v[12:15], a[88:95], v104
    v_smfmac_f32_16x16x64_bf16 v[32:35], v[28:31], a[56:63], v104
    s_waitcnt lgkmcnt(0)
    s_barrier
    ds_read_b128 v[0:3], v116 offset:16384
    ds_read_b128 v[4:7], v116 offset:17408
    v_smfmac_f32_16x16x64_bf16 v[36:39], v[28:31], a[120:127], v104
    ds_read_b128 v[8:11], v116 offset:18432
    v_smfmac_f32_16x16x64_bf16 v[40:43], v[12:15], a[152:159], v104
    ds_read_b128 v[16:19], v116 offset:20480
    v_smfmac_f32_16x16x64_bf16 v[44:47], v[12:15], a[216:223], v104
    ds_read_b128 v[20:23], v116 offset:21504
    v_smfmac_f32_16x16x64_bf16 v[40:43], v[28:31], a[184:191], v104
    ds_read_b128 v[24:27], v116 offset:22528
    s_waitcnt lgkmcnt(5)
    v_smfmac_f32_16x16x64_bf16 v[32:35], v[0:3], a[0:7], v104
    global_store_dword v121, v110, s[86:87] offset:1536 sc1
    v_smfmac_f32_16x16x64_bf16 v[36:39], v[0:3], a[64:71], v104
    global_store_dword v121, v111, s[86:87] offset:1792 sc1
    s_waitcnt lgkmcnt(4)
    v_smfmac_f32_16x16x64_bf16 v[32:35], v[4:7], a[8:15], v104
    s_mov_b32 m0, 162560
    v_smfmac_f32_16x16x64_bf16 v[36:39], v[4:7], a[72:79], v104
    global_load_lds_dword v127, s[80:81]
    s_waitcnt lgkmcnt(3)
    v_smfmac_f32_16x16x64_bf16 v[32:35], v[8:11], a[16:23], v104
    v_mov_b32 v122, s101
    v_smfmac_f32_16x16x64_bf16 v[36:39], v[8:11], a[80:87], v104
    global_load_dword v120, v122, s[4:5] sc1
    s_waitcnt lgkmcnt(2)
    v_smfmac_f32_16x16x64_bf16 v[32:35], v[16:19], a[32:39], v104
    v_smfmac_f32_16x16x64_bf16 v[36:39], v[16:19], a[96:103], v104
    s_waitcnt lgkmcnt(1)
    v_smfmac_f32_16x16x64_bf16 v[32:35], v[20:23], a[40:47], v104
    v_smfmac_f32_16x16x64_bf16 v[36:39], v[20:23], a[104:111], v104
    s_waitcnt lgkmcnt(0)
    v_smfmac_f32_16x16x64_bf16 v[32:35], v[24:27], a[48:55], v104
    v_smfmac_f32_16x16x64_bf16 v[36:39], v[24:27], a[112:119], v104
    v_smfmac_f32_16x16x64_bf16 v[44:47], v[28:31], a[248:255], v104
    v_smfmac_f32_16x16x64_bf16 v[40:43], v[0:3], a[128:135], v104
    v_smfmac_f32_16x16x64_bf16 v[44:47], v[0:3], a[192:199], v104
    s_nop 3
    v_add_f32 v32, v32, v34
    v_add_f32 v33, v33, v35
    v_smfmac_f32_16x16x64_bf16 v[40:43], v[4:7], a[136:143], v104
    v_add_f32 v36, v36, v38
    v_add_f32 v37, v37, v39
    v_smfmac_f32_16x16x64_bf16 v[44:47], v[4:7], a[200:207], v104
    v_cvt_pk_bf16_f32 v32, v32, v36
    v_cvt_pk_bf16_f32 v33, v33, v37
    v_smfmac_f32_16x16x64_bf16 v[40:43], v[8:11], a[144:151], v104
    ds_write2_b32 v109, v32, v33 offset0:0 offset1:72
    v_smfmac_f32_16x16x64_bf16 v[44:47], v[8:11], a[208:215], v104
    v_smfmac_f32_16x16x64_bf16 v[40:43], v[16:19], a[160:167], v104
    s_waitcnt lgkmcnt(0)
    s_barrier
    v_smfmac_f32_16x16x64_bf16 v[44:47], v[16:19], a[224:231], v104
    ds_read_b128 v[32:35], v116 offset:14336
    v_smfmac_f32_16x16x64_bf16 v[40:43], v[20:23], a[168:175], v104
    ds_read_b128 v[36:39], v116 offset:15360
    v_smfmac_f32_16x16x64_bf16 v[44:47], v[20:23], a[232:239], v104
    v_smfmac_f32_16x16x64_bf16 v[40:43], v[24:27], a[176:183], v104
    v_smfmac_f32_16x16x64_bf16 v[44:47], v[24:27], a[240:247], v104
    v_smfmac_f32_16x16x64_bf16 v[48:51], v[12:15], v[56:63], v104
    ds_read_b128 v[56:59], v114 offset:14336
    ds_read_b128 v[60:63], v114 offset:15360
    v_smfmac_f32_16x16x64_bf16 v[52:55], v[12:15], v[64:71], v104
    ds_read_b128 v[64:67], v114 offset:28672
    ds_read_b128 v[68:71], v114 offset:29696
    s_nop 0
    v_add_f32 v40, v40, v42
    v_add_f32 v41, v41, v43
    v_add_f32 v44, v44, v46
    v_add_f32 v45, v45, v47
    v_cvt_pk_bf16_f32 v40, v40, v44
    v_cvt_pk_bf16_f32 v41, v41, v45
    ds_write_b32 v109, v40 offset:2304
    ds_write_b32 v109, v41 offset:2592
    v_smfmac_f32_16x16x64_bf16 v[48:51], v[28:31], v[72:79], v104
    ds_read_b128 v[72:75], v114 offset:30720
    ds_read_b128 v[76:79], v114 offset:31744
    v_smfmac_f32_16x16x64_bf16 v[52:55], v[28:31], v[80:87], v104
    ds_read_b128 v[80:83], v114 offset:45056
    ds_read_b128 v[84:87], v114 offset:46080
    v_smfmac_f32_16x16x64_bf16 v[48:51], v[0:3], v[88:95], v104
    ds_read_b128 v[88:91], v114 offset:47104
    ds_read_b128 v[92:95], v114 offset:48128
    s_waitcnt lgkmcnt(6)
    s_barrier
    v_smfmac_f32_16x16x64_bf16 v[52:55], v[0:3], v[56:63], v104
    ds_read_b128 v[56:59], v115 offset:12288
    ds_read_b128 v[60:63], v115 offset:13312
    s_mov_b32 m0, 139264
    v_smfmac_f32_16x16x64_bf16 v[48:51], v[4:7], v[64:71], v104
    ds_read_b128 v[64:67], v115 offset:14336
    ds_read_b128 v[68:71], v115 offset:15360
    global_load_lds_dwordx4 v105, s[80:81] offset:0
    s_waitcnt lgkmcnt(8)
    v_smfmac_f32_16x16x64_bf16 v[52:55], v[4:7], v[72:79], v104
    ds_read_b128 v[72:75], v115 offset:28672
    ds_read_b128 v[76:79], v115 offset:29696
    global_load_lds_dwordx4 v105, s[80:81] offset:1024
    s_waitcnt lgkmcnt(8)
    v_smfmac_f32_16x16x64_bf16 v[48:51], v[8:11], v[80:87], v104
    ds_read_b128 v[80:83], v115 offset:30720
    ds_read_b128 v[84:87], v115 offset:31744
    global_load_lds_dwordx4 v105, s[80:81] offset:2048
    s_waitcnt lgkmcnt(8)
    v_smfmac_f32_16x16x64_bf16 v[52:55], v[8:11], v[88:95], v104
    ds_read_b128 v[88:91], v115 offset:45056
    ds_read_b128 v[92:95], v115 offset:46080
    global_load_lds_dwordx4 v105, s[80:81] offset:3072
    s_waitcnt lgkmcnt(8)
    v_smfmac_f32_16x16x64_bf16 v[48:51], v[16:19], v[56:63], v104
    ds_read_b128 v[56:59], v115 offset:47104
    ds_read_b128 v[60:63], v115 offset:48128
    v_add_u32 v122, 4096, v105
    s_waitcnt lgkmcnt(8)
    v_smfmac_f32_16x16x64_bf16 v[52:55], v[16:19], v[64:71], v104
    s_mov_b32 m0, 143360
    s_waitcnt lgkmcnt(6)
    v_smfmac_f32_16x16x64_bf16 v[48:51], v[20:23], v[72:79], v104
    global_load_lds_dwordx4 v122, s[80:81] offset:0
    s_waitcnt lgkmcnt(4)
    v_smfmac_f32_16x16x64_bf16 v[52:55], v[20:23], v[80:87], v104
    global_load_lds_dwordx4 v122, s[80:81] offset:1024
    s_waitcnt lgkmcnt(2)
    v_smfmac_f32_16x16x64_bf16 v[48:51], v[24:27], v[88:95], v104
    global_load_lds_dwordx4 v122, s[80:81] offset:2048
    s_waitcnt lgkmcnt(0)
    v_smfmac_f32_16x16x64_bf16 v[52:55], v[24:27], v[56:63], v104
    global_load_lds_dwordx4 v122, s[80:81] offset:3072
    v_mov_b64 v[72:73], 0
    v_mov_b64 v[74:75], 0
    s_nop 1
    v_pk_add_f32 v[48:49], v[48:49], v[50:51]
    v_cvt_pk_bf16_f32 v48, v48, v49
    v_mov_b32 v49, 0
    v_pk_add_f32 v[52:53], v[52:53], v[54:55]
    v_cvt_pk_bf16_f32 v52, v52, v53
    v_mov_b32 v53, 0
    v_mfma_f32_32x32x16_bf16 v[0:15], v[72:75], v[72:75], 0
    v_mfma_f32_32x32x16_bf16 v[16:31], v[72:75], v[72:75], 0
    v_mov_b32 v110, v48
    v_mov_b32 v111, v52
    s_waitcnt lgkmcnt(0)
    s_barrier
    ds_read_b128 v[44:47], v116 offset:16384
    ds_read_b64 v[126:127], v116 offset:17408
    v_add_u32 v122, 32768, v107
    s_add_u32 s76, s68, 1
    v_mov_b32 v123, 0
    v_mov_b32 v124, s76
    s_waitcnt lgkmcnt(1)
    v_mfma_f32_16x16x32_bf16 v[56:59], v[32:35], v[44:47], 0
    v_mfma_f32_16x16x32_bf16 v[60:63], v[36:39], v[44:47], 0
    s_waitcnt lgkmcnt(0)
    s_nop 3
    v_mfma_f32_16x16x16_bf16 v[56:59], v[48:49], v[126:127], v[56:59]
    v_mfma_f32_16x16x16_bf16 v[60:63], v[52:53], v[126:127], v[60:63]
    s_nop 6
    v_cvt_pk_bf16_f32 v56, v56, v57
    v_cvt_pk_bf16_f32 v57, v58, v59
    ds_write_b64 v112, v[56:57] offset:192
    v_cvt_pk_bf16_f32 v60, v60, v61
    v_cvt_pk_bf16_f32 v61, v62, v63
    ds_write_b64 v112, v[60:61] offset:224
    s_waitcnt lgkmcnt(0)
    s_barrier
    ds_read_b128 v[40:43], v113 offset:0
    ds_read_b128 v[44:47], v113 offset:128
    s_waitcnt lgkmcnt(1)
    v_smfmac_f32_16x16x64_bf16 v[0:3], v[40:43], v[128:135], v104
    v_smfmac_f32_16x16x64_bf16 v[4:7], v[40:43], v[144:151], v104
    s_waitcnt lgkmcnt(0)
    v_smfmac_f32_16x16x64_bf16 v[0:3], v[44:47], v[136:143], v104
    v_smfmac_f32_16x16x64_bf16 v[4:7], v[44:47], v[152:159], v104
    v_smfmac_f32_16x16x64_bf16 v[8:11], v[40:43], v[160:167], v104
    v_smfmac_f32_16x16x64_bf16 v[12:15], v[40:43], v[176:183], v104
    s_nop 4
    v_add_f32 v0, v0, v2
    v_add_f32 v1, v1, v3
    v_smfmac_f32_16x16x64_bf16 v[8:11], v[44:47], v[168:175], v104
    v_cvt_pk_bf16_f32 v32, v0, v1
    v_add_f32 v4, v4, v6
    v_smfmac_f32_16x16x64_bf16 v[12:15], v[44:47], v[184:191], v104
    v_add_f32 v5, v5, v7
    v_cvt_pk_bf16_f32 v33, v4, v5
    v_smfmac_f32_16x16x64_bf16 v[16:19], v[40:43], v[192:199], v104
    v_smfmac_f32_16x16x64_bf16 v[20:23], v[40:43], v[208:215], v104
    s_nop 0
    v_add_f32 v8, v8, v10
    v_add_f32 v9, v9, v11
    v_smfmac_f32_16x16x64_bf16 v[16:19], v[44:47], v[200:207], v104
    v_cvt_pk_bf16_f32 v34, v8, v9
    v_add_f32 v12, v12, v14
    v_smfmac_f32_16x16x64_bf16 v[20:23], v[44:47], v[216:223], v104
    v_add_f32 v13, v13, v15
    v_cvt_pk_bf16_f32 v35, v12, v13
    v_smfmac_f32_16x16x64_bf16 v[24:27], v[40:43], v[224:231], v104
    global_store_dwordx4 v107, v[32:35], s[44:45]
    global_store_dword v123, v124, s[8:9]
    v_smfmac_f32_16x16x64_bf16 v[28:31], v[40:43], v[240:247], v104
    v_add_f32 v16, v16, v18
    v_add_f32 v17, v17, v19
    v_smfmac_f32_16x16x64_bf16 v[24:27], v[44:47], v[232:239], v104
    v_cvt_pk_bf16_f32 v36, v16, v17
    v_add_f32 v20, v20, v22
    v_smfmac_f32_16x16x64_bf16 v[28:31], v[44:47], v[248:255], v104
    v_add_f32 v21, v21, v23
    v_cvt_pk_bf16_f32 v37, v20, v21
    s_nop 2
    v_pk_add_f32 v[24:25], v[24:25], v[26:27]
    s_nop 1
    v_pk_add_f32 v[28:29], v[28:29], v[30:31]
    v_cvt_pk_bf16_f32 v38, v24, v25
    v_cvt_pk_bf16_f32 v39, v28, v29
    global_store_dwordx4 v122, v[36:39], s[44:45]
    global_store_dword v123, v124, s[8:9] offset:128
    s_add_u32 s80, s80, 262144
    s_addc_u32 s81, s81, 0
    v_lshlrev_b32 v127, 3, v105
    s_add_u32 s86, s86, 65536
    s_addc_u32 s87, s87, 0
    s_mov_b64 s[70:71], s[60:61]
    s_mov_b64 s[60:61], s[62:63]
    s_mov_b64 s[62:63], s[64:65]
    s_mov_b64 s[64:65], s[66:67]
    s_mov_b64 s[66:67], s[70:71]
    s_add_u32 s68, s68, 1
    v_mfma_f32_32x32x16_bf16 v[32:47], v[72:75], v[72:75], 0
    v_mfma_f32_16x16x32_bf16 v[48:51], v[72:75], v[72:75], 0
    v_mfma_f32_16x16x32_bf16 v[52:55], v[72:75], v[72:75], 0
    v_mfma_f32_16x16x32_bf16 v[100:103], v[72:75], v[72:75], 0
    ds_read_b128 v[56:59], v114 offset:61440
    ds_read_b128 v[60:63], v114 offset:62464
    ds_read_b128 v[64:67], v114 offset:63488
    ds_read_b128 v[68:71], v114 offset:64512
    ds_read_b128 v[72:75], v115 offset:61440
    ds_read_b128 v[76:79], v115 offset:62464
    ds_read_b128 v[80:83], v115 offset:63488
    ds_read_b128 v[84:87], v115 offset:64512
    ds_read_b128 v[88:91], v114 offset:12288
    ds_read_b128 v[92:95], v114 offset:13312
    s_barrier
    global_load_dwordx4 v[12:15], v106, s[60:61] sc1
    global_load_dwordx4 v[28:31], v106, s[60:61] offset:1024 sc1
c_chk1_125:
    s_waitcnt vmcnt(1)
    v_max3_u32 v122, v12, v13, v14
    s_waitcnt vmcnt(0)
    v_max3_u32 v123, v15, v28, v29
    v_max3_u32 v122, v122, v30, v31
    v_max_u32 v122, v122, v123
    v_cmp_eq_u32 vcc, -1, v122
    ds_write_b128 v117, v[12:15]
    ds_write_b128 v117, v[28:31] offset:4096
    s_cbranch_vccnz c_retry_126
    v_smfmac_f32_16x16x64_bf16 v[32:35], v[12:15], a[24:31], v104
    v_smfmac_f32_16x16x64_bf16 v[36:39], v[12:15], a[88:95], v104
    v_smfmac_f32_16x16x64_bf16 v[32:35], v[28:31], a[56:63], v104
    s_waitcnt lgkmcnt(0)
    s_barrier
    ds_read_b128 v[0:3], v116 offset:16384
    ds_read_b128 v[4:7], v116 offset:17408
    v_smfmac_f32_16x16x64_bf16 v[36:39], v[28:31], a[120:127], v104
    ds_read_b128 v[8:11], v116 offset:18432
    v_smfmac_f32_16x16x64_bf16 v[40:43], v[12:15], a[152:159], v104
    ds_read_b128 v[16:19], v116 offset:20480
    v_smfmac_f32_16x16x64_bf16 v[44:47], v[12:15], a[216:223], v104
    ds_read_b128 v[20:23], v116 offset:21504
    v_smfmac_f32_16x16x64_bf16 v[40:43], v[28:31], a[184:191], v104
    ds_read_b128 v[24:27], v116 offset:22528
    s_waitcnt lgkmcnt(5)
    v_smfmac_f32_16x16x64_bf16 v[32:35], v[0:3], a[0:7], v104
    global_store_dword v121, v110, s[86:87] offset:1536 sc1
    v_smfmac_f32_16x16x64_bf16 v[36:39], v[0:3], a[64:71], v104
    global_store_dword v121, v111, s[86:87] offset:1792 sc1
    s_waitcnt lgkmcnt(4)
    v_smfmac_f32_16x16x64_bf16 v[32:35], v[4:7], a[8:15], v104
    s_mov_b32 m0, 162560
    v_smfmac_f32_16x16x64_bf16 v[36:39], v[4:7], a[72:79], v104
    global_load_lds_dword v127, s[80:81]
    s_waitcnt lgkmcnt(3)
    v_smfmac_f32_16x16x64_bf16 v[32:35], v[8:11], a[16:23], v104
    v_smfmac_f32_16x16x64_bf16 v[36:39], v[8:11], a[80:87], v104
    s_waitcnt lgkmcnt(2)
    v_smfmac_f32_16x16x64_bf16 v[32:35], v[16:19], a[32:39], v104
    v_smfmac_f32_16x16x64_bf16 v[36:39], v[16:19], a[96:103], v104
    s_waitcnt lgkmcnt(1)
    v_smfmac_f32_16x16x64_bf16 v[32:35], v[20:23], a[40:47], v104
    v_smfmac_f32_16x16x64_bf16 v[36:39], v[20:23], a[104:111], v104
    s_waitcnt lgkmcnt(0)
    v_smfmac_f32_16x16x64_bf16 v[32:35], v[24:27], a[48:55], v104
    v_smfmac_f32_16x16x64_bf16 v[36:39], v[24:27], a[112:119], v104
    v_smfmac_f32_16x16x64_bf16 v[44:47], v[28:31], a[248:255], v104
    v_smfmac_f32_16x16x64_bf16 v[40:43], v[0:3], a[128:135], v104
    v_smfmac_f32_16x16x64_bf16 v[44:47], v[0:3], a[192:199], v104
    s_nop 3
    v_add_f32 v32, v32, v34
    v_add_f32 v33, v33, v35
    v_smfmac_f32_16x16x64_bf16 v[40:43], v[4:7], a[136:143], v104
    v_add_f32 v36, v36, v38
    v_add_f32 v37, v37, v39
    v_smfmac_f32_16x16x64_bf16 v[44:47], v[4:7], a[200:207], v104
    v_cvt_pk_bf16_f32 v32, v32, v36
    v_cvt_pk_bf16_f32 v33, v33, v37
    v_smfmac_f32_16x16x64_bf16 v[40:43], v[8:11], a[144:151], v104
    ds_write2_b32 v109, v32, v33 offset0:0 offset1:72
    v_smfmac_f32_16x16x64_bf16 v[44:47], v[8:11], a[208:215], v104
    v_smfmac_f32_16x16x64_bf16 v[40:43], v[16:19], a[160:167], v104
    s_waitcnt lgkmcnt(0)
    s_barrier
    v_smfmac_f32_16x16x64_bf16 v[44:47], v[16:19], a[224:231], v104
    ds_read_b128 v[32:35], v116 offset:14336
    v_smfmac_f32_16x16x64_bf16 v[40:43], v[20:23], a[168:175], v104
    ds_read_b128 v[36:39], v116 offset:15360
    v_smfmac_f32_16x16x64_bf16 v[44:47], v[20:23], a[232:239], v104
    v_smfmac_f32_16x16x64_bf16 v[40:43], v[24:27], a[176:183], v104
    v_smfmac_f32_16x16x64_bf16 v[44:47], v[24:27], a[240:247], v104
    v_smfmac_f32_16x16x64_bf16 v[48:51], v[12:15], v[56:63], v104
    ds_read_b128 v[56:59], v114 offset:14336
    ds_read_b128 v[60:63], v114 offset:15360
    v_smfmac_f32_16x16x64_bf16 v[52:55], v[12:15], v[64:71], v104
    ds_read_b128 v[64:67], v114 offset:28672
    ds_read_b128 v[68:71], v114 offset:29696
    s_nop 0
    v_add_f32 v40, v40, v42
    v_add_f32 v41, v41, v43
    v_add_f32 v44, v44, v46
    v_add_f32 v45, v45, v47
    v_cvt_pk_bf16_f32 v40, v40, v44
    v_cvt_pk_bf16_f32 v41, v41, v45
    ds_write_b32 v109, v40 offset:2304
    ds_write_b32 v109, v41 offset:2592
    v_smfmac_f32_16x16x64_bf16 v[48:51], v[28:31], v[72:79], v104
    ds_read_b128 v[72:75], v114 offset:30720
    ds_read_b128 v[76:79], v114 offset:31744
    v_smfmac_f32_16x16x64_bf16 v[52:55], v[28:31], v[80:87], v104
    ds_read_b128 v[80:83], v114 offset:45056
    ds_read_b128 v[84:87], v114 offset:46080
    v_smfmac_f32_16x16x64_bf16 v[48:51], v[0:3], v[88:95], v104
    ds_read_b128 v[88:91], v114 offset:47104
    ds_read_b128 v[92:95], v114 offset:48128
    s_waitcnt lgkmcnt(6)
    s_barrier
    v_smfmac_f32_16x16x64_bf16 v[52:55], v[0:3], v[56:63], v104
    ds_read_b128 v[56:59], v115 offset:12288
    ds_read_b128 v[60:63], v115 offset:13312
    s_mov_b32 m0, 139264
    v_smfmac_f32_16x16x64_bf16 v[48:51], v[4:7], v[64:71], v104
    ds_read_b128 v[64:67], v115 offset:14336
    ds_read_b128 v[68:71], v115 offset:15360
    global_load_lds_dwordx4 v105, s[80:81] offset:0
    s_waitcnt lgkmcnt(8)
    v_smfmac_f32_16x16x64_bf16 v[52:55], v[4:7], v[72:79], v104
    ds_read_b128 v[72:75], v115 offset:28672
    ds_read_b128 v[76:79], v115 offset:29696
    global_load_lds_dwordx4 v105, s[80:81] offset:1024
    s_waitcnt lgkmcnt(8)
    v_smfmac_f32_16x16x64_bf16 v[48:51], v[8:11], v[80:87], v104
    ds_read_b128 v[80:83], v115 offset:30720
    ds_read_b128 v[84:87], v115 offset:31744
    global_load_lds_dwordx4 v105, s[80:81] offset:2048
    s_waitcnt lgkmcnt(8)
    v_smfmac_f32_16x16x64_bf16 v[52:55], v[8:11], v[88:95], v104
    ds_read_b128 v[88:91], v115 offset:45056
    ds_read_b128 v[92:95], v115 offset:46080
    global_load_lds_dwordx4 v105, s[80:81] offset:3072
    s_waitcnt lgkmcnt(8)
    v_smfmac_f32_16x16x64_bf16 v[48:51], v[16:19], v[56:63], v104
    ds_read_b128 v[56:59], v115 offset:47104
    ds_read_b128 v[60:63], v115 offset:48128
    v_add_u32 v122, 4096, v105
    s_waitcnt lgkmcnt(8)
    v_smfmac_f32_16x16x64_bf16 v[52:55], v[16:19], v[64:71], v104
    s_mov_b32 m0, 143360
    s_waitcnt lgkmcnt(6)
    v_smfmac_f32_16x16x64_bf16 v[48:51], v[20:23], v[72:79], v104
    global_load_lds_dwordx4 v122, s[80:81] offset:0
    s_waitcnt lgkmcnt(4)
    v_smfmac_f32_16x16x64_bf16 v[52:55], v[20:23], v[80:87], v104
    global_load_lds_dwordx4 v122, s[80:81] offset:1024
    s_waitcnt lgkmcnt(2)
    v_smfmac_f32_16x16x64_bf16 v[48:51], v[24:27], v[88:95], v104
    global_load_lds_dwordx4 v122, s[80:81] offset:2048
    s_waitcnt lgkmcnt(0)
    v_smfmac_f32_16x16x64_bf16 v[52:55], v[24:27], v[56:63], v104
    global_load_lds_dwordx4 v122, s[80:81] offset:3072
    v_mov_b64 v[72:73], 0
    v_mov_b64 v[74:75], 0
    s_nop 1
    v_pk_add_f32 v[48:49], v[48:49], v[50:51]
    v_cvt_pk_bf16_f32 v48, v48, v49
    v_mov_b32 v49, 0
    v_pk_add_f32 v[52:53], v[52:53], v[54:55]
    v_cvt_pk_bf16_f32 v52, v52, v53
    v_mov_b32 v53, 0
    v_mfma_f32_32x32x16_bf16 v[0:15], v[72:75], v[72:75], 0
    v_mfma_f32_32x32x16_bf16 v[16:31], v[72:75], v[72:75], 0
    v_mov_b32 v110, v48
    v_mov_b32 v111, v52
    s_cmp_eq_u32 s68, 63
    s_cbranch_scc1 c_end_74
    s_waitcnt lgkmcnt(0)
    s_barrier
    ds_read_b128 v[44:47], v116 offset:16384
    ds_read_b64 v[126:127], v116 offset:17408
    v_add_u32 v122, 32768, v107
    s_add_u32 s76, s68, 1
    v_mov_b32 v123, 0
    v_mov_b32 v124, s76
    s_waitcnt lgkmcnt(1)
    v_mfma_f32_16x16x32_bf16 v[56:59], v[32:35], v[44:47], 0
    v_mfma_f32_16x16x32_bf16 v[60:63], v[36:39], v[44:47], 0
    s_waitcnt lgkmcnt(0)
    s_nop 3
    v_mfma_f32_16x16x16_bf16 v[56:59], v[48:49], v[126:127], v[56:59]
    v_mfma_f32_16x16x16_bf16 v[60:63], v[52:53], v[126:127], v[60:63]
    s_nop 6
    v_cvt_pk_bf16_f32 v56, v56, v57
    v_cvt_pk_bf16_f32 v57, v58, v59
    ds_write_b64 v112, v[56:57] offset:192
    v_cvt_pk_bf16_f32 v60, v60, v61
    v_cvt_pk_bf16_f32 v61, v62, v63
    ds_write_b64 v112, v[60:61] offset:224
    s_waitcnt lgkmcnt(0)
    s_barrier
    ds_read_b128 v[40:43], v113 offset:0
    ds_read_b128 v[44:47], v113 offset:128
    s_waitcnt lgkmcnt(1)
    v_smfmac_f32_16x16x64_bf16 v[0:3], v[40:43], v[128:135], v104
    v_smfmac_f32_16x16x64_bf16 v[4:7], v[40:43], v[144:151], v104
    s_waitcnt lgkmcnt(0)
    v_smfmac_f32_16x16x64_bf16 v[0:3], v[44:47], v[136:143], v104
    v_smfmac_f32_16x16x64_bf16 v[4:7], v[44:47], v[152:159], v104
    v_smfmac_f32_16x16x64_bf16 v[8:11], v[40:43], v[160:167], v104
    v_smfmac_f32_16x16x64_bf16 v[12:15], v[40:43], v[176:183], v104
    s_nop 4
    v_add_f32 v0, v0, v2
    v_add_f32 v1, v1, v3
    v_smfmac_f32_16x16x64_bf16 v[8:11], v[44:47], v[168:175], v104
    v_cvt_pk_bf16_f32 v32, v0, v1
    v_add_f32 v4, v4, v6
    v_smfmac_f32_16x16x64_bf16 v[12:15], v[44:47], v[184:191], v104
    v_add_f32 v5, v5, v7
    v_cvt_pk_bf16_f32 v33, v4, v5
    v_smfmac_f32_16x16x64_bf16 v[16:19], v[40:43], v[192:199], v104
    v_smfmac_f32_16x16x64_bf16 v[20:23], v[40:43], v[208:215], v104
    s_nop 0
    v_add_f32 v8, v8, v10
    v_add_f32 v9, v9, v11
    v_smfmac_f32_16x16x64_bf16 v[16:19], v[44:47], v[200:207], v104
    v_cvt_pk_bf16_f32 v34, v8, v9
    v_add_f32 v12, v12, v14
    v_smfmac_f32_16x16x64_bf16 v[20:23], v[44:47], v[216:223], v104
    v_add_f32 v13, v13, v15
    v_cvt_pk_bf16_f32 v35, v12, v13
    v_smfmac_f32_16x16x64_bf16 v[24:27], v[40:43], v[224:231], v104
    global_store_dwordx4 v107, v[32:35], s[46:47]
    global_store_dword v123, v124, s[8:9]
    v_smfmac_f32_16x16x64_bf16 v[28:31], v[40:43], v[240:247], v104
    v_add_f32 v16, v16, v18
    v_add_f32 v17, v17, v19
    v_smfmac_f32_16x16x64_bf16 v[24:27], v[44:47], v[232:239], v104
    v_cvt_pk_bf16_f32 v36, v16, v17
    v_add_f32 v20, v20, v22
    v_smfmac_f32_16x16x64_bf16 v[28:31], v[44:47], v[248:255], v104
    v_add_f32 v21, v21, v23
    v_cvt_pk_bf16_f32 v37, v20, v21
    s_nop 2
    v_pk_add_f32 v[24:25], v[24:25], v[26:27]
    s_nop 1
    v_pk_add_f32 v[28:29], v[28:29], v[30:31]
    v_cvt_pk_bf16_f32 v38, v24, v25
    v_cvt_pk_bf16_f32 v39, v28, v29
    global_store_dwordx4 v122, v[36:39], s[46:47]
    global_store_dword v123, v124, s[8:9] offset:128
    s_add_u32 s80, s80, 262144
    s_addc_u32 s81, s81, 0
    v_lshlrev_b32 v127, 3, v105
    v_cmp_le_u32 vcc, 64, v120
    s_cbranch_vccnz c_fok_127
    v_mov_b32 v122, s101
c_fl_128:
    global_load_dword v120, v122, s[4:5] sc1
    s_add_u32 s69, s69, 1
    s_cmp_gt_u32 s69, 0x80000
    s_cbranch_scc1 L_fail
    s_waitcnt vmcnt(0)
    v_cmp_gt_u32 vcc, 64, v120
    s_cbranch_vccnz c_fl_128
c_fok_127:
    s_add_u32 s101, s101, 128
    s_min_u32 s101, s101, 3968
    s_add_u32 s86, s86, 65536
    s_addc_u32 s87, s87, 0
    s_mov_b64 s[70:71], s[60:61]
    s_mov_b64 s[60:61], s[62:63]
    s_mov_b64 s[62:63], s[64:65]
    s_mov_b64 s[64:65], s[66:67]
    s_mov_b64 s[66:67], s[70:71]
    s_add_u32 s68, s68, 1
    v_mfma_f32_32x32x16_bf16 v[32:47], v[72:75], v[72:75], 0
    v_mfma_f32_16x16x32_bf16 v[48:51], v[72:75], v[72:75], 0
    v_mfma_f32_16x16x32_bf16 v[52:55], v[72:75], v[72:75], 0
    v_mfma_f32_16x16x32_bf16 v[100:103], v[72:75], v[72:75], 0
    ds_read_b128 v[56:59], v114 offset:61440
    ds_read_b128 v[60:63], v114 offset:62464
    ds_read_b128 v[64:67], v114 offset:63488
    ds_read_b128 v[68:71], v114 offset:64512
    ds_read_b128 v[72:75], v115 offset:61440
    ds_read_b128 v[76:79], v115 offset:62464
    ds_read_b128 v[80:83], v115 offset:63488
    ds_read_b128 v[84:87], v115 offset:64512
    ds_read_b128 v[88:91], v114 offset:12288
    ds_read_b128 v[92:95], v114 offset:13312
    s_barrier
    global_load_dwordx4 v[12:15], v106, s[60:61] sc1
    global_load_dwordx4 v[28:31], v106, s[60:61] offset:1024 sc1
    s_branch c_chk0_121
c_pollm_88:
    global_load_dwordx4 v[0:3], v106, s[60:61] sc1
    global_load_dwordx4 v[16:19], v106, s[60:61] offset:1024 sc1
    s_branch c_chk1_89
c_pollm_104:
    global_load_dwordx4 v[4:7], v106, s[60:61] sc1
    global_load_dwordx4 v[20:23], v106, s[60:61] offset:1024 sc1
    s_branch c_chk1_105
c_pollm_113:
    global_load_dwordx4 v[8:11], v106, s[60:61] sc1
    global_load_dwordx4 v[24:27], v106, s[60:61] offset:1024 sc1
    s_branch c_chk1_114
c_pollm_124:
    global_load_dwordx4 v[12:15], v106, s[60:61] sc1
    global_load_dwordx4 v[28:31], v106, s[60:61] offset:1024 sc1
    s_branch c_chk1_125
c_retry_78:
    s_add_u32 s69, s69, 1
    s_cmp_lt_u32 s69, 0x80000
    s_cbranch_scc1 c_pollm_77
    s_branch L_fail
c_retry_86:
    s_add_u32 s69, s69, 1
    s_cmp_lt_u32 s69, 0x80000
    s_cbranch_scc1 c_light_84
    s_branch L_fail
c_retry_90:
    s_add_u32 s69, s69, 1
    s_cmp_lt_u32 s69, 0x80000
    s_cbranch_scc1 c_pollm_88
    s_branch L_fail
c_retry_98:
    s_add_u32 s69, s69, 1
    s_cmp_lt_u32 s69, 0x80000
    s_cbranch_scc1 c_light_96
    s_branch L_fail
c_retry_103:
    s_add_u32 s69, s69, 1
    s_cmp_lt_u32 s69, 0x80000
    s_cbranch_scc1 c_pollm_102
    s_branch L_fail
c_retry_106:
    s_add_u32 s69, s69, 1
    s_cmp_lt_u32 s69, 0x80000
    s_cbranch_scc1 c_pollm_104
    s_branch L_fail
c_retry_112:
    s_add_u32 s69, s69, 1
    s_cmp_lt_u32 s69, 0x80000
    s_cbranch_scc1 c_pollm_111
    s_branch L_fail
c_retry_115:
    s_add_u32 s69, s69, 1
    s_cmp_lt_u32 s69, 0x80000
    s_cbranch_scc1 c_pollm_113
    s_branch L_fail
c_retry_123:
    s_add_u32 s69, s69, 1
    s_cmp_lt_u32 s69, 0x80000
    s_cbranch_scc1 c_pollm_122
    s_branch L_fail
c_retry_126:
    s_add_u32 s69, s69, 1
    s_cmp_lt_u32 s69, 0x80000
    s_cbranch_scc1 c_pollm_124
    s_branch L_fail
c_re_87:
    global_load_dword v127, v126, s[10:11] sc1
    s_add_u32 s69, s69, 1
    s_cmp_lt_u32 s69, 0x80000
    s_cbranch_scc1 c_pollp_81
    s_branch L_fail
c_re_99:
    global_load_dword v127, v126, s[10:11] sc1
    s_add_u32 s69, s69, 1
    s_cmp_lt_u32 s69, 0x80000
    s_cbranch_scc1 c_pollp_93
    s_branch L_fail
c_slow_82:
    s_mov_b64 exec, -1
    s_add_u32 s69, s69, 1
    s_cmp_gt_u32 s69, 0x80000
    s_cbranch_scc1 L_fail
    s_and_b32 s70, s69, 31
    s_cmp_lg_u32 s70, 0
    s_cbranch_scc1 c_pollp_81
    s_mov_b32 s70, 2139193217
    s_mov_b64 s[72:73], 0
    v_cmp_eq_u32 vcc, s70, v0
    s_nop 0
    s_or_b64 s[72:73], s[72:73], vcc
    v_cmp_eq_u32 vcc, s70, v1
    s_nop 0
    s_or_b64 s[72:73], s[72:73], vcc
    v_cmp_eq_u32 vcc, s70, v2
    s_nop 0
    s_or_b64 s[72:73], s[72:73], vcc
    v_cmp_eq_u32 vcc, s70, v3
    s_nop 0
    s_or_b64 s[72:73], s[72:73], vcc
    v_cmp_eq_u32 vcc, s70, v4
    s_nop 0
    s_or_b64 s[72:73], s[72:73], vcc
    v_cmp_eq_u32 vcc, s70, v5
    s_nop 0
    s_or_b64 s[72:73], s[72:73], vcc
    v_cmp_eq_u32 vcc, s70, v6
    s_nop 0
    s_or_b64 s[72:73], s[72:73], vcc
    v_cmp_eq_u32 vcc, s70, v7
    s_nop 0
    s_or_b64 s[72:73], s[72:73], vcc
    v_cmp_eq_u32 vcc, s70, v8
    s_nop 0
    s_or_b64 s[72:73], s[72:73], vcc
    v_cmp_eq_u32 vcc, s70, v9
    s_nop 0
    s_or_b64 s[72:73], s[72:73], vcc
    v_cmp_eq_u32 vcc, s70, v10
    s_nop 0
    s_or_b64 s[72:73], s[72:73], vcc
    v_cmp_eq_u32 vcc, s70, v11
    s_nop 0
    s_or_b64 s[72:73], s[72:73], vcc
    v_cmp_eq_u32 vcc, s70, v12
    s_nop 0
    s_or_b64 s[72:73], s[72:73], vcc
    v_cmp_eq_u32 vcc, s70, v13
    s_nop 0
    s_or_b64 s[72:73], s[72:73], vcc
    v_cmp_eq_u32 vcc, s70, v14
    s_nop 0
    s_or_b64 s[72:73], s[72:73], vcc
    v_cmp_eq_u32 vcc, s70, v15
    s_nop 0
    s_or_b64 s[72:73], s[72:73], vcc
    v_cmp_eq_u32 vcc, s70, v16
    s_nop 0
    s_or_b64 s[72:73], s[72:73], vcc
    v_cmp_eq_u32 vcc, s70, v17
    s_nop 0
    s_or_b64 s[72:73], s[72:73], vcc
    v_cmp_eq_u32 vcc, s70, v18
    s_nop 0
    s_or_b64 s[72:73], s[72:73], vcc
    v_cmp_eq_u32 vcc, s70, v19
    s_nop 0
    s_or_b64 s[72:73], s[72:73], vcc
    v_cmp_eq_u32 vcc, s70, v20
    s_nop 0
    s_or_b64 s[72:73], s[72:73], vcc
    v_cmp_eq_u32 vcc, s70, v21
    s_nop 0
    s_or_b64 s[72:73], s[72:73], vcc
    v_cmp_eq_u32 vcc, s70, v22
    s_nop 0
    s_or_b64 s[72:73], s[72:73], vcc
    v_cmp_eq_u32 vcc, s70, v23
    s_nop 0
    s_or_b64 s[72:73], s[72:73], vcc
    v_cmp_eq_u32 vcc, s70, v24
    s_nop 0
    s_or_b64 s[72:73], s[72:73], vcc
    v_cmp_eq_u32 vcc, s70, v25
    s_nop 0
    s_or_b64 s[72:73], s[72:73], vcc
    v_cmp_eq_u32 vcc, s70, v26
    s_nop 0
    s_or_b64 s[72:73], s[72:73], vcc
    v_cmp_eq_u32 vcc, s70, v27
    s_nop 0
    s_or_b64 s[72:73], s[72:73], vcc
    v_cmp_eq_u32 vcc, s70, v28
    s_nop 0
    s_or_b64 s[72:73], s[72:73], vcc
    v_cmp_eq_u32 vcc, s70, v29
    s_nop 0
    s_or_b64 s[72:73], s[72:73], vcc
    v_cmp_eq_u32 vcc, s70, v30
    s_nop 0
    s_or_b64 s[72:73], s[72:73], vcc
    v_cmp_eq_u32 vcc, s70, v31
    s_nop 0
    s_or_b64 s[72:73], s[72:73], vcc
    s_cmp_lg_u64 s[72:73], 0
    s_cbranch_scc1 c_pollp_81
    s_mov_b64 exec, s[42:43]
    s_branch c_ok_83
c_slow_94:
    s_mov_b64 exec, -1
    s_add_u32 s69, s69, 1
    s_cmp_gt_u32 s69, 0x80000
    s_cbranch_scc1 L_fail
    s_and_b32 s70, s69, 31
    s_cmp_lg_u32 s70, 0
    s_cbranch_scc1 c_pollp_93
    s_mov_b32 s70, 2139193217
    s_mov_b64 s[72:73], 0
    v_cmp_eq_u32 vcc, s70, v0
    s_nop 0
    s_or_b64 s[72:73], s[72:73], vcc
    v_cmp_eq_u32 vcc, s70, v1
    s_nop 0
    s_or_b64 s[72:73], s[72:73], vcc
    v_cmp_eq_u32 vcc, s70, v2
    s_nop 0
    s_or_b64 s[72:73], s[72:73], vcc
    v_cmp_eq_u32 vcc, s70, v3
    s_nop 0
    s_or_b64 s[72:73], s[72:73], vcc
    v_cmp_eq_u32 vcc, s70, v4
    s_nop 0
    s_or_b64 s[72:73], s[72:73], vcc
    v_cmp_eq_u32 vcc, s70, v5
    s_nop 0
    s_or_b64 s[72:73], s[72:73], vcc
    v_cmp_eq_u32 vcc, s70, v6
    s_nop 0
    s_or_b64 s[72:73], s[72:73], vcc
    v_cmp_eq_u32 vcc, s70, v7
    s_nop 0
    s_or_b64 s[72:73], s[72:73], vcc
    v_cmp_eq_u32 vcc, s70, v8
    s_nop 0
    s_or_b64 s[72:73], s[72:73], vcc
    v_cmp_eq_u32 vcc, s70, v9
    s_nop 0
    s_or_b64 s[72:73], s[72:73], vcc
    v_cmp_eq_u32 vcc, s70, v10
    s_nop 0
    s_or_b64 s[72:73], s[72:73], vcc
    v_cmp_eq_u32 vcc, s70, v11
    s_nop 0
    s_or_b64 s[72:73], s[72:73], vcc
    v_cmp_eq_u32 vcc, s70, v12
    s_nop 0
    s_or_b64 s[72:73], s[72:73], vcc
    v_cmp_eq_u32 vcc, s70, v13
    s_nop 0
    s_or_b64 s[72:73], s[72:73], vcc
    v_cmp_eq_u32 vcc, s70, v14
    s_nop 0
    s_or_b64 s[72:73], s[72:73], vcc
    v_cmp_eq_u32 vcc, s70, v15
    s_nop 0
    s_or_b64 s[72:73], s[72:73], vcc
    v_cmp_eq_u32 vcc, s70, v16
    s_nop 0
    s_or_b64 s[72:73], s[72:73], vcc
    v_cmp_eq_u32 vcc, s70, v17
    s_nop 0
    s_or_b64 s[72:73], s[72:73], vcc
    v_cmp_eq_u32 vcc, s70, v18
    s_nop 0
    s_or_b64 s[72:73], s[72:73], vcc
    v_cmp_eq_u32 vcc, s70, v19
    s_nop 0
    s_or_b64 s[72:73], s[72:73], vcc
    v_cmp_eq_u32 vcc, s70, v20
    s_nop 0
    s_or_b64 s[72:73], s[72:73], vcc
    v_cmp_eq_u32 vcc, s70, v21
    s_nop 0
    s_or_b64 s[72:73], s[72:73], vcc
    v_cmp_eq_u32 vcc, s70, v22
    s_nop 0
    s_or_b64 s[72:73], s[72:73], vcc
    v_cmp_eq_u32 vcc, s70, v23
    s_nop 0
    s_or_b64 s[72:73], s[72:73], vcc
    v_cmp_eq_u32 vcc, s70, v24
    s_nop 0
    s_or_b64 s[72:73], s[72:73], vcc
    v_cmp_eq_u32 vcc, s70, v25
    s_nop 0
    s_or_b64 s[72:73], s[72:73], vcc
    v_cmp_eq_u32 vcc, s70, v26
    s_nop 0
    s_or_b64 s[72:73], s[72:73], vcc
    v_cmp_eq_u32 vcc, s70, v27
    s_nop 0
    s_or_b64 s[72:73], s[72:73], vcc
    v_cmp_eq_u32 vcc, s70, v28
    s_nop 0
    s_or_b64 s[72:73], s[72:73], vcc
    v_cmp_eq_u32 vcc, s70, v29
    s_nop 0
    s_or_b64 s[72:73], s[72:73], vcc
    v_cmp_eq_u32 vcc, s70, v30
    s_nop 0
    s_or_b64 s[72:73], s[72:73], vcc
    v_cmp_eq_u32 vcc, s70, v31
    s_nop 0
    s_or_b64 s[72:73], s[72:73], vcc
    s_cmp_lg_u64 s[72:73], 0
    s_cbranch_scc1 c_pollp_93
    s_mov_b64 exec, s[42:43]
    s_branch c_ok_95
c_fb_79:
    s_nop 7
    v_max_f32 v122, v40, v41
    v_mov_b32 v123, v122
    s_nop 1
    v_permlane32_swap_b32 v123, v122
    v_max_f32 v122, v123, v122
    v_mov_b32 v123, v122
    s_nop 1
    v_permlane16_swap_b32 v123, v122
    v_max_f32 v122, v123, v122
    v_max_f32 v122, 0, v122
    v_sub_f32 v40, v40, v122
    v_sub_f32 v41, v41, v122
    v_sub_f32 v122, 0, v122
    v_exp_f32 v122, v122
    s_nop 0
    v_mul_f32 v32, v32, v122
    v_mul_f32 v33, v33, v122
    v_mul_f32 v34, v34, v122
    v_mul_f32 v35, v35, v122
    v_mul_f32 v36, v36, v122
    v_mul_f32 v37, v37, v122
    v_mul_f32 v38, v38, v122
    v_mul_f32 v39, v39, v122
    s_branch c_fr_80
c_fb_91:
    s_nop 7
    v_max_f32 v122, v40, v41
    v_mov_b32 v123, v122
    s_nop 1
    v_permlane32_swap_b32 v123, v122
    v_max_f32 v122, v123, v122
    v_mov_b32 v123, v122
    s_nop 1
    v_permlane16_swap_b32 v123, v122
    v_max_f32 v122, v123, v122
    v_max_f32 v122, 0, v122
    v_sub_f32 v40, v40, v122
    v_sub_f32 v41, v41, v122
    v_sub_f32 v122, 0, v122
    v_exp_f32 v122, v122
    s_nop 0
    v_mul_f32 v32, v32, v122
    v_mul_f32 v33, v33, v122
    v_mul_f32 v34, v34, v122
    v_mul_f32 v35, v35, v122
    v_mul_f32 v36, v36, v122
    v_mul_f32 v37, v37, v122
    v_mul_f32 v38, v38, v122
    v_mul_f32 v39, v39, v122
    s_branch c_fr_92
c_end_74:
    s_nop 0
    s_add_u32 s86, s86, 65536
    s_addc_u32 s87, s87, 0
    s_cmp_lg_u32 s34, 1
    s_cbranch_scc1 c_fv_130
    s_add_u32 s84, s84, 131072
    s_addc_u32 s85, s85, 0
    ds_read_b128 v[0:3], v120
    ds_read_b128 v[4:7], v120 offset:1152
    s_waitcnt lgkmcnt(0)
    global_store_dwordx4 v105, v[0:3], s[84:85] sc1
    global_store_dwordx4 v105, v[4:7], s[84:85] offset:1024 sc1
    global_store_dword v121, v110, s[86:87] offset:0 sc1
    global_store_dword v121, v111, s[86:87] offset:256 sc1
    global_store_dword v121, v119, s[86:87] offset:512 sc1
c_fv_130:
    s_cmp_lg_u32 s34, 2
    s_cbranch_scc1 c_fv_131
    global_store_dword v121, v110, s[86:87] offset:768 sc1
    global_store_dword v121, v111, s[86:87] offset:1024 sc1
    global_store_dword v121, v119, s[86:87] offset:1280 sc1
c_fv_131:
    s_cmp_lg_u32 s34, 3
    s_cbranch_scc1 c_fv_132
    global_store_dword v121, v110, s[86:87] offset:1536 sc1
    global_store_dword v121, v111, s[86:87] offset:1792 sc1
c_fv_132:
    s_waitcnt vmcnt(0) lgkmcnt(0)
    s_barrier
    s_cmp_lg_u32 s34, 1
    s_cbranch_scc1 c_fin_129
    v_mov_b32 v122, s100
    v_mov_b32 v124, 64
    global_store_dword v122, v124, s[4:5] sc1
c_fin_129:
    s_waitcnt lgkmcnt(0) vmcnt(0)
    s_endpgm
L_bulk:
    s_sub_u32 s50, s3, 32
    s_cmp_lt_u32 s3, 32
    s_cbranch_scc1 L_front
    s_cmp_ge_u32 s50, 64
    s_cbranch_scc1 L_gonly
    v_mbcnt_lo_u32_b32 v120, -1, 0
    v_mbcnt_hi_u32_b32 v120, -1, v120
    v_lshrrev_b32 v121, 4, v120
    v_and_b32 v122, 15, v120
    s_lshl_b32 s70, s50, 4
    s_lshl_b32 s71, s34, 2
    s_add_u32 s70, s70, s71
    v_add_u32 v123, s70, v121
    v_lshlrev_b32 v123, 10, v123
    v_lshl_add_u32 v123, v122, 4, v123
    global_load_dwordx4 v[128:131], v123, s[18:19] offset:0
    global_load_dwordx4 v[132:135], v123, s[18:19] offset:256
    global_load_dwordx4 v[136:139], v123, s[18:19] offset:512
    global_load_dwordx4 v[140:143], v123, s[18:19] offset:768
    v_add_u32 v123, 1048576, v123
    global_load_dwordx4 v[96:99], v123, s[18:19] offset:0
    global_load_dwordx4 v[100:103], v123, s[18:19] offset:256
    global_load_dwordx4 v[104:107], v123, s[18:19] offset:512
    global_load_dwordx4 v[108:111], v123, s[18:19] offset:768
    s_waitcnt vmcnt(4)
    v_lshlrev_b32 v144, 16, v128
    v_and_b32 v145, 0xffff0000, v128
    v_lshlrev_b32 v146, 16, v129
    v_and_b32 v147, 0xffff0000, v129
    v_lshlrev_b32 v148, 16, v130
    v_and_b32 v149, 0xffff0000, v130
    v_lshlrev_b32 v150, 16, v131
    v_and_b32 v151, 0xffff0000, v131
    v_lshlrev_b32 v152, 16, v132
    v_and_b32 v153, 0xffff0000, v132
    v_lshlrev_b32 v154, 16, v133
    v_and_b32 v155, 0xffff0000, v133
    v_lshlrev_b32 v156, 16, v134
    v_and_b32 v157, 0xffff0000, v134
    v_lshlrev_b32 v158, 16, v135
    v_and_b32 v159, 0xffff0000, v135
    v_lshlrev_b32 v160, 16, v136
    v_and_b32 v161, 0xffff0000, v136
    v_lshlrev_b32 v162, 16, v137
    v_and_b32 v163, 0xffff0000, v137
    v_lshlrev_b32 v164, 16, v138
    v_and_b32 v165, 0xffff0000, v138
    v_lshlrev_b32 v166, 16, v139
    v_and_b32 v167, 0xffff0000, v139
    v_lshlrev_b32 v168, 16, v140
    v_and_b32 v169, 0xffff0000, v140
    v_lshlrev_b32 v170, 16, v141
    v_and_b32 v171, 0xffff0000, v141
    v_lshlrev_b32 v172, 16, v142
    v_and_b32 v173, 0xffff0000, v142
    v_lshlrev_b32 v174, 16, v143
    v_and_b32 v175, 0xffff0000, v143
    v_pk_add_f32 v[240:241], v[144:145], v[146:147]
    v_pk_add_f32 v[240:241], v[240:241], v[148:149]
    v_pk_add_f32 v[240:241], v[240:241], v[150:151]
    v_pk_add_f32 v[240:241], v[240:241], v[152:153]
    v_pk_add_f32 v[240:241], v[240:241], v[154:155]
    v_pk_add_f32 v[240:241], v[240:241], v[156:157]
    v_pk_add_f32 v[240:241], v[240:241], v[158:159]
    v_pk_add_f32 v[240:241], v[240:241], v[160:161]
    v_pk_add_f32 v[240:241], v[240:241], v[162:163]
    v_pk_add_f32 v[240:241], v[240:241], v[164:165]
    v_pk_add_f32 v[240:241], v[240:241], v[166:167]
    v_pk_add_f32 v[240:241], v[240:241], v[168:169]
    v_pk_add_f32 v[240:241], v[240:241], v[170:171]
    v_pk_add_f32 v[240:241], v[240:241], v[172:173]
    v_pk_add_f32 v[240:241], v[240:241], v[174:175]
    v_add_f32 v240, v240, v241
    s_nop 1
    v_add_f32_dpp v240, v240, v240 row_ror:8 row_mask:0xf bank_mask:0xf
    s_nop 1
    v_add_f32_dpp v240, v240, v240 row_ror:4 row_mask:0xf bank_mask:0xf
    s_nop 1
    v_add_f32_dpp v240, v240, v240 row_ror:2 row_mask:0xf bank_mask:0xf
    s_nop 1
    v_add_f32_dpp v240, v240, v240 row_ror:1 row_mask:0xf bank_mask:0xf
    v_mul_f32 v240, 989855744, v240
    v_mov_b32 v241, v240
    v_mov_b64 v[242:243], 0
    v_pk_add_f32 v[244:245], v[144:145], v[240:241] neg_lo:[0,1] neg_hi:[0,1]
    v_pk_fma_f32 v[242:243], v[244:245], v[244:245], v[242:243]
    v_pk_add_f32 v[244:245], v[146:147], v[240:241] neg_lo:[0,1] neg_hi:[0,1]
    v_pk_fma_f32 v[242:243], v[244:245], v[244:245], v[242:243]
    v_pk_add_f32 v[244:245], v[148:149], v[240:241] neg_lo:[0,1] neg_hi:[0,1]
    v_pk_fma_f32 v[242:243], v[244:245], v[244:245], v[242:243]
    v_pk_add_f32 v[244:245], v[150:151], v[240:241] neg_lo:[0,1] neg_hi:[0,1]
    v_pk_fma_f32 v[242:243], v[244:245], v[244:245], v[242:243]
    v_pk_add_f32 v[244:245], v[152:153], v[240:241] neg_lo:[0,1] neg_hi:[0,1]
    v_pk_fma_f32 v[242:243], v[244:245], v[244:245], v[242:243]
    v_pk_add_f32 v[244:245], v[154:155], v[240:241] neg_lo:[0,1] neg_hi:[0,1]
    v_pk_fma_f32 v[242:243], v[244:245], v[244:245], v[242:243]
    v_pk_add_f32 v[244:245], v[156:157], v[240:241] neg_lo:[0,1] neg_hi:[0,1]
    v_pk_fma_f32 v[242:243], v[244:245], v[244:245], v[242:243]
    v_pk_add_f32 v[244:245], v[158:159], v[240:241] neg_lo:[0,1] neg_hi:[0,1]
    v_pk_fma_f32 v[242:243], v[244:245], v[244:245], v[242:243]
    v_pk_add_f32 v[244:245], v[160:161], v[240:241] neg_lo:[0,1] neg_hi:[0,1]
    v_pk_fma_f32 v[242:243], v[244:245], v[244:245], v[242:243]
    v_pk_add_f32 v[244:245], v[162:163], v[240:241] neg_lo:[0,1] neg_hi:[0,1]
    v_pk_fma_f32 v[242:243], v[244:245], v[244:245], v[242:243]
    v_pk_add_f32 v[244:245], v[164:165], v[240:241] neg_lo:[0,1] neg_hi:[0,1]
    v_pk_fma_f32 v[242:243], v[244:245], v[244:245], v[242:243]
    v_pk_add_f32 v[244:245], v[166:167], v[240:241] neg_lo:[0,1] neg_hi:[0,1]
    v_pk_fma_f32 v[242:243], v[244:245], v[244:245], v[242:243]
    v_pk_add_f32 v[244:245], v[168:169], v[240:241] neg_lo:[0,1] neg_hi:[0,1]
    v_pk_fma_f32 v[242:243], v[244:245], v[244:245], v[242:243]
    v_pk_add_f32 v[244:245], v[170:171], v[240:241] neg_lo:[0,1] neg_hi:[0,1]
    v_pk_fma_f32 v[242:243], v[244:245], v[244:245], v[242:243]
    v_pk_add_f32 v[244:245], v[172:173], v[240:241] neg_lo:[0,1] neg_hi:[0,1]
    v_pk_fma_f32 v[242:243], v[244:245], v[244:245], v[242:243]
    v_pk_add_f32 v[244:245], v[174:175], v[240:241] neg_lo:[0,1] neg_hi:[0,1]
    v_pk_fma_f32 v[242:243], v[244:245], v[244:245], v[242:243]
    v_add_f32 v242, v242, v243
    s_nop 1
    v_add_f32_dpp v242, v242, v242 row_ror:8 row_mask:0xf bank_mask:0xf
    s_nop 1
    v_add_f32_dpp v242, v242, v242 row_ror:4 row_mask:0xf bank_mask:0xf
    s_nop 1
    v_add_f32_dpp v242, v242, v242 row_ror:2 row_mask:0xf bank_mask:0xf
    s_nop 1
    v_add_f32_dpp v242, v242, v242 row_ror:1 row_mask:0xf bank_mask:0xf
    v_mul_f32 v242, 989855744, v242
    v_cvt_pk_bf16_f32 v242, v242, v242
    v_lshlrev_b32 v242, 16, v242
    v_add_f32 v242, 925353388, v242
    v_cvt_pk_bf16_f32 v242, v242, v242
    v_lshlrev_b32 v242, 16, v242
    v_sqrt_f32 v242, v242
    s_nop 0
    v_cvt_pk_bf16_f32 v242, v242, v242
    v_lshlrev_b32 v242, 16, v242
    v_rcp_f32 v241, v242
    v_cvt_pk_bf16_f32 v240, v240, v240
    v_lshlrev_b32 v240, 16, v240
    s_waitcnt vmcnt(0)
    v_lshlrev_b32 v64, 16, v96
    v_and_b32 v65, 0xffff0000, v96
    v_lshlrev_b32 v66, 16, v97
    v_and_b32 v67, 0xffff0000, v97
    v_lshlrev_b32 v68, 16, v98
    v_and_b32 v69, 0xffff0000, v98
    v_lshlrev_b32 v70, 16, v99
    v_and_b32 v71, 0xffff0000, v99
    v_lshlrev_b32 v72, 16, v100
    v_and_b32 v73, 0xffff0000, v100
    v_lshlrev_b32 v74, 16, v101
    v_and_b32 v75, 0xffff0000, v101
    v_lshlrev_b32 v76, 16, v102
    v_and_b32 v77, 0xffff0000, v102
    v_lshlrev_b32 v78, 16, v103
    v_and_b32 v79, 0xffff0000, v103
    v_lshlrev_b32 v80, 16, v104
    v_and_b32 v81, 0xffff0000, v104
    v_lshlrev_b32 v82, 16, v105
    v_and_b32 v83, 0xffff0000, v105
    v_lshlrev_b32 v84, 16, v106
    v_and_b32 v85, 0xffff0000, v106
    v_lshlrev_b32 v86, 16, v107
    v_and_b32 v87, 0xffff0000, v107
    v_lshlrev_b32 v88, 16, v108
    v_and_b32 v89, 0xffff0000, v108
    v_lshlrev_b32 v90, 16, v109
    v_and_b32 v91, 0xffff0000, v109
    v_lshlrev_b32 v92, 16, v110
    v_and_b32 v93, 0xffff0000, v110
    v_lshlrev_b32 v94, 16, v111
    v_and_b32 v95, 0xffff0000, v111
    v_pk_add_f32 v[112:113], v[64:65], v[66:67]
    v_pk_add_f32 v[112:113], v[112:113], v[68:69]
    v_pk_add_f32 v[112:113], v[112:113], v[70:71]
    v_pk_add_f32 v[112:113], v[112:113], v[72:73]
    v_pk_add_f32 v[112:113], v[112:113], v[74:75]
    v_pk_add_f32 v[112:113], v[112:113], v[76:77]
    v_pk_add_f32 v[112:113], v[112:113], v[78:79]
    v_pk_add_f32 v[112:113], v[112:113], v[80:81]
    v_pk_add_f32 v[112:113], v[112:113], v[82:83]
    v_pk_add_f32 v[112:113], v[112:113], v[84:85]
    v_pk_add_f32 v[112:113], v[112:113], v[86:87]
    v_pk_add_f32 v[112:113], v[112:113], v[88:89]
    v_pk_add_f32 v[112:113], v[112:113], v[90:91]
    v_pk_add_f32 v[112:113], v[112:113], v[92:93]
    v_pk_add_f32 v[112:113], v[112:113], v[94:95]
    v_add_f32 v112, v112, v113
    s_nop 1
    v_add_f32_dpp v112, v112, v112 row_ror:8 row_mask:0xf bank_mask:0xf
    s_nop 1
    v_add_f32_dpp v112, v112, v112 row_ror:4 row_mask:0xf bank_mask:0xf
    s_nop 1
    v_add_f32_dpp v112, v112, v112 row_ror:2 row_mask:0xf bank_mask:0xf
    s_nop 1
    v_add_f32_dpp v112, v112, v112 row_ror:1 row_mask:0xf bank_mask:0xf
    v_mul_f32 v112, 989855744, v112
    v_mov_b32 v113, v112
    v_mov_b64 v[114:115], 0
    v_pk_add_f32 v[116:117], v[64:65], v[112:113] neg_lo:[0,1] neg_hi:[0,1]
    v_pk_fma_f32 v[114:115], v[116:117], v[116:117], v[114:115]
    v_pk_add_f32 v[116:117], v[66:67], v[112:113] neg_lo:[0,1] neg_hi:[0,1]
    v_pk_fma_f32 v[114:115], v[116:117], v[116:117], v[114:115]
    v_pk_add_f32 v[116:117], v[68:69], v[112:113] neg_lo:[0,1] neg_hi:[0,1]
    v_pk_fma_f32 v[114:115], v[116:117], v[116:117], v[114:115]
    v_pk_add_f32 v[116:117], v[70:71], v[112:113] neg_lo:[0,1] neg_hi:[0,1]
    v_pk_fma_f32 v[114:115], v[116:117], v[116:117], v[114:115]
    v_pk_add_f32 v[116:117], v[72:73], v[112:113] neg_lo:[0,1] neg_hi:[0,1]
    v_pk_fma_f32 v[114:115], v[116:117], v[116:117], v[114:115]
    v_pk_add_f32 v[116:117], v[74:75], v[112:113] neg_lo:[0,1] neg_hi:[0,1]
    v_pk_fma_f32 v[114:115], v[116:117], v[116:117], v[114:115]
    v_pk_add_f32 v[116:117], v[76:77], v[112:113] neg_lo:[0,1] neg_hi:[0,1]
    v_pk_fma_f32 v[114:115], v[116:117], v[116:117], v[114:115]
    v_pk_add_f32 v[116:117], v[78:79], v[112:113] neg_lo:[0,1] neg_hi:[0,1]
    v_pk_fma_f32 v[114:115], v[116:117], v[116:117], v[114:115]
    v_pk_add_f32 v[116:117], v[80:81], v[112:113] neg_lo:[0,1] neg_hi:[0,1]
    v_pk_fma_f32 v[114:115], v[116:117], v[116:117], v[114:115]
    v_pk_add_f32 v[116:117], v[82:83], v[112:113] neg_lo:[0,1] neg_hi:[0,1]
    v_pk_fma_f32 v[114:115], v[116:117], v[116:117], v[114:115]
    v_pk_add_f32 v[116:117], v[84:85], v[112:113] neg_lo:[0,1] neg_hi:[0,1]
    v_pk_fma_f32 v[114:115], v[116:117], v[116:117], v[114:115]
    v_pk_add_f32 v[116:117], v[86:87], v[112:113] neg_lo:[0,1] neg_hi:[0,1]
    v_pk_fma_f32 v[114:115], v[116:117], v[116:117], v[114:115]
    v_pk_add_f32 v[116:117], v[88:89], v[112:113] neg_lo:[0,1] neg_hi:[0,1]
    v_pk_fma_f32 v[114:115], v[116:117], v[116:117], v[114:115]
    v_pk_add_f32 v[116:117], v[90:91], v[112:113] neg_lo:[0,1] neg_hi:[0,1]
    v_pk_fma_f32 v[114:115], v[116:117], v[116:117], v[114:115]
    v_pk_add_f32 v[116:117], v[92:93], v[112:113] neg_lo:[0,1] neg_hi:[0,1]
    v_pk_fma_f32 v[114:115], v[116:117], v[116:117], v[114:115]
    v_pk_add_f32 v[116:117], v[94:95], v[112:113] neg_lo:[0,1] neg_hi:[0,1]
    v_pk_fma_f32 v[114:115], v[116:117], v[116:117], v[114:115]
    v_add_f32 v114, v114, v115
    s_nop 1
    v_add_f32_dpp v114, v114, v114 row_ror:8 row_mask:0xf bank_mask:0xf
    s_nop 1
    v_add_f32_dpp v114, v114, v114 row_ror:4 row_mask:0xf bank_mask:0xf
    s_nop 1
    v_add_f32_dpp v114, v114, v114 row_ror:2 row_mask:0xf bank_mask:0xf
    s_nop 1
    v_add_f32_dpp v114, v114, v114 row_ror:1 row_mask:0xf bank_mask:0xf
    v_mul_f32 v114, 989855744, v114
    v_cvt_pk_bf16_f32 v114, v114, v114
    v_lshlrev_b32 v114, 16, v114
    v_add_f32 v114, 925353388, v114
    v_cvt_pk_bf16_f32 v114, v114, v114
    v_lshlrev_b32 v114, 16, v114
    v_sqrt_f32 v114, v114
    s_nop 0
    v_cvt_pk_bf16_f32 v114, v114, v114
    v_lshlrev_b32 v114, 16, v114
    v_rcp_f32 v113, v114
    v_cvt_pk_bf16_f32 v112, v112, v112
    v_lshlrev_b32 v112, 16, v112
    s_cmp_lg_u32 s34, 0
    s_cbranch_scc1 polld_134
    v_mov_b32 v124, 8
    s_mov_b32 s79, 0
    s_mov_b64 exec, 1
poll_133:
    global_load_dword v125, v124, s[6:7] sc1
    s_add_u32 s79, s79, 1
    s_cmp_gt_u32 s79, 0x80000
    s_cbranch_scc1 L_fail
    s_waitcnt vmcnt(0)
    v_cmp_le_u32 vcc, 256, v125
    s_cbranch_vccnz polld_134
    s_sleep 4
    s_branch poll_133
polld_134:
    s_mov_b64 exec, -1
    s_barrier
    s_cmp_lg_u32 s34, 0
    s_cbranch_scc1 polld_136
    v_mov_b32 v124, 16
    s_mov_b32 s79, 0
    s_mov_b64 exec, 1
poll_135:
    global_load_dword v125, v124, s[6:7] sc1
    s_add_u32 s79, s79, 1
    s_cmp_gt_u32 s79, 0x80000
    s_cbranch_scc1 L_fail
    s_waitcnt vmcnt(0)
    v_cmp_le_u32 vcc, 32, v125
    s_cbranch_vccnz polld_136
    s_sleep 2
    s_branch poll_135
polld_136:
    s_mov_b64 exec, -1
    s_barrier
    v_lshlrev_b32 v124, 5, v122
    v_add_u32 v124, 65536, v124
    global_load_dwordx4 v[208:211], v124, s[4:5] offset:0 sc1
    global_load_dwordx4 v[176:179], v124, s[4:5] offset:2048 sc1
    global_load_dwordx4 v[212:215], v124, s[4:5] offset:16 sc1
    global_load_dwordx4 v[180:183], v124, s[4:5] offset:2064 sc1
    global_load_dwordx4 v[216:219], v124, s[4:5] offset:512 sc1
    global_load_dwordx4 v[184:187], v124, s[4:5] offset:2560 sc1
    global_load_dwordx4 v[220:223], v124, s[4:5] offset:528 sc1
    global_load_dwordx4 v[188:191], v124, s[4:5] offset:2576 sc1
    global_load_dwordx4 v[224:227], v124, s[4:5] offset:1024 sc1
    global_load_dwordx4 v[192:195], v124, s[4:5] offset:3072 sc1
    global_load_dwordx4 v[228:231], v124, s[4:5] offset:1040 sc1
    global_load_dwordx4 v[196:199], v124, s[4:5] offset:3088 sc1
    global_load_dwordx4 v[232:235], v124, s[4:5] offset:1536 sc1
    global_load_dwordx4 v[200:203], v124, s[4:5] offset:3584 sc1
    global_load_dwordx4 v[236:239], v124, s[4:5] offset:1552 sc1
    global_load_dwordx4 v[204:207], v124, s[4:5] offset:3600 sc1
    v_lshrrev_b32 v126, 2, v122
    v_lshlrev_b32 v126, 10, v126
    v_and_b32 v125, 3, v122
    v_lshl_add_u32 v126, v125, 8, v126
    s_lshl_b32 s71, s34, 2
    v_add_u32 v125, s71, v121
    v_lshl_add_u32 v126, v125, 4, v126
    s_lshl_b32 s70, s50, 14
    s_add_u32 s70, s70, 1048576
    v_add_u32 v126, s70, v126
    s_waitcnt vmcnt(0)
    v_mov_b32 v242, v240
    v_mov_b32 v243, v240
    v_mov_b32 v244, v241
    v_mov_b32 v245, v241
    v_pk_add_f32 v[144:145], v[144:145], v[242:243] neg_lo:[0,1] neg_hi:[0,1]
    v_cvt_pk_bf16_f32 v145, v144, v145
    v_lshlrev_b32 v144, 16, v145
    v_and_b32 v145, 0xffff0000, v145
    v_pk_mul_f32 v[144:145], v[144:145], v[244:245]
    v_cvt_pk_bf16_f32 v145, v144, v145
    v_lshlrev_b32 v144, 16, v145
    v_and_b32 v145, 0xffff0000, v145
    v_pk_mul_f32 v[144:145], v[144:145], v[176:177]
    v_cvt_pk_bf16_f32 v145, v144, v145
    v_lshlrev_b32 v144, 16, v145
    v_and_b32 v145, 0xffff0000, v145
    v_pk_add_f32 v[144:145], v[144:145], v[208:209]
    v_cvt_pk_bf16_f32 v128, v144, v145
    v_pk_add_f32 v[146:147], v[146:147], v[242:243] neg_lo:[0,1] neg_hi:[0,1]
    v_cvt_pk_bf16_f32 v147, v146, v147
    v_lshlrev_b32 v146, 16, v147
    v_and_b32 v147, 0xffff0000, v147
    v_pk_mul_f32 v[146:147], v[146:147], v[244:245]
    v_cvt_pk_bf16_f32 v147, v146, v147
    v_lshlrev_b32 v146, 16, v147
    v_and_b32 v147, 0xffff0000, v147
    v_pk_mul_f32 v[146:147], v[146:147], v[178:179]
    v_cvt_pk_bf16_f32 v147, v146, v147
    v_lshlrev_b32 v146, 16, v147
    v_and_b32 v147, 0xffff0000, v147
    v_pk_add_f32 v[146:147], v[146:147], v[210:211]
    v_cvt_pk_bf16_f32 v129, v146, v147
    v_pk_add_f32 v[148:149], v[148:149], v[242:243] neg_lo:[0,1] neg_hi:[0,1]
    v_cvt_pk_bf16_f32 v149, v148, v149
    v_lshlrev_b32 v148, 16, v149
    v_and_b32 v149, 0xffff0000, v149
    v_pk_mul_f32 v[148:149], v[148:149], v[244:245]
    v_cvt_pk_bf16_f32 v149, v148, v149
    v_lshlrev_b32 v148, 16, v149
    v_and_b32 v149, 0xffff0000, v149
    v_pk_mul_f32 v[148:149], v[148:149], v[180:181]
    v_cvt_pk_bf16_f32 v149, v148, v149
    v_lshlrev_b32 v148, 16, v149
    v_and_b32 v149, 0xffff0000, v149
    v_pk_add_f32 v[148:149], v[148:149], v[212:213]
    v_cvt_pk_bf16_f32 v130, v148, v149
    v_pk_add_f32 v[150:151], v[150:151], v[242:243] neg_lo:[0,1] neg_hi:[0,1]
    v_cvt_pk_bf16_f32 v151, v150, v151
    v_lshlrev_b32 v150, 16, v151
    v_and_b32 v151, 0xffff0000, v151
    v_pk_mul_f32 v[150:151], v[150:151], v[244:245]
    v_cvt_pk_bf16_f32 v151, v150, v151
    v_lshlrev_b32 v150, 16, v151
    v_and_b32 v151, 0xffff0000, v151
    v_pk_mul_f32 v[150:151], v[150:151], v[182:183]
    v_cvt_pk_bf16_f32 v151, v150, v151
    v_lshlrev_b32 v150, 16, v151
    v_and_b32 v151, 0xffff0000, v151
    v_pk_add_f32 v[150:151], v[150:151], v[214:215]
    v_cvt_pk_bf16_f32 v131, v150, v151
    v_pk_add_f32 v[152:153], v[152:153], v[242:243] neg_lo:[0,1] neg_hi:[0,1]
    v_cvt_pk_bf16_f32 v153, v152, v153
    v_lshlrev_b32 v152, 16, v153
    v_and_b32 v153, 0xffff0000, v153
    v_pk_mul_f32 v[152:153], v[152:153], v[244:245]
    v_cvt_pk_bf16_f32 v153, v152, v153
    v_lshlrev_b32 v152, 16, v153
    v_and_b32 v153, 0xffff0000, v153
    v_pk_mul_f32 v[152:153], v[152:153], v[184:185]
    v_cvt_pk_bf16_f32 v153, v152, v153
    v_lshlrev_b32 v152, 16, v153
    v_and_b32 v153, 0xffff0000, v153
    v_pk_add_f32 v[152:153], v[152:153], v[216:217]
    v_cvt_pk_bf16_f32 v132, v152, v153
    v_pk_add_f32 v[154:155], v[154:155], v[242:243] neg_lo:[0,1] neg_hi:[0,1]
    v_cvt_pk_bf16_f32 v155, v154, v155
    v_lshlrev_b32 v154, 16, v155
    v_and_b32 v155, 0xffff0000, v155
    v_pk_mul_f32 v[154:155], v[154:155], v[244:245]
    v_cvt_pk_bf16_f32 v155, v154, v155
    v_lshlrev_b32 v154, 16, v155
    v_and_b32 v155, 0xffff0000, v155
    v_pk_mul_f32 v[154:155], v[154:155], v[186:187]
    v_cvt_pk_bf16_f32 v155, v154, v155
    v_lshlrev_b32 v154, 16, v155
    v_and_b32 v155, 0xffff0000, v155
    v_pk_add_f32 v[154:155], v[154:155], v[218:219]
    v_cvt_pk_bf16_f32 v133, v154, v155
    v_pk_add_f32 v[156:157], v[156:157], v[242:243] neg_lo:[0,1] neg_hi:[0,1]
    v_cvt_pk_bf16_f32 v157, v156, v157
    v_lshlrev_b32 v156, 16, v157
    v_and_b32 v157, 0xffff0000, v157
    v_pk_mul_f32 v[156:157], v[156:157], v[244:245]
    v_cvt_pk_bf16_f32 v157, v156, v157
    v_lshlrev_b32 v156, 16, v157
    v_and_b32 v157, 0xffff0000, v157
    v_pk_mul_f32 v[156:157], v[156:157], v[188:189]
    v_cvt_pk_bf16_f32 v157, v156, v157
    v_lshlrev_b32 v156, 16, v157
    v_and_b32 v157, 0xffff0000, v157
    v_pk_add_f32 v[156:157], v[156:157], v[220:221]
    v_cvt_pk_bf16_f32 v134, v156, v157
    v_pk_add_f32 v[158:159], v[158:159], v[242:243] neg_lo:[0,1] neg_hi:[0,1]
    v_cvt_pk_bf16_f32 v159, v158, v159
    v_lshlrev_b32 v158, 16, v159
    v_and_b32 v159, 0xffff0000, v159
    v_pk_mul_f32 v[158:159], v[158:159], v[244:245]
    v_cvt_pk_bf16_f32 v159, v158, v159
    v_lshlrev_b32 v158, 16, v159
    v_and_b32 v159, 0xffff0000, v159
    v_pk_mul_f32 v[158:159], v[158:159], v[190:191]
    v_cvt_pk_bf16_f32 v159, v158, v159
    v_lshlrev_b32 v158, 16, v159
    v_and_b32 v159, 0xffff0000, v159
    v_pk_add_f32 v[158:159], v[158:159], v[222:223]
    v_cvt_pk_bf16_f32 v135, v158, v159
    v_pk_add_f32 v[160:161], v[160:161], v[242:243] neg_lo:[0,1] neg_hi:[0,1]
    v_cvt_pk_bf16_f32 v161, v160, v161
    v_lshlrev_b32 v160, 16, v161
    v_and_b32 v161, 0xffff0000, v161
    v_pk_mul_f32 v[160:161], v[160:161], v[244:245]
    v_cvt_pk_bf16_f32 v161, v160, v161
    v_lshlrev_b32 v160, 16, v161
    v_and_b32 v161, 0xffff0000, v161
    v_pk_mul_f32 v[160:161], v[160:161], v[192:193]
    v_cvt_pk_bf16_f32 v161, v160, v161
    v_lshlrev_b32 v160, 16, v161
    v_and_b32 v161, 0xffff0000, v161
    v_pk_add_f32 v[160:161], v[160:161], v[224:225]
    v_cvt_pk_bf16_f32 v136, v160, v161
    v_pk_add_f32 v[162:163], v[162:163], v[242:243] neg_lo:[0,1] neg_hi:[0,1]
    v_cvt_pk_bf16_f32 v163, v162, v163
    v_lshlrev_b32 v162, 16, v163
    v_and_b32 v163, 0xffff0000, v163
    v_pk_mul_f32 v[162:163], v[162:163], v[244:245]
    v_cvt_pk_bf16_f32 v163, v162, v163
    v_lshlrev_b32 v162, 16, v163
    v_and_b32 v163, 0xffff0000, v163
    v_pk_mul_f32 v[162:163], v[162:163], v[194:195]
    v_cvt_pk_bf16_f32 v163, v162, v163
    v_lshlrev_b32 v162, 16, v163
    v_and_b32 v163, 0xffff0000, v163
    v_pk_add_f32 v[162:163], v[162:163], v[226:227]
    v_cvt_pk_bf16_f32 v137, v162, v163
    v_pk_add_f32 v[164:165], v[164:165], v[242:243] neg_lo:[0,1] neg_hi:[0,1]
    v_cvt_pk_bf16_f32 v165, v164, v165
    v_lshlrev_b32 v164, 16, v165
    v_and_b32 v165, 0xffff0000, v165
    v_pk_mul_f32 v[164:165], v[164:165], v[244:245]
    v_cvt_pk_bf16_f32 v165, v164, v165
    v_lshlrev_b32 v164, 16, v165
    v_and_b32 v165, 0xffff0000, v165
    v_pk_mul_f32 v[164:165], v[164:165], v[196:197]
    v_cvt_pk_bf16_f32 v165, v164, v165
    v_lshlrev_b32 v164, 16, v165
    v_and_b32 v165, 0xffff0000, v165
    v_pk_add_f32 v[164:165], v[164:165], v[228:229]
    v_cvt_pk_bf16_f32 v138, v164, v165
    v_pk_add_f32 v[166:167], v[166:167], v[242:243] neg_lo:[0,1] neg_hi:[0,1]
    v_cvt_pk_bf16_f32 v167, v166, v167
    v_lshlrev_b32 v166, 16, v167
    v_and_b32 v167, 0xffff0000, v167
    v_pk_mul_f32 v[166:167], v[166:167], v[244:245]
    v_cvt_pk_bf16_f32 v167, v166, v167
    v_lshlrev_b32 v166, 16, v167
    v_and_b32 v167, 0xffff0000, v167
    v_pk_mul_f32 v[166:167], v[166:167], v[198:199]
    v_cvt_pk_bf16_f32 v167, v166, v167
    v_lshlrev_b32 v166, 16, v167
    v_and_b32 v167, 0xffff0000, v167
    v_pk_add_f32 v[166:167], v[166:167], v[230:231]
    v_cvt_pk_bf16_f32 v139, v166, v167
    v_pk_add_f32 v[168:169], v[168:169], v[242:243] neg_lo:[0,1] neg_hi:[0,1]
    v_cvt_pk_bf16_f32 v169, v168, v169
    v_lshlrev_b32 v168, 16, v169
    v_and_b32 v169, 0xffff0000, v169
    v_pk_mul_f32 v[168:169], v[168:169], v[244:245]
    v_cvt_pk_bf16_f32 v169, v168, v169
    v_lshlrev_b32 v168, 16, v169
    v_and_b32 v169, 0xffff0000, v169
    v_pk_mul_f32 v[168:169], v[168:169], v[200:201]
    v_cvt_pk_bf16_f32 v169, v168, v169
    v_lshlrev_b32 v168, 16, v169
    v_and_b32 v169, 0xffff0000, v169
    v_pk_add_f32 v[168:169], v[168:169], v[232:233]
    v_cvt_pk_bf16_f32 v140, v168, v169
    v_pk_add_f32 v[170:171], v[170:171], v[242:243] neg_lo:[0,1] neg_hi:[0,1]
    v_cvt_pk_bf16_f32 v171, v170, v171
    v_lshlrev_b32 v170, 16, v171
    v_and_b32 v171, 0xffff0000, v171
    v_pk_mul_f32 v[170:171], v[170:171], v[244:245]
    v_cvt_pk_bf16_f32 v171, v170, v171
    v_lshlrev_b32 v170, 16, v171
    v_and_b32 v171, 0xffff0000, v171
    v_pk_mul_f32 v[170:171], v[170:171], v[202:203]
    v_cvt_pk_bf16_f32 v171, v170, v171
    v_lshlrev_b32 v170, 16, v171
    v_and_b32 v171, 0xffff0000, v171
    v_pk_add_f32 v[170:171], v[170:171], v[234:235]
    v_cvt_pk_bf16_f32 v141, v170, v171
    v_pk_add_f32 v[172:173], v[172:173], v[242:243] neg_lo:[0,1] neg_hi:[0,1]
    v_cvt_pk_bf16_f32 v173, v172, v173
    v_lshlrev_b32 v172, 16, v173
    v_and_b32 v173, 0xffff0000, v173
    v_pk_mul_f32 v[172:173], v[172:173], v[244:245]
    v_cvt_pk_bf16_f32 v173, v172, v173
    v_lshlrev_b32 v172, 16, v173
    v_and_b32 v173, 0xffff0000, v173
    v_pk_mul_f32 v[172:173], v[172:173], v[204:205]
    v_cvt_pk_bf16_f32 v173, v172, v173
    v_lshlrev_b32 v172, 16, v173
    v_and_b32 v173, 0xffff0000, v173
    v_pk_add_f32 v[172:173], v[172:173], v[236:237]
    v_cvt_pk_bf16_f32 v142, v172, v173
    v_pk_add_f32 v[174:175], v[174:175], v[242:243] neg_lo:[0,1] neg_hi:[0,1]
    v_cvt_pk_bf16_f32 v175, v174, v175
    v_lshlrev_b32 v174, 16, v175
    v_and_b32 v175, 0xffff0000, v175
    v_pk_mul_f32 v[174:175], v[174:175], v[244:245]
    v_cvt_pk_bf16_f32 v175, v174, v175
    v_lshlrev_b32 v174, 16, v175
    v_and_b32 v175, 0xffff0000, v175
    v_pk_mul_f32 v[174:175], v[174:175], v[206:207]
    v_cvt_pk_bf16_f32 v175, v174, v175
    v_lshlrev_b32 v174, 16, v175
    v_and_b32 v175, 0xffff0000, v175
    v_pk_add_f32 v[174:175], v[174:175], v[238:239]
    v_cvt_pk_bf16_f32 v143, v174, v175
    v_add_u32 v127, 0, v126
    global_store_dwordx4 v127, v[128:131], s[4:5] sc1
    v_add_u32 v127, 4096, v127
    global_store_dwordx4 v127, v[132:135], s[4:5] sc1
    v_add_u32 v127, 4096, v127
    global_store_dwordx4 v127, v[136:139], s[4:5] sc1
    v_add_u32 v127, 4096, v127
    global_store_dwordx4 v127, v[140:143], s[4:5] sc1
    s_waitcnt vmcnt(0)
    s_barrier
    s_add_u32 s78, s50, 0
    s_lshr_b32 s78, s78, 2
    s_lshl_b32 s78, s78, 7
    s_add_u32 s78, s78, 4096
    s_cmp_lg_u32 s34, 0
    s_cbranch_scc1 sig_137
    v_mov_b32 v124, s78
    v_mov_b32 v125, 1
    s_mov_b64 exec, 1
    global_atomic_add v124, v125, s[4:5]
    s_mov_b64 exec, -1
sig_137:
    s_cmp_lg_u32 s34, 0
    s_cbranch_scc1 sig_138
    v_mov_b32 v124, 28672
    v_mov_b32 v125, 1
    s_mov_b64 exec, 1
    global_atomic_add v124, v125, s[4:5]
    s_mov_b64 exec, -1
sig_138:
    v_mov_b32 v114, v112
    v_mov_b32 v115, v112
    v_mov_b32 v116, v113
    v_mov_b32 v117, v113
    v_pk_add_f32 v[64:65], v[64:65], v[114:115] neg_lo:[0,1] neg_hi:[0,1]
    v_cvt_pk_bf16_f32 v65, v64, v65
    v_lshlrev_b32 v64, 16, v65
    v_and_b32 v65, 0xffff0000, v65
    v_pk_mul_f32 v[64:65], v[64:65], v[116:117]
    v_cvt_pk_bf16_f32 v65, v64, v65
    v_lshlrev_b32 v64, 16, v65
    v_and_b32 v65, 0xffff0000, v65
    v_pk_mul_f32 v[64:65], v[64:65], v[176:177]
    v_cvt_pk_bf16_f32 v65, v64, v65
    v_lshlrev_b32 v64, 16, v65
    v_and_b32 v65, 0xffff0000, v65
    v_pk_add_f32 v[64:65], v[64:65], v[208:209]
    v_cvt_pk_bf16_f32 v96, v64, v65
    v_pk_add_f32 v[66:67], v[66:67], v[114:115] neg_lo:[0,1] neg_hi:[0,1]
    v_cvt_pk_bf16_f32 v67, v66, v67
    v_lshlrev_b32 v66, 16, v67
    v_and_b32 v67, 0xffff0000, v67
    v_pk_mul_f32 v[66:67], v[66:67], v[116:117]
    v_cvt_pk_bf16_f32 v67, v66, v67
    v_lshlrev_b32 v66, 16, v67
    v_and_b32 v67, 0xffff0000, v67
    v_pk_mul_f32 v[66:67], v[66:67], v[178:179]
    v_cvt_pk_bf16_f32 v67, v66, v67
    v_lshlrev_b32 v66, 16, v67
    v_and_b32 v67, 0xffff0000, v67
    v_pk_add_f32 v[66:67], v[66:67], v[210:211]
    v_cvt_pk_bf16_f32 v97, v66, v67
    v_pk_add_f32 v[68:69], v[68:69], v[114:115] neg_lo:[0,1] neg_hi:[0,1]
    v_cvt_pk_bf16_f32 v69, v68, v69
    v_lshlrev_b32 v68, 16, v69
    v_and_b32 v69, 0xffff0000, v69
    v_pk_mul_f32 v[68:69], v[68:69], v[116:117]
    v_cvt_pk_bf16_f32 v69, v68, v69
    v_lshlrev_b32 v68, 16, v69
    v_and_b32 v69, 0xffff0000, v69
    v_pk_mul_f32 v[68:69], v[68:69], v[180:181]
    v_cvt_pk_bf16_f32 v69, v68, v69
    v_lshlrev_b32 v68, 16, v69
    v_and_b32 v69, 0xffff0000, v69
    v_pk_add_f32 v[68:69], v[68:69], v[212:213]
    v_cvt_pk_bf16_f32 v98, v68, v69
    v_pk_add_f32 v[70:71], v[70:71], v[114:115] neg_lo:[0,1] neg_hi:[0,1]
    v_cvt_pk_bf16_f32 v71, v70, v71
    v_lshlrev_b32 v70, 16, v71
    v_and_b32 v71, 0xffff0000, v71
    v_pk_mul_f32 v[70:71], v[70:71], v[116:117]
    v_cvt_pk_bf16_f32 v71, v70, v71
    v_lshlrev_b32 v70, 16, v71
    v_and_b32 v71, 0xffff0000, v71
    v_pk_mul_f32 v[70:71], v[70:71], v[182:183]
    v_cvt_pk_bf16_f32 v71, v70, v71
    v_lshlrev_b32 v70, 16, v71
    v_and_b32 v71, 0xffff0000, v71
    v_pk_add_f32 v[70:71], v[70:71], v[214:215]
    v_cvt_pk_bf16_f32 v99, v70, v71
    v_pk_add_f32 v[72:73], v[72:73], v[114:115] neg_lo:[0,1] neg_hi:[0,1]
    v_cvt_pk_bf16_f32 v73, v72, v73
    v_lshlrev_b32 v72, 16, v73
    v_and_b32 v73, 0xffff0000, v73
    v_pk_mul_f32 v[72:73], v[72:73], v[116:117]
    v_cvt_pk_bf16_f32 v73, v72, v73
    v_lshlrev_b32 v72, 16, v73
    v_and_b32 v73, 0xffff0000, v73
    v_pk_mul_f32 v[72:73], v[72:73], v[184:185]
    v_cvt_pk_bf16_f32 v73, v72, v73
    v_lshlrev_b32 v72, 16, v73
    v_and_b32 v73, 0xffff0000, v73
    v_pk_add_f32 v[72:73], v[72:73], v[216:217]
    v_cvt_pk_bf16_f32 v100, v72, v73
    v_pk_add_f32 v[74:75], v[74:75], v[114:115] neg_lo:[0,1] neg_hi:[0,1]
    v_cvt_pk_bf16_f32 v75, v74, v75
    v_lshlrev_b32 v74, 16, v75
    v_and_b32 v75, 0xffff0000, v75
    v_pk_mul_f32 v[74:75], v[74:75], v[116:117]
    v_cvt_pk_bf16_f32 v75, v74, v75
    v_lshlrev_b32 v74, 16, v75
    v_and_b32 v75, 0xffff0000, v75
    v_pk_mul_f32 v[74:75], v[74:75], v[186:187]
    v_cvt_pk_bf16_f32 v75, v74, v75
    v_lshlrev_b32 v74, 16, v75
    v_and_b32 v75, 0xffff0000, v75
    v_pk_add_f32 v[74:75], v[74:75], v[218:219]
    v_cvt_pk_bf16_f32 v101, v74, v75
    v_pk_add_f32 v[76:77], v[76:77], v[114:115] neg_lo:[0,1] neg_hi:[0,1]
    v_cvt_pk_bf16_f32 v77, v76, v77
    v_lshlrev_b32 v76, 16, v77
    v_and_b32 v77, 0xffff0000, v77
    v_pk_mul_f32 v[76:77], v[76:77], v[116:117]
    v_cvt_pk_bf16_f32 v77, v76, v77
    v_lshlrev_b32 v76, 16, v77
    v_and_b32 v77, 0xffff0000, v77
    v_pk_mul_f32 v[76:77], v[76:77], v[188:189]
    v_cvt_pk_bf16_f32 v77, v76, v77
    v_lshlrev_b32 v76, 16, v77
    v_and_b32 v77, 0xffff0000, v77
    v_pk_add_f32 v[76:77], v[76:77], v[220:221]
    v_cvt_pk_bf16_f32 v102, v76, v77
    v_pk_add_f32 v[78:79], v[78:79], v[114:115] neg_lo:[0,1] neg_hi:[0,1]
    v_cvt_pk_bf16_f32 v79, v78, v79
    v_lshlrev_b32 v78, 16, v79
    v_and_b32 v79, 0xffff0000, v79
    v_pk_mul_f32 v[78:79], v[78:79], v[116:117]
    v_cvt_pk_bf16_f32 v79, v78, v79
    v_lshlrev_b32 v78, 16, v79
    v_and_b32 v79, 0xffff0000, v79
    v_pk_mul_f32 v[78:79], v[78:79], v[190:191]
    v_cvt_pk_bf16_f32 v79, v78, v79
    v_lshlrev_b32 v78, 16, v79
    v_and_b32 v79, 0xffff0000, v79
    v_pk_add_f32 v[78:79], v[78:79], v[222:223]
    v_cvt_pk_bf16_f32 v103, v78, v79
    v_pk_add_f32 v[80:81], v[80:81], v[114:115] neg_lo:[0,1] neg_hi:[0,1]
    v_cvt_pk_bf16_f32 v81, v80, v81
    v_lshlrev_b32 v80, 16, v81
    v_and_b32 v81, 0xffff0000, v81
    v_pk_mul_f32 v[80:81], v[80:81], v[116:117]
    v_cvt_pk_bf16_f32 v81, v80, v81
    v_lshlrev_b32 v80, 16, v81
    v_and_b32 v81, 0xffff0000, v81
    v_pk_mul_f32 v[80:81], v[80:81], v[192:193]
    v_cvt_pk_bf16_f32 v81, v80, v81
    v_lshlrev_b32 v80, 16, v81
    v_and_b32 v81, 0xffff0000, v81
    v_pk_add_f32 v[80:81], v[80:81], v[224:225]
    v_cvt_pk_bf16_f32 v104, v80, v81
    v_pk_add_f32 v[82:83], v[82:83], v[114:115] neg_lo:[0,1] neg_hi:[0,1]
    v_cvt_pk_bf16_f32 v83, v82, v83
    v_lshlrev_b32 v82, 16, v83
    v_and_b32 v83, 0xffff0000, v83
    v_pk_mul_f32 v[82:83], v[82:83], v[116:117]
    v_cvt_pk_bf16_f32 v83, v82, v83
    v_lshlrev_b32 v82, 16, v83
    v_and_b32 v83, 0xffff0000, v83
    v_pk_mul_f32 v[82:83], v[82:83], v[194:195]
    v_cvt_pk_bf16_f32 v83, v82, v83
    v_lshlrev_b32 v82, 16, v83
    v_and_b32 v83, 0xffff0000, v83
    v_pk_add_f32 v[82:83], v[82:83], v[226:227]
    v_cvt_pk_bf16_f32 v105, v82, v83
    v_pk_add_f32 v[84:85], v[84:85], v[114:115] neg_lo:[0,1] neg_hi:[0,1]
    v_cvt_pk_bf16_f32 v85, v84, v85
    v_lshlrev_b32 v84, 16, v85
    v_and_b32 v85, 0xffff0000, v85
    v_pk_mul_f32 v[84:85], v[84:85], v[116:117]
    v_cvt_pk_bf16_f32 v85, v84, v85
    v_lshlrev_b32 v84, 16, v85
    v_and_b32 v85, 0xffff0000, v85
    v_pk_mul_f32 v[84:85], v[84:85], v[196:197]
    v_cvt_pk_bf16_f32 v85, v84, v85
    v_lshlrev_b32 v84, 16, v85
    v_and_b32 v85, 0xffff0000, v85
    v_pk_add_f32 v[84:85], v[84:85], v[228:229]
    v_cvt_pk_bf16_f32 v106, v84, v85
    v_pk_add_f32 v[86:87], v[86:87], v[114:115] neg_lo:[0,1] neg_hi:[0,1]
    v_cvt_pk_bf16_f32 v87, v86, v87
    v_lshlrev_b32 v86, 16, v87
    v_and_b32 v87, 0xffff0000, v87
    v_pk_mul_f32 v[86:87], v[86:87], v[116:117]
    v_cvt_pk_bf16_f32 v87, v86, v87
    v_lshlrev_b32 v86, 16, v87
    v_and_b32 v87, 0xffff0000, v87
    v_pk_mul_f32 v[86:87], v[86:87], v[198:199]
    v_cvt_pk_bf16_f32 v87, v86, v87
    v_lshlrev_b32 v86, 16, v87
    v_and_b32 v87, 0xffff0000, v87
    v_pk_add_f32 v[86:87], v[86:87], v[230:231]
    v_cvt_pk_bf16_f32 v107, v86, v87
    v_pk_add_f32 v[88:89], v[88:89], v[114:115] neg_lo:[0,1] neg_hi:[0,1]
    v_cvt_pk_bf16_f32 v89, v88, v89
    v_lshlrev_b32 v88, 16, v89
    v_and_b32 v89, 0xffff0000, v89
    v_pk_mul_f32 v[88:89], v[88:89], v[116:117]
    v_cvt_pk_bf16_f32 v89, v88, v89
    v_lshlrev_b32 v88, 16, v89
    v_and_b32 v89, 0xffff0000, v89
    v_pk_mul_f32 v[88:89], v[88:89], v[200:201]
    v_cvt_pk_bf16_f32 v89, v88, v89
    v_lshlrev_b32 v88, 16, v89
    v_and_b32 v89, 0xffff0000, v89
    v_pk_add_f32 v[88:89], v[88:89], v[232:233]
    v_cvt_pk_bf16_f32 v108, v88, v89
    v_pk_add_f32 v[90:91], v[90:91], v[114:115] neg_lo:[0,1] neg_hi:[0,1]
    v_cvt_pk_bf16_f32 v91, v90, v91
    v_lshlrev_b32 v90, 16, v91
    v_and_b32 v91, 0xffff0000, v91
    v_pk_mul_f32 v[90:91], v[90:91], v[116:117]
    v_cvt_pk_bf16_f32 v91, v90, v91
    v_lshlrev_b32 v90, 16, v91
    v_and_b32 v91, 0xffff0000, v91
    v_pk_mul_f32 v[90:91], v[90:91], v[202:203]
    v_cvt_pk_bf16_f32 v91, v90, v91
    v_lshlrev_b32 v90, 16, v91
    v_and_b32 v91, 0xffff0000, v91
    v_pk_add_f32 v[90:91], v[90:91], v[234:235]
    v_cvt_pk_bf16_f32 v109, v90, v91
    v_pk_add_f32 v[92:93], v[92:93], v[114:115] neg_lo:[0,1] neg_hi:[0,1]
    v_cvt_pk_bf16_f32 v93, v92, v93
    v_lshlrev_b32 v92, 16, v93
    v_and_b32 v93, 0xffff0000, v93
    v_pk_mul_f32 v[92:93], v[92:93], v[116:117]
    v_cvt_pk_bf16_f32 v93, v92, v93
    v_lshlrev_b32 v92, 16, v93
    v_and_b32 v93, 0xffff0000, v93
    v_pk_mul_f32 v[92:93], v[92:93], v[204:205]
    v_cvt_pk_bf16_f32 v93, v92, v93
    v_lshlrev_b32 v92, 16, v93
    v_and_b32 v93, 0xffff0000, v93
    v_pk_add_f32 v[92:93], v[92:93], v[236:237]
    v_cvt_pk_bf16_f32 v110, v92, v93
    v_pk_add_f32 v[94:95], v[94:95], v[114:115] neg_lo:[0,1] neg_hi:[0,1]
    v_cvt_pk_bf16_f32 v95, v94, v95
    v_lshlrev_b32 v94, 16, v95
    v_and_b32 v95, 0xffff0000, v95
    v_pk_mul_f32 v[94:95], v[94:95], v[116:117]
    v_cvt_pk_bf16_f32 v95, v94, v95
    v_lshlrev_b32 v94, 16, v95
    v_and_b32 v95, 0xffff0000, v95
    v_pk_mul_f32 v[94:95], v[94:95], v[206:207]
    v_cvt_pk_bf16_f32 v95, v94, v95
    v_lshlrev_b32 v94, 16, v95
    v_and_b32 v95, 0xffff0000, v95
    v_pk_add_f32 v[94:95], v[94:95], v[238:239]
    v_cvt_pk_bf16_f32 v111, v94, v95
    v_add_u32 v127, 1048576, v126
    global_store_dwordx4 v127, v[96:99], s[4:5] sc1
    v_add_u32 v127, 4096, v127
    global_store_dwordx4 v127, v[100:103], s[4:5] sc1
    v_add_u32 v127, 4096, v127
    global_store_dwordx4 v127, v[104:107], s[4:5] sc1
    v_add_u32 v127, 4096, v127
    global_store_dwordx4 v127, v[108:111], s[4:5] sc1
    s_waitcnt vmcnt(0)
    s_barrier
    s_add_u32 s78, s50, 64
    s_lshr_b32 s78, s78, 2
    s_lshl_b32 s78, s78, 7
    s_add_u32 s78, s78, 4096
    s_cmp_lg_u32 s34, 0
    s_cbranch_scc1 sig_139
    v_mov_b32 v124, s78
    v_mov_b32 v125, 1
    s_mov_b64 exec, 1
    global_atomic_add v124, v125, s[4:5]
    s_mov_b64 exec, -1
sig_139:
    s_cmp_lg_u32 s34, 0
    s_cbranch_scc1 sig_140
    v_mov_b32 v124, 28672
    v_mov_b32 v125, 1
    s_mov_b64 exec, 1
    global_atomic_add v124, v125, s[4:5]
    s_mov_b64 exec, -1
sig_140:
    s_lshr_b32 s41, s50, 5
    s_mov_b32 s42, 2
    s_and_b32 s43, s50, 31
    s_mov_b64 s[76:77], s[10:11]
    s_cmp_eq_u32 s42, 1
    s_cselect_b64 s[76:77], s[12:13], s[76:77]
    s_cmp_eq_u32 s42, 2
    s_cselect_b64 s[76:77], s[8:9], s[76:77]
    s_lshl_b32 s70, s43, 8
    s_add_u32 s76, s76, s70
    s_addc_u32 s77, s77, 0
    v_mbcnt_lo_u32_b32 v2, -1, 0
    v_mbcnt_hi_u32_b32 v2, -1, v2
    v_lshrrev_b32 v3, 4, v2
    v_and_b32 v4, 15, v2
    v_lshrrev_b32 v5, 1, v4
    v_xor_b32 v5, v5, v3
    v_xor_b32 v6, 0, v5
    v_lshlrev_b32 v6, 5, v6
    v_and_b32 v2, 1, v4
    v_lshl_add_u32 v6, v2, 4, v6
    s_mov_b32 s70, 8192
    v_mad_u32_u24 v6, v3, s70, v6
    v_xor_b32 v7, 4, v5
    v_lshlrev_b32 v7, 5, v7
    v_and_b32 v2, 1, v4
    v_lshl_add_u32 v7, v2, 4, v7
    s_mov_b32 s70, 8192
    v_mad_u32_u24 v7, v3, s70, v7
    s_mul_i32 s70, s34, 1048576
    s_add_u32 s72, s76, s70
    s_addc_u32 s73, s77, 0
    s_mul_i32 s71, s34, 32768
    s_add_u32 s71, s71, 0
    s_add_u32 m0, s71, 0
    s_nop 0
    global_load_lds_dwordx4 v6, s[72:73]
    s_add_u32 s72, s72, 32768
    s_addc_u32 s73, s73, 0
    s_add_u32 m0, s71, 1024
    s_nop 0
    global_load_lds_dwordx4 v6, s[72:73]
    s_add_u32 s72, s72, 32768
    s_addc_u32 s73, s73, 0
    s_add_u32 m0, s71, 2048
    s_nop 0
    global_load_lds_dwordx4 v7, s[72:73]
    s_add_u32 s72, s72, 32768
    s_addc_u32 s73, s73, 0
    s_add_u32 m0, s71, 3072
    s_nop 0
    global_load_lds_dwordx4 v7, s[72:73]
    s_add_u32 s72, s72, 32768
    s_addc_u32 s73, s73, 0
    s_add_u32 m0, s71, 4096
    s_nop 0
    global_load_lds_dwordx4 v6, s[72:73]
    s_add_u32 s72, s72, 32768
    s_addc_u32 s73, s73, 0
    s_add_u32 m0, s71, 5120
    s_nop 0
    global_load_lds_dwordx4 v6, s[72:73]
    s_add_u32 s72, s72, 32768
    s_addc_u32 s73, s73, 0
    s_add_u32 m0, s71, 6144
    s_nop 0
    global_load_lds_dwordx4 v7, s[72:73]
    s_add_u32 s72, s72, 32768
    s_addc_u32 s73, s73, 0
    s_add_u32 m0, s71, 7168
    s_nop 0
    global_load_lds_dwordx4 v7, s[72:73]
    s_add_u32 s72, s72, 32768
    s_addc_u32 s73, s73, 0
    s_add_u32 m0, s71, 8192
    s_nop 0
    global_load_lds_dwordx4 v6, s[72:73]
    s_add_u32 s72, s72, 32768
    s_addc_u32 s73, s73, 0
    s_add_u32 m0, s71, 9216
    s_nop 0
    global_load_lds_dwordx4 v6, s[72:73]
    s_add_u32 s72, s72, 32768
    s_addc_u32 s73, s73, 0
    s_add_u32 m0, s71, 10240
    s_nop 0
    global_load_lds_dwordx4 v7, s[72:73]
    s_add_u32 s72, s72, 32768
    s_addc_u32 s73, s73, 0
    s_add_u32 m0, s71, 11264
    s_nop 0
    global_load_lds_dwordx4 v7, s[72:73]
    s_add_u32 s72, s72, 32768
    s_addc_u32 s73, s73, 0
    s_add_u32 m0, s71, 12288
    s_nop 0
    global_load_lds_dwordx4 v6, s[72:73]
    s_add_u32 s72, s72, 32768
    s_addc_u32 s73, s73, 0
    s_add_u32 m0, s71, 13312
    s_nop 0
    global_load_lds_dwordx4 v6, s[72:73]
    s_add_u32 s72, s72, 32768
    s_addc_u32 s73, s73, 0
    s_add_u32 m0, s71, 14336
    s_nop 0
    global_load_lds_dwordx4 v7, s[72:73]
    s_add_u32 s72, s72, 32768
    s_addc_u32 s73, s73, 0
    s_add_u32 m0, s71, 15360
    s_nop 0
    global_load_lds_dwordx4 v7, s[72:73]
    s_add_u32 s72, s72, 32768
    s_addc_u32 s73, s73, 0
    s_add_u32 m0, s71, 16384
    s_nop 0
    global_load_lds_dwordx4 v6, s[72:73]
    s_add_u32 s72, s72, 32768
    s_addc_u32 s73, s73, 0
    s_add_u32 m0, s71, 17408
    s_nop 0
    global_load_lds_dwordx4 v6, s[72:73]
    s_add_u32 s72, s72, 32768
    s_addc_u32 s73, s73, 0
    s_add_u32 m0, s71, 18432
    s_nop 0
    global_load_lds_dwordx4 v7, s[72:73]
    s_add_u32 s72, s72, 32768
    s_addc_u32 s73, s73, 0
    s_add_u32 m0, s71, 19456
    s_nop 0
    global_load_lds_dwordx4 v7, s[72:73]
    s_add_u32 s72, s72, 32768
    s_addc_u32 s73, s73, 0
    s_add_u32 m0, s71, 20480
    s_nop 0
    global_load_lds_dwordx4 v6, s[72:73]
    s_add_u32 s72, s72, 32768
    s_addc_u32 s73, s73, 0
    s_add_u32 m0, s71, 21504
    s_nop 0
    global_load_lds_dwordx4 v6, s[72:73]
    s_add_u32 s72, s72, 32768
    s_addc_u32 s73, s73, 0
    s_add_u32 m0, s71, 22528
    s_nop 0
    global_load_lds_dwordx4 v7, s[72:73]
    s_add_u32 s72, s72, 32768
    s_addc_u32 s73, s73, 0
    s_add_u32 m0, s71, 23552
    s_nop 0
    global_load_lds_dwordx4 v7, s[72:73]
    s_add_u32 s72, s72, 32768
    s_addc_u32 s73, s73, 0
    s_add_u32 m0, s71, 24576
    s_nop 0
    global_load_lds_dwordx4 v6, s[72:73]
    s_add_u32 s72, s72, 32768
    s_addc_u32 s73, s73, 0
    s_add_u32 m0, s71, 25600
    s_nop 0
    global_load_lds_dwordx4 v6, s[72:73]
    s_add_u32 s72, s72, 32768
    s_addc_u32 s73, s73, 0
    s_add_u32 m0, s71, 26624
    s_nop 0
    global_load_lds_dwordx4 v7, s[72:73]
    s_add_u32 s72, s72, 32768
    s_addc_u32 s73, s73, 0
    s_add_u32 m0, s71, 27648
    s_nop 0
    global_load_lds_dwordx4 v7, s[72:73]
    s_add_u32 s72, s72, 32768
    s_addc_u32 s73, s73, 0
    s_add_u32 m0, s71, 28672
    s_nop 0
    global_load_lds_dwordx4 v6, s[72:73]
    s_add_u32 s72, s72, 32768
    s_addc_u32 s73, s73, 0
    s_add_u32 m0, s71, 29696
    s_nop 0
    global_load_lds_dwordx4 v6, s[72:73]
    s_add_u32 s72, s72, 32768
    s_addc_u32 s73, s73, 0
    s_add_u32 m0, s71, 30720
    s_nop 0
    global_load_lds_dwordx4 v7, s[72:73]
    s_add_u32 s72, s72, 32768
    s_addc_u32 s73, s73, 0
    s_add_u32 m0, s71, 31744
    s_nop 0
    global_load_lds_dwordx4 v7, s[72:73]
    s_branch L_gemm
L_gonly:
    s_sub_u32 s50, s50, 64
    s_lshr_b32 s41, s50, 6
    s_bfe_u32 s42, s50, 0x10005
    s_and_b32 s43, s50, 31
    s_mov_b64 s[76:77], s[10:11]
    s_cmp_eq_u32 s42, 1
    s_cselect_b64 s[76:77], s[12:13], s[76:77]
    s_cmp_eq_u32 s42, 2
    s_cselect_b64 s[76:77], s[8:9], s[76:77]
    s_lshl_b32 s70, s43, 8
    s_add_u32 s76, s76, s70
    s_addc_u32 s77, s77, 0
    v_mbcnt_lo_u32_b32 v2, -1, 0
    v_mbcnt_hi_u32_b32 v2, -1, v2
    v_lshrrev_b32 v3, 4, v2
    v_and_b32 v4, 15, v2
    v_lshrrev_b32 v5, 1, v4
    v_xor_b32 v5, v5, v3
    v_xor_b32 v6, 0, v5
    v_lshlrev_b32 v6, 5, v6
    v_and_b32 v2, 1, v4
    v_lshl_add_u32 v6, v2, 4, v6
    s_mov_b32 s70, 8192
    v_mad_u32_u24 v6, v3, s70, v6
    v_xor_b32 v7, 4, v5
    v_lshlrev_b32 v7, 5, v7
    v_and_b32 v2, 1, v4
    v_lshl_add_u32 v7, v2, 4, v7
    s_mov_b32 s70, 8192
    v_mad_u32_u24 v7, v3, s70, v7
    s_mul_i32 s70, s34, 1048576
    s_add_u32 s72, s76, s70
    s_addc_u32 s73, s77, 0
    s_mul_i32 s71, s34, 32768
    s_add_u32 s71, s71, 0
    s_add_u32 m0, s71, 0
    s_nop 0
    global_load_lds_dwordx4 v6, s[72:73]
    s_add_u32 s72, s72, 32768
    s_addc_u32 s73, s73, 0
    s_add_u32 m0, s71, 1024
    s_nop 0
    global_load_lds_dwordx4 v6, s[72:73]
    s_add_u32 s72, s72, 32768
    s_addc_u32 s73, s73, 0
    s_add_u32 m0, s71, 2048
    s_nop 0
    global_load_lds_dwordx4 v7, s[72:73]
    s_add_u32 s72, s72, 32768
    s_addc_u32 s73, s73, 0
    s_add_u32 m0, s71, 3072
    s_nop 0
    global_load_lds_dwordx4 v7, s[72:73]
    s_add_u32 s72, s72, 32768
    s_addc_u32 s73, s73, 0
    s_add_u32 m0, s71, 4096
    s_nop 0
    global_load_lds_dwordx4 v6, s[72:73]
    s_add_u32 s72, s72, 32768
    s_addc_u32 s73, s73, 0
    s_add_u32 m0, s71, 5120
    s_nop 0
    global_load_lds_dwordx4 v6, s[72:73]
    s_add_u32 s72, s72, 32768
    s_addc_u32 s73, s73, 0
    s_add_u32 m0, s71, 6144
    s_nop 0
    global_load_lds_dwordx4 v7, s[72:73]
    s_add_u32 s72, s72, 32768
    s_addc_u32 s73, s73, 0
    s_add_u32 m0, s71, 7168
    s_nop 0
    global_load_lds_dwordx4 v7, s[72:73]
    s_add_u32 s72, s72, 32768
    s_addc_u32 s73, s73, 0
    s_add_u32 m0, s71, 8192
    s_nop 0
    global_load_lds_dwordx4 v6, s[72:73]
    s_add_u32 s72, s72, 32768
    s_addc_u32 s73, s73, 0
    s_add_u32 m0, s71, 9216
    s_nop 0
    global_load_lds_dwordx4 v6, s[72:73]
    s_add_u32 s72, s72, 32768
    s_addc_u32 s73, s73, 0
    s_add_u32 m0, s71, 10240
    s_nop 0
    global_load_lds_dwordx4 v7, s[72:73]
    s_add_u32 s72, s72, 32768
    s_addc_u32 s73, s73, 0
    s_add_u32 m0, s71, 11264
    s_nop 0
    global_load_lds_dwordx4 v7, s[72:73]
    s_add_u32 s72, s72, 32768
    s_addc_u32 s73, s73, 0
    s_add_u32 m0, s71, 12288
    s_nop 0
    global_load_lds_dwordx4 v6, s[72:73]
    s_add_u32 s72, s72, 32768
    s_addc_u32 s73, s73, 0
    s_add_u32 m0, s71, 13312
    s_nop 0
    global_load_lds_dwordx4 v6, s[72:73]
    s_add_u32 s72, s72, 32768
    s_addc_u32 s73, s73, 0
    s_add_u32 m0, s71, 14336
    s_nop 0
    global_load_lds_dwordx4 v7, s[72:73]
    s_add_u32 s72, s72, 32768
    s_addc_u32 s73, s73, 0
    s_add_u32 m0, s71, 15360
    s_nop 0
    global_load_lds_dwordx4 v7, s[72:73]
    s_add_u32 s72, s72, 32768
    s_addc_u32 s73, s73, 0
    s_add_u32 m0, s71, 16384
    s_nop 0
    global_load_lds_dwordx4 v6, s[72:73]
    s_add_u32 s72, s72, 32768
    s_addc_u32 s73, s73, 0
    s_add_u32 m0, s71, 17408
    s_nop 0
    global_load_lds_dwordx4 v6, s[72:73]
    s_add_u32 s72, s72, 32768
    s_addc_u32 s73, s73, 0
    s_add_u32 m0, s71, 18432
    s_nop 0
    global_load_lds_dwordx4 v7, s[72:73]
    s_add_u32 s72, s72, 32768
    s_addc_u32 s73, s73, 0
    s_add_u32 m0, s71, 19456
    s_nop 0
    global_load_lds_dwordx4 v7, s[72:73]
    s_add_u32 s72, s72, 32768
    s_addc_u32 s73, s73, 0
    s_add_u32 m0, s71, 20480
    s_nop 0
    global_load_lds_dwordx4 v6, s[72:73]
    s_add_u32 s72, s72, 32768
    s_addc_u32 s73, s73, 0
    s_add_u32 m0, s71, 21504
    s_nop 0
    global_load_lds_dwordx4 v6, s[72:73]
    s_add_u32 s72, s72, 32768
    s_addc_u32 s73, s73, 0
    s_add_u32 m0, s71, 22528
    s_nop 0
    global_load_lds_dwordx4 v7, s[72:73]
    s_add_u32 s72, s72, 32768
    s_addc_u32 s73, s73, 0
    s_add_u32 m0, s71, 23552
    s_nop 0
    global_load_lds_dwordx4 v7, s[72:73]
    s_add_u32 s72, s72, 32768
    s_addc_u32 s73, s73, 0
    s_add_u32 m0, s71, 24576
    s_nop 0
    global_load_lds_dwordx4 v6, s[72:73]
    s_add_u32 s72, s72, 32768
    s_addc_u32 s73, s73, 0
    s_add_u32 m0, s71, 25600
    s_nop 0
    global_load_lds_dwordx4 v6, s[72:73]
    s_add_u32 s72, s72, 32768
    s_addc_u32 s73, s73, 0
    s_add_u32 m0, s71, 26624
    s_nop 0
    global_load_lds_dwordx4 v7, s[72:73]
    s_add_u32 s72, s72, 32768
    s_addc_u32 s73, s73, 0
    s_add_u32 m0, s71, 27648
    s_nop 0
    global_load_lds_dwordx4 v7, s[72:73]
    s_add_u32 s72, s72, 32768
    s_addc_u32 s73, s73, 0
    s_add_u32 m0, s71, 28672
    s_nop 0
    global_load_lds_dwordx4 v6, s[72:73]
    s_add_u32 s72, s72, 32768
    s_addc_u32 s73, s73, 0
    s_add_u32 m0, s71, 29696
    s_nop 0
    global_load_lds_dwordx4 v6, s[72:73]
    s_add_u32 s72, s72, 32768
    s_addc_u32 s73, s73, 0
    s_add_u32 m0, s71, 30720
    s_nop 0
    global_load_lds_dwordx4 v7, s[72:73]
    s_add_u32 s72, s72, 32768
    s_addc_u32 s73, s73, 0
    s_add_u32 m0, s71, 31744
    s_nop 0
    global_load_lds_dwordx4 v7, s[72:73]
L_gemm:
    s_waitcnt vmcnt(0)
    s_barrier
    v_mbcnt_lo_u32_b32 v2, -1, 0
    v_mbcnt_hi_u32_b32 v2, -1, v2
    v_lshrrev_b32 v3, 4, v2
    v_and_b32 v4, 15, v2
    v_lshrrev_b32 v5, 2, v4
    v_lshl_add_u32 v10, v3, 3, v5
    v_lshlrev_b32 v10, 8, v10
    v_and_b32 v2, 1, v3
    v_lshl_add_u32 v11, v2, 2, v5
    v_and_b32 v2, 3, v4
    v_lshl_add_u32 v10, v2, 3, v10
    s_lshl_b32 s70, s34, 1
    s_add_u32 s70, s70, 0
    v_xor_b32 v14, s70, v11
    v_lshl_add_u32 v14, v14, 5, v10
    v_add_u32 v15, 0x10000, v14
    ds_read_b64_tr_b16 a[0:1], v14 offset:0
    ds_read_b64_tr_b16 a[2:3], v14 offset:1024
    ds_read_b64_tr_b16 a[4:5], v14 offset:8192
    ds_read_b64_tr_b16 a[6:7], v14 offset:9216
    ds_read_b64_tr_b16 a[8:9], v14 offset:16384
    ds_read_b64_tr_b16 a[10:11], v14 offset:17408
    ds_read_b64_tr_b16 a[12:13], v14 offset:24576
    ds_read_b64_tr_b16 a[14:15], v14 offset:25600
    ds_read_b64_tr_b16 a[16:17], v14 offset:32768
    ds_read_b64_tr_b16 a[18:19], v14 offset:33792
    ds_read_b64_tr_b16 a[20:21], v14 offset:40960
    ds_read_b64_tr_b16 a[22:23], v14 offset:41984
    ds_read_b64_tr_b16 a[24:25], v14 offset:49152
    ds_read_b64_tr_b16 a[26:27], v14 offset:50176
    ds_read_b64_tr_b16 a[28:29], v14 offset:57344
    ds_read_b64_tr_b16 a[30:31], v14 offset:58368
    ds_read_b64_tr_b16 a[32:33], v15 offset:0
    ds_read_b64_tr_b16 a[34:35], v15 offset:1024
    ds_read_b64_tr_b16 a[36:37], v15 offset:8192
    ds_read_b64_tr_b16 a[38:39], v15 offset:9216
    ds_read_b64_tr_b16 a[40:41], v15 offset:16384
    ds_read_b64_tr_b16 a[42:43], v15 offset:17408
    ds_read_b64_tr_b16 a[44:45], v15 offset:24576
    ds_read_b64_tr_b16 a[46:47], v15 offset:25600
    ds_read_b64_tr_b16 a[48:49], v15 offset:32768
    ds_read_b64_tr_b16 a[50:51], v15 offset:33792
    ds_read_b64_tr_b16 a[52:53], v15 offset:40960
    ds_read_b64_tr_b16 a[54:55], v15 offset:41984
    ds_read_b64_tr_b16 a[56:57], v15 offset:49152
    ds_read_b64_tr_b16 a[58:59], v15 offset:50176
    ds_read_b64_tr_b16 a[60:61], v15 offset:57344
    ds_read_b64_tr_b16 a[62:63], v15 offset:58368
    s_lshl_b32 s70, s34, 1
    s_add_u32 s70, s70, 1
    v_xor_b32 v14, s70, v11
    v_lshl_add_u32 v14, v14, 5, v10
    v_add_u32 v15, 0x10000, v14
    ds_read_b64_tr_b16 a[64:65], v14 offset:0
    ds_read_b64_tr_b16 a[66:67], v14 offset:1024
    ds_read_b64_tr_b16 a[68:69], v14 offset:8192
    ds_read_b64_tr_b16 a[70:71], v14 offset:9216
    ds_read_b64_tr_b16 a[72:73], v14 offset:16384
    ds_read_b64_tr_b16 a[74:75], v14 offset:17408
    ds_read_b64_tr_b16 a[76:77], v14 offset:24576
    ds_read_b64_tr_b16 a[78:79], v14 offset:25600
    ds_read_b64_tr_b16 a[80:81], v14 offset:32768
    ds_read_b64_tr_b16 a[82:83], v14 offset:33792
    ds_read_b64_tr_b16 a[84:85], v14 offset:40960
    ds_read_b64_tr_b16 a[86:87], v14 offset:41984
    ds_read_b64_tr_b16 a[88:89], v14 offset:49152
    ds_read_b64_tr_b16 a[90:91], v14 offset:50176
    ds_read_b64_tr_b16 a[92:93], v14 offset:57344
    ds_read_b64_tr_b16 a[94:95], v14 offset:58368
    ds_read_b64_tr_b16 a[96:97], v15 offset:0
    ds_read_b64_tr_b16 a[98:99], v15 offset:1024
    ds_read_b64_tr_b16 a[100:101], v15 offset:8192
    ds_read_b64_tr_b16 a[102:103], v15 offset:9216
    ds_read_b64_tr_b16 a[104:105], v15 offset:16384
    ds_read_b64_tr_b16 a[106:107], v15 offset:17408
    ds_read_b64_tr_b16 a[108:109], v15 offset:24576
    ds_read_b64_tr_b16 a[110:111], v15 offset:25600
    ds_read_b64_tr_b16 a[112:113], v15 offset:32768
    ds_read_b64_tr_b16 a[114:115], v15 offset:33792
    ds_read_b64_tr_b16 a[116:117], v15 offset:40960
    ds_read_b64_tr_b16 a[118:119], v15 offset:41984
    ds_read_b64_tr_b16 a[120:121], v15 offset:49152
    ds_read_b64_tr_b16 a[122:123], v15 offset:50176
    ds_read_b64_tr_b16 a[124:125], v15 offset:57344
    ds_read_b64_tr_b16 a[126:127], v15 offset:58368
    s_waitcnt lgkmcnt(0)
    s_mov_b32 s70, 50331648
    s_cmp_eq_u32 s42, 1
    s_cselect_b32 s70, 67108864, s70
    s_cmp_eq_u32 s42, 2
    s_cselect_b32 s70, 33554432, s70
    s_lshl_b32 s71, s43, 13
    s_add_u32 s70, s70, s71
    s_lshl_b32 s71, s41, 19
    s_add_u32 s70, s70, s71
    s_add_u32 s44, s4, s70
    s_addc_u32 s45, s5, 0
    s_lshl_b32 s70, s41, 16
    s_lshl_b32 s71, s34, 14
    s_add_u32 s70, s70, s71
    s_add_u32 s70, s70, 1048576
    s_add_u32 s46, s4, s70
    s_addc_u32 s47, s5, 0
    v_mbcnt_lo_u32_b32 v2, -1, 0
    v_mbcnt_hi_u32_b32 v2, -1, v2
    v_lshrrev_b32 v3, 4, v2
    v_and_b32 v4, 15, v2
    v_lshlrev_b32 v5, 4, v2
    v_add_u32 v6, 0x10000, v5
    v_add_u32 v7, 4096, v5
    v_add_u32 v8, 8192, v5
    v_add_u32 v9, 12288, v5
    s_lshl_b32 s70, s34, 10
    v_add_u32 v12, s70, v5
    s_lshl_b32 s70, s34, 11
    v_add_u32 v13, s70, v5
    v_add_u32 v14, 0x40000, v12
    v_add_u32 v15, 0x40000, v13
    v_add_u32 v19, 4096, v12
    v_add_u32 v20, 4096, v14
    s_cmp_lg_u32 s34, 0
    s_cbranch_scc1 polld_142
    v_mov_b32 v16, 8
    s_mov_b32 s79, 0
    s_mov_b64 exec, 1
poll_141:
    global_load_dword v17, v16, s[6:7] sc1
    s_add_u32 s79, s79, 1
    s_cmp_gt_u32 s79, 0x80000
    s_cbranch_scc1 L_fail
    s_waitcnt vmcnt(0)
    v_cmp_le_u32 vcc, 256, v17
    s_cbranch_vccnz polld_142
    s_sleep 4
    s_branch poll_141
polld_142:
    s_mov_b64 exec, -1
    s_barrier
    s_lshl_b32 s78, s41, 7
    s_add_u32 s78, s78, 4096
    s_cmp_lg_u32 s34, 0
    s_cbranch_scc1 polld_144
    v_mov_b32 v16, s78
    s_mov_b32 s79, 0
    s_mov_b64 exec, 1
poll_143:
    global_load_dword v17, v16, s[4:5] sc1
    s_add_u32 s79, s79, 1
    s_cmp_gt_u32 s79, 0x80000
    s_cbranch_scc1 L_fail
    s_waitcnt vmcnt(0)
    v_cmp_le_u32 vcc, 4, v17
    s_cbranch_vccnz polld_144
    s_sleep 2
    s_branch poll_143
polld_144:
    s_mov_b64 exec, -1
    s_barrier
    s_barrier
    s_lshl_b32 s70, s34, 14
    s_add_u32 m0, s70, 0
    s_nop 0
    global_load_lds_dwordx4 v5, s[46:47] offset:0 sc1
    global_load_lds_dwordx4 v5, s[46:47] offset:1024 sc1
    global_load_lds_dwordx4 v5, s[46:47] offset:2048 sc1
    global_load_lds_dwordx4 v5, s[46:47] offset:3072 sc1
    s_add_u32 m0, s70, 4096
    s_nop 0
    global_load_lds_dwordx4 v7, s[46:47] offset:0 sc1
    global_load_lds_dwordx4 v7, s[46:47] offset:1024 sc1
    global_load_lds_dwordx4 v7, s[46:47] offset:2048 sc1
    global_load_lds_dwordx4 v7, s[46:47] offset:3072 sc1
    s_add_u32 m0, s70, 8192
    s_nop 0
    global_load_lds_dwordx4 v8, s[46:47] offset:0 sc1
    global_load_lds_dwordx4 v8, s[46:47] offset:1024 sc1
    global_load_lds_dwordx4 v8, s[46:47] offset:2048 sc1
    global_load_lds_dwordx4 v8, s[46:47] offset:3072 sc1
    s_add_u32 m0, s70, 12288
    s_nop 0
    global_load_lds_dwordx4 v9, s[46:47] offset:0 sc1
    global_load_lds_dwordx4 v9, s[46:47] offset:1024 sc1
    global_load_lds_dwordx4 v9, s[46:47] offset:2048 sc1
    global_load_lds_dwordx4 v9, s[46:47] offset:3072 sc1
    s_add_u32 s46, s46, 131072
    s_addc_u32 s47, s47, 0
    s_waitcnt vmcnt(0)
    s_mov_b32 s48, 0
    s_lshl_b32 s49, s41, 7
    s_add_u32 s49, s49, -256
    s_cmp_eq_u32 s42, 2
    s_cselect_b32 s70, 36864, 0
    s_add_u32 s49, s49, s70
    s_cmp_eq_u32 s42, 1
    s_cbranch_scc1 gemmV_145
gloop_147:
    s_waitcnt vmcnt(4)
    s_barrier
    s_cmp_lt_u32 s48, 3
    s_cbranch_scc1 gs_148
    s_sub_u32 s78, s49, 256
    s_cmp_lg_u32 s34, 0
    s_cbranch_scc1 sig_149
    v_mov_b32 v16, s78
    v_mov_b32 v17, 1
    s_mov_b64 exec, 1
    global_atomic_add v16, v17, s[4:5]
    s_mov_b64 exec, -1
sig_149:
gs_148:
    s_cmp_ge_u32 s48, 15
    s_cbranch_scc1 gn_150
    s_cmp_eq_u32 s48, 0
    s_cbranch_scc1 gn_150
    s_lshl_b32 s70, s34, 14
    s_add_u32 m0, s70, 65536
    s_nop 0
    global_load_lds_dwordx4 v5, s[46:47] offset:0 sc1
    global_load_lds_dwordx4 v5, s[46:47] offset:1024 sc1
    global_load_lds_dwordx4 v5, s[46:47] offset:2048 sc1
    global_load_lds_dwordx4 v5, s[46:47] offset:3072 sc1
    s_add_u32 m0, s70, 69632
    s_nop 0
    global_load_lds_dwordx4 v7, s[46:47] offset:0 sc1
    global_load_lds_dwordx4 v7, s[46:47] offset:1024 sc1
    global_load_lds_dwordx4 v7, s[46:47] offset:2048 sc1
    global_load_lds_dwordx4 v7, s[46:47] offset:3072 sc1
    s_add_u32 m0, s70, 73728
    s_nop 0
    global_load_lds_dwordx4 v8, s[46:47] offset:0 sc1
    global_load_lds_dwordx4 v8, s[46:47] offset:1024 sc1
    global_load_lds_dwordx4 v8, s[46:47] offset:2048 sc1
    global_load_lds_dwordx4 v8, s[46:47] offset:3072 sc1
    s_add_u32 m0, s70, 77824
    s_nop 0
    global_load_lds_dwordx4 v9, s[46:47] offset:0 sc1
    global_load_lds_dwordx4 v9, s[46:47] offset:1024 sc1
    global_load_lds_dwordx4 v9, s[46:47] offset:2048 sc1
    global_load_lds_dwordx4 v9, s[46:47] offset:3072 sc1
    s_add_u32 s46, s46, 131072
    s_addc_u32 s47, s47, 0
gn_150:
    ds_read_b128 v[64:67], v5 offset:0
    ds_read_b128 v[68:71], v5 offset:16384
    ds_read_b128 v[72:75], v5 offset:32768
    ds_read_b128 v[76:79], v5 offset:49152
    ds_read_b128 v[80:83], v5 offset:1024
    ds_read_b128 v[84:87], v5 offset:17408
    s_waitcnt lgkmcnt(5)
    v_mfma_f32_16x16x32_bf16 v[32:35], a[0:3], v[64:67], 0
    ds_read_b128 v[88:91], v5 offset:33792
    v_mfma_f32_16x16x32_bf16 v[36:39], a[64:67], v[64:67], 0
    s_waitcnt lgkmcnt(5)
    v_mfma_f32_16x16x32_bf16 v[40:43], a[0:3], v[68:71], 0
    ds_read_b128 v[92:95], v5 offset:50176
    v_mfma_f32_16x16x32_bf16 v[44:47], a[64:67], v[68:71], 0
    s_waitcnt lgkmcnt(5)
    v_mfma_f32_16x16x32_bf16 v[48:51], a[0:3], v[72:75], 0
    ds_read_b128 v[64:67], v5 offset:2048
    v_mfma_f32_16x16x32_bf16 v[52:55], a[64:67], v[72:75], 0
    s_waitcnt lgkmcnt(5)
    v_mfma_f32_16x16x32_bf16 v[56:59], a[0:3], v[76:79], 0
    ds_read_b128 v[68:71], v5 offset:18432
    v_mfma_f32_16x16x32_bf16 v[60:63], a[64:67], v[76:79], 0
    s_waitcnt lgkmcnt(5)
    v_mfma_f32_16x16x32_bf16 v[32:35], a[4:7], v[80:83], v[32:35]
    ds_read_b128 v[72:75], v5 offset:34816
    v_mfma_f32_16x16x32_bf16 v[36:39], a[68:71], v[80:83], v[36:39]
    s_waitcnt lgkmcnt(5)
    v_mfma_f32_16x16x32_bf16 v[40:43], a[4:7], v[84:87], v[40:43]
    ds_read_b128 v[76:79], v5 offset:51200
    v_mfma_f32_16x16x32_bf16 v[44:47], a[68:71], v[84:87], v[44:47]
    s_waitcnt lgkmcnt(5)
    v_mfma_f32_16x16x32_bf16 v[48:51], a[4:7], v[88:91], v[48:51]
    ds_read_b128 v[80:83], v5 offset:3072
    v_mfma_f32_16x16x32_bf16 v[52:55], a[68:71], v[88:91], v[52:55]
    s_waitcnt lgkmcnt(5)
    v_mfma_f32_16x16x32_bf16 v[56:59], a[4:7], v[92:95], v[56:59]
    ds_read_b128 v[84:87], v5 offset:19456
    v_mfma_f32_16x16x32_bf16 v[60:63], a[68:71], v[92:95], v[60:63]
    s_waitcnt lgkmcnt(5)
    v_mfma_f32_16x16x32_bf16 v[32:35], a[8:11], v[64:67], v[32:35]
    ds_read_b128 v[88:91], v5 offset:35840
    v_mfma_f32_16x16x32_bf16 v[36:39], a[72:75], v[64:67], v[36:39]
    s_waitcnt lgkmcnt(5)
    v_mfma_f32_16x16x32_bf16 v[40:43], a[8:11], v[68:71], v[40:43]
    ds_read_b128 v[92:95], v5 offset:52224
    v_mfma_f32_16x16x32_bf16 v[44:47], a[72:75], v[68:71], v[44:47]
    s_waitcnt lgkmcnt(5)
    v_mfma_f32_16x16x32_bf16 v[48:51], a[8:11], v[72:75], v[48:51]
    ds_read_b128 v[64:67], v5 offset:4096
    v_mfma_f32_16x16x32_bf16 v[52:55], a[72:75], v[72:75], v[52:55]
    s_waitcnt lgkmcnt(5)
    v_mfma_f32_16x16x32_bf16 v[56:59], a[8:11], v[76:79], v[56:59]
    ds_read_b128 v[68:71], v5 offset:20480
    v_mfma_f32_16x16x32_bf16 v[60:63], a[72:75], v[76:79], v[60:63]
    s_waitcnt lgkmcnt(5)
    v_mfma_f32_16x16x32_bf16 v[32:35], a[12:15], v[80:83], v[32:35]
    ds_read_b128 v[72:75], v5 offset:36864
    v_mfma_f32_16x16x32_bf16 v[36:39], a[76:79], v[80:83], v[36:39]
    s_waitcnt lgkmcnt(5)
    v_mfma_f32_16x16x32_bf16 v[40:43], a[12:15], v[84:87], v[40:43]
    ds_read_b128 v[76:79], v5 offset:53248
    v_mfma_f32_16x16x32_bf16 v[44:47], a[76:79], v[84:87], v[44:47]
    s_waitcnt lgkmcnt(5)
    v_mfma_f32_16x16x32_bf16 v[48:51], a[12:15], v[88:91], v[48:51]
    ds_read_b128 v[80:83], v5 offset:5120
    v_mfma_f32_16x16x32_bf16 v[52:55], a[76:79], v[88:91], v[52:55]
    s_waitcnt lgkmcnt(5)
    v_mfma_f32_16x16x32_bf16 v[56:59], a[12:15], v[92:95], v[56:59]
    ds_read_b128 v[84:87], v5 offset:21504
    v_mfma_f32_16x16x32_bf16 v[60:63], a[76:79], v[92:95], v[60:63]
    s_waitcnt lgkmcnt(5)
    v_mfma_f32_16x16x32_bf16 v[32:35], a[16:19], v[64:67], v[32:35]
    ds_read_b128 v[88:91], v5 offset:37888
    v_mfma_f32_16x16x32_bf16 v[36:39], a[80:83], v[64:67], v[36:39]
    s_waitcnt lgkmcnt(5)
    v_mfma_f32_16x16x32_bf16 v[40:43], a[16:19], v[68:71], v[40:43]
    ds_read_b128 v[92:95], v5 offset:54272
    v_mfma_f32_16x16x32_bf16 v[44:47], a[80:83], v[68:71], v[44:47]
    s_waitcnt lgkmcnt(5)
    v_mfma_f32_16x16x32_bf16 v[48:51], a[16:19], v[72:75], v[48:51]
    ds_read_b128 v[64:67], v5 offset:6144
    v_mfma_f32_16x16x32_bf16 v[52:55], a[80:83], v[72:75], v[52:55]
    s_waitcnt lgkmcnt(5)
    v_mfma_f32_16x16x32_bf16 v[56:59], a[16:19], v[76:79], v[56:59]
    ds_read_b128 v[68:71], v5 offset:22528
    v_mfma_f32_16x16x32_bf16 v[60:63], a[80:83], v[76:79], v[60:63]
    s_waitcnt lgkmcnt(5)
    v_mfma_f32_16x16x32_bf16 v[32:35], a[20:23], v[80:83], v[32:35]
    ds_read_b128 v[72:75], v5 offset:38912
    v_mfma_f32_16x16x32_bf16 v[36:39], a[84:87], v[80:83], v[36:39]
    s_waitcnt lgkmcnt(5)
    v_mfma_f32_16x16x32_bf16 v[40:43], a[20:23], v[84:87], v[40:43]
    ds_read_b128 v[76:79], v5 offset:55296
    v_mfma_f32_16x16x32_bf16 v[44:47], a[84:87], v[84:87], v[44:47]
    s_waitcnt lgkmcnt(5)
    v_mfma_f32_16x16x32_bf16 v[48:51], a[20:23], v[88:91], v[48:51]
    ds_read_b128 v[80:83], v5 offset:7168
    v_mfma_f32_16x16x32_bf16 v[52:55], a[84:87], v[88:91], v[52:55]
    s_waitcnt lgkmcnt(5)
    v_mfma_f32_16x16x32_bf16 v[56:59], a[20:23], v[92:95], v[56:59]
    ds_read_b128 v[84:87], v5 offset:23552
    v_mfma_f32_16x16x32_bf16 v[60:63], a[84:87], v[92:95], v[60:63]
    s_waitcnt lgkmcnt(5)
    v_mfma_f32_16x16x32_bf16 v[32:35], a[24:27], v[64:67], v[32:35]
    ds_read_b128 v[88:91], v5 offset:39936
    v_mfma_f32_16x16x32_bf16 v[36:39], a[88:91], v[64:67], v[36:39]
    s_waitcnt lgkmcnt(5)
    v_mfma_f32_16x16x32_bf16 v[40:43], a[24:27], v[68:71], v[40:43]
    ds_read_b128 v[92:95], v5 offset:56320
    v_mfma_f32_16x16x32_bf16 v[44:47], a[88:91], v[68:71], v[44:47]
    s_waitcnt lgkmcnt(5)
    v_mfma_f32_16x16x32_bf16 v[48:51], a[24:27], v[72:75], v[48:51]
    ds_read_b128 v[64:67], v5 offset:8192
    v_mfma_f32_16x16x32_bf16 v[52:55], a[88:91], v[72:75], v[52:55]
    s_waitcnt lgkmcnt(5)
    v_mfma_f32_16x16x32_bf16 v[56:59], a[24:27], v[76:79], v[56:59]
    ds_read_b128 v[68:71], v5 offset:24576
    v_mfma_f32_16x16x32_bf16 v[60:63], a[88:91], v[76:79], v[60:63]
    s_waitcnt lgkmcnt(5)
    v_mfma_f32_16x16x32_bf16 v[32:35], a[28:31], v[80:83], v[32:35]
    ds_read_b128 v[72:75], v5 offset:40960
    v_mfma_f32_16x16x32_bf16 v[36:39], a[92:95], v[80:83], v[36:39]
    s_waitcnt lgkmcnt(5)
    v_mfma_f32_16x16x32_bf16 v[40:43], a[28:31], v[84:87], v[40:43]
    ds_read_b128 v[76:79], v5 offset:57344
    v_mfma_f32_16x16x32_bf16 v[44:47], a[92:95], v[84:87], v[44:47]
    s_waitcnt lgkmcnt(5)
    v_mfma_f32_16x16x32_bf16 v[48:51], a[28:31], v[88:91], v[48:51]
    ds_read_b128 v[80:83], v5 offset:9216
    v_mfma_f32_16x16x32_bf16 v[52:55], a[92:95], v[88:91], v[52:55]
    s_waitcnt lgkmcnt(5)
    v_mfma_f32_16x16x32_bf16 v[56:59], a[28:31], v[92:95], v[56:59]
    ds_read_b128 v[84:87], v5 offset:25600
    v_mfma_f32_16x16x32_bf16 v[60:63], a[92:95], v[92:95], v[60:63]
    s_waitcnt lgkmcnt(5)
    v_mfma_f32_16x16x32_bf16 v[32:35], a[32:35], v[64:67], v[32:35]
    ds_read_b128 v[88:91], v5 offset:41984
    v_mfma_f32_16x16x32_bf16 v[36:39], a[96:99], v[64:67], v[36:39]
    s_waitcnt lgkmcnt(5)
    v_mfma_f32_16x16x32_bf16 v[40:43], a[32:35], v[68:71], v[40:43]
    ds_read_b128 v[92:95], v5 offset:58368
    v_mfma_f32_16x16x32_bf16 v[44:47], a[96:99], v[68:71], v[44:47]
    s_waitcnt lgkmcnt(5)
    v_mfma_f32_16x16x32_bf16 v[48:51], a[32:35], v[72:75], v[48:51]
    ds_read_b128 v[64:67], v5 offset:10240
    v_mfma_f32_16x16x32_bf16 v[52:55], a[96:99], v[72:75], v[52:55]
    s_waitcnt lgkmcnt(5)
    v_mfma_f32_16x16x32_bf16 v[56:59], a[32:35], v[76:79], v[56:59]
    ds_read_b128 v[68:71], v5 offset:26624
    v_mfma_f32_16x16x32_bf16 v[60:63], a[96:99], v[76:79], v[60:63]
    s_waitcnt lgkmcnt(5)
    v_mfma_f32_16x16x32_bf16 v[32:35], a[36:39], v[80:83], v[32:35]
    ds_read_b128 v[72:75], v5 offset:43008
    v_mfma_f32_16x16x32_bf16 v[36:39], a[100:103], v[80:83], v[36:39]
    s_waitcnt lgkmcnt(5)
    v_mfma_f32_16x16x32_bf16 v[40:43], a[36:39], v[84:87], v[40:43]
    ds_read_b128 v[76:79], v5 offset:59392
    v_mfma_f32_16x16x32_bf16 v[44:47], a[100:103], v[84:87], v[44:47]
    s_waitcnt lgkmcnt(5)
    v_mfma_f32_16x16x32_bf16 v[48:51], a[36:39], v[88:91], v[48:51]
    ds_read_b128 v[80:83], v5 offset:11264
    v_mfma_f32_16x16x32_bf16 v[52:55], a[100:103], v[88:91], v[52:55]
    s_waitcnt lgkmcnt(5)
    v_mfma_f32_16x16x32_bf16 v[56:59], a[36:39], v[92:95], v[56:59]
    ds_read_b128 v[84:87], v5 offset:27648
    v_mfma_f32_16x16x32_bf16 v[60:63], a[100:103], v[92:95], v[60:63]
    s_waitcnt lgkmcnt(5)
    v_mfma_f32_16x16x32_bf16 v[32:35], a[40:43], v[64:67], v[32:35]
    ds_read_b128 v[88:91], v5 offset:44032
    v_mfma_f32_16x16x32_bf16 v[36:39], a[104:107], v[64:67], v[36:39]
    s_waitcnt lgkmcnt(5)
    v_mfma_f32_16x16x32_bf16 v[40:43], a[40:43], v[68:71], v[40:43]
    ds_read_b128 v[92:95], v5 offset:60416
    v_mfma_f32_16x16x32_bf16 v[44:47], a[104:107], v[68:71], v[44:47]
    s_waitcnt lgkmcnt(5)
    v_mfma_f32_16x16x32_bf16 v[48:51], a[40:43], v[72:75], v[48:51]
    ds_read_b128 v[64:67], v5 offset:12288
    v_mfma_f32_16x16x32_bf16 v[52:55], a[104:107], v[72:75], v[52:55]
    s_waitcnt lgkmcnt(5)
    v_mfma_f32_16x16x32_bf16 v[56:59], a[40:43], v[76:79], v[56:59]
    ds_read_b128 v[68:71], v5 offset:28672
    v_mfma_f32_16x16x32_bf16 v[60:63], a[104:107], v[76:79], v[60:63]
    s_waitcnt lgkmcnt(5)
    v_mfma_f32_16x16x32_bf16 v[32:35], a[44:47], v[80:83], v[32:35]
    ds_read_b128 v[72:75], v5 offset:45056
    v_mfma_f32_16x16x32_bf16 v[36:39], a[108:111], v[80:83], v[36:39]
    s_waitcnt lgkmcnt(5)
    v_mfma_f32_16x16x32_bf16 v[40:43], a[44:47], v[84:87], v[40:43]
    ds_read_b128 v[76:79], v5 offset:61440
    v_mfma_f32_16x16x32_bf16 v[44:47], a[108:111], v[84:87], v[44:47]
    s_waitcnt lgkmcnt(5)
    v_mfma_f32_16x16x32_bf16 v[48:51], a[44:47], v[88:91], v[48:51]
    ds_read_b128 v[80:83], v5 offset:13312
    v_mfma_f32_16x16x32_bf16 v[52:55], a[108:111], v[88:91], v[52:55]
    s_waitcnt lgkmcnt(5)
    v_mfma_f32_16x16x32_bf16 v[56:59], a[44:47], v[92:95], v[56:59]
    ds_read_b128 v[84:87], v5 offset:29696
    v_mfma_f32_16x16x32_bf16 v[60:63], a[108:111], v[92:95], v[60:63]
    s_waitcnt lgkmcnt(5)
    v_mfma_f32_16x16x32_bf16 v[32:35], a[48:51], v[64:67], v[32:35]
    ds_read_b128 v[88:91], v5 offset:46080
    v_mfma_f32_16x16x32_bf16 v[36:39], a[112:115], v[64:67], v[36:39]
    s_waitcnt lgkmcnt(5)
    v_mfma_f32_16x16x32_bf16 v[40:43], a[48:51], v[68:71], v[40:43]
    ds_read_b128 v[92:95], v5 offset:62464
    v_mfma_f32_16x16x32_bf16 v[44:47], a[112:115], v[68:71], v[44:47]
    s_waitcnt lgkmcnt(5)
    v_mfma_f32_16x16x32_bf16 v[48:51], a[48:51], v[72:75], v[48:51]
    ds_read_b128 v[64:67], v5 offset:14336
    v_mfma_f32_16x16x32_bf16 v[52:55], a[112:115], v[72:75], v[52:55]
    s_waitcnt lgkmcnt(5)
    v_mfma_f32_16x16x32_bf16 v[56:59], a[48:51], v[76:79], v[56:59]
    ds_read_b128 v[68:71], v5 offset:30720
    v_mfma_f32_16x16x32_bf16 v[60:63], a[112:115], v[76:79], v[60:63]
    s_waitcnt lgkmcnt(5)
    v_mfma_f32_16x16x32_bf16 v[32:35], a[52:55], v[80:83], v[32:35]
    ds_read_b128 v[72:75], v5 offset:47104
    v_mfma_f32_16x16x32_bf16 v[36:39], a[116:119], v[80:83], v[36:39]
    s_waitcnt lgkmcnt(5)
    v_mfma_f32_16x16x32_bf16 v[40:43], a[52:55], v[84:87], v[40:43]
    ds_read_b128 v[76:79], v5 offset:63488
    v_mfma_f32_16x16x32_bf16 v[44:47], a[116:119], v[84:87], v[44:47]
    s_waitcnt lgkmcnt(5)
    v_mfma_f32_16x16x32_bf16 v[48:51], a[52:55], v[88:91], v[48:51]
    ds_read_b128 v[80:83], v5 offset:15360
    v_mfma_f32_16x16x32_bf16 v[52:55], a[116:119], v[88:91], v[52:55]
    s_waitcnt lgkmcnt(5)
    v_mfma_f32_16x16x32_bf16 v[56:59], a[52:55], v[92:95], v[56:59]
    ds_read_b128 v[84:87], v5 offset:31744
    v_mfma_f32_16x16x32_bf16 v[60:63], a[116:119], v[92:95], v[60:63]
    s_waitcnt lgkmcnt(5)
    v_mfma_f32_16x16x32_bf16 v[32:35], a[56:59], v[64:67], v[32:35]
    ds_read_b128 v[88:91], v5 offset:48128
    v_mfma_f32_16x16x32_bf16 v[36:39], a[120:123], v[64:67], v[36:39]
    s_waitcnt lgkmcnt(5)
    v_mfma_f32_16x16x32_bf16 v[40:43], a[56:59], v[68:71], v[40:43]
    ds_read_b128 v[92:95], v5 offset:64512
    v_mfma_f32_16x16x32_bf16 v[44:47], a[120:123], v[68:71], v[44:47]
    s_waitcnt lgkmcnt(5)
    v_mfma_f32_16x16x32_bf16 v[48:51], a[56:59], v[72:75], v[48:51]
    v_mfma_f32_16x16x32_bf16 v[52:55], a[120:123], v[72:75], v[52:55]
    s_waitcnt lgkmcnt(4)
    v_mfma_f32_16x16x32_bf16 v[56:59], a[56:59], v[76:79], v[56:59]
    v_mfma_f32_16x16x32_bf16 v[60:63], a[120:123], v[76:79], v[60:63]
    s_waitcnt lgkmcnt(3)
    v_mfma_f32_16x16x32_bf16 v[32:35], a[60:63], v[80:83], v[32:35]
    v_mfma_f32_16x16x32_bf16 v[36:39], a[124:127], v[80:83], v[36:39]
    s_waitcnt lgkmcnt(2)
    v_mfma_f32_16x16x32_bf16 v[40:43], a[60:63], v[84:87], v[40:43]
    v_mfma_f32_16x16x32_bf16 v[44:47], a[124:127], v[84:87], v[44:47]
    s_waitcnt lgkmcnt(1)
    v_mfma_f32_16x16x32_bf16 v[48:51], a[60:63], v[88:91], v[48:51]
    v_mfma_f32_16x16x32_bf16 v[52:55], a[124:127], v[88:91], v[52:55]
    s_waitcnt lgkmcnt(0)
    v_mfma_f32_16x16x32_bf16 v[56:59], a[60:63], v[92:95], v[56:59]
    v_mfma_f32_16x16x32_bf16 v[60:63], a[124:127], v[92:95], v[60:63]
    v_cvt_pk_bf16_f32 v96, v32, v36
    v_cvt_pk_bf16_f32 v97, v33, v37
    v_cvt_pk_bf16_f32 v98, v34, v38
    v_cvt_pk_bf16_f32 v99, v35, v39
    global_store_dwordx4 v12, v[96:99], s[44:45] sc1
    v_cvt_pk_bf16_f32 v100, v40, v44
    v_cvt_pk_bf16_f32 v101, v41, v45
    v_cvt_pk_bf16_f32 v102, v42, v46
    v_cvt_pk_bf16_f32 v103, v43, v47
    global_store_dwordx4 v19, v[100:103], s[44:45] sc1
    v_cvt_pk_bf16_f32 v104, v48, v52
    v_cvt_pk_bf16_f32 v105, v49, v53
    v_cvt_pk_bf16_f32 v106, v50, v54
    v_cvt_pk_bf16_f32 v107, v51, v55
    global_store_dwordx4 v14, v[104:107], s[44:45] sc1
    v_cvt_pk_bf16_f32 v108, v56, v60
    v_cvt_pk_bf16_f32 v109, v57, v61
    v_cvt_pk_bf16_f32 v110, v58, v62
    v_cvt_pk_bf16_f32 v111, v59, v63
    global_store_dwordx4 v20, v[108:111], s[44:45] sc1
    s_add_u32 s44, s44, 1048576
    s_addc_u32 s45, s45, 0
    s_add_u32 s49, s49, 256
    s_cmp_lg_u32 s48, 0
    s_cbranch_scc1 gfirst_151
    s_waitcnt vmcnt(0)
    s_barrier
    s_cmp_lg_u32 s34, 0
    s_cbranch_scc1 sig_152
    v_mov_b32 v16, s49
    v_mov_b32 v17, 1
    s_mov_b64 exec, 1
    global_atomic_add v16, v17, s[4:5]
    s_mov_b64 exec, -1
sig_152:
    s_cmp_lg_u32 s34, 0
    s_cbranch_scc1 polld_154
    v_mov_b32 v16, 28672
    s_mov_b32 s79, 0
    s_mov_b64 exec, 1
poll_153:
    global_load_dword v17, v16, s[4:5] sc1
    s_add_u32 s79, s79, 1
    s_cmp_gt_u32 s79, 0x80000
    s_cbranch_scc1 L_fail
    s_waitcnt vmcnt(0)
    v_cmp_le_u32 vcc, 128, v17
    s_cbranch_vccnz polld_154
    s_sleep 8
    s_branch poll_153
polld_154:
    s_mov_b64 exec, -1
    s_barrier
    s_lshl_b32 s70, s34, 14
    s_add_u32 m0, s70, 65536
    s_nop 0
    global_load_lds_dwordx4 v5, s[46:47] offset:0 sc1
    global_load_lds_dwordx4 v5, s[46:47] offset:1024 sc1
    global_load_lds_dwordx4 v5, s[46:47] offset:2048 sc1
    global_load_lds_dwordx4 v5, s[46:47] offset:3072 sc1
    s_add_u32 m0, s70, 69632
    s_nop 0
    global_load_lds_dwordx4 v7, s[46:47] offset:0 sc1
    global_load_lds_dwordx4 v7, s[46:47] offset:1024 sc1
    global_load_lds_dwordx4 v7, s[46:47] offset:2048 sc1
    global_load_lds_dwordx4 v7, s[46:47] offset:3072 sc1
    s_add_u32 m0, s70, 73728
    s_nop 0
    global_load_lds_dwordx4 v8, s[46:47] offset:0 sc1
    global_load_lds_dwordx4 v8, s[46:47] offset:1024 sc1
    global_load_lds_dwordx4 v8, s[46:47] offset:2048 sc1
    global_load_lds_dwordx4 v8, s[46:47] offset:3072 sc1
    s_add_u32 m0, s70, 77824
    s_nop 0
    global_load_lds_dwordx4 v9, s[46:47] offset:0 sc1
    global_load_lds_dwordx4 v9, s[46:47] offset:1024 sc1
    global_load_lds_dwordx4 v9, s[46:47] offset:2048 sc1
    global_load_lds_dwordx4 v9, s[46:47] offset:3072 sc1
    s_add_u32 s46, s46, 131072
    s_addc_u32 s47, s47, 0
    s_waitcnt vmcnt(0)
gfirst_151:
    s_add_u32 s48, s48, 1
    s_waitcnt vmcnt(4)
    s_barrier
    s_cmp_lt_u32 s48, 3
    s_cbranch_scc1 gs_155
    s_sub_u32 s78, s49, 256
    s_cmp_lg_u32 s34, 0
    s_cbranch_scc1 sig_156
    v_mov_b32 v16, s78
    v_mov_b32 v17, 1
    s_mov_b64 exec, 1
    global_atomic_add v16, v17, s[4:5]
    s_mov_b64 exec, -1
sig_156:
gs_155:
    s_cmp_ge_u32 s48, 15
    s_cbranch_scc1 gn_157
    s_lshl_b32 s70, s34, 14
    s_add_u32 m0, s70, 0
    s_nop 0
    global_load_lds_dwordx4 v5, s[46:47] offset:0 sc1
    global_load_lds_dwordx4 v5, s[46:47] offset:1024 sc1
    global_load_lds_dwordx4 v5, s[46:47] offset:2048 sc1
    global_load_lds_dwordx4 v5, s[46:47] offset:3072 sc1
    s_add_u32 m0, s70, 4096
    s_nop 0
    global_load_lds_dwordx4 v7, s[46:47] offset:0 sc1
    global_load_lds_dwordx4 v7, s[46:47] offset:1024 sc1
    global_load_lds_dwordx4 v7, s[46:47] offset:2048 sc1
    global_load_lds_dwordx4 v7, s[46:47] offset:3072 sc1
    s_add_u32 m0, s70, 8192
    s_nop 0
    global_load_lds_dwordx4 v8, s[46:47] offset:0 sc1
    global_load_lds_dwordx4 v8, s[46:47] offset:1024 sc1
    global_load_lds_dwordx4 v8, s[46:47] offset:2048 sc1
    global_load_lds_dwordx4 v8, s[46:47] offset:3072 sc1
    s_add_u32 m0, s70, 12288
    s_nop 0
    global_load_lds_dwordx4 v9, s[46:47] offset:0 sc1
    global_load_lds_dwordx4 v9, s[46:47] offset:1024 sc1
    global_load_lds_dwordx4 v9, s[46:47] offset:2048 sc1
    global_load_lds_dwordx4 v9, s[46:47] offset:3072 sc1
    s_add_u32 s46, s46, 131072
    s_addc_u32 s47, s47, 0
gn_157:
    ds_read_b128 v[64:67], v6 offset:0
    ds_read_b128 v[68:71], v6 offset:16384
    ds_read_b128 v[72:75], v6 offset:32768
    ds_read_b128 v[76:79], v6 offset:49152
    ds_read_b128 v[80:83], v6 offset:1024
    ds_read_b128 v[84:87], v6 offset:17408
    s_waitcnt lgkmcnt(5)
    v_mfma_f32_16x16x32_bf16 v[32:35], a[0:3], v[64:67], 0
    ds_read_b128 v[88:91], v6 offset:33792
    v_mfma_f32_16x16x32_bf16 v[36:39], a[64:67], v[64:67], 0
    s_waitcnt lgkmcnt(5)
    v_mfma_f32_16x16x32_bf16 v[40:43], a[0:3], v[68:71], 0
    ds_read_b128 v[92:95], v6 offset:50176
    v_mfma_f32_16x16x32_bf16 v[44:47], a[64:67], v[68:71], 0
    s_waitcnt lgkmcnt(5)
    v_mfma_f32_16x16x32_bf16 v[48:51], a[0:3], v[72:75], 0
    ds_read_b128 v[64:67], v6 offset:2048
    v_mfma_f32_16x16x32_bf16 v[52:55], a[64:67], v[72:75], 0
    s_waitcnt lgkmcnt(5)
    v_mfma_f32_16x16x32_bf16 v[56:59], a[0:3], v[76:79], 0
    ds_read_b128 v[68:71], v6 offset:18432
    v_mfma_f32_16x16x32_bf16 v[60:63], a[64:67], v[76:79], 0
    s_waitcnt lgkmcnt(5)
    v_mfma_f32_16x16x32_bf16 v[32:35], a[4:7], v[80:83], v[32:35]
    ds_read_b128 v[72:75], v6 offset:34816
    v_mfma_f32_16x16x32_bf16 v[36:39], a[68:71], v[80:83], v[36:39]
    s_waitcnt lgkmcnt(5)
    v_mfma_f32_16x16x32_bf16 v[40:43], a[4:7], v[84:87], v[40:43]
    ds_read_b128 v[76:79], v6 offset:51200
    v_mfma_f32_16x16x32_bf16 v[44:47], a[68:71], v[84:87], v[44:47]
    s_waitcnt lgkmcnt(5)
    v_mfma_f32_16x16x32_bf16 v[48:51], a[4:7], v[88:91], v[48:51]
    ds_read_b128 v[80:83], v6 offset:3072
    v_mfma_f32_16x16x32_bf16 v[52:55], a[68:71], v[88:91], v[52:55]
    s_waitcnt lgkmcnt(5)
    v_mfma_f32_16x16x32_bf16 v[56:59], a[4:7], v[92:95], v[56:59]
    ds_read_b128 v[84:87], v6 offset:19456
    v_mfma_f32_16x16x32_bf16 v[60:63], a[68:71], v[92:95], v[60:63]
    s_waitcnt lgkmcnt(5)
    v_mfma_f32_16x16x32_bf16 v[32:35], a[8:11], v[64:67], v[32:35]
    ds_read_b128 v[88:91], v6 offset:35840
    v_mfma_f32_16x16x32_bf16 v[36:39], a[72:75], v[64:67], v[36:39]
    s_waitcnt lgkmcnt(5)
    v_mfma_f32_16x16x32_bf16 v[40:43], a[8:11], v[68:71], v[40:43]
    ds_read_b128 v[92:95], v6 offset:52224
    v_mfma_f32_16x16x32_bf16 v[44:47], a[72:75], v[68:71], v[44:47]
    s_waitcnt lgkmcnt(5)
    v_mfma_f32_16x16x32_bf16 v[48:51], a[8:11], v[72:75], v[48:51]
    ds_read_b128 v[64:67], v6 offset:4096
    v_mfma_f32_16x16x32_bf16 v[52:55], a[72:75], v[72:75], v[52:55]
    s_waitcnt lgkmcnt(5)
    v_mfma_f32_16x16x32_bf16 v[56:59], a[8:11], v[76:79], v[56:59]
    ds_read_b128 v[68:71], v6 offset:20480
    v_mfma_f32_16x16x32_bf16 v[60:63], a[72:75], v[76:79], v[60:63]
    s_waitcnt lgkmcnt(5)
    v_mfma_f32_16x16x32_bf16 v[32:35], a[12:15], v[80:83], v[32:35]
    ds_read_b128 v[72:75], v6 offset:36864
    v_mfma_f32_16x16x32_bf16 v[36:39], a[76:79], v[80:83], v[36:39]
    s_waitcnt lgkmcnt(5)
    v_mfma_f32_16x16x32_bf16 v[40:43], a[12:15], v[84:87], v[40:43]
    ds_read_b128 v[76:79], v6 offset:53248
    v_mfma_f32_16x16x32_bf16 v[44:47], a[76:79], v[84:87], v[44:47]
    s_waitcnt lgkmcnt(5)
    v_mfma_f32_16x16x32_bf16 v[48:51], a[12:15], v[88:91], v[48:51]
    ds_read_b128 v[80:83], v6 offset:5120
    v_mfma_f32_16x16x32_bf16 v[52:55], a[76:79], v[88:91], v[52:55]
    s_waitcnt lgkmcnt(5)
    v_mfma_f32_16x16x32_bf16 v[56:59], a[12:15], v[92:95], v[56:59]
    ds_read_b128 v[84:87], v6 offset:21504
    v_mfma_f32_16x16x32_bf16 v[60:63], a[76:79], v[92:95], v[60:63]
    s_waitcnt lgkmcnt(5)
    v_mfma_f32_16x16x32_bf16 v[32:35], a[16:19], v[64:67], v[32:35]
    ds_read_b128 v[88:91], v6 offset:37888
    v_mfma_f32_16x16x32_bf16 v[36:39], a[80:83], v[64:67], v[36:39]
    s_waitcnt lgkmcnt(5)
    v_mfma_f32_16x16x32_bf16 v[40:43], a[16:19], v[68:71], v[40:43]
    ds_read_b128 v[92:95], v6 offset:54272
    v_mfma_f32_16x16x32_bf16 v[44:47], a[80:83], v[68:71], v[44:47]
    s_waitcnt lgkmcnt(5)
    v_mfma_f32_16x16x32_bf16 v[48:51], a[16:19], v[72:75], v[48:51]
    ds_read_b128 v[64:67], v6 offset:6144
    v_mfma_f32_16x16x32_bf16 v[52:55], a[80:83], v[72:75], v[52:55]
    s_waitcnt lgkmcnt(5)
    v_mfma_f32_16x16x32_bf16 v[56:59], a[16:19], v[76:79], v[56:59]
    ds_read_b128 v[68:71], v6 offset:22528
    v_mfma_f32_16x16x32_bf16 v[60:63], a[80:83], v[76:79], v[60:63]
    s_waitcnt lgkmcnt(5)
    v_mfma_f32_16x16x32_bf16 v[32:35], a[20:23], v[80:83], v[32:35]
    ds_read_b128 v[72:75], v6 offset:38912
    v_mfma_f32_16x16x32_bf16 v[36:39], a[84:87], v[80:83], v[36:39]
    s_waitcnt lgkmcnt(5)
    v_mfma_f32_16x16x32_bf16 v[40:43], a[20:23], v[84:87], v[40:43]
    ds_read_b128 v[76:79], v6 offset:55296
    v_mfma_f32_16x16x32_bf16 v[44:47], a[84:87], v[84:87], v[44:47]
    s_waitcnt lgkmcnt(5)
    v_mfma_f32_16x16x32_bf16 v[48:51], a[20:23], v[88:91], v[48:51]
    ds_read_b128 v[80:83], v6 offset:7168
    v_mfma_f32_16x16x32_bf16 v[52:55], a[84:87], v[88:91], v[52:55]
    s_waitcnt lgkmcnt(5)
    v_mfma_f32_16x16x32_bf16 v[56:59], a[20:23], v[92:95], v[56:59]
    ds_read_b128 v[84:87], v6 offset:23552
    v_mfma_f32_16x16x32_bf16 v[60:63], a[84:87], v[92:95], v[60:63]
    s_waitcnt lgkmcnt(5)
    v_mfma_f32_16x16x32_bf16 v[32:35], a[24:27], v[64:67], v[32:35]
    ds_read_b128 v[88:91], v6 offset:39936
    v_mfma_f32_16x16x32_bf16 v[36:39], a[88:91], v[64:67], v[36:39]
    s_waitcnt lgkmcnt(5)
    v_mfma_f32_16x16x32_bf16 v[40:43], a[24:27], v[68:71], v[40:43]
    ds_read_b128 v[92:95], v6 offset:56320
    v_mfma_f32_16x16x32_bf16 v[44:47], a[88:91], v[68:71], v[44:47]
    s_waitcnt lgkmcnt(5)
    v_mfma_f32_16x16x32_bf16 v[48:51], a[24:27], v[72:75], v[48:51]
    ds_read_b128 v[64:67], v6 offset:8192
    v_mfma_f32_16x16x32_bf16 v[52:55], a[88:91], v[72:75], v[52:55]
    s_waitcnt lgkmcnt(5)
    v_mfma_f32_16x16x32_bf16 v[56:59], a[24:27], v[76:79], v[56:59]
    ds_read_b128 v[68:71], v6 offset:24576
    v_mfma_f32_16x16x32_bf16 v[60:63], a[88:91], v[76:79], v[60:63]
    s_waitcnt lgkmcnt(5)
    v_mfma_f32_16x16x32_bf16 v[32:35], a[28:31], v[80:83], v[32:35]
    ds_read_b128 v[72:75], v6 offset:40960
    v_mfma_f32_16x16x32_bf16 v[36:39], a[92:95], v[80:83], v[36:39]
    s_waitcnt lgkmcnt(5)
    v_mfma_f32_16x16x32_bf16 v[40:43], a[28:31], v[84:87], v[40:43]
    ds_read_b128 v[76:79], v6 offset:57344
    v_mfma_f32_16x16x32_bf16 v[44:47], a[92:95], v[84:87], v[44:47]
    s_waitcnt lgkmcnt(5)
    v_mfma_f32_16x16x32_bf16 v[48:51], a[28:31], v[88:91], v[48:51]
    ds_read_b128 v[80:83], v6 offset:9216
    v_mfma_f32_16x16x32_bf16 v[52:55], a[92:95], v[88:91], v[52:55]
    s_waitcnt lgkmcnt(5)
    v_mfma_f32_16x16x32_bf16 v[56:59], a[28:31], v[92:95], v[56:59]
    ds_read_b128 v[84:87], v6 offset:25600
    v_mfma_f32_16x16x32_bf16 v[60:63], a[92:95], v[92:95], v[60:63]
    s_waitcnt lgkmcnt(5)
    v_mfma_f32_16x16x32_bf16 v[32:35], a[32:35], v[64:67], v[32:35]
    ds_read_b128 v[88:91], v6 offset:41984
    v_mfma_f32_16x16x32_bf16 v[36:39], a[96:99], v[64:67], v[36:39]
    s_waitcnt lgkmcnt(5)
    v_mfma_f32_16x16x32_bf16 v[40:43], a[32:35], v[68:71], v[40:43]
    ds_read_b128 v[92:95], v6 offset:58368
    v_mfma_f32_16x16x32_bf16 v[44:47], a[96:99], v[68:71], v[44:47]
    s_waitcnt lgkmcnt(5)
    v_mfma_f32_16x16x32_bf16 v[48:51], a[32:35], v[72:75], v[48:51]
    ds_read_b128 v[64:67], v6 offset:10240
    v_mfma_f32_16x16x32_bf16 v[52:55], a[96:99], v[72:75], v[52:55]
    s_waitcnt lgkmcnt(5)
    v_mfma_f32_16x16x32_bf16 v[56:59], a[32:35], v[76:79], v[56:59]
    ds_read_b128 v[68:71], v6 offset:26624
    v_mfma_f32_16x16x32_bf16 v[60:63], a[96:99], v[76:79], v[60:63]
    s_waitcnt lgkmcnt(5)
    v_mfma_f32_16x16x32_bf16 v[32:35], a[36:39], v[80:83], v[32:35]
    ds_read_b128 v[72:75], v6 offset:43008
    v_mfma_f32_16x16x32_bf16 v[36:39], a[100:103], v[80:83], v[36:39]
    s_waitcnt lgkmcnt(5)
    v_mfma_f32_16x16x32_bf16 v[40:43], a[36:39], v[84:87], v[40:43]
    ds_read_b128 v[76:79], v6 offset:59392
    v_mfma_f32_16x16x32_bf16 v[44:47], a[100:103], v[84:87], v[44:47]
    s_waitcnt lgkmcnt(5)
    v_mfma_f32_16x16x32_bf16 v[48:51], a[36:39], v[88:91], v[48:51]
    ds_read_b128 v[80:83], v6 offset:11264
    v_mfma_f32_16x16x32_bf16 v[52:55], a[100:103], v[88:91], v[52:55]
    s_waitcnt lgkmcnt(5)
    v_mfma_f32_16x16x32_bf16 v[56:59], a[36:39], v[92:95], v[56:59]
    ds_read_b128 v[84:87], v6 offset:27648
    v_mfma_f32_16x16x32_bf16 v[60:63], a[100:103], v[92:95], v[60:63]
    s_waitcnt lgkmcnt(5)
    v_mfma_f32_16x16x32_bf16 v[32:35], a[40:43], v[64:67], v[32:35]
    ds_read_b128 v[88:91], v6 offset:44032
    v_mfma_f32_16x16x32_bf16 v[36:39], a[104:107], v[64:67], v[36:39]
    s_waitcnt lgkmcnt(5)
    v_mfma_f32_16x16x32_bf16 v[40:43], a[40:43], v[68:71], v[40:43]
    ds_read_b128 v[92:95], v6 offset:60416
    v_mfma_f32_16x16x32_bf16 v[44:47], a[104:107], v[68:71], v[44:47]
    s_waitcnt lgkmcnt(5)
    v_mfma_f32_16x16x32_bf16 v[48:51], a[40:43], v[72:75], v[48:51]
    ds_read_b128 v[64:67], v6 offset:12288
    v_mfma_f32_16x16x32_bf16 v[52:55], a[104:107], v[72:75], v[52:55]
    s_waitcnt lgkmcnt(5)
    v_mfma_f32_16x16x32_bf16 v[56:59], a[40:43], v[76:79], v[56:59]
    ds_read_b128 v[68:71], v6 offset:28672
    v_mfma_f32_16x16x32_bf16 v[60:63], a[104:107], v[76:79], v[60:63]
    s_waitcnt lgkmcnt(5)
    v_mfma_f32_16x16x32_bf16 v[32:35], a[44:47], v[80:83], v[32:35]
    ds_read_b128 v[72:75], v6 offset:45056
    v_mfma_f32_16x16x32_bf16 v[36:39], a[108:111], v[80:83], v[36:39]
    s_waitcnt lgkmcnt(5)
    v_mfma_f32_16x16x32_bf16 v[40:43], a[44:47], v[84:87], v[40:43]
    ds_read_b128 v[76:79], v6 offset:61440
    v_mfma_f32_16x16x32_bf16 v[44:47], a[108:111], v[84:87], v[44:47]
    s_waitcnt lgkmcnt(5)
    v_mfma_f32_16x16x32_bf16 v[48:51], a[44:47], v[88:91], v[48:51]
    ds_read_b128 v[80:83], v6 offset:13312
    v_mfma_f32_16x16x32_bf16 v[52:55], a[108:111], v[88:91], v[52:55]
    s_waitcnt lgkmcnt(5)
    v_mfma_f32_16x16x32_bf16 v[56:59], a[44:47], v[92:95], v[56:59]
    ds_read_b128 v[84:87], v6 offset:29696
    v_mfma_f32_16x16x32_bf16 v[60:63], a[108:111], v[92:95], v[60:63]
    s_waitcnt lgkmcnt(5)
    v_mfma_f32_16x16x32_bf16 v[32:35], a[48:51], v[64:67], v[32:35]
    ds_read_b128 v[88:91], v6 offset:46080
    v_mfma_f32_16x16x32_bf16 v[36:39], a[112:115], v[64:67], v[36:39]
    s_waitcnt lgkmcnt(5)
    v_mfma_f32_16x16x32_bf16 v[40:43], a[48:51], v[68:71], v[40:43]
    ds_read_b128 v[92:95], v6 offset:62464
    v_mfma_f32_16x16x32_bf16 v[44:47], a[112:115], v[68:71], v[44:47]
    s_waitcnt lgkmcnt(5)
    v_mfma_f32_16x16x32_bf16 v[48:51], a[48:51], v[72:75], v[48:51]
    ds_read_b128 v[64:67], v6 offset:14336
    v_mfma_f32_16x16x32_bf16 v[52:55], a[112:115], v[72:75], v[52:55]
    s_waitcnt lgkmcnt(5)
    v_mfma_f32_16x16x32_bf16 v[56:59], a[48:51], v[76:79], v[56:59]
    ds_read_b128 v[68:71], v6 offset:30720
    v_mfma_f32_16x16x32_bf16 v[60:63], a[112:115], v[76:79], v[60:63]
    s_waitcnt lgkmcnt(5)
    v_mfma_f32_16x16x32_bf16 v[32:35], a[52:55], v[80:83], v[32:35]
    ds_read_b128 v[72:75], v6 offset:47104
    v_mfma_f32_16x16x32_bf16 v[36:39], a[116:119], v[80:83], v[36:39]
    s_waitcnt lgkmcnt(5)
    v_mfma_f32_16x16x32_bf16 v[40:43], a[52:55], v[84:87], v[40:43]
    ds_read_b128 v[76:79], v6 offset:63488
    v_mfma_f32_16x16x32_bf16 v[44:47], a[116:119], v[84:87], v[44:47]
    s_waitcnt lgkmcnt(5)
    v_mfma_f32_16x16x32_bf16 v[48:51], a[52:55], v[88:91], v[48:51]
    ds_read_b128 v[80:83], v6 offset:15360
    v_mfma_f32_16x16x32_bf16 v[52:55], a[116:119], v[88:91], v[52:55]
    s_waitcnt lgkmcnt(5)
    v_mfma_f32_16x16x32_bf16 v[56:59], a[52:55], v[92:95], v[56:59]
    ds_read_b128 v[84:87], v6 offset:31744
    v_mfma_f32_16x16x32_bf16 v[60:63], a[116:119], v[92:95], v[60:63]
    s_waitcnt lgkmcnt(5)
    v_mfma_f32_16x16x32_bf16 v[32:35], a[56:59], v[64:67], v[32:35]
    ds_read_b128 v[88:91], v6 offset:48128
    v_mfma_f32_16x16x32_bf16 v[36:39], a[120:123], v[64:67], v[36:39]
    s_waitcnt lgkmcnt(5)
    v_mfma_f32_16x16x32_bf16 v[40:43], a[56:59], v[68:71], v[40:43]
    ds_read_b128 v[92:95], v6 offset:64512
    v_mfma_f32_16x16x32_bf16 v[44:47], a[120:123], v[68:71], v[44:47]
    s_waitcnt lgkmcnt(5)
    v_mfma_f32_16x16x32_bf16 v[48:51], a[56:59], v[72:75], v[48:51]
    v_mfma_f32_16x16x32_bf16 v[52:55], a[120:123], v[72:75], v[52:55]
    s_waitcnt lgkmcnt(4)
    v_mfma_f32_16x16x32_bf16 v[56:59], a[56:59], v[76:79], v[56:59]
    v_mfma_f32_16x16x32_bf16 v[60:63], a[120:123], v[76:79], v[60:63]
    s_waitcnt lgkmcnt(3)
    v_mfma_f32_16x16x32_bf16 v[32:35], a[60:63], v[80:83], v[32:35]
    v_mfma_f32_16x16x32_bf16 v[36:39], a[124:127], v[80:83], v[36:39]
    s_waitcnt lgkmcnt(2)
    v_mfma_f32_16x16x32_bf16 v[40:43], a[60:63], v[84:87], v[40:43]
    v_mfma_f32_16x16x32_bf16 v[44:47], a[124:127], v[84:87], v[44:47]
    s_waitcnt lgkmcnt(1)
    v_mfma_f32_16x16x32_bf16 v[48:51], a[60:63], v[88:91], v[48:51]
    v_mfma_f32_16x16x32_bf16 v[52:55], a[124:127], v[88:91], v[52:55]
    s_waitcnt lgkmcnt(0)
    v_mfma_f32_16x16x32_bf16 v[56:59], a[60:63], v[92:95], v[56:59]
    v_mfma_f32_16x16x32_bf16 v[60:63], a[124:127], v[92:95], v[60:63]
    v_cvt_pk_bf16_f32 v96, v32, v36
    v_cvt_pk_bf16_f32 v97, v33, v37
    v_cvt_pk_bf16_f32 v98, v34, v38
    v_cvt_pk_bf16_f32 v99, v35, v39
    global_store_dwordx4 v12, v[96:99], s[44:45] sc1
    v_cvt_pk_bf16_f32 v100, v40, v44
    v_cvt_pk_bf16_f32 v101, v41, v45
    v_cvt_pk_bf16_f32 v102, v42, v46
    v_cvt_pk_bf16_f32 v103, v43, v47
    global_store_dwordx4 v19, v[100:103], s[44:45] sc1
    v_cvt_pk_bf16_f32 v104, v48, v52
    v_cvt_pk_bf16_f32 v105, v49, v53
    v_cvt_pk_bf16_f32 v106, v50, v54
    v_cvt_pk_bf16_f32 v107, v51, v55
    global_store_dwordx4 v14, v[104:107], s[44:45] sc1
    v_cvt_pk_bf16_f32 v108, v56, v60
    v_cvt_pk_bf16_f32 v109, v57, v61
    v_cvt_pk_bf16_f32 v110, v58, v62
    v_cvt_pk_bf16_f32 v111, v59, v63
    global_store_dwordx4 v20, v[108:111], s[44:45] sc1
    s_add_u32 s44, s44, 1048576
    s_addc_u32 s45, s45, 0
    s_add_u32 s49, s49, 256
    s_add_u32 s48, s48, 1
    s_cmp_lt_u32 s48, 16
    s_cbranch_scc1 gloop_147
    s_branch gemmdone_146
gemmV_145:
gloop_158:
    s_waitcnt vmcnt(4)
    s_barrier
    s_cmp_lt_u32 s48, 3
    s_cbranch_scc1 gs_159
    s_sub_u32 s78, s49, 256
    s_cmp_lg_u32 s34, 0
    s_cbranch_scc1 sig_160
    v_mov_b32 v16, s78
    v_mov_b32 v17, 1
    s_mov_b64 exec, 1
    global_atomic_add v16, v17, s[4:5]
    s_mov_b64 exec, -1
sig_160:
gs_159:
    s_cmp_ge_u32 s48, 15
    s_cbranch_scc1 gn_161
    s_cmp_eq_u32 s48, 0
    s_cbranch_scc1 gn_161
    s_lshl_b32 s70, s34, 14
    s_add_u32 m0, s70, 65536
    s_nop 0
    global_load_lds_dwordx4 v5, s[46:47] offset:0 sc1
    global_load_lds_dwordx4 v5, s[46:47] offset:1024 sc1
    global_load_lds_dwordx4 v5, s[46:47] offset:2048 sc1
    global_load_lds_dwordx4 v5, s[46:47] offset:3072 sc1
    s_add_u32 m0, s70, 69632
    s_nop 0
    global_load_lds_dwordx4 v7, s[46:47] offset:0 sc1
    global_load_lds_dwordx4 v7, s[46:47] offset:1024 sc1
    global_load_lds_dwordx4 v7, s[46:47] offset:2048 sc1
    global_load_lds_dwordx4 v7, s[46:47] offset:3072 sc1
    s_add_u32 m0, s70, 73728
    s_nop 0
    global_load_lds_dwordx4 v8, s[46:47] offset:0 sc1
    global_load_lds_dwordx4 v8, s[46:47] offset:1024 sc1
    global_load_lds_dwordx4 v8, s[46:47] offset:2048 sc1
    global_load_lds_dwordx4 v8, s[46:47] offset:3072 sc1
    s_add_u32 m0, s70, 77824
    s_nop 0
    global_load_lds_dwordx4 v9, s[46:47] offset:0 sc1
    global_load_lds_dwordx4 v9, s[46:47] offset:1024 sc1
    global_load_lds_dwordx4 v9, s[46:47] offset:2048 sc1
    global_load_lds_dwordx4 v9, s[46:47] offset:3072 sc1
    s_add_u32 s46, s46, 131072
    s_addc_u32 s47, s47, 0
gn_161:
    ds_read_b128 v[64:67], v5 offset:0
    ds_read_b128 v[68:71], v5 offset:16384
    ds_read_b128 v[72:75], v5 offset:32768
    ds_read_b128 v[76:79], v5 offset:49152
    ds_read_b128 v[80:83], v5 offset:1024
    ds_read_b128 v[84:87], v5 offset:17408
    s_waitcnt lgkmcnt(5)
    v_mfma_f32_16x16x32_bf16 v[32:35], v[64:67], a[0:3], 0
    ds_read_b128 v[88:91], v5 offset:33792
    v_mfma_f32_16x16x32_bf16 v[36:39], v[64:67], a[64:67], 0
    s_waitcnt lgkmcnt(5)
    v_mfma_f32_16x16x32_bf16 v[40:43], v[68:71], a[0:3], 0
    ds_read_b128 v[92:95], v5 offset:50176
    v_mfma_f32_16x16x32_bf16 v[44:47], v[68:71], a[64:67], 0
    s_waitcnt lgkmcnt(5)
    v_mfma_f32_16x16x32_bf16 v[48:51], v[72:75], a[0:3], 0
    ds_read_b128 v[64:67], v5 offset:2048
    v_mfma_f32_16x16x32_bf16 v[52:55], v[72:75], a[64:67], 0
    s_waitcnt lgkmcnt(5)
    v_mfma_f32_16x16x32_bf16 v[56:59], v[76:79], a[0:3], 0
    ds_read_b128 v[68:71], v5 offset:18432
    v_mfma_f32_16x16x32_bf16 v[60:63], v[76:79], a[64:67], 0
    s_waitcnt lgkmcnt(5)
    v_mfma_f32_16x16x32_bf16 v[32:35], v[80:83], a[4:7], v[32:35]
    ds_read_b128 v[72:75], v5 offset:34816
    v_mfma_f32_16x16x32_bf16 v[36:39], v[80:83], a[68:71], v[36:39]
    s_waitcnt lgkmcnt(5)
    v_mfma_f32_16x16x32_bf16 v[40:43], v[84:87], a[4:7], v[40:43]
    ds_read_b128 v[76:79], v5 offset:51200
    v_mfma_f32_16x16x32_bf16 v[44:47], v[84:87], a[68:71], v[44:47]
    s_waitcnt lgkmcnt(5)
    v_mfma_f32_16x16x32_bf16 v[48:51], v[88:91], a[4:7], v[48:51]
    ds_read_b128 v[80:83], v5 offset:3072
    v_mfma_f32_16x16x32_bf16 v[52:55], v[88:91], a[68:71], v[52:55]
    s_waitcnt lgkmcnt(5)
    v_mfma_f32_16x16x32_bf16 v[56:59], v[92:95], a[4:7], v[56:59]
    ds_read_b128 v[84:87], v5 offset:19456
    v_mfma_f32_16x16x32_bf16 v[60:63], v[92:95], a[68:71], v[60:63]
    s_waitcnt lgkmcnt(5)
    v_mfma_f32_16x16x32_bf16 v[32:35], v[64:67], a[8:11], v[32:35]
    ds_read_b128 v[88:91], v5 offset:35840
    v_mfma_f32_16x16x32_bf16 v[36:39], v[64:67], a[72:75], v[36:39]
    s_waitcnt lgkmcnt(5)
    v_mfma_f32_16x16x32_bf16 v[40:43], v[68:71], a[8:11], v[40:43]
    ds_read_b128 v[92:95], v5 offset:52224
    v_mfma_f32_16x16x32_bf16 v[44:47], v[68:71], a[72:75], v[44:47]
    s_waitcnt lgkmcnt(5)
    v_mfma_f32_16x16x32_bf16 v[48:51], v[72:75], a[8:11], v[48:51]
    ds_read_b128 v[64:67], v5 offset:4096
    v_mfma_f32_16x16x32_bf16 v[52:55], v[72:75], a[72:75], v[52:55]
    s_waitcnt lgkmcnt(5)
    v_mfma_f32_16x16x32_bf16 v[56:59], v[76:79], a[8:11], v[56:59]
    ds_read_b128 v[68:71], v5 offset:20480
    v_mfma_f32_16x16x32_bf16 v[60:63], v[76:79], a[72:75], v[60:63]
    s_waitcnt lgkmcnt(5)
    v_mfma_f32_16x16x32_bf16 v[32:35], v[80:83], a[12:15], v[32:35]
    ds_read_b128 v[72:75], v5 offset:36864
    v_mfma_f32_16x16x32_bf16 v[36:39], v[80:83], a[76:79], v[36:39]
    s_waitcnt lgkmcnt(5)
    v_mfma_f32_16x16x32_bf16 v[40:43], v[84:87], a[12:15], v[40:43]
    ds_read_b128 v[76:79], v5 offset:53248
    v_mfma_f32_16x16x32_bf16 v[44:47], v[84:87], a[76:79], v[44:47]
    s_waitcnt lgkmcnt(5)
    v_mfma_f32_16x16x32_bf16 v[48:51], v[88:91], a[12:15], v[48:51]
    ds_read_b128 v[80:83], v5 offset:5120
    v_mfma_f32_16x16x32_bf16 v[52:55], v[88:91], a[76:79], v[52:55]
    s_waitcnt lgkmcnt(5)
    v_mfma_f32_16x16x32_bf16 v[56:59], v[92:95], a[12:15], v[56:59]
    ds_read_b128 v[84:87], v5 offset:21504
    v_mfma_f32_16x16x32_bf16 v[60:63], v[92:95], a[76:79], v[60:63]
    s_waitcnt lgkmcnt(5)
    v_mfma_f32_16x16x32_bf16 v[32:35], v[64:67], a[16:19], v[32:35]
    ds_read_b128 v[88:91], v5 offset:37888
    v_mfma_f32_16x16x32_bf16 v[36:39], v[64:67], a[80:83], v[36:39]
    s_waitcnt lgkmcnt(5)
    v_mfma_f32_16x16x32_bf16 v[40:43], v[68:71], a[16:19], v[40:43]
    ds_read_b128 v[92:95], v5 offset:54272
    v_mfma_f32_16x16x32_bf16 v[44:47], v[68:71], a[80:83], v[44:47]
    s_waitcnt lgkmcnt(5)
    v_mfma_f32_16x16x32_bf16 v[48:51], v[72:75], a[16:19], v[48:51]
    ds_read_b128 v[64:67], v5 offset:6144
    v_mfma_f32_16x16x32_bf16 v[52:55], v[72:75], a[80:83], v[52:55]
    s_waitcnt lgkmcnt(5)
    v_mfma_f32_16x16x32_bf16 v[56:59], v[76:79], a[16:19], v[56:59]
    ds_read_b128 v[68:71], v5 offset:22528
    v_mfma_f32_16x16x32_bf16 v[60:63], v[76:79], a[80:83], v[60:63]
    s_waitcnt lgkmcnt(5)
    v_mfma_f32_16x16x32_bf16 v[32:35], v[80:83], a[20:23], v[32:35]
    ds_read_b128 v[72:75], v5 offset:38912
    v_mfma_f32_16x16x32_bf16 v[36:39], v[80:83], a[84:87], v[36:39]
    s_waitcnt lgkmcnt(5)
    v_mfma_f32_16x16x32_bf16 v[40:43], v[84:87], a[20:23], v[40:43]
    ds_read_b128 v[76:79], v5 offset:55296
    v_mfma_f32_16x16x32_bf16 v[44:47], v[84:87], a[84:87], v[44:47]
    s_waitcnt lgkmcnt(5)
    v_mfma_f32_16x16x32_bf16 v[48:51], v[88:91], a[20:23], v[48:51]
    ds_read_b128 v[80:83], v5 offset:7168
    v_mfma_f32_16x16x32_bf16 v[52:55], v[88:91], a[84:87], v[52:55]
    s_waitcnt lgkmcnt(5)
    v_mfma_f32_16x16x32_bf16 v[56:59], v[92:95], a[20:23], v[56:59]
    ds_read_b128 v[84:87], v5 offset:23552
    v_mfma_f32_16x16x32_bf16 v[60:63], v[92:95], a[84:87], v[60:63]
    s_waitcnt lgkmcnt(5)
    v_mfma_f32_16x16x32_bf16 v[32:35], v[64:67], a[24:27], v[32:35]
    ds_read_b128 v[88:91], v5 offset:39936
    v_mfma_f32_16x16x32_bf16 v[36:39], v[64:67], a[88:91], v[36:39]
    s_waitcnt lgkmcnt(5)
    v_mfma_f32_16x16x32_bf16 v[40:43], v[68:71], a[24:27], v[40:43]
    ds_read_b128 v[92:95], v5 offset:56320
    v_mfma_f32_16x16x32_bf16 v[44:47], v[68:71], a[88:91], v[44:47]
    s_waitcnt lgkmcnt(5)
    v_mfma_f32_16x16x32_bf16 v[48:51], v[72:75], a[24:27], v[48:51]
    ds_read_b128 v[64:67], v5 offset:8192
    v_mfma_f32_16x16x32_bf16 v[52:55], v[72:75], a[88:91], v[52:55]
    s_waitcnt lgkmcnt(5)
    v_mfma_f32_16x16x32_bf16 v[56:59], v[76:79], a[24:27], v[56:59]
    ds_read_b128 v[68:71], v5 offset:24576
    v_mfma_f32_16x16x32_bf16 v[60:63], v[76:79], a[88:91], v[60:63]
    s_waitcnt lgkmcnt(5)
    v_mfma_f32_16x16x32_bf16 v[32:35], v[80:83], a[28:31], v[32:35]
    ds_read_b128 v[72:75], v5 offset:40960
    v_mfma_f32_16x16x32_bf16 v[36:39], v[80:83], a[92:95], v[36:39]
    s_waitcnt lgkmcnt(5)
    v_mfma_f32_16x16x32_bf16 v[40:43], v[84:87], a[28:31], v[40:43]
    ds_read_b128 v[76:79], v5 offset:57344
    v_mfma_f32_16x16x32_bf16 v[44:47], v[84:87], a[92:95], v[44:47]
    s_waitcnt lgkmcnt(5)
    v_mfma_f32_16x16x32_bf16 v[48:51], v[88:91], a[28:31], v[48:51]
    ds_read_b128 v[80:83], v5 offset:9216
    v_mfma_f32_16x16x32_bf16 v[52:55], v[88:91], a[92:95], v[52:55]
    s_waitcnt lgkmcnt(5)
    v_mfma_f32_16x16x32_bf16 v[56:59], v[92:95], a[28:31], v[56:59]
    ds_read_b128 v[84:87], v5 offset:25600
    v_mfma_f32_16x16x32_bf16 v[60:63], v[92:95], a[92:95], v[60:63]
    s_waitcnt lgkmcnt(5)
    v_mfma_f32_16x16x32_bf16 v[32:35], v[64:67], a[32:35], v[32:35]
    ds_read_b128 v[88:91], v5 offset:41984
    v_mfma_f32_16x16x32_bf16 v[36:39], v[64:67], a[96:99], v[36:39]
    s_waitcnt lgkmcnt(5)
    v_mfma_f32_16x16x32_bf16 v[40:43], v[68:71], a[32:35], v[40:43]
    ds_read_b128 v[92:95], v5 offset:58368
    v_mfma_f32_16x16x32_bf16 v[44:47], v[68:71], a[96:99], v[44:47]
    s_waitcnt lgkmcnt(5)
    v_mfma_f32_16x16x32_bf16 v[48:51], v[72:75], a[32:35], v[48:51]
    ds_read_b128 v[64:67], v5 offset:10240
    v_mfma_f32_16x16x32_bf16 v[52:55], v[72:75], a[96:99], v[52:55]
    s_waitcnt lgkmcnt(5)
    v_mfma_f32_16x16x32_bf16 v[56:59], v[76:79], a[32:35], v[56:59]
    ds_read_b128 v[68:71], v5 offset:26624
    v_mfma_f32_16x16x32_bf16 v[60:63], v[76:79], a[96:99], v[60:63]
    s_waitcnt lgkmcnt(5)
    v_mfma_f32_16x16x32_bf16 v[32:35], v[80:83], a[36:39], v[32:35]
    ds_read_b128 v[72:75], v5 offset:43008
    v_mfma_f32_16x16x32_bf16 v[36:39], v[80:83], a[100:103], v[36:39]
    s_waitcnt lgkmcnt(5)
    v_mfma_f32_16x16x32_bf16 v[40:43], v[84:87], a[36:39], v[40:43]
    ds_read_b128 v[76:79], v5 offset:59392
    v_mfma_f32_16x16x32_bf16 v[44:47], v[84:87], a[100:103], v[44:47]
    s_waitcnt lgkmcnt(5)
    v_mfma_f32_16x16x32_bf16 v[48:51], v[88:91], a[36:39], v[48:51]
    ds_read_b128 v[80:83], v5 offset:11264
    v_mfma_f32_16x16x32_bf16 v[52:55], v[88:91], a[100:103], v[52:55]
    s_waitcnt lgkmcnt(5)
    v_mfma_f32_16x16x32_bf16 v[56:59], v[92:95], a[36:39], v[56:59]
    ds_read_b128 v[84:87], v5 offset:27648
    v_mfma_f32_16x16x32_bf16 v[60:63], v[92:95], a[100:103], v[60:63]
    s_waitcnt lgkmcnt(5)
    v_mfma_f32_16x16x32_bf16 v[32:35], v[64:67], a[40:43], v[32:35]
    ds_read_b128 v[88:91], v5 offset:44032
    v_mfma_f32_16x16x32_bf16 v[36:39], v[64:67], a[104:107], v[36:39]
    s_waitcnt lgkmcnt(5)
    v_mfma_f32_16x16x32_bf16 v[40:43], v[68:71], a[40:43], v[40:43]
    ds_read_b128 v[92:95], v5 offset:60416
    v_mfma_f32_16x16x32_bf16 v[44:47], v[68:71], a[104:107], v[44:47]
    s_waitcnt lgkmcnt(5)
    v_mfma_f32_16x16x32_bf16 v[48:51], v[72:75], a[40:43], v[48:51]
    ds_read_b128 v[64:67], v5 offset:12288
    v_mfma_f32_16x16x32_bf16 v[52:55], v[72:75], a[104:107], v[52:55]
    s_waitcnt lgkmcnt(5)
    v_mfma_f32_16x16x32_bf16 v[56:59], v[76:79], a[40:43], v[56:59]
    ds_read_b128 v[68:71], v5 offset:28672
    v_mfma_f32_16x16x32_bf16 v[60:63], v[76:79], a[104:107], v[60:63]
    s_waitcnt lgkmcnt(5)
    v_mfma_f32_16x16x32_bf16 v[32:35], v[80:83], a[44:47], v[32:35]
    ds_read_b128 v[72:75], v5 offset:45056
    v_mfma_f32_16x16x32_bf16 v[36:39], v[80:83], a[108:111], v[36:39]
    s_waitcnt lgkmcnt(5)
    v_mfma_f32_16x16x32_bf16 v[40:43], v[84:87], a[44:47], v[40:43]
    ds_read_b128 v[76:79], v5 offset:61440
    v_mfma_f32_16x16x32_bf16 v[44:47], v[84:87], a[108:111], v[44:47]
    s_waitcnt lgkmcnt(5)
    v_mfma_f32_16x16x32_bf16 v[48:51], v[88:91], a[44:47], v[48:51]
    ds_read_b128 v[80:83], v5 offset:13312
    v_mfma_f32_16x16x32_bf16 v[52:55], v[88:91], a[108:111], v[52:55]
    s_waitcnt lgkmcnt(5)
    v_mfma_f32_16x16x32_bf16 v[56:59], v[92:95], a[44:47], v[56:59]
    ds_read_b128 v[84:87], v5 offset:29696
    v_mfma_f32_16x16x32_bf16 v[60:63], v[92:95], a[108:111], v[60:63]
    s_waitcnt lgkmcnt(5)
    v_mfma_f32_16x16x32_bf16 v[32:35], v[64:67], a[48:51], v[32:35]
    ds_read_b128 v[88:91], v5 offset:46080
    v_mfma_f32_16x16x32_bf16 v[36:39], v[64:67], a[112:115], v[36:39]
    s_waitcnt lgkmcnt(5)
    v_mfma_f32_16x16x32_bf16 v[40:43], v[68:71], a[48:51], v[40:43]
    ds_read_b128 v[92:95], v5 offset:62464
    v_mfma_f32_16x16x32_bf16 v[44:47], v[68:71], a[112:115], v[44:47]
    s_waitcnt lgkmcnt(5)
    v_mfma_f32_16x16x32_bf16 v[48:51], v[72:75], a[48:51], v[48:51]
    ds_read_b128 v[64:67], v5 offset:14336
    v_mfma_f32_16x16x32_bf16 v[52:55], v[72:75], a[112:115], v[52:55]
    s_waitcnt lgkmcnt(5)
    v_mfma_f32_16x16x32_bf16 v[56:59], v[76:79], a[48:51], v[56:59]
    ds_read_b128 v[68:71], v5 offset:30720
    v_mfma_f32_16x16x32_bf16 v[60:63], v[76:79], a[112:115], v[60:63]
    s_waitcnt lgkmcnt(5)
    v_mfma_f32_16x16x32_bf16 v[32:35], v[80:83], a[52:55], v[32:35]
    ds_read_b128 v[72:75], v5 offset:47104
    v_mfma_f32_16x16x32_bf16 v[36:39], v[80:83], a[116:119], v[36:39]
    s_waitcnt lgkmcnt(5)
    v_mfma_f32_16x16x32_bf16 v[40:43], v[84:87], a[52:55], v[40:43]
    ds_read_b128 v[76:79], v5 offset:63488
    v_mfma_f32_16x16x32_bf16 v[44:47], v[84:87], a[116:119], v[44:47]
    s_waitcnt lgkmcnt(5)
    v_mfma_f32_16x16x32_bf16 v[48:51], v[88:91], a[52:55], v[48:51]
    ds_read_b128 v[80:83], v5 offset:15360
    v_mfma_f32_16x16x32_bf16 v[52:55], v[88:91], a[116:119], v[52:55]
    s_waitcnt lgkmcnt(5)
    v_mfma_f32_16x16x32_bf16 v[56:59], v[92:95], a[52:55], v[56:59]
    ds_read_b128 v[84:87], v5 offset:31744
    v_mfma_f32_16x16x32_bf16 v[60:63], v[92:95], a[116:119], v[60:63]
    s_waitcnt lgkmcnt(5)
    v_mfma_f32_16x16x32_bf16 v[32:35], v[64:67], a[56:59], v[32:35]
    ds_read_b128 v[88:91], v5 offset:48128
    v_mfma_f32_16x16x32_bf16 v[36:39], v[64:67], a[120:123], v[36:39]
    s_waitcnt lgkmcnt(5)
    v_mfma_f32_16x16x32_bf16 v[40:43], v[68:71], a[56:59], v[40:43]
    ds_read_b128 v[92:95], v5 offset:64512
    v_mfma_f32_16x16x32_bf16 v[44:47], v[68:71], a[120:123], v[44:47]
    s_waitcnt lgkmcnt(5)
    v_mfma_f32_16x16x32_bf16 v[48:51], v[72:75], a[56:59], v[48:51]
    v_mfma_f32_16x16x32_bf16 v[52:55], v[72:75], a[120:123], v[52:55]
    s_waitcnt lgkmcnt(4)
    v_mfma_f32_16x16x32_bf16 v[56:59], v[76:79], a[56:59], v[56:59]
    v_mfma_f32_16x16x32_bf16 v[60:63], v[76:79], a[120:123], v[60:63]
    s_waitcnt lgkmcnt(3)
    v_mfma_f32_16x16x32_bf16 v[32:35], v[80:83], a[60:63], v[32:35]
    v_mfma_f32_16x16x32_bf16 v[36:39], v[80:83], a[124:127], v[36:39]
    s_waitcnt lgkmcnt(2)
    v_mfma_f32_16x16x32_bf16 v[40:43], v[84:87], a[60:63], v[40:43]
    v_mfma_f32_16x16x32_bf16 v[44:47], v[84:87], a[124:127], v[44:47]
    s_waitcnt lgkmcnt(1)
    v_mfma_f32_16x16x32_bf16 v[48:51], v[88:91], a[60:63], v[48:51]
    v_mfma_f32_16x16x32_bf16 v[52:55], v[88:91], a[124:127], v[52:55]
    s_waitcnt lgkmcnt(0)
    v_mfma_f32_16x16x32_bf16 v[56:59], v[92:95], a[60:63], v[56:59]
    v_mfma_f32_16x16x32_bf16 v[60:63], v[92:95], a[124:127], v[60:63]
    v_cvt_pk_bf16_f32 v96, v32, v33
    v_cvt_pk_bf16_f32 v97, v34, v35
    v_cvt_pk_bf16_f32 v98, v40, v41
    v_cvt_pk_bf16_f32 v99, v42, v43
    global_store_dwordx4 v13, v[96:99], s[44:45] offset:0 sc1
    v_cvt_pk_bf16_f32 v100, v36, v37
    v_cvt_pk_bf16_f32 v101, v38, v39
    v_cvt_pk_bf16_f32 v102, v44, v45
    v_cvt_pk_bf16_f32 v103, v46, v47
    global_store_dwordx4 v13, v[100:103], s[44:45] offset:1024 sc1
    v_cvt_pk_bf16_f32 v104, v48, v49
    v_cvt_pk_bf16_f32 v105, v50, v51
    v_cvt_pk_bf16_f32 v106, v56, v57
    v_cvt_pk_bf16_f32 v107, v58, v59
    global_store_dwordx4 v15, v[104:107], s[44:45] offset:0 sc1
    v_cvt_pk_bf16_f32 v108, v52, v53
    v_cvt_pk_bf16_f32 v109, v54, v55
    v_cvt_pk_bf16_f32 v110, v60, v61
    v_cvt_pk_bf16_f32 v111, v62, v63
    global_store_dwordx4 v15, v[108:111], s[44:45] offset:1024 sc1
    s_add_u32 s44, s44, 1048576
    s_addc_u32 s45, s45, 0
    s_add_u32 s49, s49, 256
    s_cmp_lg_u32 s48, 0
    s_cbranch_scc1 gfirst_162
    s_waitcnt vmcnt(0)
    s_barrier
    s_cmp_lg_u32 s34, 0
    s_cbranch_scc1 sig_163
    v_mov_b32 v16, s49
    v_mov_b32 v17, 1
    s_mov_b64 exec, 1
    global_atomic_add v16, v17, s[4:5]
    s_mov_b64 exec, -1
sig_163:
    s_cmp_lg_u32 s34, 0
    s_cbranch_scc1 polld_165
    v_mov_b32 v16, 28672
    s_mov_b32 s79, 0
    s_mov_b64 exec, 1
poll_164:
    global_load_dword v17, v16, s[4:5] sc1
    s_add_u32 s79, s79, 1
    s_cmp_gt_u32 s79, 0x80000
    s_cbranch_scc1 L_fail
    s_waitcnt vmcnt(0)
    v_cmp_le_u32 vcc, 128, v17
    s_cbranch_vccnz polld_165
    s_sleep 8
    s_branch poll_164
polld_165:
    s_mov_b64 exec, -1
    s_barrier
    s_lshl_b32 s70, s34, 14
    s_add_u32 m0, s70, 65536
    s_nop 0
    global_load_lds_dwordx4 v5, s[46:47] offset:0 sc1
    global_load_lds_dwordx4 v5, s[46:47] offset:1024 sc1
    global_load_lds_dwordx4 v5, s[46:47] offset:2048 sc1
    global_load_lds_dwordx4 v5, s[46:47] offset:3072 sc1
    s_add_u32 m0, s70, 69632
    s_nop 0
    global_load_lds_dwordx4 v7, s[46:47] offset:0 sc1
    global_load_lds_dwordx4 v7, s[46:47] offset:1024 sc1
    global_load_lds_dwordx4 v7, s[46:47] offset:2048 sc1
    global_load_lds_dwordx4 v7, s[46:47] offset:3072 sc1
    s_add_u32 m0, s70, 73728
    s_nop 0
    global_load_lds_dwordx4 v8, s[46:47] offset:0 sc1
    global_load_lds_dwordx4 v8, s[46:47] offset:1024 sc1
    global_load_lds_dwordx4 v8, s[46:47] offset:2048 sc1
    global_load_lds_dwordx4 v8, s[46:47] offset:3072 sc1
    s_add_u32 m0, s70, 77824
    s_nop 0
    global_load_lds_dwordx4 v9, s[46:47] offset:0 sc1
    global_load_lds_dwordx4 v9, s[46:47] offset:1024 sc1
    global_load_lds_dwordx4 v9, s[46:47] offset:2048 sc1
    global_load_lds_dwordx4 v9, s[46:47] offset:3072 sc1
    s_add_u32 s46, s46, 131072
    s_addc_u32 s47, s47, 0
    s_waitcnt vmcnt(0)
gfirst_162:
    s_add_u32 s48, s48, 1
    s_waitcnt vmcnt(4)
    s_barrier
    s_cmp_lt_u32 s48, 3
    s_cbranch_scc1 gs_166
    s_sub_u32 s78, s49, 256
    s_cmp_lg_u32 s34, 0
    s_cbranch_scc1 sig_167
    v_mov_b32 v16, s78
    v_mov_b32 v17, 1
    s_mov_b64 exec, 1
    global_atomic_add v16, v17, s[4:5]
    s_mov_b64 exec, -1
sig_167:
gs_166:
    s_cmp_ge_u32 s48, 15
    s_cbranch_scc1 gn_168
    s_lshl_b32 s70, s34, 14
    s_add_u32 m0, s70, 0
    s_nop 0
    global_load_lds_dwordx4 v5, s[46:47] offset:0 sc1
    global_load_lds_dwordx4 v5, s[46:47] offset:1024 sc1
    global_load_lds_dwordx4 v5, s[46:47] offset:2048 sc1
    global_load_lds_dwordx4 v5, s[46:47] offset:3072 sc1
    s_add_u32 m0, s70, 4096
    s_nop 0
    global_load_lds_dwordx4 v7, s[46:47] offset:0 sc1
    global_load_lds_dwordx4 v7, s[46:47] offset:1024 sc1
    global_load_lds_dwordx4 v7, s[46:47] offset:2048 sc1
    global_load_lds_dwordx4 v7, s[46:47] offset:3072 sc1
    s_add_u32 m0, s70, 8192
    s_nop 0
    global_load_lds_dwordx4 v8, s[46:47] offset:0 sc1
    global_load_lds_dwordx4 v8, s[46:47] offset:1024 sc1
    global_load_lds_dwordx4 v8, s[46:47] offset:2048 sc1
    global_load_lds_dwordx4 v8, s[46:47] offset:3072 sc1
    s_add_u32 m0, s70, 12288
    s_nop 0
    global_load_lds_dwordx4 v9, s[46:47] offset:0 sc1
    global_load_lds_dwordx4 v9, s[46:47] offset:1024 sc1
    global_load_lds_dwordx4 v9, s[46:47] offset:2048 sc1
    global_load_lds_dwordx4 v9, s[46:47] offset:3072 sc1
    s_add_u32 s46, s46, 131072
    s_addc_u32 s47, s47, 0
gn_168:
    ds_read_b128 v[64:67], v6 offset:0
    ds_read_b128 v[68:71], v6 offset:16384
    ds_read_b128 v[72:75], v6 offset:32768
    ds_read_b128 v[76:79], v6 offset:49152
    ds_read_b128 v[80:83], v6 offset:1024
    ds_read_b128 v[84:87], v6 offset:17408
    s_waitcnt lgkmcnt(5)
    v_mfma_f32_16x16x32_bf16 v[32:35], v[64:67], a[0:3], 0
    ds_read_b128 v[88:91], v6 offset:33792
    v_mfma_f32_16x16x32_bf16 v[36:39], v[64:67], a[64:67], 0
    s_waitcnt lgkmcnt(5)
    v_mfma_f32_16x16x32_bf16 v[40:43], v[68:71], a[0:3], 0
    ds_read_b128 v[92:95], v6 offset:50176
    v_mfma_f32_16x16x32_bf16 v[44:47], v[68:71], a[64:67], 0
    s_waitcnt lgkmcnt(5)
    v_mfma_f32_16x16x32_bf16 v[48:51], v[72:75], a[0:3], 0
    ds_read_b128 v[64:67], v6 offset:2048
    v_mfma_f32_16x16x32_bf16 v[52:55], v[72:75], a[64:67], 0
    s_waitcnt lgkmcnt(5)
    v_mfma_f32_16x16x32_bf16 v[56:59], v[76:79], a[0:3], 0
    ds_read_b128 v[68:71], v6 offset:18432
    v_mfma_f32_16x16x32_bf16 v[60:63], v[76:79], a[64:67], 0
    s_waitcnt lgkmcnt(5)
    v_mfma_f32_16x16x32_bf16 v[32:35], v[80:83], a[4:7], v[32:35]
    ds_read_b128 v[72:75], v6 offset:34816
    v_mfma_f32_16x16x32_bf16 v[36:39], v[80:83], a[68:71], v[36:39]
    s_waitcnt lgkmcnt(5)
    v_mfma_f32_16x16x32_bf16 v[40:43], v[84:87], a[4:7], v[40:43]
    ds_read_b128 v[76:79], v6 offset:51200
    v_mfma_f32_16x16x32_bf16 v[44:47], v[84:87], a[68:71], v[44:47]
    s_waitcnt lgkmcnt(5)
    v_mfma_f32_16x16x32_bf16 v[48:51], v[88:91], a[4:7], v[48:51]
    ds_read_b128 v[80:83], v6 offset:3072
    v_mfma_f32_16x16x32_bf16 v[52:55], v[88:91], a[68:71], v[52:55]
    s_waitcnt lgkmcnt(5)
    v_mfma_f32_16x16x32_bf16 v[56:59], v[92:95], a[4:7], v[56:59]
    ds_read_b128 v[84:87], v6 offset:19456
    v_mfma_f32_16x16x32_bf16 v[60:63], v[92:95], a[68:71], v[60:63]
    s_waitcnt lgkmcnt(5)
    v_mfma_f32_16x16x32_bf16 v[32:35], v[64:67], a[8:11], v[32:35]
    ds_read_b128 v[88:91], v6 offset:35840
    v_mfma_f32_16x16x32_bf16 v[36:39], v[64:67], a[72:75], v[36:39]
    s_waitcnt lgkmcnt(5)
    v_mfma_f32_16x16x32_bf16 v[40:43], v[68:71], a[8:11], v[40:43]
    ds_read_b128 v[92:95], v6 offset:52224
    v_mfma_f32_16x16x32_bf16 v[44:47], v[68:71], a[72:75], v[44:47]
    s_waitcnt lgkmcnt(5)
    v_mfma_f32_16x16x32_bf16 v[48:51], v[72:75], a[8:11], v[48:51]
    ds_read_b128 v[64:67], v6 offset:4096
    v_mfma_f32_16x16x32_bf16 v[52:55], v[72:75], a[72:75], v[52:55]
    s_waitcnt lgkmcnt(5)
    v_mfma_f32_16x16x32_bf16 v[56:59], v[76:79], a[8:11], v[56:59]
    ds_read_b128 v[68:71], v6 offset:20480
    v_mfma_f32_16x16x32_bf16 v[60:63], v[76:79], a[72:75], v[60:63]
    s_waitcnt lgkmcnt(5)
    v_mfma_f32_16x16x32_bf16 v[32:35], v[80:83], a[12:15], v[32:35]
    ds_read_b128 v[72:75], v6 offset:36864
    v_mfma_f32_16x16x32_bf16 v[36:39], v[80:83], a[76:79], v[36:39]
    s_waitcnt lgkmcnt(5)
    v_mfma_f32_16x16x32_bf16 v[40:43], v[84:87], a[12:15], v[40:43]
    ds_read_b128 v[76:79], v6 offset:53248
    v_mfma_f32_16x16x32_bf16 v[44:47], v[84:87], a[76:79], v[44:47]
    s_waitcnt lgkmcnt(5)
    v_mfma_f32_16x16x32_bf16 v[48:51], v[88:91], a[12:15], v[48:51]
    ds_read_b128 v[80:83], v6 offset:5120
    v_mfma_f32_16x16x32_bf16 v[52:55], v[88:91], a[76:79], v[52:55]
    s_waitcnt lgkmcnt(5)
    v_mfma_f32_16x16x32_bf16 v[56:59], v[92:95], a[12:15], v[56:59]
    ds_read_b128 v[84:87], v6 offset:21504
    v_mfma_f32_16x16x32_bf16 v[60:63], v[92:95], a[76:79], v[60:63]
    s_waitcnt lgkmcnt(5)
    v_mfma_f32_16x16x32_bf16 v[32:35], v[64:67], a[16:19], v[32:35]
    ds_read_b128 v[88:91], v6 offset:37888
    v_mfma_f32_16x16x32_bf16 v[36:39], v[64:67], a[80:83], v[36:39]
    s_waitcnt lgkmcnt(5)
    v_mfma_f32_16x16x32_bf16 v[40:43], v[68:71], a[16:19], v[40:43]
    ds_read_b128 v[92:95], v6 offset:54272
    v_mfma_f32_16x16x32_bf16 v[44:47], v[68:71], a[80:83], v[44:47]
    s_waitcnt lgkmcnt(5)
    v_mfma_f32_16x16x32_bf16 v[48:51], v[72:75], a[16:19], v[48:51]
    ds_read_b128 v[64:67], v6 offset:6144
    v_mfma_f32_16x16x32_bf16 v[52:55], v[72:75], a[80:83], v[52:55]
    s_waitcnt lgkmcnt(5)
    v_mfma_f32_16x16x32_bf16 v[56:59], v[76:79], a[16:19], v[56:59]
    ds_read_b128 v[68:71], v6 offset:22528
    v_mfma_f32_16x16x32_bf16 v[60:63], v[76:79], a[80:83], v[60:63]
    s_waitcnt lgkmcnt(5)
    v_mfma_f32_16x16x32_bf16 v[32:35], v[80:83], a[20:23], v[32:35]
    ds_read_b128 v[72:75], v6 offset:38912
    v_mfma_f32_16x16x32_bf16 v[36:39], v[80:83], a[84:87], v[36:39]
    s_waitcnt lgkmcnt(5)
    v_mfma_f32_16x16x32_bf16 v[40:43], v[84:87], a[20:23], v[40:43]
    ds_read_b128 v[76:79], v6 offset:55296
    v_mfma_f32_16x16x32_bf16 v[44:47], v[84:87], a[84:87], v[44:47]
    s_waitcnt lgkmcnt(5)
    v_mfma_f32_16x16x32_bf16 v[48:51], v[88:91], a[20:23], v[48:51]
    ds_read_b128 v[80:83], v6 offset:7168
    v_mfma_f32_16x16x32_bf16 v[52:55], v[88:91], a[84:87], v[52:55]
    s_waitcnt lgkmcnt(5)
    v_mfma_f32_16x16x32_bf16 v[56:59], v[92:95], a[20:23], v[56:59]
    ds_read_b128 v[84:87], v6 offset:23552
    v_mfma_f32_16x16x32_bf16 v[60:63], v[92:95], a[84:87], v[60:63]
    s_waitcnt lgkmcnt(5)
    v_mfma_f32_16x16x32_bf16 v[32:35], v[64:67], a[24:27], v[32:35]
    ds_read_b128 v[88:91], v6 offset:39936
    v_mfma_f32_16x16x32_bf16 v[36:39], v[64:67], a[88:91], v[36:39]
    s_waitcnt lgkmcnt(5)
    v_mfma_f32_16x16x32_bf16 v[40:43], v[68:71], a[24:27], v[40:43]
    ds_read_b128 v[92:95], v6 offset:56320
    v_mfma_f32_16x16x32_bf16 v[44:47], v[68:71], a[88:91], v[44:47]
    s_waitcnt lgkmcnt(5)
    v_mfma_f32_16x16x32_bf16 v[48:51], v[72:75], a[24:27], v[48:51]
    ds_read_b128 v[64:67], v6 offset:8192
    v_mfma_f32_16x16x32_bf16 v[52:55], v[72:75], a[88:91], v[52:55]
    s_waitcnt lgkmcnt(5)
    v_mfma_f32_16x16x32_bf16 v[56:59], v[76:79], a[24:27], v[56:59]
    ds_read_b128 v[68:71], v6 offset:24576
    v_mfma_f32_16x16x32_bf16 v[60:63], v[76:79], a[88:91], v[60:63]
    s_waitcnt lgkmcnt(5)
    v_mfma_f32_16x16x32_bf16 v[32:35], v[80:83], a[28:31], v[32:35]
    ds_read_b128 v[72:75], v6 offset:40960
    v_mfma_f32_16x16x32_bf16 v[36:39], v[80:83], a[92:95], v[36:39]
    s_waitcnt lgkmcnt(5)
    v_mfma_f32_16x16x32_bf16 v[40:43], v[84:87], a[28:31], v[40:43]
    ds_read_b128 v[76:79], v6 offset:57344
    v_mfma_f32_16x16x32_bf16 v[44:47], v[84:87], a[92:95], v[44:47]
    s_waitcnt lgkmcnt(5)
    v_mfma_f32_16x16x32_bf16 v[48:51], v[88:91], a[28:31], v[48:51]
    ds_read_b128 v[80:83], v6 offset:9216
    v_mfma_f32_16x16x32_bf16 v[52:55], v[88:91], a[92:95], v[52:55]
    s_waitcnt lgkmcnt(5)
    v_mfma_f32_16x16x32_bf16 v[56:59], v[92:95], a[28:31], v[56:59]
    ds_read_b128 v[84:87], v6 offset:25600
    v_mfma_f32_16x16x32_bf16 v[60:63], v[92:95], a[92:95], v[60:63]
    s_waitcnt lgkmcnt(5)
    v_mfma_f32_16x16x32_bf16 v[32:35], v[64:67], a[32:35], v[32:35]
    ds_read_b128 v[88:91], v6 offset:41984
    v_mfma_f32_16x16x32_bf16 v[36:39], v[64:67], a[96:99], v[36:39]
    s_waitcnt lgkmcnt(5)
    v_mfma_f32_16x16x32_bf16 v[40:43], v[68:71], a[32:35], v[40:43]
    ds_read_b128 v[92:95], v6 offset:58368
    v_mfma_f32_16x16x32_bf16 v[44:47], v[68:71], a[96:99], v[44:47]
    s_waitcnt lgkmcnt(5)
    v_mfma_f32_16x16x32_bf16 v[48:51], v[72:75], a[32:35], v[48:51]
    ds_read_b128 v[64:67], v6 offset:10240
    v_mfma_f32_16x16x32_bf16 v[52:55], v[72:75], a[96:99], v[52:55]
    s_waitcnt lgkmcnt(5)
    v_mfma_f32_16x16x32_bf16 v[56:59], v[76:79], a[32:35], v[56:59]
    ds_read_b128 v[68:71], v6 offset:26624
    v_mfma_f32_16x16x32_bf16 v[60:63], v[76:79], a[96:99], v[60:63]
    s_waitcnt lgkmcnt(5)
    v_mfma_f32_16x16x32_bf16 v[32:35], v[80:83], a[36:39], v[32:35]
    ds_read_b128 v[72:75], v6 offset:43008
    v_mfma_f32_16x16x32_bf16 v[36:39], v[80:83], a[100:103], v[36:39]
    s_waitcnt lgkmcnt(5)
    v_mfma_f32_16x16x32_bf16 v[40:43], v[84:87], a[36:39], v[40:43]
    ds_read_b128 v[76:79], v6 offset:59392
    v_mfma_f32_16x16x32_bf16 v[44:47], v[84:87], a[100:103], v[44:47]
    s_waitcnt lgkmcnt(5)
    v_mfma_f32_16x16x32_bf16 v[48:51], v[88:91], a[36:39], v[48:51]
    ds_read_b128 v[80:83], v6 offset:11264
    v_mfma_f32_16x16x32_bf16 v[52:55], v[88:91], a[100:103], v[52:55]
    s_waitcnt lgkmcnt(5)
    v_mfma_f32_16x16x32_bf16 v[56:59], v[92:95], a[36:39], v[56:59]
    ds_read_b128 v[84:87], v6 offset:27648
    v_mfma_f32_16x16x32_bf16 v[60:63], v[92:95], a[100:103], v[60:63]
    s_waitcnt lgkmcnt(5)
    v_mfma_f32_16x16x32_bf16 v[32:35], v[64:67], a[40:43], v[32:35]
    ds_read_b128 v[88:91], v6 offset:44032
    v_mfma_f32_16x16x32_bf16 v[36:39], v[64:67], a[104:107], v[36:39]
    s_waitcnt lgkmcnt(5)
    v_mfma_f32_16x16x32_bf16 v[40:43], v[68:71], a[40:43], v[40:43]
    ds_read_b128 v[92:95], v6 offset:60416
    v_mfma_f32_16x16x32_bf16 v[44:47], v[68:71], a[104:107], v[44:47]
    s_waitcnt lgkmcnt(5)
    v_mfma_f32_16x16x32_bf16 v[48:51], v[72:75], a[40:43], v[48:51]
    ds_read_b128 v[64:67], v6 offset:12288
    v_mfma_f32_16x16x32_bf16 v[52:55], v[72:75], a[104:107], v[52:55]
    s_waitcnt lgkmcnt(5)
    v_mfma_f32_16x16x32_bf16 v[56:59], v[76:79], a[40:43], v[56:59]
    ds_read_b128 v[68:71], v6 offset:28672
    v_mfma_f32_16x16x32_bf16 v[60:63], v[76:79], a[104:107], v[60:63]
    s_waitcnt lgkmcnt(5)
    v_mfma_f32_16x16x32_bf16 v[32:35], v[80:83], a[44:47], v[32:35]
    ds_read_b128 v[72:75], v6 offset:45056
    v_mfma_f32_16x16x32_bf16 v[36:39], v[80:83], a[108:111], v[36:39]
    s_waitcnt lgkmcnt(5)
    v_mfma_f32_16x16x32_bf16 v[40:43], v[84:87], a[44:47], v[40:43]
    ds_read_b128 v[76:79], v6 offset:61440
    v_mfma_f32_16x16x32_bf16 v[44:47], v[84:87], a[108:111], v[44:47]
    s_waitcnt lgkmcnt(5)
    v_mfma_f32_16x16x32_bf16 v[48:51], v[88:91], a[44:47], v[48:51]
    ds_read_b128 v[80:83], v6 offset:13312
    v_mfma_f32_16x16x32_bf16 v[52:55], v[88:91], a[108:111], v[52:55]
    s_waitcnt lgkmcnt(5)
    v_mfma_f32_16x16x32_bf16 v[56:59], v[92:95], a[44:47], v[56:59]
    ds_read_b128 v[84:87], v6 offset:29696
    v_mfma_f32_16x16x32_bf16 v[60:63], v[92:95], a[108:111], v[60:63]
    s_waitcnt lgkmcnt(5)
    v_mfma_f32_16x16x32_bf16 v[32:35], v[64:67], a[48:51], v[32:35]
    ds_read_b128 v[88:91], v6 offset:46080
    v_mfma_f32_16x16x32_bf16 v[36:39], v[64:67], a[112:115], v[36:39]
    s_waitcnt lgkmcnt(5)
    v_mfma_f32_16x16x32_bf16 v[40:43], v[68:71], a[48:51], v[40:43]
    ds_read_b128 v[92:95], v6 offset:62464
    v_mfma_f32_16x16x32_bf16 v[44:47], v[68:71], a[112:115], v[44:47]
    s_waitcnt lgkmcnt(5)
    v_mfma_f32_16x16x32_bf16 v[48:51], v[72:75], a[48:51], v[48:51]
    ds_read_b128 v[64:67], v6 offset:14336
    v_mfma_f32_16x16x32_bf16 v[52:55], v[72:75], a[112:115], v[52:55]
    s_waitcnt lgkmcnt(5)
    v_mfma_f32_16x16x32_bf16 v[56:59], v[76:79], a[48:51], v[56:59]
    ds_read_b128 v[68:71], v6 offset:30720
    v_mfma_f32_16x16x32_bf16 v[60:63], v[76:79], a[112:115], v[60:63]
    s_waitcnt lgkmcnt(5)
    v_mfma_f32_16x16x32_bf16 v[32:35], v[80:83], a[52:55], v[32:35]
    ds_read_b128 v[72:75], v6 offset:47104
    v_mfma_f32_16x16x32_bf16 v[36:39], v[80:83], a[116:119], v[36:39]
    s_waitcnt lgkmcnt(5)
    v_mfma_f32_16x16x32_bf16 v[40:43], v[84:87], a[52:55], v[40:43]
    ds_read_b128 v[76:79], v6 offset:63488
    v_mfma_f32_16x16x32_bf16 v[44:47], v[84:87], a[116:119], v[44:47]
    s_waitcnt lgkmcnt(5)
    v_mfma_f32_16x16x32_bf16 v[48:51], v[88:91], a[52:55], v[48:51]
    ds_read_b128 v[80:83], v6 offset:15360
    v_mfma_f32_16x16x32_bf16 v[52:55], v[88:91], a[116:119], v[52:55]
    s_waitcnt lgkmcnt(5)
    v_mfma_f32_16x16x32_bf16 v[56:59], v[92:95], a[52:55], v[56:59]
    ds_read_b128 v[84:87], v6 offset:31744
    v_mfma_f32_16x16x32_bf16 v[60:63], v[92:95], a[116:119], v[60:63]
    s_waitcnt lgkmcnt(5)
    v_mfma_f32_16x16x32_bf16 v[32:35], v[64:67], a[56:59], v[32:35]
    ds_read_b128 v[88:91], v6 offset:48128
    v_mfma_f32_16x16x32_bf16 v[36:39], v[64:67], a[120:123], v[36:39]
    s_waitcnt lgkmcnt(5)
    v_mfma_f32_16x16x32_bf16 v[40:43], v[68:71], a[56:59], v[40:43]
    ds_read_b128 v[92:95], v6 offset:64512
    v_mfma_f32_16x16x32_bf16 v[44:47], v[68:71], a[120:123], v[44:47]
    s_waitcnt lgkmcnt(5)
    v_mfma_f32_16x16x32_bf16 v[48:51], v[72:75], a[56:59], v[48:51]
    v_mfma_f32_16x16x32_bf16 v[52:55], v[72:75], a[120:123], v[52:55]
    s_waitcnt lgkmcnt(4)
    v_mfma_f32_16x16x32_bf16 v[56:59], v[76:79], a[56:59], v[56:59]
    v_mfma_f32_16x16x32_bf16 v[60:63], v[76:79], a[120:123], v[60:63]
    s_waitcnt lgkmcnt(3)
    v_mfma_f32_16x16x32_bf16 v[32:35], v[80:83], a[60:63], v[32:35]
    v_mfma_f32_16x16x32_bf16 v[36:39], v[80:83], a[124:127], v[36:39]
    s_waitcnt lgkmcnt(2)
    v_mfma_f32_16x16x32_bf16 v[40:43], v[84:87], a[60:63], v[40:43]
    v_mfma_f32_16x16x32_bf16 v[44:47], v[84:87], a[124:127], v[44:47]
    s_waitcnt lgkmcnt(1)
    v_mfma_f32_16x16x32_bf16 v[48:51], v[88:91], a[60:63], v[48:51]
    v_mfma_f32_16x16x32_bf16 v[52:55], v[88:91], a[124:127], v[52:55]
    s_waitcnt lgkmcnt(0)
    v_mfma_f32_16x16x32_bf16 v[56:59], v[92:95], a[60:63], v[56:59]
    v_mfma_f32_16x16x32_bf16 v[60:63], v[92:95], a[124:127], v[60:63]
    v_cvt_pk_bf16_f32 v96, v32, v33
    v_cvt_pk_bf16_f32 v97, v34, v35
    v_cvt_pk_bf16_f32 v98, v40, v41
    v_cvt_pk_bf16_f32 v99, v42, v43
    global_store_dwordx4 v13, v[96:99], s[44:45] offset:0 sc1
    v_cvt_pk_bf16_f32 v100, v36, v37
    v_cvt_pk_bf16_f32 v101, v38, v39
    v_cvt_pk_bf16_f32 v102, v44, v45
    v_cvt_pk_bf16_f32 v103, v46, v47
    global_store_dwordx4 v13, v[100:103], s[44:45] offset:1024 sc1
    v_cvt_pk_bf16_f32 v104, v48, v49
    v_cvt_pk_bf16_f32 v105, v50, v51
    v_cvt_pk_bf16_f32 v106, v56, v57
    v_cvt_pk_bf16_f32 v107, v58, v59
    global_store_dwordx4 v15, v[104:107], s[44:45] offset:0 sc1
    v_cvt_pk_bf16_f32 v108, v52, v53
    v_cvt_pk_bf16_f32 v109, v54, v55
    v_cvt_pk_bf16_f32 v110, v60, v61
    v_cvt_pk_bf16_f32 v111, v62, v63
    global_store_dwordx4 v15, v[108:111], s[44:45] offset:1024 sc1
    s_add_u32 s44, s44, 1048576
    s_addc_u32 s45, s45, 0
    s_add_u32 s49, s49, 256
    s_add_u32 s48, s48, 1
    s_cmp_lt_u32 s48, 16
    s_cbranch_scc1 gloop_158
gemmdone_146:
    s_waitcnt vmcnt(0)
    s_barrier
    s_sub_u32 s78, s49, 256
    s_cmp_lg_u32 s34, 0
    s_cbranch_scc1 sig_169
    v_mov_b32 v16, s78
    v_mov_b32 v17, 1
    s_mov_b64 exec, 1
    global_atomic_add v16, v17, s[4:5]
    s_mov_b64 exec, -1
sig_169:
    s_cmp_lg_u32 s34, 0
    s_cbranch_scc1 sig_170
    v_mov_b32 v16, s49
    v_mov_b32 v17, 1
    s_mov_b64 exec, 1
    global_atomic_add v16, v17, s[4:5]
    s_mov_b64 exec, -1
sig_170:
    s_branch L_ef
L_front:
    v_lshlrev_b32 v20, 2, v0
    global_load_dword v21, v20, s[24:25]
    v_mbcnt_lo_u32_b32 v2, -1, 0
    v_mbcnt_hi_u32_b32 v2, -1, v2
    v_lshrrev_b32 v3, 4, v2
    v_and_b32 v4, 15, v2
    v_lshrrev_b32 v5, 2, v2
    s_mov_b32 s70, 6144
    v_mul_lo_u32 v5, v5, s70
    v_and_b32 v6, 3, v2
    v_lshl_add_u32 v5, v6, 4, v5
    s_mul_i32 s70, s3, 64
    s_mul_i32 s71, s34, 786432
    s_add_u32 s70, s70, s71
    s_add_u32 s70, s70, 0
    s_add_u32 s72, s22, s70
    s_addc_u32 s73, s23, 0
    s_mul_i32 s71, s34, 8192
    s_add_u32 m0, s71, 0
    s_nop 0
    global_load_lds_dwordx4 v5, s[72:73]
    s_add_u32 s72, s72, 98304
    s_addc_u32 s73, s73, 0
    s_add_u32 m0, s71, 1024
    s_nop 0
    global_load_lds_dwordx4 v5, s[72:73]
    s_add_u32 s72, s72, 98304
    s_addc_u32 s73, s73, 0
    s_add_u32 m0, s71, 2048
    s_nop 0
    global_load_lds_dwordx4 v5, s[72:73]
    s_add_u32 s72, s72, 98304
    s_addc_u32 s73, s73, 0
    s_add_u32 m0, s71, 3072
    s_nop 0
    global_load_lds_dwordx4 v5, s[72:73]
    s_add_u32 s72, s72, 98304
    s_addc_u32 s73, s73, 0
    s_add_u32 m0, s71, 4096
    s_nop 0
    global_load_lds_dwordx4 v5, s[72:73]
    s_add_u32 s72, s72, 98304
    s_addc_u32 s73, s73, 0
    s_add_u32 m0, s71, 5120
    s_nop 0
    global_load_lds_dwordx4 v5, s[72:73]
    s_add_u32 s72, s72, 98304
    s_addc_u32 s73, s73, 0
    s_add_u32 m0, s71, 6144
    s_nop 0
    global_load_lds_dwordx4 v5, s[72:73]
    s_add_u32 s72, s72, 98304
    s_addc_u32 s73, s73, 0
    s_add_u32 m0, s71, 7168
    s_nop 0
    global_load_lds_dwordx4 v5, s[72:73]
    s_waitcnt vmcnt(8)
    v_lshlrev_b32 v22, 16, v21
    v_and_b32 v23, 0xffff0000, v21
    s_mov_b32 s70, 3216550459
    v_mul_f32 v24, s70, v22
    v_exp_f32 v24, v24
    s_nop 0
    v_add_f32 v24, 1.0, v24
    v_rcp_f32 v24, v24
    s_nop 0
    v_mul_f32 v22, v22, v24
    v_mul_f32 v25, s70, v23
    v_exp_f32 v25, v25
    s_nop 0
    v_add_f32 v25, 1.0, v25
    v_rcp_f32 v25, v25
    s_nop 0
    v_mul_f32 v23, v23, v25
    v_cvt_pk_bf16_f32 v22, v22, v23
    v_add_u32 v20, 131072, v20
    v_mov_b32 v23, 0
    ds_write_b32 v20, v22
    ds_write_b32 v20, v23 offset:1024
    s_lshl_b32 s70, s34, 8
    s_add_u32 s71, s70, 131072
    v_lshl_add_u32 v12, v3, 4, s71
    s_add_u32 s71, s70, 132096
    v_mov_b32 v13, s71
    v_cmp_eq_u32 vcc, 0, v4
    s_nop 1
    v_cndmask_b32 v12, v13, v12, vcc
    s_waitcnt lgkmcnt(0)
    ds_read_b128 v[32:35], v12 offset:0
    ds_read_b128 v[36:39], v12 offset:64
    ds_read_b128 v[40:43], v12 offset:128
    ds_read_b128 v[44:47], v12 offset:192
    v_lshrrev_b32 v7, 2, v4
    v_lshl_add_u32 v7, v3, 3, v7
    v_and_b32 v8, 3, v4
    v_mul_u32_u24 v9, 64, v7
    v_lshl_add_u32 v9, v8, 3, v9
    s_mul_i32 s71, s34, 8192
    s_add_u32 s71, s71, 0
    v_add_u32 v9, s71, v9
    s_waitcnt vmcnt(0)
    ds_read_b64_tr_b16 v[64:65], v9 offset:0
    ds_read_b64_tr_b16 v[66:67], v9 offset:256
    ds_read_b64_tr_b16 v[68:69], v9 offset:2048
    ds_read_b64_tr_b16 v[70:71], v9 offset:2304
    ds_read_b64_tr_b16 v[72:73], v9 offset:4096
    ds_read_b64_tr_b16 v[74:75], v9 offset:4352
    ds_read_b64_tr_b16 v[76:77], v9 offset:6144
    ds_read_b64_tr_b16 v[78:79], v9 offset:6400
    ds_read_b64_tr_b16 v[80:81], v9 offset:32
    ds_read_b64_tr_b16 v[82:83], v9 offset:288
    ds_read_b64_tr_b16 v[84:85], v9 offset:2080
    ds_read_b64_tr_b16 v[86:87], v9 offset:2336
    ds_read_b64_tr_b16 v[88:89], v9 offset:4128
    ds_read_b64_tr_b16 v[90:91], v9 offset:4384
    ds_read_b64_tr_b16 v[92:93], v9 offset:6176
    ds_read_b64_tr_b16 v[94:95], v9 offset:6432
    s_waitcnt lgkmcnt(0)
    v_mfma_f32_16x16x32_bf16 v[48:51], v[32:35], v[64:67], 0
    v_mfma_f32_16x16x32_bf16 v[48:51], v[36:39], v[68:71], v[48:51]
    v_mfma_f32_16x16x32_bf16 v[48:51], v[40:43], v[72:75], v[48:51]
    v_mfma_f32_16x16x32_bf16 v[48:51], v[44:47], v[76:79], v[48:51]
    v_mfma_f32_16x16x32_bf16 v[52:55], v[32:35], v[80:83], 0
    v_mfma_f32_16x16x32_bf16 v[52:55], v[36:39], v[84:87], v[52:55]
    v_mfma_f32_16x16x32_bf16 v[52:55], v[40:43], v[88:91], v[52:55]
    v_mfma_f32_16x16x32_bf16 v[52:55], v[44:47], v[92:95], v[52:55]
    s_lshl_b32 s70, s34, 8
    s_add_u32 s70, s70, 133120
    v_lshl_add_u32 v10, v4, 2, s70
    s_mov_b64 exec, 0xffff
    ds_write_b32 v10, v48 offset:0
    s_nop 2
    ds_write_b32 v10, v52 offset:64
    s_mov_b64 exec, -1
    s_waitcnt lgkmcnt(0)
    s_barrier
    s_cmp_lg_u32 s34, 0
    s_cbranch_scc1 modw_171
    v_lshlrev_b32 v10, 2, v2
    v_add_u32 v11, 133120, v10
    ds_read_b32 v14, v11 offset:0
    ds_read_b32 v15, v11 offset:256
    ds_read_b32 v16, v11 offset:512
    ds_read_b32 v17, v11 offset:768
    s_waitcnt lgkmcnt(0)
    v_add_f32 v14, v14, v15
    v_add_f32 v16, v16, v17
    v_add_f32 v16, v14, v16
    v_cvt_pk_bf16_f32 v16, v16, v16
    v_lshlrev_b32 v16, 16, v16
    s_mul_i32 s71, s3, 32
    s_add_u32 s71, s71, 0
    s_lshr_b32 s72, s71, 9
    s_cmp_eq_u32 s72, 1
    s_cselect_b32 s73, 1.0, 0
    s_cmp_eq_u32 s72, 4
    s_cselect_b32 s73, 1.0, s73
    v_add_f32 v16, s73, v16
    v_cvt_pk_bf16_f32 v16, v16, v16
    v_lshlrev_b32 v16, 16, v16
    s_lshl_b32 s71, s71, 2
    s_add_u32 s71, s71, 65536
    v_add_u32 v10, s71, v10
    s_mov_b32 exec_hi, 0
    global_store_dword v10, v16, s[4:5] sc1
    s_mov_b64 exec, 1
    v_mov_b32 v10, 16
    v_mov_b32 v11, 1
    s_waitcnt vmcnt(0)
    global_atomic_add v10, v11, s[6:7]
    s_mov_b64 exec, -1
modw_171:
    s_barrier
    s_lshl_b32 s70, s3, 17
    s_lshl_b32 s71, s34, 15
    s_add_u32 s70, s70, s71
    v_lshl_add_u32 v10, v2, 7, s70
    global_load_dword v248, v10, s[14:15]
    v_add_u32 v10, 0x2000, v10
    global_load_dword v248, v10, s[14:15]
    v_add_u32 v10, 0x2000, v10
    global_load_dword v248, v10, s[14:15]
    v_add_u32 v10, 0x2000, v10
    global_load_dword v248, v10, s[14:15]
    v_add_u32 v10, 0x2000, v10
    v_mul_u32_u24 v9, 128, v7
    v_lshl_add_u32 v9, v8, 3, v9
    s_mul_i32 s71, s34, 16384
    s_add_u32 s71, s71, 32768
    v_add_u32 v9, s71, v9
    v_lshrrev_b32 v5, 3, v2
    s_mov_b32 s70, 6144
    v_mul_lo_u32 v5, v5, s70
    v_and_b32 v6, 7, v2
    v_lshl_add_u32 v5, v6, 4, v5
    s_mul_i32 s70, s3, 128
    s_mul_i32 s71, s34, 786432
    s_add_u32 s70, s70, s71
    s_add_u32 s70, s70, 2048
    s_add_u32 s72, s22, s70
    s_addc_u32 s73, s23, 0
    s_mul_i32 s71, s34, 16384
    s_add_u32 m0, s71, 32768
    s_nop 0
    global_load_lds_dwordx4 v5, s[72:73]
    s_add_u32 s72, s72, 49152
    s_addc_u32 s73, s73, 0
    s_add_u32 m0, s71, 33792
    s_nop 0
    global_load_lds_dwordx4 v5, s[72:73]
    s_add_u32 s72, s72, 49152
    s_addc_u32 s73, s73, 0
    s_add_u32 m0, s71, 34816
    s_nop 0
    global_load_lds_dwordx4 v5, s[72:73]
    s_add_u32 s72, s72, 49152
    s_addc_u32 s73, s73, 0
    s_add_u32 m0, s71, 35840
    s_nop 0
    global_load_lds_dwordx4 v5, s[72:73]
    s_add_u32 s72, s72, 49152
    s_addc_u32 s73, s73, 0
    s_add_u32 m0, s71, 36864
    s_nop 0
    global_load_lds_dwordx4 v5, s[72:73]
    s_add_u32 s72, s72, 49152
    s_addc_u32 s73, s73, 0
    s_add_u32 m0, s71, 37888
    s_nop 0
    global_load_lds_dwordx4 v5, s[72:73]
    s_add_u32 s72, s72, 49152
    s_addc_u32 s73, s73, 0
    s_add_u32 m0, s71, 38912
    s_nop 0
    global_load_lds_dwordx4 v5, s[72:73]
    s_add_u32 s72, s72, 49152
    s_addc_u32 s73, s73, 0
    s_add_u32 m0, s71, 39936
    s_nop 0
    global_load_lds_dwordx4 v5, s[72:73]
    s_add_u32 s72, s72, 49152
    s_addc_u32 s73, s73, 0
    s_add_u32 m0, s71, 40960
    s_nop 0
    global_load_lds_dwordx4 v5, s[72:73]
    s_add_u32 s72, s72, 49152
    s_addc_u32 s73, s73, 0
    s_add_u32 m0, s71, 41984
    s_nop 0
    global_load_lds_dwordx4 v5, s[72:73]
    s_add_u32 s72, s72, 49152
    s_addc_u32 s73, s73, 0
    s_add_u32 m0, s71, 43008
    s_nop 0
    global_load_lds_dwordx4 v5, s[72:73]
    s_add_u32 s72, s72, 49152
    s_addc_u32 s73, s73, 0
    s_add_u32 m0, s71, 44032
    s_nop 0
    global_load_lds_dwordx4 v5, s[72:73]
    s_add_u32 s72, s72, 49152
    s_addc_u32 s73, s73, 0
    s_add_u32 m0, s71, 45056
    s_nop 0
    global_load_lds_dwordx4 v5, s[72:73]
    s_add_u32 s72, s72, 49152
    s_addc_u32 s73, s73, 0
    s_add_u32 m0, s71, 46080
    s_nop 0
    global_load_lds_dwordx4 v5, s[72:73]
    s_add_u32 s72, s72, 49152
    s_addc_u32 s73, s73, 0
    s_add_u32 m0, s71, 47104
    s_nop 0
    global_load_lds_dwordx4 v5, s[72:73]
    s_add_u32 s72, s72, 49152
    s_addc_u32 s73, s73, 0
    s_add_u32 m0, s71, 48128
    s_nop 0
    global_load_lds_dwordx4 v5, s[72:73]
    s_waitcnt vmcnt(0)
    ds_read_b64_tr_b16 v[64:65], v9 offset:0
    ds_read_b64_tr_b16 v[66:67], v9 offset:512
    ds_read_b64_tr_b16 v[68:69], v9 offset:4096
    ds_read_b64_tr_b16 v[70:71], v9 offset:4608
    ds_read_b64_tr_b16 v[72:73], v9 offset:8192
    ds_read_b64_tr_b16 v[74:75], v9 offset:8704
    ds_read_b64_tr_b16 v[76:77], v9 offset:12288
    ds_read_b64_tr_b16 v[78:79], v9 offset:12800
    ds_read_b64_tr_b16 v[80:81], v9 offset:32
    ds_read_b64_tr_b16 v[82:83], v9 offset:544
    ds_read_b64_tr_b16 v[84:85], v9 offset:4128
    ds_read_b64_tr_b16 v[86:87], v9 offset:4640
    ds_read_b64_tr_b16 v[88:89], v9 offset:8224
    ds_read_b64_tr_b16 v[90:91], v9 offset:8736
    ds_read_b64_tr_b16 v[92:93], v9 offset:12320
    ds_read_b64_tr_b16 v[94:95], v9 offset:12832
    ds_read_b64_tr_b16 v[96:97], v9 offset:64
    ds_read_b64_tr_b16 v[98:99], v9 offset:576
    ds_read_b64_tr_b16 v[100:101], v9 offset:4160
    ds_read_b64_tr_b16 v[102:103], v9 offset:4672
    ds_read_b64_tr_b16 v[104:105], v9 offset:8256
    ds_read_b64_tr_b16 v[106:107], v9 offset:8768
    ds_read_b64_tr_b16 v[108:109], v9 offset:12352
    ds_read_b64_tr_b16 v[110:111], v9 offset:12864
    ds_read_b64_tr_b16 v[112:113], v9 offset:96
    ds_read_b64_tr_b16 v[114:115], v9 offset:608
    ds_read_b64_tr_b16 v[116:117], v9 offset:4192
    ds_read_b64_tr_b16 v[118:119], v9 offset:4704
    ds_read_b64_tr_b16 v[120:121], v9 offset:8288
    ds_read_b64_tr_b16 v[122:123], v9 offset:8800
    ds_read_b64_tr_b16 v[124:125], v9 offset:12384
    ds_read_b64_tr_b16 v[126:127], v9 offset:12896
    s_waitcnt lgkmcnt(0)
    v_mfma_f32_16x16x32_bf16 v[48:51], v[32:35], v[64:67], 0
    v_mfma_f32_16x16x32_bf16 v[48:51], v[36:39], v[68:71], v[48:51]
    v_mfma_f32_16x16x32_bf16 v[48:51], v[40:43], v[72:75], v[48:51]
    v_mfma_f32_16x16x32_bf16 v[48:51], v[44:47], v[76:79], v[48:51]
    v_mfma_f32_16x16x32_bf16 v[52:55], v[32:35], v[80:83], 0
    v_mfma_f32_16x16x32_bf16 v[52:55], v[36:39], v[84:87], v[52:55]
    v_mfma_f32_16x16x32_bf16 v[52:55], v[40:43], v[88:91], v[52:55]
    v_mfma_f32_16x16x32_bf16 v[52:55], v[44:47], v[92:95], v[52:55]
    v_mfma_f32_16x16x32_bf16 v[56:59], v[32:35], v[96:99], 0
    v_mfma_f32_16x16x32_bf16 v[56:59], v[36:39], v[100:103], v[56:59]
    v_mfma_f32_16x16x32_bf16 v[56:59], v[40:43], v[104:107], v[56:59]
    v_mfma_f32_16x16x32_bf16 v[56:59], v[44:47], v[108:111], v[56:59]
    v_mfma_f32_16x16x32_bf16 v[60:63], v[32:35], v[112:115], 0
    v_mfma_f32_16x16x32_bf16 v[60:63], v[36:39], v[116:119], v[60:63]
    v_mfma_f32_16x16x32_bf16 v[60:63], v[40:43], v[120:123], v[60:63]
    v_mfma_f32_16x16x32_bf16 v[60:63], v[44:47], v[124:127], v[60:63]
    s_lshl_b32 s70, s34, 8
    s_add_u32 s70, s70, 134144
    v_lshl_add_u32 v10, v4, 2, s70
    s_mov_b64 exec, 0xffff
    ds_write_b32 v10, v48 offset:0
    ds_write_b32 v10, v52 offset:64
    ds_write_b32 v10, v56 offset:128
    s_nop 0
    ds_write_b32 v10, v60 offset:192
    s_mov_b64 exec, -1
    s_waitcnt lgkmcnt(0)
    s_barrier
    s_cmp_lg_u32 s34, 0
    s_cbranch_scc1 modw_172
    v_lshlrev_b32 v10, 2, v2
    v_add_u32 v11, 134144, v10
    ds_read_b32 v14, v11 offset:0
    ds_read_b32 v15, v11 offset:256
    ds_read_b32 v16, v11 offset:512
    ds_read_b32 v17, v11 offset:768
    s_waitcnt lgkmcnt(0)
    v_add_f32 v14, v14, v15
    v_add_f32 v16, v16, v17
    v_add_f32 v16, v14, v16
    v_cvt_pk_bf16_f32 v16, v16, v16
    v_lshlrev_b32 v16, 16, v16
    s_mul_i32 s71, s3, 64
    s_add_u32 s71, s71, 1024
    s_lshr_b32 s72, s71, 9
    s_cmp_eq_u32 s72, 1
    s_cselect_b32 s73, 1.0, 0
    s_cmp_eq_u32 s72, 4
    s_cselect_b32 s73, 1.0, s73
    v_add_f32 v16, s73, v16
    v_cvt_pk_bf16_f32 v16, v16, v16
    v_lshlrev_b32 v16, 16, v16
    s_lshl_b32 s71, s71, 2
    s_add_u32 s71, s71, 65536
    v_add_u32 v10, s71, v10
    global_store_dword v10, v16, s[4:5] sc1
    s_mov_b64 exec, 1
    v_mov_b32 v10, 20
    v_mov_b32 v11, 1
    s_waitcnt vmcnt(0)
    global_atomic_add v10, v11, s[6:7]
    s_mov_b64 exec, -1
modw_172:
L_ef:
    s_cmp_lg_u32 s34, 0
    s_cbranch_scc1 polld_174
    v_mov_b32 v2, 8
    s_mov_b32 s79, 0
    s_mov_b64 exec, 1
poll_173:
    global_load_dword v3, v2, s[6:7] sc1
    s_add_u32 s79, s79, 1
    s_cmp_gt_u32 s79, 0x80000
    s_cbranch_scc1 L_fail
    s_waitcnt vmcnt(0)
    v_cmp_le_u32 vcc, 256, v3
    s_cbranch_vccnz polld_174
    s_sleep 4
    s_branch poll_173
polld_174:
    s_mov_b64 exec, -1
    s_barrier
    v_mov_b32 v1, 0
    global_load_dwordx2 v[4:5], v1, s[6:7] offset:128 sc1
    global_load_dword v6, v1, s[6:7] sc1
    s_waitcnt vmcnt(0)
    v_readfirstlane_b32 s78, v6
    v_xor_b32 v4, 0x20202000, v4
    v_xor_b32 v5, 0x20202020, v5
    v_xor_b32 v6, 32, v6
    v_or3_b32 v4, v4, v5, v6
    s_nop 0
    v_readfirstlane_b32 s37, v4
    s_nop 0
    s_cmp_lg_u32 s37, 0
    s_cselect_b32 s37, 1, 0
    s_cmp_eq_u32 s37, 0
    s_cbranch_scc1 L_efn
    s_lshr_b32 s35, s3, 5
    s_add_u32 s35, s35, 1
    s_and_b32 s36, s3, 31
L_efn:
    s_cmp_ge_u32 s36, 32
    s_cbranch_scc1 L_fail
    s_sub_u32 s70, s35, 1
    s_cmp_ge_u32 s70, 7
    s_cbranch_scc1 L_fail
    s_cmp_lg_u32 s35, 2
    s_cbranch_scc1 L_efs
    s_barrier
    s_cmp_ge_u32 s36, 22
    s_cbranch_scc1 ffn_skip1_175
    v_mbcnt_lo_u32_b32 v2, -1, 0
    v_mbcnt_hi_u32_b32 v2, -1, v2
    v_lshrrev_b32 v3, 4, v2
    v_and_b32 v4, 15, v2
    v_lshrrev_b32 v5, 1, v4
    v_xor_b32 v5, v5, v3
    s_lshl_b32 s76, s36, 7
    v_xor_b32 v8, 0, v5
    v_cmp_gt_u32 s[40:41], 4, v8
    v_and_b32 v8, 3, v8
    v_lshlrev_b32 v8, 5, v8
    v_and_b32 v9, 1, v4
    v_lshl_add_u32 v8, v9, 4, v8
    v_add_u32 v8, s76, v8
    v_subrev_u32 v9, 128, v8
    v_cmp_lt_u32 vcc, 2736, v8
    s_nop 1
    v_cndmask_b32 v8, v8, v9, vcc
    s_mov_b32 s70, 2752
    v_mad_u32_u24 v6, v3, s70, v8
    v_xor_b32 v8, 4, v5
    v_cmp_gt_u32 s[42:43], 4, v8
    v_and_b32 v8, 3, v8
    v_lshlrev_b32 v8, 5, v8
    v_and_b32 v9, 1, v4
    v_lshl_add_u32 v8, v9, 4, v8
    v_add_u32 v8, s76, v8
    v_subrev_u32 v9, 128, v8
    v_cmp_lt_u32 vcc, 2736, v8
    s_nop 1
    v_cndmask_b32 v8, v8, v9, vcc
    s_mov_b32 s70, 2752
    v_mad_u32_u24 v7, v3, s70, v8
    s_mul_i32 s70, s34, 352256
    s_add_u32 s72, s28, s70
    s_addc_u32 s73, s29, 0
    s_add_u32 s74, s30, s70
    s_addc_u32 s75, s31, 0
    s_lshl_b32 s71, s34, 15
    s_add_u32 m0, s71, 0
    s_mov_b64 exec, s[40:41]
    global_load_lds_dwordx4 v6, s[72:73]
    s_not_b64 exec, s[40:41]
    global_load_lds_dwordx4 v6, s[74:75]
    s_add_u32 s72, s72, 11008
    s_addc_u32 s73, s73, 0
    s_add_u32 s74, s74, 11008
    s_addc_u32 s75, s75, 0
    s_add_u32 m0, s71, 1024
    s_mov_b64 exec, s[40:41]
    global_load_lds_dwordx4 v6, s[72:73]
    s_not_b64 exec, s[40:41]
    global_load_lds_dwordx4 v6, s[74:75]
    s_add_u32 s72, s72, 11008
    s_addc_u32 s73, s73, 0
    s_add_u32 s74, s74, 11008
    s_addc_u32 s75, s75, 0
    s_add_u32 m0, s71, 2048
    s_mov_b64 exec, s[42:43]
    global_load_lds_dwordx4 v7, s[72:73]
    s_not_b64 exec, s[42:43]
    global_load_lds_dwordx4 v7, s[74:75]
    s_add_u32 s72, s72, 11008
    s_addc_u32 s73, s73, 0
    s_add_u32 s74, s74, 11008
    s_addc_u32 s75, s75, 0
    s_add_u32 m0, s71, 3072
    s_mov_b64 exec, s[42:43]
    global_load_lds_dwordx4 v7, s[72:73]
    s_not_b64 exec, s[42:43]
    global_load_lds_dwordx4 v7, s[74:75]
    s_add_u32 s72, s72, 11008
    s_addc_u32 s73, s73, 0
    s_add_u32 s74, s74, 11008
    s_addc_u32 s75, s75, 0
    s_add_u32 m0, s71, 4096
    s_mov_b64 exec, s[40:41]
    global_load_lds_dwordx4 v6, s[72:73]
    s_not_b64 exec, s[40:41]
    global_load_lds_dwordx4 v6, s[74:75]
    s_add_u32 s72, s72, 11008
    s_addc_u32 s73, s73, 0
    s_add_u32 s74, s74, 11008
    s_addc_u32 s75, s75, 0
    s_add_u32 m0, s71, 5120
    s_mov_b64 exec, s[40:41]
    global_load_lds_dwordx4 v6, s[72:73]
    s_not_b64 exec, s[40:41]
    global_load_lds_dwordx4 v6, s[74:75]
    s_add_u32 s72, s72, 11008
    s_addc_u32 s73, s73, 0
    s_add_u32 s74, s74, 11008
    s_addc_u32 s75, s75, 0
    s_add_u32 m0, s71, 6144
    s_mov_b64 exec, s[42:43]
    global_load_lds_dwordx4 v7, s[72:73]
    s_not_b64 exec, s[42:43]
    global_load_lds_dwordx4 v7, s[74:75]
    s_add_u32 s72, s72, 11008
    s_addc_u32 s73, s73, 0
    s_add_u32 s74, s74, 11008
    s_addc_u32 s75, s75, 0
    s_add_u32 m0, s71, 7168
    s_mov_b64 exec, s[42:43]
    global_load_lds_dwordx4 v7, s[72:73]
    s_not_b64 exec, s[42:43]
    global_load_lds_dwordx4 v7, s[74:75]
    s_add_u32 s72, s72, 11008
    s_addc_u32 s73, s73, 0
    s_add_u32 s74, s74, 11008
    s_addc_u32 s75, s75, 0
    s_add_u32 m0, s71, 8192
    s_mov_b64 exec, s[40:41]
    global_load_lds_dwordx4 v6, s[72:73]
    s_not_b64 exec, s[40:41]
    global_load_lds_dwordx4 v6, s[74:75]
    s_add_u32 s72, s72, 11008
    s_addc_u32 s73, s73, 0
    s_add_u32 s74, s74, 11008
    s_addc_u32 s75, s75, 0
    s_add_u32 m0, s71, 9216
    s_mov_b64 exec, s[40:41]
    global_load_lds_dwordx4 v6, s[72:73]
    s_not_b64 exec, s[40:41]
    global_load_lds_dwordx4 v6, s[74:75]
    s_add_u32 s72, s72, 11008
    s_addc_u32 s73, s73, 0
    s_add_u32 s74, s74, 11008
    s_addc_u32 s75, s75, 0
    s_add_u32 m0, s71, 10240
    s_mov_b64 exec, s[42:43]
    global_load_lds_dwordx4 v7, s[72:73]
    s_not_b64 exec, s[42:43]
    global_load_lds_dwordx4 v7, s[74:75]
    s_add_u32 s72, s72, 11008
    s_addc_u32 s73, s73, 0
    s_add_u32 s74, s74, 11008
    s_addc_u32 s75, s75, 0
    s_add_u32 m0, s71, 11264
    s_mov_b64 exec, s[42:43]
    global_load_lds_dwordx4 v7, s[72:73]
    s_not_b64 exec, s[42:43]
    global_load_lds_dwordx4 v7, s[74:75]
    s_add_u32 s72, s72, 11008
    s_addc_u32 s73, s73, 0
    s_add_u32 s74, s74, 11008
    s_addc_u32 s75, s75, 0
    s_add_u32 m0, s71, 12288
    s_mov_b64 exec, s[40:41]
    global_load_lds_dwordx4 v6, s[72:73]
    s_not_b64 exec, s[40:41]
    global_load_lds_dwordx4 v6, s[74:75]
    s_add_u32 s72, s72, 11008
    s_addc_u32 s73, s73, 0
    s_add_u32 s74, s74, 11008
    s_addc_u32 s75, s75, 0
    s_add_u32 m0, s71, 13312
    s_mov_b64 exec, s[40:41]
    global_load_lds_dwordx4 v6, s[72:73]
    s_not_b64 exec, s[40:41]
    global_load_lds_dwordx4 v6, s[74:75]
    s_add_u32 s72, s72, 11008
    s_addc_u32 s73, s73, 0
    s_add_u32 s74, s74, 11008
    s_addc_u32 s75, s75, 0
    s_add_u32 m0, s71, 14336
    s_mov_b64 exec, s[42:43]
    global_load_lds_dwordx4 v7, s[72:73]
    s_not_b64 exec, s[42:43]
    global_load_lds_dwordx4 v7, s[74:75]
    s_add_u32 s72, s72, 11008
    s_addc_u32 s73, s73, 0
    s_add_u32 s74, s74, 11008
    s_addc_u32 s75, s75, 0
    s_add_u32 m0, s71, 15360
    s_mov_b64 exec, s[42:43]
    global_load_lds_dwordx4 v7, s[72:73]
    s_not_b64 exec, s[42:43]
    global_load_lds_dwordx4 v7, s[74:75]
    s_add_u32 s72, s72, 11008
    s_addc_u32 s73, s73, 0
    s_add_u32 s74, s74, 11008
    s_addc_u32 s75, s75, 0
    s_add_u32 m0, s71, 16384
    s_mov_b64 exec, s[40:41]
    global_load_lds_dwordx4 v6, s[72:73]
    s_not_b64 exec, s[40:41]
    global_load_lds_dwordx4 v6, s[74:75]
    s_add_u32 s72, s72, 11008
    s_addc_u32 s73, s73, 0
    s_add_u32 s74, s74, 11008
    s_addc_u32 s75, s75, 0
    s_add_u32 m0, s71, 17408
    s_mov_b64 exec, s[40:41]
    global_load_lds_dwordx4 v6, s[72:73]
    s_not_b64 exec, s[40:41]
    global_load_lds_dwordx4 v6, s[74:75]
    s_add_u32 s72, s72, 11008
    s_addc_u32 s73, s73, 0
    s_add_u32 s74, s74, 11008
    s_addc_u32 s75, s75, 0
    s_add_u32 m0, s71, 18432
    s_mov_b64 exec, s[42:43]
    global_load_lds_dwordx4 v7, s[72:73]
    s_not_b64 exec, s[42:43]
    global_load_lds_dwordx4 v7, s[74:75]
    s_add_u32 s72, s72, 11008
    s_addc_u32 s73, s73, 0
    s_add_u32 s74, s74, 11008
    s_addc_u32 s75, s75, 0
    s_add_u32 m0, s71, 19456
    s_mov_b64 exec, s[42:43]
    global_load_lds_dwordx4 v7, s[72:73]
    s_not_b64 exec, s[42:43]
    global_load_lds_dwordx4 v7, s[74:75]
    s_add_u32 s72, s72, 11008
    s_addc_u32 s73, s73, 0
    s_add_u32 s74, s74, 11008
    s_addc_u32 s75, s75, 0
    s_add_u32 m0, s71, 20480
    s_mov_b64 exec, s[40:41]
    global_load_lds_dwordx4 v6, s[72:73]
    s_not_b64 exec, s[40:41]
    global_load_lds_dwordx4 v6, s[74:75]
    s_add_u32 s72, s72, 11008
    s_addc_u32 s73, s73, 0
    s_add_u32 s74, s74, 11008
    s_addc_u32 s75, s75, 0
    s_add_u32 m0, s71, 21504
    s_mov_b64 exec, s[40:41]
    global_load_lds_dwordx4 v6, s[72:73]
    s_not_b64 exec, s[40:41]
    global_load_lds_dwordx4 v6, s[74:75]
    s_add_u32 s72, s72, 11008
    s_addc_u32 s73, s73, 0
    s_add_u32 s74, s74, 11008
    s_addc_u32 s75, s75, 0
    s_add_u32 m0, s71, 22528
    s_mov_b64 exec, s[42:43]
    global_load_lds_dwordx4 v7, s[72:73]
    s_not_b64 exec, s[42:43]
    global_load_lds_dwordx4 v7, s[74:75]
    s_add_u32 s72, s72, 11008
    s_addc_u32 s73, s73, 0
    s_add_u32 s74, s74, 11008
    s_addc_u32 s75, s75, 0
    s_add_u32 m0, s71, 23552
    s_mov_b64 exec, s[42:43]
    global_load_lds_dwordx4 v7, s[72:73]
    s_not_b64 exec, s[42:43]
    global_load_lds_dwordx4 v7, s[74:75]
    s_add_u32 s72, s72, 11008
    s_addc_u32 s73, s73, 0
    s_add_u32 s74, s74, 11008
    s_addc_u32 s75, s75, 0
    s_add_u32 m0, s71, 24576
    s_mov_b64 exec, s[40:41]
    global_load_lds_dwordx4 v6, s[72:73]
    s_not_b64 exec, s[40:41]
    global_load_lds_dwordx4 v6, s[74:75]
    s_add_u32 s72, s72, 11008
    s_addc_u32 s73, s73, 0
    s_add_u32 s74, s74, 11008
    s_addc_u32 s75, s75, 0
    s_waitcnt vmcnt(20)
    s_add_u32 m0, s71, 25600
    s_mov_b64 exec, s[40:41]
    global_load_lds_dwordx4 v6, s[72:73]
    s_not_b64 exec, s[40:41]
    global_load_lds_dwordx4 v6, s[74:75]
    s_add_u32 s72, s72, 11008
    s_addc_u32 s73, s73, 0
    s_add_u32 s74, s74, 11008
    s_addc_u32 s75, s75, 0
    s_add_u32 m0, s71, 26624
    s_mov_b64 exec, s[42:43]
    global_load_lds_dwordx4 v7, s[72:73]
    s_not_b64 exec, s[42:43]
    global_load_lds_dwordx4 v7, s[74:75]
    s_add_u32 s72, s72, 11008
    s_addc_u32 s73, s73, 0
    s_add_u32 s74, s74, 11008
    s_addc_u32 s75, s75, 0
    s_add_u32 m0, s71, 27648
    s_mov_b64 exec, s[42:43]
    global_load_lds_dwordx4 v7, s[72:73]
    s_not_b64 exec, s[42:43]
    global_load_lds_dwordx4 v7, s[74:75]
    s_add_u32 s72, s72, 11008
    s_addc_u32 s73, s73, 0
    s_add_u32 s74, s74, 11008
    s_addc_u32 s75, s75, 0
    s_add_u32 m0, s71, 28672
    s_mov_b64 exec, s[40:41]
    global_load_lds_dwordx4 v6, s[72:73]
    s_not_b64 exec, s[40:41]
    global_load_lds_dwordx4 v6, s[74:75]
    s_add_u32 s72, s72, 11008
    s_addc_u32 s73, s73, 0
    s_add_u32 s74, s74, 11008
    s_addc_u32 s75, s75, 0
    s_add_u32 m0, s71, 29696
    s_mov_b64 exec, s[40:41]
    global_load_lds_dwordx4 v6, s[72:73]
    s_not_b64 exec, s[40:41]
    global_load_lds_dwordx4 v6, s[74:75]
    s_add_u32 s72, s72, 11008
    s_addc_u32 s73, s73, 0
    s_add_u32 s74, s74, 11008
    s_addc_u32 s75, s75, 0
    s_add_u32 m0, s71, 30720
    s_mov_b64 exec, s[42:43]
    global_load_lds_dwordx4 v7, s[72:73]
    s_not_b64 exec, s[42:43]
    global_load_lds_dwordx4 v7, s[74:75]
    s_add_u32 s72, s72, 11008
    s_addc_u32 s73, s73, 0
    s_add_u32 s74, s74, 11008
    s_addc_u32 s75, s75, 0
    s_add_u32 m0, s71, 31744
    s_mov_b64 exec, s[42:43]
    global_load_lds_dwordx4 v7, s[72:73]
    s_not_b64 exec, s[42:43]
    global_load_lds_dwordx4 v7, s[74:75]
    s_mov_b64 exec, -1
    v_mbcnt_lo_u32_b32 v2, -1, 0
    v_mbcnt_hi_u32_b32 v2, -1, v2
    v_lshrrev_b32 v3, 4, v2
    v_and_b32 v4, 15, v2
    v_lshrrev_b32 v5, 2, v4
    v_lshl_add_u32 v10, v3, 3, v5
    v_lshlrev_b32 v10, 8, v10
    v_and_b32 v2, 1, v3
    v_lshl_add_u32 v11, v2, 2, v5
    v_and_b32 v2, 3, v4
    v_lshl_add_u32 v10, v2, 3, v10
    s_waitcnt vmcnt(0)
    s_barrier
    s_add_u32 s70, s34, 0
    v_xor_b32 v14, s70, v11
    v_lshl_add_u32 v14, v14, 5, v10
    v_add_u32 v15, 0x10000, v14
    ds_read_b64_tr_b16 a[128:129], v14 offset:0
    ds_read_b64_tr_b16 a[130:131], v14 offset:1024
    ds_read_b64_tr_b16 a[132:133], v14 offset:8192
    ds_read_b64_tr_b16 a[134:135], v14 offset:9216
    ds_read_b64_tr_b16 a[136:137], v14 offset:16384
    ds_read_b64_tr_b16 a[138:139], v14 offset:17408
    ds_read_b64_tr_b16 a[140:141], v14 offset:24576
    ds_read_b64_tr_b16 a[142:143], v14 offset:25600
    ds_read_b64_tr_b16 a[144:145], v14 offset:32768
    ds_read_b64_tr_b16 a[146:147], v14 offset:33792
    ds_read_b64_tr_b16 a[148:149], v14 offset:40960
    ds_read_b64_tr_b16 a[150:151], v14 offset:41984
    ds_read_b64_tr_b16 a[152:153], v14 offset:49152
    ds_read_b64_tr_b16 a[154:155], v14 offset:50176
    ds_read_b64_tr_b16 a[156:157], v14 offset:57344
    ds_read_b64_tr_b16 a[158:159], v14 offset:58368
    ds_read_b64_tr_b16 a[160:161], v15 offset:0
    ds_read_b64_tr_b16 a[162:163], v15 offset:1024
    ds_read_b64_tr_b16 a[164:165], v15 offset:8192
    ds_read_b64_tr_b16 a[166:167], v15 offset:9216
    ds_read_b64_tr_b16 a[168:169], v15 offset:16384
    ds_read_b64_tr_b16 a[170:171], v15 offset:17408
    ds_read_b64_tr_b16 a[172:173], v15 offset:24576
    ds_read_b64_tr_b16 a[174:175], v15 offset:25600
    ds_read_b64_tr_b16 a[176:177], v15 offset:32768
    ds_read_b64_tr_b16 a[178:179], v15 offset:33792
    ds_read_b64_tr_b16 a[180:181], v15 offset:40960
    ds_read_b64_tr_b16 a[182:183], v15 offset:41984
    ds_read_b64_tr_b16 a[184:185], v15 offset:49152
    ds_read_b64_tr_b16 a[186:187], v15 offset:50176
    ds_read_b64_tr_b16 a[188:189], v15 offset:57344
    ds_read_b64_tr_b16 a[190:191], v15 offset:58368
    s_add_u32 s70, s34, 4
    v_xor_b32 v14, s70, v11
    v_lshl_add_u32 v14, v14, 5, v10
    v_add_u32 v15, 0x10000, v14
    ds_read_b64_tr_b16 a[192:193], v14 offset:0
    ds_read_b64_tr_b16 a[194:195], v14 offset:1024
    ds_read_b64_tr_b16 a[196:197], v14 offset:8192
    ds_read_b64_tr_b16 a[198:199], v14 offset:9216
    ds_read_b64_tr_b16 a[200:201], v14 offset:16384
    ds_read_b64_tr_b16 a[202:203], v14 offset:17408
    ds_read_b64_tr_b16 a[204:205], v14 offset:24576
    ds_read_b64_tr_b16 a[206:207], v14 offset:25600
    ds_read_b64_tr_b16 a[208:209], v14 offset:32768
    ds_read_b64_tr_b16 a[210:211], v14 offset:33792
    ds_read_b64_tr_b16 a[212:213], v14 offset:40960
    ds_read_b64_tr_b16 a[214:215], v14 offset:41984
    ds_read_b64_tr_b16 a[216:217], v14 offset:49152
    ds_read_b64_tr_b16 a[218:219], v14 offset:50176
    ds_read_b64_tr_b16 a[220:221], v14 offset:57344
    ds_read_b64_tr_b16 a[222:223], v14 offset:58368
    ds_read_b64_tr_b16 a[224:225], v15 offset:0
    ds_read_b64_tr_b16 a[226:227], v15 offset:1024
    ds_read_b64_tr_b16 a[228:229], v15 offset:8192
    ds_read_b64_tr_b16 a[230:231], v15 offset:9216
    ds_read_b64_tr_b16 a[232:233], v15 offset:16384
    ds_read_b64_tr_b16 a[234:235], v15 offset:17408
    ds_read_b64_tr_b16 a[236:237], v15 offset:24576
    ds_read_b64_tr_b16 a[238:239], v15 offset:25600
    ds_read_b64_tr_b16 a[240:241], v15 offset:32768
    ds_read_b64_tr_b16 a[242:243], v15 offset:33792
    ds_read_b64_tr_b16 a[244:245], v15 offset:40960
    ds_read_b64_tr_b16 a[246:247], v15 offset:41984
    ds_read_b64_tr_b16 a[248:249], v15 offset:49152
    ds_read_b64_tr_b16 a[250:251], v15 offset:50176
    ds_read_b64_tr_b16 a[252:253], v15 offset:57344
    ds_read_b64_tr_b16 a[254:255], v15 offset:58368
    s_waitcnt lgkmcnt(0)
    s_barrier
ffn_skip1_175:
    v_mbcnt_lo_u32_b32 v2, -1, 0
    v_mbcnt_hi_u32_b32 v2, -1, v2
    v_lshrrev_b32 v3, 4, v2
    v_and_b32 v4, 15, v2
    v_lshrrev_b32 v5, 1, v2
    v_lshlrev_b32 v5, 10, v5
    v_and_b32 v6, 1, v2
    v_lshl_add_u32 v5, v6, 4, v5
    s_lshl_b32 s70, s36, 5
    s_lshl_b32 s71, s34, 15
    s_add_u32 s70, s70, s71
    s_add_u32 s72, s32, s70
    s_addc_u32 s73, s33, 0
    s_lshl_b32 s71, s34, 10
    s_add_u32 m0, s71, 0
    s_nop 0
    global_load_lds_dwordx4 v5, s[72:73]
    s_add_u32 s72, s72, 131072
    s_addc_u32 s73, s73, 0
    s_add_u32 m0, s71, 4096
    s_nop 0
    global_load_lds_dwordx4 v5, s[72:73]
    s_add_u32 s72, s72, 131072
    s_addc_u32 s73, s73, 0
    s_add_u32 m0, s71, 8192
    s_nop 0
    global_load_lds_dwordx4 v5, s[72:73]
    s_add_u32 s72, s72, 131072
    s_addc_u32 s73, s73, 0
    s_add_u32 m0, s71, 12288
    s_nop 0
    global_load_lds_dwordx4 v5, s[72:73]
    s_add_u32 s72, s72, 131072
    s_addc_u32 s73, s73, 0
    s_add_u32 m0, s71, 16384
    s_nop 0
    global_load_lds_dwordx4 v5, s[72:73]
    s_add_u32 s72, s72, 131072
    s_addc_u32 s73, s73, 0
    s_add_u32 m0, s71, 20480
    s_nop 0
    global_load_lds_dwordx4 v5, s[72:73]
    s_add_u32 s72, s72, 131072
    s_addc_u32 s73, s73, 0
    s_add_u32 m0, s71, 24576
    s_nop 0
    global_load_lds_dwordx4 v5, s[72:73]
    s_add_u32 s72, s72, 131072
    s_addc_u32 s73, s73, 0
    s_add_u32 m0, s71, 28672
    s_nop 0
    global_load_lds_dwordx4 v5, s[72:73]
    s_add_u32 s72, s72, 131072
    s_addc_u32 s73, s73, 0
    s_add_u32 m0, s71, 32768
    s_nop 0
    global_load_lds_dwordx4 v5, s[72:73]
    s_add_u32 s72, s72, 131072
    s_addc_u32 s73, s73, 0
    s_add_u32 m0, s71, 36864
    s_nop 0
    global_load_lds_dwordx4 v5, s[72:73]
    s_add_u32 s72, s72, 131072
    s_addc_u32 s73, s73, 0
    s_cmp_eq_u32 s34, 3
    s_cbranch_scc1 wd3_176
    s_add_u32 m0, s71, 40960
    s_nop 0
    global_load_lds_dwordx4 v5, s[72:73]
    s_add_u32 s72, s72, 131072
    s_addc_u32 s73, s73, 0
wd3_176:
    v_lshrrev_b32 v5, 2, v4
    v_lshl_add_u32 v5, v3, 3, v5
    v_lshlrev_b32 v5, 5, v5
    v_and_b32 v6, 3, v4
    v_lshl_add_u32 v5, v6, 3, v5
    v_add_u32 v5, s71, v5
    s_waitcnt vmcnt(0)
    ds_read_b64_tr_b16 v[200:201], v5 offset:0
    ds_read_b64_tr_b16 v[202:203], v5 offset:128
    ds_read_b64_tr_b16 v[204:205], v5 offset:4096
    ds_read_b64_tr_b16 v[206:207], v5 offset:4224
    ds_read_b64_tr_b16 v[208:209], v5 offset:8192
    ds_read_b64_tr_b16 v[210:211], v5 offset:8320
    ds_read_b64_tr_b16 v[212:213], v5 offset:12288
    ds_read_b64_tr_b16 v[214:215], v5 offset:12416
    ds_read_b64_tr_b16 v[216:217], v5 offset:16384
    ds_read_b64_tr_b16 v[218:219], v5 offset:16512
    ds_read_b64_tr_b16 v[220:221], v5 offset:20480
    ds_read_b64_tr_b16 v[222:223], v5 offset:20608
    ds_read_b64_tr_b16 v[224:225], v5 offset:24576
    ds_read_b64_tr_b16 v[226:227], v5 offset:24704
    ds_read_b64_tr_b16 v[228:229], v5 offset:28672
    ds_read_b64_tr_b16 v[230:231], v5 offset:28800
    ds_read_b64_tr_b16 v[232:233], v5 offset:32768
    ds_read_b64_tr_b16 v[234:235], v5 offset:32896
    ds_read_b64_tr_b16 v[236:237], v5 offset:36864
    ds_read_b64_tr_b16 v[238:239], v5 offset:36992
    ds_read_b64_tr_b16 v[240:241], v5 offset:40960
    ds_read_b64_tr_b16 v[242:243], v5 offset:41088
    s_waitcnt lgkmcnt(0)
L_efs:
    s_barrier
    s_lshl_b32 s76, s36, 17
    s_add_u32 s76, s76, 0
    s_add_u32 s76, s14, s76
    s_addc_u32 s77, s15, 0
    v_mbcnt_lo_u32_b32 v2, -1, 0
    v_mbcnt_hi_u32_b32 v2, -1, v2
    v_lshrrev_b32 v3, 4, v2
    v_and_b32 v4, 15, v2
    v_lshrrev_b32 v5, 1, v4
    v_xor_b32 v5, v5, v3
    v_xor_b32 v6, 0, v5
    v_lshlrev_b32 v6, 5, v6
    v_and_b32 v2, 1, v4
    v_lshl_add_u32 v6, v2, 4, v6
    s_mov_b32 s70, 1024
    v_mad_u32_u24 v6, v3, s70, v6
    v_xor_b32 v7, 4, v5
    v_lshlrev_b32 v7, 5, v7
    v_and_b32 v2, 1, v4
    v_lshl_add_u32 v7, v2, 4, v7
    s_mov_b32 s70, 1024
    v_mad_u32_u24 v7, v3, s70, v7
    s_mul_i32 s70, s34, 32768
    s_add_u32 s72, s76, s70
    s_addc_u32 s73, s77, 0
    s_mul_i32 s71, s34, 8192
    s_add_u32 s71, s71, 0
    s_add_u32 m0, s71, 0
    s_nop 0
    global_load_lds_dwordx4 v6, s[72:73]
    s_add_u32 s72, s72, 4096
    s_addc_u32 s73, s73, 0
    s_add_u32 m0, s71, 1024
    s_nop 0
    global_load_lds_dwordx4 v6, s[72:73]
    s_add_u32 s72, s72, 4096
    s_addc_u32 s73, s73, 0
    s_add_u32 m0, s71, 2048
    s_nop 0
    global_load_lds_dwordx4 v7, s[72:73]
    s_add_u32 s72, s72, 4096
    s_addc_u32 s73, s73, 0
    s_add_u32 m0, s71, 3072
    s_nop 0
    global_load_lds_dwordx4 v7, s[72:73]
    s_add_u32 s72, s72, 4096
    s_addc_u32 s73, s73, 0
    s_add_u32 m0, s71, 4096
    s_nop 0
    global_load_lds_dwordx4 v6, s[72:73]
    s_add_u32 s72, s72, 4096
    s_addc_u32 s73, s73, 0
    s_add_u32 m0, s71, 5120
    s_nop 0
    global_load_lds_dwordx4 v6, s[72:73]
    s_add_u32 s72, s72, 4096
    s_addc_u32 s73, s73, 0
    s_add_u32 m0, s71, 6144
    s_nop 0
    global_load_lds_dwordx4 v7, s[72:73]
    s_add_u32 s72, s72, 4096
    s_addc_u32 s73, s73, 0
    s_add_u32 m0, s71, 7168
    s_nop 0
    global_load_lds_dwordx4 v7, s[72:73]
    s_lshl_b32 s76, s36, 17
    s_add_u32 s76, s76, 256
    s_add_u32 s76, s14, s76
    s_addc_u32 s77, s15, 0
    v_mbcnt_lo_u32_b32 v2, -1, 0
    v_mbcnt_hi_u32_b32 v2, -1, v2
    v_lshrrev_b32 v3, 4, v2
    v_and_b32 v4, 15, v2
    v_lshrrev_b32 v5, 1, v4
    v_xor_b32 v5, v5, v3
    v_xor_b32 v6, 0, v5
    v_lshlrev_b32 v6, 5, v6
    v_and_b32 v2, 1, v4
    v_lshl_add_u32 v6, v2, 4, v6
    s_mov_b32 s70, 1024
    v_mad_u32_u24 v6, v3, s70, v6
    v_xor_b32 v7, 4, v5
    v_lshlrev_b32 v7, 5, v7
    v_and_b32 v2, 1, v4
    v_lshl_add_u32 v7, v2, 4, v7
    s_mov_b32 s70, 1024
    v_mad_u32_u24 v7, v3, s70, v7
    s_mul_i32 s70, s34, 32768
    s_add_u32 s72, s76, s70
    s_addc_u32 s73, s77, 0
    s_mul_i32 s71, s34, 8192
    s_add_u32 s71, s71, 32768
    s_add_u32 m0, s71, 0
    s_nop 0
    global_load_lds_dwordx4 v6, s[72:73]
    s_add_u32 s72, s72, 4096
    s_addc_u32 s73, s73, 0
    s_add_u32 m0, s71, 1024
    s_nop 0
    global_load_lds_dwordx4 v6, s[72:73]
    s_add_u32 s72, s72, 4096
    s_addc_u32 s73, s73, 0
    s_add_u32 m0, s71, 2048
    s_nop 0
    global_load_lds_dwordx4 v7, s[72:73]
    s_add_u32 s72, s72, 4096
    s_addc_u32 s73, s73, 0
    s_add_u32 m0, s71, 3072
    s_nop 0
    global_load_lds_dwordx4 v7, s[72:73]
    s_add_u32 s72, s72, 4096
    s_addc_u32 s73, s73, 0
    s_add_u32 m0, s71, 4096
    s_nop 0
    global_load_lds_dwordx4 v6, s[72:73]
    s_add_u32 s72, s72, 4096
    s_addc_u32 s73, s73, 0
    s_add_u32 m0, s71, 5120
    s_nop 0
    global_load_lds_dwordx4 v6, s[72:73]
    s_add_u32 s72, s72, 4096
    s_addc_u32 s73, s73, 0
    s_add_u32 m0, s71, 6144
    s_nop 0
    global_load_lds_dwordx4 v7, s[72:73]
    s_add_u32 s72, s72, 4096
    s_addc_u32 s73, s73, 0
    s_add_u32 m0, s71, 7168
    s_nop 0
    global_load_lds_dwordx4 v7, s[72:73]
    s_lshl_b32 s76, s36, 17
    s_add_u32 s76, s76, 512
    s_add_u32 s76, s14, s76
    s_addc_u32 s77, s15, 0
    v_mbcnt_lo_u32_b32 v2, -1, 0
    v_mbcnt_hi_u32_b32 v2, -1, v2
    v_lshrrev_b32 v3, 4, v2
    v_and_b32 v4, 15, v2
    v_lshrrev_b32 v5, 1, v4
    v_xor_b32 v5, v5, v3
    v_xor_b32 v6, 0, v5
    v_lshlrev_b32 v6, 5, v6
    v_and_b32 v2, 1, v4
    v_lshl_add_u32 v6, v2, 4, v6
    s_mov_b32 s70, 1024
    v_mad_u32_u24 v6, v3, s70, v6
    v_xor_b32 v7, 4, v5
    v_lshlrev_b32 v7, 5, v7
    v_and_b32 v2, 1, v4
    v_lshl_add_u32 v7, v2, 4, v7
    s_mov_b32 s70, 1024
    v_mad_u32_u24 v7, v3, s70, v7
    s_mul_i32 s70, s34, 32768
    s_add_u32 s72, s76, s70
    s_addc_u32 s73, s77, 0
    s_mul_i32 s71, s34, 8192
    s_add_u32 s71, s71, 65536
    s_add_u32 m0, s71, 0
    s_nop 0
    global_load_lds_dwordx4 v6, s[72:73]
    s_add_u32 s72, s72, 4096
    s_addc_u32 s73, s73, 0
    s_add_u32 m0, s71, 1024
    s_nop 0
    global_load_lds_dwordx4 v6, s[72:73]
    s_add_u32 s72, s72, 4096
    s_addc_u32 s73, s73, 0
    s_add_u32 m0, s71, 2048
    s_nop 0
    global_load_lds_dwordx4 v7, s[72:73]
    s_add_u32 s72, s72, 4096
    s_addc_u32 s73, s73, 0
    s_add_u32 m0, s71, 3072
    s_nop 0
    global_load_lds_dwordx4 v7, s[72:73]
    s_add_u32 s72, s72, 4096
    s_addc_u32 s73, s73, 0
    s_add_u32 m0, s71, 4096
    s_nop 0
    global_load_lds_dwordx4 v6, s[72:73]
    s_add_u32 s72, s72, 4096
    s_addc_u32 s73, s73, 0
    s_add_u32 m0, s71, 5120
    s_nop 0
    global_load_lds_dwordx4 v6, s[72:73]
    s_add_u32 s72, s72, 4096
    s_addc_u32 s73, s73, 0
    s_add_u32 m0, s71, 6144
    s_nop 0
    global_load_lds_dwordx4 v7, s[72:73]
    s_add_u32 s72, s72, 4096
    s_addc_u32 s73, s73, 0
    s_add_u32 m0, s71, 7168
    s_nop 0
    global_load_lds_dwordx4 v7, s[72:73]
    s_lshl_b32 s76, s36, 17
    s_add_u32 s76, s76, 768
    s_add_u32 s76, s14, s76
    s_addc_u32 s77, s15, 0
    v_mbcnt_lo_u32_b32 v2, -1, 0
    v_mbcnt_hi_u32_b32 v2, -1, v2
    v_lshrrev_b32 v3, 4, v2
    v_and_b32 v4, 15, v2
    v_lshrrev_b32 v5, 1, v4
    v_xor_b32 v5, v5, v3
    v_xor_b32 v6, 0, v5
    v_lshlrev_b32 v6, 5, v6
    v_and_b32 v2, 1, v4
    v_lshl_add_u32 v6, v2, 4, v6
    s_mov_b32 s70, 1024
    v_mad_u32_u24 v6, v3, s70, v6
    v_xor_b32 v7, 4, v5
    v_lshlrev_b32 v7, 5, v7
    v_and_b32 v2, 1, v4
    v_lshl_add_u32 v7, v2, 4, v7
    s_mov_b32 s70, 1024
    v_mad_u32_u24 v7, v3, s70, v7
    s_mul_i32 s70, s34, 32768
    s_add_u32 s72, s76, s70
    s_addc_u32 s73, s77, 0
    s_mul_i32 s71, s34, 8192
    s_add_u32 s71, s71, 98304
    s_add_u32 m0, s71, 0
    s_nop 0
    global_load_lds_dwordx4 v6, s[72:73]
    s_add_u32 s72, s72, 4096
    s_addc_u32 s73, s73, 0
    s_add_u32 m0, s71, 1024
    s_nop 0
    global_load_lds_dwordx4 v6, s[72:73]
    s_add_u32 s72, s72, 4096
    s_addc_u32 s73, s73, 0
    s_add_u32 m0, s71, 2048
    s_nop 0
    global_load_lds_dwordx4 v7, s[72:73]
    s_add_u32 s72, s72, 4096
    s_addc_u32 s73, s73, 0
    s_add_u32 m0, s71, 3072
    s_nop 0
    global_load_lds_dwordx4 v7, s[72:73]
    s_add_u32 s72, s72, 4096
    s_addc_u32 s73, s73, 0
    s_add_u32 m0, s71, 4096
    s_nop 0
    global_load_lds_dwordx4 v6, s[72:73]
    s_add_u32 s72, s72, 4096
    s_addc_u32 s73, s73, 0
    s_add_u32 m0, s71, 5120
    s_nop 0
    global_load_lds_dwordx4 v6, s[72:73]
    s_add_u32 s72, s72, 4096
    s_addc_u32 s73, s73, 0
    s_add_u32 m0, s71, 6144
    s_nop 0
    global_load_lds_dwordx4 v7, s[72:73]
    s_add_u32 s72, s72, 4096
    s_addc_u32 s73, s73, 0
    s_add_u32 m0, s71, 7168
    s_nop 0
    global_load_lds_dwordx4 v7, s[72:73]
    v_mbcnt_lo_u32_b32 v2, -1, 0
    v_mbcnt_hi_u32_b32 v2, -1, v2
    v_lshrrev_b32 v3, 4, v2
    v_and_b32 v4, 15, v2
    v_lshrrev_b32 v5, 2, v4
    v_lshl_add_u32 v10, v3, 3, v5
    v_lshlrev_b32 v10, 8, v10
    v_and_b32 v2, 1, v3
    v_lshl_add_u32 v11, v2, 2, v5
    v_and_b32 v2, 3, v4
    v_lshrrev_b32 v12, 1, v2
    v_xor_b32 v11, v11, v12
    v_and_b32 v12, 1, v2
    v_lshl_add_u32 v10, v12, 4, v10
    s_lshl_b32 s70, s34, 15
    v_add_u32 v10, s70, v10
    s_waitcnt vmcnt(0)
    s_barrier
    v_xor_b32 v12, 0, v11
    v_lshl_add_u32 v12, v12, 5, v10
    ds_read_b64_tr_b16 a[0:1], v12 offset:0
    ds_read_b64_tr_b16 a[2:3], v12 offset:1024
    ds_read_b64_tr_b16 a[4:5], v12 offset:8192
    ds_read_b64_tr_b16 a[6:7], v12 offset:9216
    ds_read_b64_tr_b16 a[8:9], v12 offset:16384
    ds_read_b64_tr_b16 a[10:11], v12 offset:17408
    ds_read_b64_tr_b16 a[12:13], v12 offset:24576
    ds_read_b64_tr_b16 a[14:15], v12 offset:25600
    ds_read_b64_tr_b16 a[16:17], v12 offset:8
    ds_read_b64_tr_b16 a[18:19], v12 offset:1032
    ds_read_b64_tr_b16 a[20:21], v12 offset:8200
    ds_read_b64_tr_b16 a[22:23], v12 offset:9224
    ds_read_b64_tr_b16 a[24:25], v12 offset:16392
    ds_read_b64_tr_b16 a[26:27], v12 offset:17416
    ds_read_b64_tr_b16 a[28:29], v12 offset:24584
    ds_read_b64_tr_b16 a[30:31], v12 offset:25608
    v_xor_b32 v12, 2, v11
    v_lshl_add_u32 v12, v12, 5, v10
    ds_read_b64_tr_b16 a[32:33], v12 offset:0
    ds_read_b64_tr_b16 a[34:35], v12 offset:1024
    ds_read_b64_tr_b16 a[36:37], v12 offset:8192
    ds_read_b64_tr_b16 a[38:39], v12 offset:9216
    ds_read_b64_tr_b16 a[40:41], v12 offset:16384
    ds_read_b64_tr_b16 a[42:43], v12 offset:17408
    ds_read_b64_tr_b16 a[44:45], v12 offset:24576
    ds_read_b64_tr_b16 a[46:47], v12 offset:25600
    ds_read_b64_tr_b16 a[48:49], v12 offset:8
    ds_read_b64_tr_b16 a[50:51], v12 offset:1032
    ds_read_b64_tr_b16 a[52:53], v12 offset:8200
    ds_read_b64_tr_b16 a[54:55], v12 offset:9224
    ds_read_b64_tr_b16 a[56:57], v12 offset:16392
    ds_read_b64_tr_b16 a[58:59], v12 offset:17416
    ds_read_b64_tr_b16 a[60:61], v12 offset:24584
    ds_read_b64_tr_b16 a[62:63], v12 offset:25608
    v_xor_b32 v12, 4, v11
    v_lshl_add_u32 v12, v12, 5, v10
    ds_read_b64_tr_b16 a[64:65], v12 offset:0
    ds_read_b64_tr_b16 a[66:67], v12 offset:1024
    ds_read_b64_tr_b16 a[68:69], v12 offset:8192
    ds_read_b64_tr_b16 a[70:71], v12 offset:9216
    ds_read_b64_tr_b16 a[72:73], v12 offset:16384
    ds_read_b64_tr_b16 a[74:75], v12 offset:17408
    ds_read_b64_tr_b16 a[76:77], v12 offset:24576
    ds_read_b64_tr_b16 a[78:79], v12 offset:25600
    ds_read_b64_tr_b16 a[80:81], v12 offset:8
    ds_read_b64_tr_b16 a[82:83], v12 offset:1032
    ds_read_b64_tr_b16 a[84:85], v12 offset:8200
    ds_read_b64_tr_b16 a[86:87], v12 offset:9224
    ds_read_b64_tr_b16 a[88:89], v12 offset:16392
    ds_read_b64_tr_b16 a[90:91], v12 offset:17416
    ds_read_b64_tr_b16 a[92:93], v12 offset:24584
    ds_read_b64_tr_b16 a[94:95], v12 offset:25608
    v_xor_b32 v12, 6, v11
    v_lshl_add_u32 v12, v12, 5, v10
    ds_read_b64_tr_b16 a[96:97], v12 offset:0
    ds_read_b64_tr_b16 a[98:99], v12 offset:1024
    ds_read_b64_tr_b16 a[100:101], v12 offset:8192
    ds_read_b64_tr_b16 a[102:103], v12 offset:9216
    ds_read_b64_tr_b16 a[104:105], v12 offset:16384
    ds_read_b64_tr_b16 a[106:107], v12 offset:17408
    ds_read_b64_tr_b16 a[108:109], v12 offset:24576
    ds_read_b64_tr_b16 a[110:111], v12 offset:25600
    ds_read_b64_tr_b16 a[112:113], v12 offset:8
    ds_read_b64_tr_b16 a[114:115], v12 offset:1032
    ds_read_b64_tr_b16 a[116:117], v12 offset:8200
    ds_read_b64_tr_b16 a[118:119], v12 offset:9224
    ds_read_b64_tr_b16 a[120:121], v12 offset:16392
    ds_read_b64_tr_b16 a[122:123], v12 offset:17416
    ds_read_b64_tr_b16 a[124:125], v12 offset:24584
    ds_read_b64_tr_b16 a[126:127], v12 offset:25608
    s_waitcnt lgkmcnt(0)
    s_barrier
    v_mbcnt_lo_u32_b32 v1, -1, 0
    v_mbcnt_hi_u32_b32 v1, -1, v1
    v_lshrrev_b32 v2, 4, v1
    v_and_b32 v3, 15, v1
    v_lshlrev_b32 v4, 4, v1
    v_and_b32 v5, 1, v2
    v_lshlrev_b32 v5, 2, v5
    v_lshl_add_u32 v5, v3, 3, v5
    v_lshrrev_b32 v6, 1, v2
    v_lshl_add_u32 v5, v6, 1, v5
    s_lshl_b32 s70, s34, 7
    v_add_u32 v30, s70, v5
    v_and_b32 v5, 1, v3
    v_lshlrev_b32 v5, 4, v5
    v_mov_b32 v6, 0x3F80
    v_lshlrev_b32 v5, v5, v6
    v_lshrrev_b32 v6, 1, v3
    v_cmp_eq_u32 vcc, 0, v6
    s_nop 1
    v_cndmask_b32 v192, 0, v5, vcc
    v_cmp_eq_u32 vcc, 1, v6
    s_nop 1
    v_cndmask_b32 v193, 0, v5, vcc
    v_cmp_eq_u32 vcc, 2, v6
    s_nop 1
    v_cndmask_b32 v194, 0, v5, vcc
    v_cmp_eq_u32 vcc, 3, v6
    s_nop 1
    v_cndmask_b32 v195, 0, v5, vcc
    s_cmp_lg_u32 s34, 0
    s_cbranch_scc1 polld_178
    v_mov_b32 v5, 20
    s_mov_b32 s79, 0
    s_mov_b64 exec, 1
poll_177:
    global_load_dword v6, v5, s[6:7] sc1
    s_add_u32 s79, s79, 1
    s_cmp_gt_u32 s79, 0x80000
    s_cbranch_scc1 L_fail
    s_waitcnt vmcnt(0)
    v_cmp_le_u32 vcc, 32, v6
    s_cbranch_vccnz polld_178
    s_sleep 4
    s_branch poll_177
polld_178:
    s_mov_b64 exec, -1
    s_barrier
    v_lshlrev_b32 v5, 2, v30
    v_add_u32 v5, 69632, v5
    v_add_u32 v6, 4096, v5
    global_load_dwordx2 v[16:17], v5, s[4:5] sc1
    global_load_dwordx2 v[18:19], v5, s[4:5] offset:2048 sc1
    global_load_dwordx2 v[20:21], v6, s[4:5] sc1
    global_load_dwordx2 v[22:23], v6, s[4:5] offset:2048 sc1
    v_lshlrev_b32 v30, 1, v30
    global_load_dword v25, v30, s[26:27]
    s_and_b32 s70, s34, 1
    s_lshr_b32 s71, s34, 1
    s_mul_i32 s72, s70, 4352
    s_lshl_b32 s73, s71, 7
    s_add_u32 s72, s72, s73
    v_mul_u32_u24 v5, 272, v3
    v_lshl_add_u32 v26, v2, 3, v5
    v_add_u32 v26, s72, v26
    v_lshl_add_u32 v27, v2, 4, v5
    v_mul_u32_u24 v28, 2064, v3
    v_lshl_add_u32 v28, v2, 4, v28
    s_lshl_b32 s73, s34, 8
    s_add_u32 s72, s73, 16384
    v_add_u32 v28, s72, v28
    s_mul_i32 s72, s34, 16512
    s_add_u32 s72, s72, 16384
    v_add_u32 v196, s72, v4
    s_lshl_b32 s72, s34, 19
    s_lshl_b32 s74, s36, 11
    s_add_u32 s72, s72, s74
    v_add_u32 v197, s72, v4
    v_lshlrev_b32 v5, 10, v2
    v_lshl_add_u32 v5, v3, 4, v5
    s_lshl_b32 s72, s36, 16
    s_add_u32 s72, s72, s73
    v_add_u32 v29, s72, v5
    s_lshl_b32 s72, s71, 10
    v_lshl_add_u32 v31, v1, 2, s72
    v_lshrrev_b32 v5, 2, v3
    v_and_b32 v6, 1, v3
    v_lshl_add_u32 v5, v5, 1, v6
    v_lshlrev_b32 v5, 8, v5
    v_lshl_add_u32 v198, v2, 4, v5
    s_lshl_b32 s72, s70, 4
    v_add_u32 v5, s72, v3
    v_lshlrev_b32 v6, 2, v2
    v_sub_u32 v5, v5, v6
    v_cmp_gt_i32 s[80:81], 0, v5
    v_cmp_gt_i32 s[82:83], 1, v5
    v_cmp_gt_i32 s[84:85], 2, v5
    v_cmp_gt_i32 s[86:87], 3, v5
    v_cmp_gt_i32 s[88:89], 16, v5
    v_cmp_gt_i32 s[90:91], 17, v5
    v_cmp_gt_i32 s[92:93], 18, v5
    v_cmp_gt_i32 s[94:95], 19, v5
    s_lshl_b32 s72, s35, 21
    s_add_u32 s72, s72, 83886080
    s_add_u32 s42, s4, s72
    s_addc_u32 s43, s5, 0
    s_lshl_b32 s72, s35, 7
    s_add_u32 s96, s72, 20480
    s_add_u32 s97, s72, 24576
    s_mov_b32 s98, 1069066811
    s_mov_b32 s99, 1035273459
    v_mov_b32 v113, 0
    v_mov_b32 v115, 0
    v_mov_b32 v117, 0
    v_mov_b32 v119, 0
    v_mov_b32 v137, 0
    s_waitcnt vmcnt(0)
    v_lshlrev_b32 v24, 16, v25
    v_and_b32 v25, 0xffff0000, v25
    s_cmp_lg_u32 s37, 0
    s_cbranch_scc1 L_ef1
    s_sub_u32 s40, s35, 1
    s_mov_b32 s41, 0
efloop_179:
    s_lshl_b32 s74, s40, 5
    s_add_u32 s74, s74, s36
    s_lshl_b32 s75, s74, 10
    v_add_u32 v14, s75, v30
    global_load_dword v15, v14, s[18:19]
    s_lshl_b32 s70, s40, 18
    s_lshl_b32 s71, s36, 13
    s_add_u32 s70, s70, s71
    s_and_b32 s72, s34, 1
    s_lshl_b32 s72, s72, 12
    s_add_u32 s72, s72, s70
    s_add_u32 s72, s72, 33554432
    s_add_u32 s46, s4, s72
    s_addc_u32 s47, s5, 0
    s_add_u32 s72, s70, 50331648
    s_add_u32 s48, s4, s72
    s_addc_u32 s49, s5, 0
    s_lshr_b32 s72, s34, 1
    s_lshl_b32 s72, s72, 12
    s_add_u32 s72, s72, s70
    s_add_u32 s72, s72, 67108864
    s_add_u32 s50, s4, s72
    s_addc_u32 s51, s5, 0
    s_lshr_b32 s72, s70, 1
    s_add_u32 s72, s72, 8388608
    s_add_u32 s52, s4, s72
    s_addc_u32 s53, s5, 0
    s_lshr_b32 s72, s70, 2
    s_add_u32 s72, s72, 16842752
    s_add_u32 s54, s4, s72
    s_addc_u32 s55, s5, 0
    s_lshr_b32 s72, s40, 1
    s_lshl_b32 s72, s72, 7
    s_add_u32 s72, s72, 0
    s_cmp_lg_u32 s34, 0
    s_cbranch_scc1 polld_181
    v_mov_b32 v5, s72
    s_mov_b32 s79, 0
    s_mov_b64 exec, 1
poll_180:
    global_load_dword v6, v5, s[4:5] sc1
    s_add_u32 s79, s79, 1
    s_cmp_gt_u32 s79, 0x80000
    s_cbranch_scc1 L_fail
    s_waitcnt vmcnt(0)
    v_cmp_le_u32 vcc, 64, v6
    s_cbranch_vccnz polld_181
    s_sleep 4
    s_branch poll_180
polld_181:
    s_mov_b64 exec, -1
    s_barrier
    s_add_u32 s72, s72, 36864
    s_cmp_lg_u32 s34, 0
    s_cbranch_scc1 polld_183
    v_mov_b32 v5, s72
    s_mov_b32 s79, 0
    s_mov_b64 exec, 1
poll_182:
    global_load_dword v6, v5, s[4:5] sc1
    s_add_u32 s79, s79, 1
    s_cmp_gt_u32 s79, 0x80000
    s_cbranch_scc1 L_fail
    s_waitcnt vmcnt(0)
    v_cmp_le_u32 vcc, 32, v6
    s_cbranch_vccnz polld_183
    s_sleep 4
    s_branch poll_182
polld_183:
    s_mov_b64 exec, -1
    s_barrier
    v_add_u32 v7, 4096, v4
    global_load_dwordx4 v[32:35], v4, s[46:47] offset:0 sc1
    global_load_dwordx4 v[36:39], v4, s[46:47] offset:1024 sc1
    global_load_dwordx4 v[40:43], v4, s[46:47] offset:2048 sc1
    global_load_dwordx4 v[44:47], v4, s[46:47] offset:3072 sc1
    global_load_dwordx4 v[48:51], v4, s[48:49] offset:0 sc1
    global_load_dwordx4 v[52:55], v4, s[48:49] offset:1024 sc1
    global_load_dwordx4 v[56:59], v4, s[48:49] offset:2048 sc1
    global_load_dwordx4 v[60:63], v4, s[48:49] offset:3072 sc1
    global_load_dwordx4 v[64:67], v7, s[48:49] offset:0 sc1
    global_load_dwordx4 v[68:71], v7, s[48:49] offset:1024 sc1
    global_load_dwordx4 v[72:75], v7, s[48:49] offset:2048 sc1
    global_load_dwordx4 v[76:79], v7, s[48:49] offset:3072 sc1
    global_load_dwordx4 v[96:99], v4, s[50:51] offset:0 sc1
    global_load_dwordx4 v[100:103], v4, s[50:51] offset:1024 sc1
    global_load_dwordx4 v[104:107], v4, s[50:51] offset:2048 sc1
    global_load_dwordx4 v[108:111], v4, s[50:51] offset:3072 sc1
    v_and_b32 v5, 31, v1
    v_lshl_add_u32 v5, v5, 2, s97
    s_mov_b32 s79, 0
pf_184:
    global_load_dword v6, v5, s[4:5] sc1
    s_add_u32 s79, s79, 1
    s_cmp_gt_u32 s79, 0x80000
    s_cbranch_scc1 L_fail
    s_waitcnt vmcnt(0)
    v_cmp_gt_u32 vcc, s41, v6
    s_cbranch_vccnz pf_184
    v_mfma_f32_16x16x32_bf16 v[124:127], v[48:51], v[32:35], 0
    v_mfma_f32_16x16x32_bf16 v[124:127], v[52:55], v[36:39], v[124:127]
    v_mfma_f32_16x16x32_bf16 v[124:127], v[56:59], v[40:43], v[124:127]
    v_mfma_f32_16x16x32_bf16 v[124:127], v[60:63], v[44:47], v[124:127]
    v_mfma_f32_16x16x32_bf16 v[128:131], v[64:67], v[32:35], 0
    v_mfma_f32_16x16x32_bf16 v[128:131], v[68:71], v[36:39], v[128:131]
    v_mfma_f32_16x16x32_bf16 v[128:131], v[72:75], v[40:43], v[128:131]
    v_mfma_f32_16x16x32_bf16 v[128:131], v[76:79], v[44:47], v[128:131]
    s_nop 3
    v_cvt_pk_bf16_f32 v125, v124, v125
    v_lshlrev_b32 v124, 16, v125
    v_and_b32 v125, 0xffff0000, v125
    v_mul_f32 v124, s99, v124
    v_mul_f32 v125, s99, v125
    v_cvt_pk_bf16_f32 v125, v124, v125
    v_lshlrev_b32 v124, 16, v125
    v_and_b32 v125, 0xffff0000, v125
    v_cvt_pk_bf16_f32 v127, v126, v127
    v_lshlrev_b32 v126, 16, v127
    v_and_b32 v127, 0xffff0000, v127
    v_mul_f32 v126, s99, v126
    v_mul_f32 v127, s99, v127
    v_cvt_pk_bf16_f32 v127, v126, v127
    v_lshlrev_b32 v126, 16, v127
    v_and_b32 v127, 0xffff0000, v127
    v_cvt_pk_bf16_f32 v129, v128, v129
    v_lshlrev_b32 v128, 16, v129
    v_and_b32 v129, 0xffff0000, v129
    v_mul_f32 v128, s99, v128
    v_mul_f32 v129, s99, v129
    v_cvt_pk_bf16_f32 v129, v128, v129
    v_lshlrev_b32 v128, 16, v129
    v_and_b32 v129, 0xffff0000, v129
    v_cvt_pk_bf16_f32 v131, v130, v131
    v_lshlrev_b32 v130, 16, v131
    v_and_b32 v131, 0xffff0000, v131
    v_mul_f32 v130, s99, v130
    v_mul_f32 v131, s99, v131
    v_cvt_pk_bf16_f32 v131, v130, v131
    v_lshlrev_b32 v130, 16, v131
    v_and_b32 v131, 0xffff0000, v131
    v_mov_b32 v5, 3463342888
    v_cndmask_b32 v124, v124, v5, s[80:81]
    v_cndmask_b32 v125, v125, v5, s[82:83]
    v_cndmask_b32 v126, v126, v5, s[84:85]
    v_cndmask_b32 v127, v127, v5, s[86:87]
    v_cndmask_b32 v128, v128, v5, s[88:89]
    v_cndmask_b32 v129, v129, v5, s[90:91]
    v_cndmask_b32 v130, v130, v5, s[92:93]
    v_cndmask_b32 v131, v131, v5, s[94:95]
    s_lshl_b32 s72, s36, 7
    s_add_u32 s72, s72, 12288
    s_add_u32 s73, s40, 1
    s_cmp_ge_u32 s40, 62
    s_cselect_b32 s73, 61, s73
    s_cmp_lg_u32 s34, 0
    s_cbranch_scc1 polld_186
    v_mov_b32 v5, s72
    s_mov_b32 s79, 0
    s_mov_b64 exec, 1
poll_185:
    global_load_dword v6, v5, s[4:5] sc1
    s_add_u32 s79, s79, 1
    s_cmp_gt_u32 s79, 0x80000
    s_cbranch_scc1 L_fail
    s_waitcnt vmcnt(0)
    v_cmp_le_u32 vcc, s73, v6
    s_cbranch_vccnz polld_186
    s_sleep 2
    s_branch poll_185
polld_186:
    s_mov_b64 exec, -1
    s_barrier
    s_mov_b32 s79, 0
    s_mov_b32 s73, 2139193217
kmp_187:
    global_load_dwordx4 v[80:83], v198, s[52:53] offset:0 sc1
    global_load_dwordx4 v[84:87], v198, s[52:53] offset:64 sc1
    global_load_dwordx4 v[88:91], v198, s[52:53] offset:128 sc1
    global_load_dwordx4 v[92:95], v198, s[52:53] offset:192 sc1
    global_load_dword v112, v31, s[54:55] offset:0 sc1
    global_load_dword v114, v31, s[54:55] offset:256 sc1
    global_load_dword v116, v31, s[54:55] offset:512 sc1
    global_load_dword v118, v31, s[54:55] offset:768 sc1
    s_cmp_lt_u32 s40, 62
    s_cbranch_scc1 kmok_188
    s_add_u32 s79, s79, 1
    s_cmp_gt_u32 s79, 0x80000
    s_cbranch_scc1 L_fail
    s_waitcnt vmcnt(0)
    v_xor_b32 v160, s73, v80
    v_xor_b32 v161, s73, v81
    v_xor_b32 v162, s73, v82
    v_xor_b32 v163, s73, v83
    v_xor_b32 v164, s73, v84
    v_xor_b32 v165, s73, v85
    v_xor_b32 v166, s73, v86
    v_xor_b32 v167, s73, v87
    v_xor_b32 v168, s73, v88
    v_xor_b32 v169, s73, v89
    v_xor_b32 v170, s73, v90
    v_xor_b32 v171, s73, v91
    v_xor_b32 v172, s73, v92
    v_xor_b32 v173, s73, v93
    v_xor_b32 v174, s73, v94
    v_xor_b32 v175, s73, v95
    v_xor_b32 v176, s73, v112
    v_xor_b32 v177, s73, v114
    v_xor_b32 v178, s73, v116
    v_xor_b32 v179, s73, v118
    v_min3_u32 v5, v160, v161, v162
    v_min3_u32 v5, v5, v163, v164
    v_min3_u32 v5, v5, v165, v166
    v_min3_u32 v5, v5, v167, v168
    v_min3_u32 v5, v5, v169, v170
    v_min3_u32 v5, v5, v171, v172
    v_min3_u32 v5, v5, v173, v174
    v_min3_u32 v5, v5, v175, v176
    v_min3_u32 v5, v5, v177, v178
    v_min_u32 v5, v5, v179
    v_cmp_eq_u32 vcc, 0, v5
    s_cbranch_vccnz kmp_187
kmok_188:
    s_waitcnt vmcnt(7)
    v_mfma_f32_16x16x32_bf16 v[120:123], v[80:83], v[32:35], 0
    s_waitcnt vmcnt(6)
    v_mfma_f32_16x16x32_bf16 v[120:123], v[84:87], v[36:39], v[120:123]
    s_waitcnt vmcnt(5)
    v_mfma_f32_16x16x32_bf16 v[120:123], v[88:91], v[40:43], v[120:123]
    s_waitcnt vmcnt(4)
    v_mfma_f32_16x16x32_bf16 v[120:123], v[92:95], v[44:47], v[120:123]
    s_nop 7
    v_cvt_pk_bf16_f32 v121, v120, v121
    v_lshlrev_b32 v120, 16, v121
    v_and_b32 v121, 0xffff0000, v121
    v_mul_f32 v120, s99, v120
    v_mul_f32 v121, s99, v121
    v_cvt_pk_bf16_f32 v121, v120, v121
    v_lshlrev_b32 v120, 16, v121
    v_and_b32 v121, 0xffff0000, v121
    v_max3_f32 v5, v124, v125, v126
    v_max3_f32 v5, v5, v127, v128
    v_max3_f32 v5, v5, v129, v130
    v_max3_f32 v5, v5, v131, v120
    v_max_f32 v5, v5, v121
    v_mov_b32 v6, v5
    s_nop 1
    v_permlane32_swap_b32 v6, v5
    v_max_f32 v5, v6, v5
    v_mov_b32 v6, v5
    s_nop 1
    v_permlane16_swap_b32 v6, v5
    v_max_f32 v5, v6, v5
    v_sub_f32 v124, v124, v5
    v_mul_f32 v124, s98, v124
    v_exp_f32 v124, v124
    v_sub_f32 v125, v125, v5
    v_mul_f32 v125, s98, v125
    v_exp_f32 v125, v125
    v_sub_f32 v126, v126, v5
    v_mul_f32 v126, s98, v126
    v_exp_f32 v126, v126
    v_sub_f32 v127, v127, v5
    v_mul_f32 v127, s98, v127
    v_exp_f32 v127, v127
    v_sub_f32 v128, v128, v5
    v_mul_f32 v128, s98, v128
    v_exp_f32 v128, v128
    v_sub_f32 v129, v129, v5
    v_mul_f32 v129, s98, v129
    v_exp_f32 v129, v129
    v_sub_f32 v130, v130, v5
    v_mul_f32 v130, s98, v130
    v_exp_f32 v130, v130
    v_sub_f32 v131, v131, v5
    v_mul_f32 v131, s98, v131
    v_exp_f32 v131, v131
    v_sub_f32 v120, v120, v5
    v_mul_f32 v120, s98, v120
    v_exp_f32 v120, v120
    v_sub_f32 v121, v121, v5
    v_mul_f32 v121, s98, v121
    v_exp_f32 v121, v121
    v_add_f32 v7, v124, v125
    v_add_f32 v7, v7, v126
    v_add_f32 v7, v7, v127
    v_add_f32 v7, v7, v128
    v_add_f32 v7, v7, v129
    v_add_f32 v7, v7, v130
    v_add_f32 v7, v7, v131
    v_add_f32 v7, v7, v120
    v_add_f32 v7, v7, v121
    v_mov_b32 v6, v7
    s_nop 1
    v_permlane32_swap_b32 v6, v7
    v_add_f32 v7, v6, v7
    v_mov_b32 v6, v7
    s_nop 1
    v_permlane16_swap_b32 v6, v7
    v_add_f32 v7, v6, v7
    v_rcp_f32 v7, v7
    s_nop 0
    v_mul_f32 v124, v124, v7
    v_mul_f32 v125, v125, v7
    v_mul_f32 v126, v126, v7
    v_mul_f32 v127, v127, v7
    v_mul_f32 v128, v128, v7
    v_mul_f32 v129, v129, v7
    v_mul_f32 v130, v130, v7
    v_mul_f32 v131, v131, v7
    v_mul_f32 v120, v120, v7
    v_mul_f32 v121, v121, v7
    v_cvt_pk_bf16_f32 v132, v124, v125
    v_cvt_pk_bf16_f32 v133, v126, v127
    v_cvt_pk_bf16_f32 v134, v128, v129
    v_cvt_pk_bf16_f32 v135, v130, v131
    v_cvt_pk_bf16_f32 v136, v120, v121
    s_nop 0
    v_mfma_f32_16x16x32_bf16 v[140:143], v[96:99], v[132:135], 0
    v_mfma_f32_16x16x32_bf16 v[144:147], v[100:103], v[132:135], 0
    v_mfma_f32_16x16x32_bf16 v[148:151], v[104:107], v[132:135], 0
    v_mfma_f32_16x16x32_bf16 v[152:155], v[108:111], v[132:135], 0
    s_waitcnt vmcnt(0)
    s_nop 1
    v_mfma_f32_16x16x16_bf16 v[140:143], v[112:113], v[136:137], v[140:143]
    v_mfma_f32_16x16x16_bf16 v[144:147], v[114:115], v[136:137], v[144:147]
    v_mfma_f32_16x16x16_bf16 v[148:151], v[116:117], v[136:137], v[148:151]
    v_mfma_f32_16x16x16_bf16 v[152:155], v[118:119], v[136:137], v[152:155]
    s_nop 4
    v_cvt_pk_bf16_f32 v140, v140, v141
    v_cvt_pk_bf16_f32 v141, v142, v143
    ds_write_b64 v26, v[140:141] offset:0
    v_cvt_pk_bf16_f32 v144, v144, v145
    v_cvt_pk_bf16_f32 v145, v146, v147
    ds_write_b64 v26, v[144:145] offset:32
    v_cvt_pk_bf16_f32 v148, v148, v149
    v_cvt_pk_bf16_f32 v149, v150, v151
    ds_write_b64 v26, v[148:149] offset:64
    v_cvt_pk_bf16_f32 v152, v152, v153
    v_cvt_pk_bf16_f32 v153, v154, v155
    ds_write_b64 v26, v[152:153] offset:96
    s_waitcnt lgkmcnt(0)
    s_barrier
    ds_read_b128 v[160:163], v27 offset:0
    ds_read_b128 v[164:167], v27 offset:64
    ds_read_b128 v[168:171], v27 offset:128
    ds_read_b128 v[172:175], v27 offset:192
    ds_read_b128 v[176:179], v27 offset:4352
    ds_read_b128 v[180:183], v27 offset:4416
    ds_read_b128 v[184:187], v27 offset:4480
    ds_read_b128 v[188:191], v27 offset:4544
    s_waitcnt lgkmcnt(0)
    v_mfma_f32_16x16x32_bf16 v[32:35], a[0:3], v[160:163], 0
    v_mfma_f32_16x16x32_bf16 v[32:35], a[4:7], v[164:167], v[32:35]
    v_mfma_f32_16x16x32_bf16 v[32:35], a[8:11], v[168:171], v[32:35]
    v_mfma_f32_16x16x32_bf16 v[32:35], a[12:15], v[172:175], v[32:35]
    v_mfma_f32_16x16x32_bf16 v[36:39], a[16:19], v[160:163], 0
    v_mfma_f32_16x16x32_bf16 v[36:39], a[20:23], v[164:167], v[36:39]
    v_mfma_f32_16x16x32_bf16 v[36:39], a[24:27], v[168:171], v[36:39]
    v_mfma_f32_16x16x32_bf16 v[36:39], a[28:31], v[172:175], v[36:39]
    v_mfma_f32_16x16x32_bf16 v[40:43], a[32:35], v[160:163], 0
    v_mfma_f32_16x16x32_bf16 v[40:43], a[36:39], v[164:167], v[40:43]
    v_mfma_f32_16x16x32_bf16 v[40:43], a[40:43], v[168:171], v[40:43]
    v_mfma_f32_16x16x32_bf16 v[40:43], a[44:47], v[172:175], v[40:43]
    v_mfma_f32_16x16x32_bf16 v[44:47], a[48:51], v[160:163], 0
    v_mfma_f32_16x16x32_bf16 v[44:47], a[52:55], v[164:167], v[44:47]
    v_mfma_f32_16x16x32_bf16 v[44:47], a[56:59], v[168:171], v[44:47]
    v_mfma_f32_16x16x32_bf16 v[44:47], a[60:63], v[172:175], v[44:47]
    v_cvt_pk_bf16_f32 v140, v32, v33
    v_lshlrev_b32 v120, 16, v140
    v_and_b32 v121, 0xffff0000, v140
    v_sub_f32 v32, v32, v120
    v_sub_f32 v33, v33, v121
    v_cvt_pk_bf16_f32 v144, v32, v33
    v_cvt_pk_bf16_f32 v141, v34, v35
    v_lshlrev_b32 v120, 16, v141
    v_and_b32 v121, 0xffff0000, v141
    v_sub_f32 v34, v34, v120
    v_sub_f32 v35, v35, v121
    v_cvt_pk_bf16_f32 v145, v34, v35
    v_cvt_pk_bf16_f32 v142, v36, v37
    v_lshlrev_b32 v120, 16, v142
    v_and_b32 v121, 0xffff0000, v142
    v_sub_f32 v36, v36, v120
    v_sub_f32 v37, v37, v121
    v_cvt_pk_bf16_f32 v146, v36, v37
    v_cvt_pk_bf16_f32 v143, v38, v39
    v_lshlrev_b32 v120, 16, v143
    v_and_b32 v121, 0xffff0000, v143
    v_sub_f32 v38, v38, v120
    v_sub_f32 v39, v39, v121
    v_cvt_pk_bf16_f32 v147, v38, v39
    ds_write_b128 v28, v[140:143] offset:0
    ds_write_b128 v28, v[144:147] offset:1024
    v_mfma_f32_16x16x32_bf16 v[48:51], a[64:67], v[160:163], 0
    v_mfma_f32_16x16x32_bf16 v[48:51], a[68:71], v[164:167], v[48:51]
    v_mfma_f32_16x16x32_bf16 v[48:51], a[72:75], v[168:171], v[48:51]
    v_mfma_f32_16x16x32_bf16 v[48:51], a[76:79], v[172:175], v[48:51]
    v_mfma_f32_16x16x32_bf16 v[52:55], a[80:83], v[160:163], 0
    v_mfma_f32_16x16x32_bf16 v[52:55], a[84:87], v[164:167], v[52:55]
    v_mfma_f32_16x16x32_bf16 v[52:55], a[88:91], v[168:171], v[52:55]
    v_mfma_f32_16x16x32_bf16 v[52:55], a[92:95], v[172:175], v[52:55]
    v_cvt_pk_bf16_f32 v148, v40, v41
    v_lshlrev_b32 v120, 16, v148
    v_and_b32 v121, 0xffff0000, v148
    v_sub_f32 v40, v40, v120
    v_sub_f32 v41, v41, v121
    v_cvt_pk_bf16_f32 v152, v40, v41
    v_cvt_pk_bf16_f32 v149, v42, v43
    v_lshlrev_b32 v120, 16, v149
    v_and_b32 v121, 0xffff0000, v149
    v_sub_f32 v42, v42, v120
    v_sub_f32 v43, v43, v121
    v_cvt_pk_bf16_f32 v153, v42, v43
    v_cvt_pk_bf16_f32 v150, v44, v45
    v_lshlrev_b32 v120, 16, v150
    v_and_b32 v121, 0xffff0000, v150
    v_sub_f32 v44, v44, v120
    v_sub_f32 v45, v45, v121
    v_cvt_pk_bf16_f32 v154, v44, v45
    v_cvt_pk_bf16_f32 v151, v46, v47
    v_lshlrev_b32 v120, 16, v151
    v_and_b32 v121, 0xffff0000, v151
    v_sub_f32 v46, v46, v120
    v_sub_f32 v47, v47, v121
    v_cvt_pk_bf16_f32 v155, v46, v47
    ds_write_b128 v28, v[148:151] offset:64
    ds_write_b128 v28, v[152:155] offset:1088
    v_mfma_f32_16x16x32_bf16 v[56:59], a[96:99], v[160:163], 0
    v_mfma_f32_16x16x32_bf16 v[56:59], a[100:103], v[164:167], v[56:59]
    v_mfma_f32_16x16x32_bf16 v[56:59], a[104:107], v[168:171], v[56:59]
    v_mfma_f32_16x16x32_bf16 v[56:59], a[108:111], v[172:175], v[56:59]
    v_mfma_f32_16x16x32_bf16 v[60:63], a[112:115], v[160:163], 0
    v_mfma_f32_16x16x32_bf16 v[60:63], a[116:119], v[164:167], v[60:63]
    v_mfma_f32_16x16x32_bf16 v[60:63], a[120:123], v[168:171], v[60:63]
    v_mfma_f32_16x16x32_bf16 v[60:63], a[124:127], v[172:175], v[60:63]
    v_cvt_pk_bf16_f32 v140, v48, v49
    v_lshlrev_b32 v120, 16, v140
    v_and_b32 v121, 0xffff0000, v140
    v_sub_f32 v48, v48, v120
    v_sub_f32 v49, v49, v121
    v_cvt_pk_bf16_f32 v144, v48, v49
    v_cvt_pk_bf16_f32 v141, v50, v51
    v_lshlrev_b32 v120, 16, v141
    v_and_b32 v121, 0xffff0000, v141
    v_sub_f32 v50, v50, v120
    v_sub_f32 v51, v51, v121
    v_cvt_pk_bf16_f32 v145, v50, v51
    v_cvt_pk_bf16_f32 v142, v52, v53
    v_lshlrev_b32 v120, 16, v142
    v_and_b32 v121, 0xffff0000, v142
    v_sub_f32 v52, v52, v120
    v_sub_f32 v53, v53, v121
    v_cvt_pk_bf16_f32 v146, v52, v53
    v_cvt_pk_bf16_f32 v143, v54, v55
    v_lshlrev_b32 v120, 16, v143
    v_and_b32 v121, 0xffff0000, v143
    v_sub_f32 v54, v54, v120
    v_sub_f32 v55, v55, v121
    v_cvt_pk_bf16_f32 v147, v54, v55
    ds_write_b128 v28, v[140:143] offset:128
    ds_write_b128 v28, v[144:147] offset:1152
    v_mfma_f32_16x16x32_bf16 v[64:67], a[0:3], v[176:179], 0
    v_mfma_f32_16x16x32_bf16 v[64:67], a[4:7], v[180:183], v[64:67]
    v_mfma_f32_16x16x32_bf16 v[64:67], a[8:11], v[184:187], v[64:67]
    v_mfma_f32_16x16x32_bf16 v[64:67], a[12:15], v[188:191], v[64:67]
    v_mfma_f32_16x16x32_bf16 v[68:71], a[16:19], v[176:179], 0
    v_mfma_f32_16x16x32_bf16 v[68:71], a[20:23], v[180:183], v[68:71]
    v_mfma_f32_16x16x32_bf16 v[68:71], a[24:27], v[184:187], v[68:71]
    v_mfma_f32_16x16x32_bf16 v[68:71], a[28:31], v[188:191], v[68:71]
    v_cvt_pk_bf16_f32 v148, v56, v57
    v_lshlrev_b32 v120, 16, v148
    v_and_b32 v121, 0xffff0000, v148
    v_sub_f32 v56, v56, v120
    v_sub_f32 v57, v57, v121
    v_cvt_pk_bf16_f32 v152, v56, v57
    v_cvt_pk_bf16_f32 v149, v58, v59
    v_lshlrev_b32 v120, 16, v149
    v_and_b32 v121, 0xffff0000, v149
    v_sub_f32 v58, v58, v120
    v_sub_f32 v59, v59, v121
    v_cvt_pk_bf16_f32 v153, v58, v59
    v_cvt_pk_bf16_f32 v150, v60, v61
    v_lshlrev_b32 v120, 16, v150
    v_and_b32 v121, 0xffff0000, v150
    v_sub_f32 v60, v60, v120
    v_sub_f32 v61, v61, v121
    v_cvt_pk_bf16_f32 v154, v60, v61
    v_cvt_pk_bf16_f32 v151, v62, v63
    v_lshlrev_b32 v120, 16, v151
    v_and_b32 v121, 0xffff0000, v151
    v_sub_f32 v62, v62, v120
    v_sub_f32 v63, v63, v121
    v_cvt_pk_bf16_f32 v155, v62, v63
    ds_write_b128 v28, v[148:151] offset:192
    ds_write_b128 v28, v[152:155] offset:1216
    v_mfma_f32_16x16x32_bf16 v[72:75], a[32:35], v[176:179], 0
    v_mfma_f32_16x16x32_bf16 v[72:75], a[36:39], v[180:183], v[72:75]
    v_mfma_f32_16x16x32_bf16 v[72:75], a[40:43], v[184:187], v[72:75]
    v_mfma_f32_16x16x32_bf16 v[72:75], a[44:47], v[188:191], v[72:75]
    v_mfma_f32_16x16x32_bf16 v[76:79], a[48:51], v[176:179], 0
    v_mfma_f32_16x16x32_bf16 v[76:79], a[52:55], v[180:183], v[76:79]
    v_mfma_f32_16x16x32_bf16 v[76:79], a[56:59], v[184:187], v[76:79]
    v_mfma_f32_16x16x32_bf16 v[76:79], a[60:63], v[188:191], v[76:79]
    v_cvt_pk_bf16_f32 v140, v64, v65
    v_lshlrev_b32 v120, 16, v140
    v_and_b32 v121, 0xffff0000, v140
    v_sub_f32 v64, v64, v120
    v_sub_f32 v65, v65, v121
    v_cvt_pk_bf16_f32 v144, v64, v65
    v_cvt_pk_bf16_f32 v141, v66, v67
    v_lshlrev_b32 v120, 16, v141
    v_and_b32 v121, 0xffff0000, v141
    v_sub_f32 v66, v66, v120
    v_sub_f32 v67, v67, v121
    v_cvt_pk_bf16_f32 v145, v66, v67
    v_cvt_pk_bf16_f32 v142, v68, v69
    v_lshlrev_b32 v120, 16, v142
    v_and_b32 v121, 0xffff0000, v142
    v_sub_f32 v68, v68, v120
    v_sub_f32 v69, v69, v121
    v_cvt_pk_bf16_f32 v146, v68, v69
    v_cvt_pk_bf16_f32 v143, v70, v71
    v_lshlrev_b32 v120, 16, v143
    v_and_b32 v121, 0xffff0000, v143
    v_sub_f32 v70, v70, v120
    v_sub_f32 v71, v71, v121
    v_cvt_pk_bf16_f32 v147, v70, v71
    ds_write_b128 v28, v[140:143] offset:33024
    ds_write_b128 v28, v[144:147] offset:34048
    v_mfma_f32_16x16x32_bf16 v[80:83], a[64:67], v[176:179], 0
    v_mfma_f32_16x16x32_bf16 v[80:83], a[68:71], v[180:183], v[80:83]
    v_mfma_f32_16x16x32_bf16 v[80:83], a[72:75], v[184:187], v[80:83]
    v_mfma_f32_16x16x32_bf16 v[80:83], a[76:79], v[188:191], v[80:83]
    v_mfma_f32_16x16x32_bf16 v[84:87], a[80:83], v[176:179], 0
    v_mfma_f32_16x16x32_bf16 v[84:87], a[84:87], v[180:183], v[84:87]
    v_mfma_f32_16x16x32_bf16 v[84:87], a[88:91], v[184:187], v[84:87]
    v_mfma_f32_16x16x32_bf16 v[84:87], a[92:95], v[188:191], v[84:87]
    v_cvt_pk_bf16_f32 v148, v72, v73
    v_lshlrev_b32 v120, 16, v148
    v_and_b32 v121, 0xffff0000, v148
    v_sub_f32 v72, v72, v120
    v_sub_f32 v73, v73, v121
    v_cvt_pk_bf16_f32 v152, v72, v73
    v_cvt_pk_bf16_f32 v149, v74, v75
    v_lshlrev_b32 v120, 16, v149
    v_and_b32 v121, 0xffff0000, v149
    v_sub_f32 v74, v74, v120
    v_sub_f32 v75, v75, v121
    v_cvt_pk_bf16_f32 v153, v74, v75
    v_cvt_pk_bf16_f32 v150, v76, v77
    v_lshlrev_b32 v120, 16, v150
    v_and_b32 v121, 0xffff0000, v150
    v_sub_f32 v76, v76, v120
    v_sub_f32 v77, v77, v121
    v_cvt_pk_bf16_f32 v154, v76, v77
    v_cvt_pk_bf16_f32 v151, v78, v79
    v_lshlrev_b32 v120, 16, v151
    v_and_b32 v121, 0xffff0000, v151
    v_sub_f32 v78, v78, v120
    v_sub_f32 v79, v79, v121
    v_cvt_pk_bf16_f32 v155, v78, v79
    ds_write_b128 v28, v[148:151] offset:33088
    ds_write_b128 v28, v[152:155] offset:34112
    v_mfma_f32_16x16x32_bf16 v[88:91], a[96:99], v[176:179], 0
    v_mfma_f32_16x16x32_bf16 v[88:91], a[100:103], v[180:183], v[88:91]
    v_mfma_f32_16x16x32_bf16 v[88:91], a[104:107], v[184:187], v[88:91]
    v_mfma_f32_16x16x32_bf16 v[88:91], a[108:111], v[188:191], v[88:91]
    v_mfma_f32_16x16x32_bf16 v[92:95], a[112:115], v[176:179], 0
    v_mfma_f32_16x16x32_bf16 v[92:95], a[116:119], v[180:183], v[92:95]
    v_mfma_f32_16x16x32_bf16 v[92:95], a[120:123], v[184:187], v[92:95]
    v_mfma_f32_16x16x32_bf16 v[92:95], a[124:127], v[188:191], v[92:95]
    v_cvt_pk_bf16_f32 v140, v80, v81
    v_lshlrev_b32 v120, 16, v140
    v_and_b32 v121, 0xffff0000, v140
    v_sub_f32 v80, v80, v120
    v_sub_f32 v81, v81, v121
    v_cvt_pk_bf16_f32 v144, v80, v81
    v_cvt_pk_bf16_f32 v141, v82, v83
    v_lshlrev_b32 v120, 16, v141
    v_and_b32 v121, 0xffff0000, v141
    v_sub_f32 v82, v82, v120
    v_sub_f32 v83, v83, v121
    v_cvt_pk_bf16_f32 v145, v82, v83
    v_cvt_pk_bf16_f32 v142, v84, v85
    v_lshlrev_b32 v120, 16, v142
    v_and_b32 v121, 0xffff0000, v142
    v_sub_f32 v84, v84, v120
    v_sub_f32 v85, v85, v121
    v_cvt_pk_bf16_f32 v146, v84, v85
    v_cvt_pk_bf16_f32 v143, v86, v87
    v_lshlrev_b32 v120, 16, v143
    v_and_b32 v121, 0xffff0000, v143
    v_sub_f32 v86, v86, v120
    v_sub_f32 v87, v87, v121
    v_cvt_pk_bf16_f32 v147, v86, v87
    ds_write_b128 v28, v[140:143] offset:33152
    ds_write_b128 v28, v[144:147] offset:34176
    v_cvt_pk_bf16_f32 v148, v88, v89
    v_lshlrev_b32 v120, 16, v148
    v_and_b32 v121, 0xffff0000, v148
    v_sub_f32 v88, v88, v120
    v_sub_f32 v89, v89, v121
    v_cvt_pk_bf16_f32 v152, v88, v89
    v_cvt_pk_bf16_f32 v149, v90, v91
    v_lshlrev_b32 v120, 16, v149
    v_and_b32 v121, 0xffff0000, v149
    v_sub_f32 v90, v90, v120
    v_sub_f32 v91, v91, v121
    v_cvt_pk_bf16_f32 v153, v90, v91
    v_cvt_pk_bf16_f32 v150, v92, v93
    v_lshlrev_b32 v120, 16, v150
    v_and_b32 v121, 0xffff0000, v150
    v_sub_f32 v92, v92, v120
    v_sub_f32 v93, v93, v121
    v_cvt_pk_bf16_f32 v154, v92, v93
    v_cvt_pk_bf16_f32 v151, v94, v95
    v_lshlrev_b32 v120, 16, v151
    v_and_b32 v121, 0xffff0000, v151
    v_sub_f32 v94, v94, v120
    v_sub_f32 v95, v95, v121
    v_cvt_pk_bf16_f32 v155, v94, v95
    ds_write_b128 v28, v[148:151] offset:33216
    ds_write_b128 v28, v[152:155] offset:34240
    s_waitcnt lgkmcnt(0)
    s_barrier
    ds_read_b128 v[32:35], v196 offset:0
    ds_read_b128 v[36:39], v196 offset:1024
    ds_read_b128 v[40:43], v196 offset:2064
    ds_read_b128 v[44:47], v196 offset:3088
    ds_read_b128 v[48:51], v196 offset:4128
    ds_read_b128 v[52:55], v196 offset:5152
    ds_read_b128 v[56:59], v196 offset:6192
    ds_read_b128 v[60:63], v196 offset:7216
    ds_read_b128 v[64:67], v196 offset:8256
    ds_read_b128 v[68:71], v196 offset:9280
    ds_read_b128 v[72:75], v196 offset:10320
    ds_read_b128 v[76:79], v196 offset:11344
    ds_read_b128 v[80:83], v196 offset:12384
    ds_read_b128 v[84:87], v196 offset:13408
    ds_read_b128 v[88:91], v196 offset:14448
    ds_read_b128 v[92:95], v196 offset:15472
    v_mov_b32 v7, v197
    s_waitcnt lgkmcnt(14)
    global_store_dwordx4 v7, v[32:35], s[42:43] offset:0
    global_store_dwordx4 v7, v[36:39], s[42:43] offset:1024
    v_add_u32 v7, 0x10000, v7
    s_waitcnt lgkmcnt(12)
    global_store_dwordx4 v7, v[40:43], s[42:43] offset:0
    global_store_dwordx4 v7, v[44:47], s[42:43] offset:1024
    v_add_u32 v7, 0x10000, v7
    s_waitcnt lgkmcnt(10)
    global_store_dwordx4 v7, v[48:51], s[42:43] offset:0
    global_store_dwordx4 v7, v[52:55], s[42:43] offset:1024
    v_add_u32 v7, 0x10000, v7
    s_waitcnt lgkmcnt(8)
    global_store_dwordx4 v7, v[56:59], s[42:43] offset:0
    global_store_dwordx4 v7, v[60:63], s[42:43] offset:1024
    v_add_u32 v7, 0x10000, v7
    s_waitcnt lgkmcnt(6)
    global_store_dwordx4 v7, v[64:67], s[42:43] offset:0
    global_store_dwordx4 v7, v[68:71], s[42:43] offset:1024
    v_add_u32 v7, 0x10000, v7
    s_waitcnt lgkmcnt(4)
    global_store_dwordx4 v7, v[72:75], s[42:43] offset:0
    global_store_dwordx4 v7, v[76:79], s[42:43] offset:1024
    v_add_u32 v7, 0x10000, v7
    s_waitcnt lgkmcnt(2)
    global_store_dwordx4 v7, v[80:83], s[42:43] offset:0
    global_store_dwordx4 v7, v[84:87], s[42:43] offset:1024
    v_add_u32 v7, 0x10000, v7
    s_waitcnt lgkmcnt(0)
    global_store_dwordx4 v7, v[88:91], s[42:43] offset:0
    global_store_dwordx4 v7, v[92:95], s[42:43] offset:1024
    s_add_u32 s41, s41, 1
    s_waitcnt vmcnt(0)
    s_barrier
    s_cmp_lg_u32 s34, 0
    s_cbranch_scc1 sf_189
    s_lshl_b32 s70, s36, 2
    s_add_u32 s70, s70, s96
    v_mov_b32 v5, s70
    v_mov_b32 v6, s41
    s_mov_b64 exec, 1
    global_store_dword v5, v6, s[4:5]
    s_mov_b64 exec, -1
sf_189:
    v_and_b32 v5, 31, v1
    v_lshl_add_u32 v5, v5, 2, s96
    s_mov_b32 s79, 0
pf_190:
    global_load_dword v6, v5, s[4:5] sc1
    s_add_u32 s79, s79, 1
    s_cmp_gt_u32 s79, 0x80000
    s_cbranch_scc1 L_fail
    s_waitcnt vmcnt(0)
    v_cmp_gt_u32 vcc, s41, v6
    s_cbranch_vccnz pf_190
    v_mov_b32 v7, v29
    global_load_dwordx4 v[40:43], v7, s[42:43] sc1
    v_add_u32 v7, 4096, v7
    global_load_dwordx4 v[44:47], v7, s[42:43] sc1
    v_add_u32 v7, 4096, v7
    global_load_dwordx4 v[48:51], v7, s[42:43] sc1
    v_add_u32 v7, 4096, v7
    global_load_dwordx4 v[52:55], v7, s[42:43] sc1
    v_add_u32 v7, 4096, v7
    global_load_dwordx4 v[56:59], v7, s[42:43] sc1
    v_add_u32 v7, 4096, v7
    global_load_dwordx4 v[60:63], v7, s[42:43] sc1
    v_add_u32 v7, 4096, v7
    global_load_dwordx4 v[64:67], v7, s[42:43] sc1
    v_add_u32 v7, 4096, v7
    global_load_dwordx4 v[68:71], v7, s[42:43] sc1
    v_add_u32 v7, 4096, v7
    global_load_dwordx4 v[72:75], v7, s[42:43] sc1
    v_add_u32 v7, 4096, v7
    global_load_dwordx4 v[76:79], v7, s[42:43] sc1
    v_add_u32 v7, 4096, v7
    global_load_dwordx4 v[80:83], v7, s[42:43] sc1
    v_add_u32 v7, 4096, v7
    global_load_dwordx4 v[84:87], v7, s[42:43] sc1
    v_add_u32 v7, 4096, v7
    global_load_dwordx4 v[88:91], v7, s[42:43] sc1
    v_add_u32 v7, 4096, v7
    global_load_dwordx4 v[92:95], v7, s[42:43] sc1
    v_add_u32 v7, 4096, v7
    global_load_dwordx4 v[160:163], v7, s[42:43] sc1
    v_add_u32 v7, 4096, v7
    global_load_dwordx4 v[164:167], v7, s[42:43] sc1
    s_waitcnt vmcnt(15)
    v_mfma_f32_16x16x32_bf16 v[32:35], v[192:195], v[40:43], 0
    s_waitcnt vmcnt(14)
    v_mfma_f32_16x16x32_bf16 v[32:35], v[192:195], v[44:47], v[32:35]
    s_waitcnt vmcnt(13)
    v_mfma_f32_16x16x32_bf16 v[32:35], v[192:195], v[48:51], v[32:35]
    s_waitcnt vmcnt(12)
    v_mfma_f32_16x16x32_bf16 v[32:35], v[192:195], v[52:55], v[32:35]
    s_waitcnt vmcnt(11)
    v_mfma_f32_16x16x32_bf16 v[32:35], v[192:195], v[56:59], v[32:35]
    s_waitcnt vmcnt(10)
    v_mfma_f32_16x16x32_bf16 v[32:35], v[192:195], v[60:63], v[32:35]
    s_waitcnt vmcnt(9)
    v_mfma_f32_16x16x32_bf16 v[32:35], v[192:195], v[64:67], v[32:35]
    s_waitcnt vmcnt(8)
    v_mfma_f32_16x16x32_bf16 v[32:35], v[192:195], v[68:71], v[32:35]
    s_waitcnt vmcnt(7)
    v_mfma_f32_16x16x32_bf16 v[32:35], v[192:195], v[72:75], v[32:35]
    s_waitcnt vmcnt(6)
    v_mfma_f32_16x16x32_bf16 v[32:35], v[192:195], v[76:79], v[32:35]
    s_waitcnt vmcnt(5)
    v_mfma_f32_16x16x32_bf16 v[32:35], v[192:195], v[80:83], v[32:35]
    s_waitcnt vmcnt(4)
    v_mfma_f32_16x16x32_bf16 v[32:35], v[192:195], v[84:87], v[32:35]
    s_waitcnt vmcnt(3)
    v_mfma_f32_16x16x32_bf16 v[32:35], v[192:195], v[88:91], v[32:35]
    s_waitcnt vmcnt(2)
    v_mfma_f32_16x16x32_bf16 v[32:35], v[192:195], v[92:95], v[32:35]
    s_waitcnt vmcnt(1)
    v_mfma_f32_16x16x32_bf16 v[32:35], v[192:195], v[160:163], v[32:35]
    s_waitcnt vmcnt(0)
    v_mfma_f32_16x16x32_bf16 v[32:35], v[192:195], v[164:167], v[32:35]
    s_nop 7
    v_permlane32_swap_b32 v32, v34
    v_permlane32_swap_b32 v33, v35
    v_cvt_pk_bf16_f32 v33, v32, v33
    v_lshlrev_b32 v32, 16, v33
    v_and_b32 v33, 0xffff0000, v33
    v_pk_mul_f32 v[32:33], v[32:33], v[16:17]
    v_cvt_pk_bf16_f32 v33, v32, v33
    v_lshlrev_b32 v32, 16, v33
    v_and_b32 v33, 0xffff0000, v33
    v_lshlrev_b32 v40, 16, v15
    v_and_b32 v41, 0xffff0000, v15
    v_pk_add_f32 v[40:41], v[40:41], v[32:33]
    v_cvt_pk_bf16_f32 v36, v40, v41
    v_add_u32 v37, 3145728, v14
    global_store_dword v37, v36, s[4:5] sc1
    v_lshlrev_b32 v40, 16, v36
    v_and_b32 v41, 0xffff0000, v36
    v_add_f32 v42, v40, v41
    s_nop 1
    v_add_f32_dpp v42, v42, v42 row_ror:8 row_mask:0xf bank_mask:0xf
    s_nop 1
    v_add_f32_dpp v42, v42, v42 row_ror:4 row_mask:0xf bank_mask:0xf
    s_nop 1
    v_add_f32_dpp v42, v42, v42 row_ror:2 row_mask:0xf bank_mask:0xf
    s_nop 1
    v_add_f32_dpp v42, v42, v42 row_ror:1 row_mask:0xf bank_mask:0xf
    v_mov_b32 v48, v42
    s_nop 1
    v_permlane32_swap_b32 v48, v42
    v_add_f32 v42, v48, v42
    v_mov_b32 v48, v42
    s_nop 1
    v_permlane16_swap_b32 v48, v42
    v_add_f32 v42, v48, v42
    s_lshl_b32 s70, s34, 2
    s_add_u32 s70, s70, 9216
    v_mov_b32 v48, s70
    ds_write_b32 v48, v42
    v_mov_b32 v48, 9216
    s_waitcnt lgkmcnt(0)
    s_barrier
    ds_read_b128 v[50:53], v48
    s_waitcnt lgkmcnt(0)
    v_add_f32 v50, v50, v51
    v_add_f32 v52, v52, v53
    v_add_f32 v42, v50, v52
    s_cmp_lg_u32 s34, 0
    s_cbranch_scc1 sf_191
    s_lshl_b32 s70, s36, 2
    s_add_u32 s70, s70, s97
    v_mov_b32 v5, s70
    v_mov_b32 v6, s41
    s_mov_b64 exec, 1
    global_store_dword v5, v6, s[4:5]
    s_mov_b64 exec, -1
sf_191:
    v_mul_f32 v42, 989855744, v42
    v_sub_f32 v44, v40, v42
    v_sub_f32 v45, v41, v42
    v_mul_f32 v44, v44, v44
    v_fmac_f32 v44, v45, v45
    s_nop 1
    v_add_f32_dpp v44, v44, v44 row_ror:8 row_mask:0xf bank_mask:0xf
    s_nop 1
    v_add_f32_dpp v44, v44, v44 row_ror:4 row_mask:0xf bank_mask:0xf
    s_nop 1
    v_add_f32_dpp v44, v44, v44 row_ror:2 row_mask:0xf bank_mask:0xf
    s_nop 1
    v_add_f32_dpp v44, v44, v44 row_ror:1 row_mask:0xf bank_mask:0xf
    v_mov_b32 v48, v44
    s_nop 1
    v_permlane32_swap_b32 v48, v44
    v_add_f32 v44, v48, v44
    v_mov_b32 v48, v44
    s_nop 1
    v_permlane16_swap_b32 v48, v44
    v_add_f32 v44, v48, v44
    s_lshl_b32 s70, s34, 2
    s_add_u32 s70, s70, 9232
    v_mov_b32 v48, s70
    ds_write_b32 v48, v44
    v_mov_b32 v48, 9232
    s_waitcnt lgkmcnt(0)
    s_barrier
    ds_read_b128 v[50:53], v48
    s_waitcnt lgkmcnt(0)
    v_add_f32 v50, v50, v51
    v_add_f32 v52, v52, v53
    v_add_f32 v44, v50, v52
    v_mul_f32 v44, 989855744, v44
    v_cvt_pk_bf16_f32 v44, v44, v44
    v_lshlrev_b32 v44, 16, v44
    v_add_f32 v44, 925353388, v44
    v_cvt_pk_bf16_f32 v44, v44, v44
    v_lshlrev_b32 v44, 16, v44
    v_sqrt_f32 v44, v44
    s_nop 0
    v_cvt_pk_bf16_f32 v44, v44, v44
    v_lshlrev_b32 v44, 16, v44
    v_rcp_f32 v44, v44
    v_cvt_pk_bf16_f32 v42, v42, v42
    v_lshlrev_b32 v42, 16, v42
    v_sub_f32 v32, v40, v42
    v_sub_f32 v33, v41, v42
    v_cvt_pk_bf16_f32 v33, v32, v33
    v_lshlrev_b32 v32, 16, v33
    v_and_b32 v33, 0xffff0000, v33
    v_mul_f32 v32, v32, v44
    v_mul_f32 v33, v33, v44
    v_cvt_pk_bf16_f32 v33, v32, v33
    v_lshlrev_b32 v32, 16, v33
    v_and_b32 v33, 0xffff0000, v33
    v_pk_mul_f32 v[32:33], v[32:33], v[20:21]
    v_cvt_pk_bf16_f32 v33, v32, v33
    v_lshlrev_b32 v32, 16, v33
    v_and_b32 v33, 0xffff0000, v33
    v_pk_add_f32 v[32:33], v[32:33], v[18:19]
    v_cvt_pk_bf16_f32 v36, v32, v33
    v_add_u32 v37, 5242880, v14
    global_store_dword v37, v36, s[4:5] sc1
    v_lshlrev_b32 v32, 16, v36
    v_and_b32 v33, 0xffff0000, v36
    v_mul_f32 v42, v32, v24
    v_fmac_f32 v42, v33, v25
    v_pk_mul_f32 v[32:33], v[32:33], v[22:23]
    v_cvt_pk_bf16_f32 v33, v32, v33
    v_lshlrev_b32 v32, 16, v33
    v_and_b32 v33, 0xffff0000, v33
    v_pk_add_f32 v[32:33], v[32:33], v[40:41]
    v_cvt_pk_bf16_f32 v36, v32, v33
    global_store_dword v14, v36, s[20:21] sc1
    s_waitcnt vmcnt(0)
    v_add_f32_dpp v42, v42, v42 row_ror:8 row_mask:0xf bank_mask:0xf
    s_nop 1
    v_add_f32_dpp v42, v42, v42 row_ror:4 row_mask:0xf bank_mask:0xf
    s_nop 1
    v_add_f32_dpp v42, v42, v42 row_ror:2 row_mask:0xf bank_mask:0xf
    s_nop 1
    v_add_f32_dpp v42, v42, v42 row_ror:1 row_mask:0xf bank_mask:0xf
    v_mov_b32 v48, v42
    s_nop 1
    v_permlane32_swap_b32 v48, v42
    v_add_f32 v42, v48, v42
    v_mov_b32 v48, v42
    s_nop 1
    v_permlane16_swap_b32 v48, v42
    v_add_f32 v42, v48, v42
    s_lshl_b32 s70, s34, 2
    s_add_u32 s70, s70, 9248
    v_mov_b32 v48, s70
    ds_write_b32 v48, v42
    v_mov_b32 v48, 9248
    s_waitcnt lgkmcnt(0)
    s_barrier
    ds_read_b128 v[50:53], v48
    s_waitcnt lgkmcnt(0)
    v_add_f32 v50, v50, v51
    v_add_f32 v52, v52, v53
    v_add_f32 v42, v50, v52
    v_cvt_pk_bf16_f32 v42, v42, v42
    v_lshlrev_b32 v42, 16, v42
    v_ashrrev_i32 v48, 31, v42
    v_or_b32 v48, 0x80000000, v48
    v_xor_b32 v42, v42, v48
    v_and_b32 v42, 0xffff0000, v42
    s_sub_u32 s75, 6143, s74
    v_or_b32 v42, s75, v42
    s_lshl_b32 s74, s74, 2
    s_add_u32 s74, s74, 49152
    v_mov_b32 v48, s74
    s_mov_b64 exec, 1
    global_store_dword v48, v42, s[4:5] sc1
    s_mov_b64 exec, -1
    s_add_u32 s40, s40, 7
    s_cmp_lt_u32 s40, 64
    s_cbranch_scc1 efloop_179
    s_cmp_lg_u32 s35, 2
    s_cbranch_scc1 L_exit
    s_mov_b32 s44, 0
    s_cmp_eq_u32 s34, 3
    s_cselect_b32 s48, 0xff000000, 0
    s_cselect_b32 s49, -1, 0
round_192:
    s_lshl_b32 s70, s34, 11
    s_add_u32 s70, s70, 49152
    v_add_u32 v5, s70, v4
    s_mov_b32 s79, 0
keys_194:
    global_load_dwordx4 v[32:35], v5, s[4:5] sc1
    global_load_dwordx4 v[36:39], v5, s[4:5] offset:1024 sc1
    s_add_u32 s79, s79, 1
    s_cmp_gt_u32 s79, 0x80000
    s_cbranch_scc1 L_fail
    s_sleep 2
    s_waitcnt vmcnt(0)
    v_cndmask_b32 v36, v36, 1, s[48:49]
    v_cndmask_b32 v37, v37, 1, s[48:49]
    v_cndmask_b32 v38, v38, 1, s[48:49]
    v_cndmask_b32 v39, v39, 1, s[48:49]
    v_min3_u32 v40, v32, v33, v34
    v_min3_u32 v40, v40, v35, v36
    v_min3_u32 v40, v40, v37, v38
    v_min_u32 v40, v40, v39
    v_cmp_eq_u32 vcc, 0, v40
    s_cbranch_vccnz keys_194
    v_max_u32 v40, v32, v33
    v_min_u32 v41, v32, v33
    v_med3_u32 v41, v40, v41, v34
    v_max_u32 v40, v40, v34
    v_med3_u32 v41, v40, v41, v35
    v_max_u32 v40, v40, v35
    v_med3_u32 v41, v40, v41, v36
    v_max_u32 v40, v40, v36
    v_med3_u32 v41, v40, v41, v37
    v_max_u32 v40, v40, v37
    v_med3_u32 v41, v40, v41, v38
    v_max_u32 v40, v40, v38
    v_med3_u32 v41, v40, v41, v39
    v_max_u32 v40, v40, v39
    s_nop 1
    v_mov_b32_dpp v42, v40 row_ror:8 row_mask:0xf bank_mask:0xf
    v_mov_b32_dpp v43, v41 row_ror:8 row_mask:0xf bank_mask:0xf
    v_min_u32 v44, v40, v42
    v_max_u32 v40, v40, v42
    v_max3_u32 v41, v44, v41, v43
    s_nop 0
    v_mov_b32_dpp v42, v40 row_ror:4 row_mask:0xf bank_mask:0xf
    v_mov_b32_dpp v43, v41 row_ror:4 row_mask:0xf bank_mask:0xf
    v_min_u32 v44, v40, v42
    v_max_u32 v40, v40, v42
    v_max3_u32 v41, v44, v41, v43
    s_nop 0
    v_mov_b32_dpp v42, v40 row_ror:2 row_mask:0xf bank_mask:0xf
    v_mov_b32_dpp v43, v41 row_ror:2 row_mask:0xf bank_mask:0xf
    v_min_u32 v44, v40, v42
    v_max_u32 v40, v40, v42
    v_max3_u32 v41, v44, v41, v43
    s_nop 0
    v_mov_b32_dpp v42, v40 row_ror:1 row_mask:0xf bank_mask:0xf
    v_mov_b32_dpp v43, v41 row_ror:1 row_mask:0xf bank_mask:0xf
    v_min_u32 v44, v40, v42
    v_max_u32 v40, v40, v42
    v_max3_u32 v41, v44, v41, v43
    v_mov_b32 v42, v40
    v_mov_b32 v43, v41
    s_nop 0
    v_permlane16_swap_b32 v42, v40
    v_permlane16_swap_b32 v43, v41
    v_min_u32 v44, v40, v42
    v_max_u32 v40, v40, v42
    v_max3_u32 v41, v44, v41, v43
    v_mov_b32 v42, v40
    v_mov_b32 v43, v41
    s_nop 0
    v_permlane32_swap_b32 v42, v40
    v_permlane32_swap_b32 v43, v41
    v_min_u32 v44, v40, v42
    v_max_u32 v40, v40, v42
    v_max3_u32 v41, v44, v41, v43
    s_lshl_b32 s70, s34, 3
    s_add_u32 s70, s70, 9280
    v_mov_b32 v5, s70
    ds_write_b64 v5, v[40:41]
    v_mov_b32 v5, 9280
    s_waitcnt lgkmcnt(0)
    s_barrier
    ds_read_b128 v[32:35], v5
    ds_read_b128 v[36:39], v5 offset:16
    s_waitcnt lgkmcnt(0)
    v_mov_b32 v40, v32
    v_mov_b32 v41, v33
    v_mov_b32 v42, v34
    v_mov_b32 v43, v35
    v_min_u32 v44, v40, v42
    v_max_u32 v40, v40, v42
    v_max3_u32 v41, v44, v41, v43
    v_mov_b32 v42, v36
    v_mov_b32 v43, v37
    v_min_u32 v44, v40, v42
    v_max_u32 v40, v40, v42
    v_max3_u32 v41, v44, v41, v43
    v_mov_b32 v42, v38
    v_mov_b32 v43, v39
    v_min_u32 v44, v40, v42
    v_max_u32 v40, v40, v42
    v_max3_u32 v41, v44, v41, v43
    v_readfirstlane_b32 s40, v40
    v_readfirstlane_b32 s41, v41
    s_barrier
    s_cmp_eq_u32 s44, 0
    s_cbranch_scc1 fgo_195
    s_cmp_lg_u32 s40, s45
    s_cbranch_scc1 fgo_195
    s_cmp_eq_u32 s41, s46
    s_cbranch_scc1 fwrite_193
fgo_195:
    s_lshl_b32 s47, s44, 13
    s_and_b32 s42, s40, 0x7ff
    s_sub_u32 s42, 2047, s42
    s_lshl_b32 s42, s42, 10
    s_and_b32 s43, s41, 0x7ff
    s_sub_u32 s43, 2047, s43
    s_lshl_b32 s43, s43, 10
    v_mov_b32 v5, s42
    v_mov_b32 v6, s43
    v_and_b32 v7, 1, v3
    v_cmp_eq_u32 vcc, 1, v7
    s_nop 1
    v_cndmask_b32 v8, v5, v6, vcc
    s_lshl_b32 s76, s36, 2
    s_add_u32 s76, s76, s34
    s_cmp_ge_u32 s76, 86
    s_cbranch_scc1 ffn_s1_196
    v_lshl_add_u32 v9, v2, 4, v8
    v_add_u32 v9, 5242880, v9
    global_load_dwordx4 v[48:51], v9, s[4:5] offset:0 sc1
    global_load_dwordx4 v[52:55], v9, s[4:5] offset:64 sc1
    global_load_dwordx4 v[56:59], v9, s[4:5] offset:128 sc1
    global_load_dwordx4 v[60:63], v9, s[4:5] offset:192 sc1
    global_load_dwordx4 v[64:67], v9, s[4:5] offset:256 sc1
    global_load_dwordx4 v[68:71], v9, s[4:5] offset:320 sc1
    global_load_dwordx4 v[72:75], v9, s[4:5] offset:384 sc1
    global_load_dwordx4 v[76:79], v9, s[4:5] offset:448 sc1
    global_load_dwordx4 v[80:83], v9, s[4:5] offset:512 sc1
    global_load_dwordx4 v[84:87], v9, s[4:5] offset:576 sc1
    global_load_dwordx4 v[88:91], v9, s[4:5] offset:640 sc1
    global_load_dwordx4 v[92:95], v9, s[4:5] offset:704 sc1
    global_load_dwordx4 v[96:99], v9, s[4:5] offset:768 sc1
    global_load_dwordx4 v[100:103], v9, s[4:5] offset:832 sc1
    global_load_dwordx4 v[104:107], v9, s[4:5] offset:896 sc1
    global_load_dwordx4 v[108:111], v9, s[4:5] offset:960 sc1
    s_waitcnt vmcnt(15)
    v_mfma_f32_16x16x32_bf16 v[32:35], v[48:51], a[128:131], 0
    v_mfma_f32_16x16x32_bf16 v[36:39], v[48:51], a[192:195], 0
    s_waitcnt vmcnt(14)
    v_mfma_f32_16x16x32_bf16 v[32:35], v[52:55], a[132:135], v[32:35]
    v_mfma_f32_16x16x32_bf16 v[36:39], v[52:55], a[196:199], v[36:39]
    s_waitcnt vmcnt(13)
    v_mfma_f32_16x16x32_bf16 v[32:35], v[56:59], a[136:139], v[32:35]
    v_mfma_f32_16x16x32_bf16 v[36:39], v[56:59], a[200:203], v[36:39]
    s_waitcnt vmcnt(12)
    v_mfma_f32_16x16x32_bf16 v[32:35], v[60:63], a[140:143], v[32:35]
    v_mfma_f32_16x16x32_bf16 v[36:39], v[60:63], a[204:207], v[36:39]
    s_waitcnt vmcnt(11)
    v_mfma_f32_16x16x32_bf16 v[32:35], v[64:67], a[144:147], v[32:35]
    v_mfma_f32_16x16x32_bf16 v[36:39], v[64:67], a[208:211], v[36:39]
    s_waitcnt vmcnt(10)
    v_mfma_f32_16x16x32_bf16 v[32:35], v[68:71], a[148:151], v[32:35]
    v_mfma_f32_16x16x32_bf16 v[36:39], v[68:71], a[212:215], v[36:39]
    s_waitcnt vmcnt(9)
    v_mfma_f32_16x16x32_bf16 v[32:35], v[72:75], a[152:155], v[32:35]
    v_mfma_f32_16x16x32_bf16 v[36:39], v[72:75], a[216:219], v[36:39]
    s_waitcnt vmcnt(8)
    v_mfma_f32_16x16x32_bf16 v[32:35], v[76:79], a[156:159], v[32:35]
    v_mfma_f32_16x16x32_bf16 v[36:39], v[76:79], a[220:223], v[36:39]
    s_waitcnt vmcnt(7)
    v_mfma_f32_16x16x32_bf16 v[32:35], v[80:83], a[160:163], v[32:35]
    v_mfma_f32_16x16x32_bf16 v[36:39], v[80:83], a[224:227], v[36:39]
    s_waitcnt vmcnt(6)
    v_mfma_f32_16x16x32_bf16 v[32:35], v[84:87], a[164:167], v[32:35]
    v_mfma_f32_16x16x32_bf16 v[36:39], v[84:87], a[228:231], v[36:39]
    s_waitcnt vmcnt(5)
    v_mfma_f32_16x16x32_bf16 v[32:35], v[88:91], a[168:171], v[32:35]
    v_mfma_f32_16x16x32_bf16 v[36:39], v[88:91], a[232:235], v[36:39]
    s_waitcnt vmcnt(4)
    v_mfma_f32_16x16x32_bf16 v[32:35], v[92:95], a[172:175], v[32:35]
    v_mfma_f32_16x16x32_bf16 v[36:39], v[92:95], a[236:239], v[36:39]
    s_waitcnt vmcnt(3)
    v_mfma_f32_16x16x32_bf16 v[32:35], v[96:99], a[176:179], v[32:35]
    v_mfma_f32_16x16x32_bf16 v[36:39], v[96:99], a[240:243], v[36:39]
    s_waitcnt vmcnt(2)
    v_mfma_f32_16x16x32_bf16 v[32:35], v[100:103], a[180:183], v[32:35]
    v_mfma_f32_16x16x32_bf16 v[36:39], v[100:103], a[244:247], v[36:39]
    s_waitcnt vmcnt(1)
    v_mfma_f32_16x16x32_bf16 v[32:35], v[104:107], a[184:187], v[32:35]
    v_mfma_f32_16x16x32_bf16 v[36:39], v[104:107], a[248:251], v[36:39]
    s_waitcnt vmcnt(0)
    v_mfma_f32_16x16x32_bf16 v[32:35], v[108:111], a[188:191], v[32:35]
    v_mfma_f32_16x16x32_bf16 v[36:39], v[108:111], a[252:255], v[36:39]
    s_nop 6
    v_cvt_pk_bf16_f32 v33, v32, v33
    v_lshlrev_b32 v32, 16, v33
    v_and_b32 v33, 0xffff0000, v33
    v_cvt_pk_bf16_f32 v37, v36, v37
    v_lshlrev_b32 v36, 16, v37
    v_and_b32 v37, 0xffff0000, v37
    s_mov_b32 s70, 3216550459
    v_mul_f32 v34, s70, v32
    v_exp_f32 v34, v34
    s_nop 0
    v_add_f32 v34, 1.0, v34
    v_rcp_f32 v34, v34
    s_nop 0
    v_mul_f32 v32, v32, v34
    v_mul_f32 v35, s70, v33
    v_exp_f32 v35, v35
    s_nop 0
    v_add_f32 v35, 1.0, v35
    v_rcp_f32 v35, v35
    s_nop 0
    v_mul_f32 v33, v33, v35
    v_cvt_pk_bf16_f32 v33, v32, v33
    v_lshlrev_b32 v32, 16, v33
    v_and_b32 v33, 0xffff0000, v33
    v_pk_mul_f32 v[32:33], v[32:33], v[36:37]
    s_nop 1
    v_mov_b32_dpp v34, v32 quad_perm:[1,0,3,2] row_mask:0xf bank_mask:0xf
    v_cvt_pk_bf16_f32 v32, v32, v34
    v_min_u32 v32, -2, v32
    v_mov_b32_dpp v35, v33 quad_perm:[1,0,3,2] row_mask:0xf bank_mask:0xf
    v_cvt_pk_bf16_f32 v33, v33, v35
    v_min_u32 v33, -2, v33
    s_lshl_b32 s70, s76, 5
    s_add_u32 s70, s70, 131072
    s_add_u32 s70, s70, s47
    v_lshl_add_u32 v9, v3, 1, s70
    s_mov_b64 exec, 0x5555
    global_store_dword v9, v32, s[4:5]
    global_store_dword v9, v33, s[4:5] offset:2752
    s_mov_b64 exec, -1
ffn_s1_196:
    s_lshl_b32 s70, s36, 5
    v_lshl_add_u32 v10, v3, 1, s70
    v_add_u32 v120, s42, v10
    v_add_u32 v11, 5242880, v120
    global_load_ushort v112, v11, s[4:5] sc1
    v_add_u32 v11, 3145728, v120
    global_load_ushort v114, v11, s[4:5] sc1
    v_add_u32 v121, s43, v10
    v_add_u32 v11, 5242880, v121
    global_load_ushort v113, v11, s[4:5] sc1
    v_add_u32 v11, 3145728, v121
    global_load_ushort v115, v11, s[4:5] sc1
    v_lshlrev_b32 v11, 1, v10
    v_add_u32 v11, 75776, v11
    global_load_dword v116, v11, s[4:5] sc1
    v_mul_u32_u24 v9, 2752, v7
    v_lshl_add_u32 v9, v2, 4, v9
    s_lshl_b32 s70, s34, 6
    s_add_u32 s70, s70, 131072
    s_add_u32 s70, s70, s47
    v_add_u32 v9, s70, v9
    s_cmp_eq_u32 s34, 3
    s_cselect_b32 s77, 0, 256
    v_add_u32 v11, s77, v9
    s_mov_b32 s79, 0
actpoll_197:
    global_load_dwordx4 v[48:51], v9, s[4:5] offset:0 sc1
    global_load_dwordx4 v[52:55], v9, s[4:5] offset:256 sc1
    global_load_dwordx4 v[56:59], v9, s[4:5] offset:512 sc1
    global_load_dwordx4 v[60:63], v9, s[4:5] offset:768 sc1
    global_load_dwordx4 v[64:67], v9, s[4:5] offset:1024 sc1
    global_load_dwordx4 v[68:71], v9, s[4:5] offset:1280 sc1
    global_load_dwordx4 v[72:75], v9, s[4:5] offset:1536 sc1
    global_load_dwordx4 v[76:79], v9, s[4:5] offset:1792 sc1
    global_load_dwordx4 v[80:83], v9, s[4:5] offset:2048 sc1
    global_load_dwordx4 v[84:87], v9, s[4:5] offset:2304 sc1
    global_load_dwordx4 v[88:91], v11, s[4:5] offset:2304 sc1
    s_add_u32 s79, s79, 1
    s_cmp_gt_u32 s79, 0x80000
    s_cbranch_scc1 L_fail
    s_waitcnt vmcnt(0)
    v_max3_u32 v12, v48, v49, v50
    v_max3_u32 v12, v12, v51, v52
    v_max3_u32 v12, v12, v53, v54
    v_max3_u32 v12, v12, v55, v56
    v_max3_u32 v12, v12, v57, v58
    v_max3_u32 v12, v12, v59, v60
    v_max3_u32 v12, v12, v61, v62
    v_max3_u32 v12, v12, v63, v64
    v_max3_u32 v12, v12, v65, v66
    v_max3_u32 v12, v12, v67, v68
    v_max3_u32 v12, v12, v69, v70
    v_max3_u32 v12, v12, v71, v72
    v_max3_u32 v12, v12, v73, v74
    v_max3_u32 v12, v12, v75, v76
    v_max3_u32 v12, v12, v77, v78
    v_max3_u32 v12, v12, v79, v80
    v_max3_u32 v12, v12, v81, v82
    v_max3_u32 v12, v12, v83, v84
    v_max3_u32 v12, v12, v85, v86
    v_max3_u32 v12, v12, v87, v88
    v_max3_u32 v12, v12, v89, v90
    v_max_u32 v12, v12, v91
    v_cmp_eq_u32 vcc, -1, v12
    s_cbranch_vccnz actpoll_197
    v_mfma_f32_16x16x32_bf16 v[32:35], v[48:51], v[200:203], 0
    v_mfma_f32_16x16x32_bf16 v[32:35], v[52:55], v[204:207], v[32:35]
    v_mfma_f32_16x16x32_bf16 v[32:35], v[56:59], v[208:211], v[32:35]
    v_mfma_f32_16x16x32_bf16 v[32:35], v[60:63], v[212:215], v[32:35]
    v_mfma_f32_16x16x32_bf16 v[32:35], v[64:67], v[216:219], v[32:35]
    v_mfma_f32_16x16x32_bf16 v[32:35], v[68:71], v[220:223], v[32:35]
    v_mfma_f32_16x16x32_bf16 v[32:35], v[72:75], v[224:227], v[32:35]
    v_mfma_f32_16x16x32_bf16 v[32:35], v[76:79], v[228:231], v[32:35]
    v_mfma_f32_16x16x32_bf16 v[32:35], v[80:83], v[232:235], v[32:35]
    v_mfma_f32_16x16x32_bf16 v[32:35], v[84:87], v[236:239], v[32:35]
    s_cmp_eq_u32 s34, 3
    s_cbranch_scc1 y3_198
    v_mfma_f32_16x16x32_bf16 v[32:35], v[88:91], v[240:243], v[32:35]
y3_198:
    s_nop 7
    s_lshl_b32 s70, s34, 7
    s_add_u32 s70, s70, 9344
    v_lshl_add_u32 v9, v3, 3, s70
    s_mov_b64 exec, 0xffff
    ds_write_b64 v9, v[32:33]
    s_mov_b64 exec, -1
    v_lshlrev_b32 v9, 3, v3
    v_add_u32 v9, 9344, v9
    s_waitcnt lgkmcnt(0)
    s_barrier
    s_cmp_lg_u32 s34, 0
    s_cbranch_scc1 fdone_199
    ds_read_b64 v[32:33], v9 offset:0
    ds_read_b64 v[34:35], v9 offset:128
    ds_read_b64 v[36:37], v9 offset:256
    ds_read_b64 v[38:39], v9 offset:384
    s_waitcnt lgkmcnt(0)
    v_pk_add_f32 v[32:33], v[32:33], v[34:35]
    v_pk_add_f32 v[36:37], v[36:37], v[38:39]
    v_pk_add_f32 v[32:33], v[32:33], v[36:37]
    v_cvt_pk_bf16_f32 v33, v32, v33
    v_lshlrev_b32 v32, 16, v33
    v_and_b32 v33, 0xffff0000, v33
    s_and_b32 s70, s40, 0xffff0000
    s_xor_b32 s71, s70, 0x80000000
    s_not_b32 s72, s70
    s_and_b32 s72, s72, 0xffff0000
    s_bitcmp1_b32 s70, 31
    s_cselect_b32 s70, s71, s72
    v_mov_b32 v34, s70
    v_mul_f32 v34, 3216550459, v34
    v_exp_f32 v34, v34
    s_nop 0
    v_add_f32 v34, 1.0, v34
    v_rcp_f32 v34, v34
    s_and_b32 s70, s41, 0xffff0000
    s_xor_b32 s71, s70, 0x80000000
    s_not_b32 s72, s70
    s_and_b32 s72, s72, 0xffff0000
    s_bitcmp1_b32 s70, 31
    s_cselect_b32 s70, s71, s72
    v_mov_b32 v35, s70
    v_mul_f32 v35, 3216550459, v35
    v_exp_f32 v35, v35
    s_nop 0
    v_add_f32 v35, 1.0, v35
    v_rcp_f32 v35, v35
    s_nop 0
    v_cvt_pk_bf16_f32 v35, v34, v35
    v_lshlrev_b32 v34, 16, v35
    v_and_b32 v35, 0xffff0000, v35
    v_pk_mul_f32 v[32:33], v[32:33], v[34:35]
    v_cvt_pk_bf16_f32 v33, v32, v33
    v_lshlrev_b32 v32, 16, v33
    v_and_b32 v33, 0xffff0000, v33
    v_lshlrev_b32 v112, 16, v112
    v_lshlrev_b32 v113, 16, v113
    v_lshlrev_b32 v114, 16, v114
    v_lshlrev_b32 v115, 16, v115
    v_pk_add_f32 v[32:33], v[32:33], v[112:113]
    v_cvt_pk_bf16_f32 v33, v32, v33
    v_lshlrev_b32 v32, 16, v33
    v_and_b32 v33, 0xffff0000, v33
    v_mul_f32 v32, v32, v116
    v_mul_f32 v33, v33, v116
    v_cvt_pk_bf16_f32 v33, v32, v33
    v_lshlrev_b32 v32, 16, v33
    v_and_b32 v33, 0xffff0000, v33
    v_pk_add_f32 v[32:33], v[32:33], v[114:115]
    v_cvt_pk_bf16_f32 v122, v32, v33
    v_lshrrev_b32 v123, 16, v122
fdone_199:
    s_nop 1
    s_cmp_lg_u32 s44, 0
    s_cbranch_scc1 fwrite_193
    s_mov_b32 s44, 1
    s_mov_b32 s45, s40
    s_mov_b32 s46, s41
    s_mov_b64 s[48:49], 0
    s_branch round_192
fwrite_193:
    s_cmp_lg_u32 s34, 0
    s_cbranch_scc1 fend_200
    s_mov_b64 exec, 0xffff
    global_store_short v120, v122, s[20:21] sc1
    global_store_short v121, v123, s[20:21] sc1
    s_mov_b64 exec, -1
fend_200:
    s_endpgm
L_ef1:
    s_sub_u32 s40, s35, 1
    s_mov_b32 s41, 0
efloop_201:
    s_lshl_b32 s74, s40, 5
    s_add_u32 s74, s74, s36
    s_lshl_b32 s75, s74, 10
    v_add_u32 v14, s75, v30
    global_load_dword v15, v14, s[18:19]
    s_lshl_b32 s70, s40, 18
    s_lshl_b32 s71, s36, 13
    s_add_u32 s70, s70, s71
    s_and_b32 s72, s34, 1
    s_lshl_b32 s72, s72, 12
    s_add_u32 s72, s72, s70
    s_add_u32 s72, s72, 33554432
    s_add_u32 s46, s4, s72
    s_addc_u32 s47, s5, 0
    s_add_u32 s72, s70, 50331648
    s_add_u32 s48, s4, s72
    s_addc_u32 s49, s5, 0
    s_lshr_b32 s72, s34, 1
    s_lshl_b32 s72, s72, 12
    s_add_u32 s72, s72, s70
    s_add_u32 s72, s72, 67108864
    s_add_u32 s50, s4, s72
    s_addc_u32 s51, s5, 0
    s_lshr_b32 s72, s70, 1
    s_add_u32 s72, s72, 8388608
    s_add_u32 s52, s4, s72
    s_addc_u32 s53, s5, 0
    s_lshr_b32 s72, s70, 2
    s_add_u32 s72, s72, 16842752
    s_add_u32 s54, s4, s72
    s_addc_u32 s55, s5, 0
    s_lshr_b32 s72, s40, 1
    s_lshl_b32 s72, s72, 7
    s_add_u32 s72, s72, 0
    s_cmp_lg_u32 s34, 0
    s_cbranch_scc1 polld_203
    v_mov_b32 v5, s72
    s_mov_b32 s79, 0
    s_mov_b64 exec, 1
poll_202:
    global_load_dword v6, v5, s[4:5] sc1
    s_add_u32 s79, s79, 1
    s_cmp_gt_u32 s79, 0x80000
    s_cbranch_scc1 L_fail
    s_waitcnt vmcnt(0)
    v_cmp_le_u32 vcc, 64, v6
    s_cbranch_vccnz polld_203
    s_sleep 4
    s_branch poll_202
polld_203:
    s_mov_b64 exec, -1
    s_barrier
    s_add_u32 s72, s72, 36864
    s_cmp_lg_u32 s34, 0
    s_cbranch_scc1 polld_205
    v_mov_b32 v5, s72
    s_mov_b32 s79, 0
    s_mov_b64 exec, 1
poll_204:
    global_load_dword v6, v5, s[4:5] sc1
    s_add_u32 s79, s79, 1
    s_cmp_gt_u32 s79, 0x80000
    s_cbranch_scc1 L_fail
    s_waitcnt vmcnt(0)
    v_cmp_le_u32 vcc, 32, v6
    s_cbranch_vccnz polld_205
    s_sleep 4
    s_branch poll_204
polld_205:
    s_mov_b64 exec, -1
    s_barrier
    v_add_u32 v7, 4096, v4
    global_load_dwordx4 v[32:35], v4, s[46:47] offset:0 sc1
    global_load_dwordx4 v[36:39], v4, s[46:47] offset:1024 sc1
    global_load_dwordx4 v[40:43], v4, s[46:47] offset:2048 sc1
    global_load_dwordx4 v[44:47], v4, s[46:47] offset:3072 sc1
    global_load_dwordx4 v[48:51], v4, s[48:49] offset:0 sc1
    global_load_dwordx4 v[52:55], v4, s[48:49] offset:1024 sc1
    global_load_dwordx4 v[56:59], v4, s[48:49] offset:2048 sc1
    global_load_dwordx4 v[60:63], v4, s[48:49] offset:3072 sc1
    global_load_dwordx4 v[64:67], v7, s[48:49] offset:0 sc1
    global_load_dwordx4 v[68:71], v7, s[48:49] offset:1024 sc1
    global_load_dwordx4 v[72:75], v7, s[48:49] offset:2048 sc1
    global_load_dwordx4 v[76:79], v7, s[48:49] offset:3072 sc1
    global_load_dwordx4 v[96:99], v4, s[50:51] offset:0 sc1
    global_load_dwordx4 v[100:103], v4, s[50:51] offset:1024 sc1
    global_load_dwordx4 v[104:107], v4, s[50:51] offset:2048 sc1
    global_load_dwordx4 v[108:111], v4, s[50:51] offset:3072 sc1
    v_and_b32 v5, 31, v1
    v_lshl_add_u32 v5, v5, 2, s97
    s_mov_b32 s79, 0
pf_206:
    global_load_dword v6, v5, s[4:5] sc1
    s_add_u32 s79, s79, 1
    s_cmp_gt_u32 s79, 0x80000
    s_cbranch_scc1 L_fail
    s_waitcnt vmcnt(0)
    v_cmp_gt_u32 vcc, s41, v6
    s_cbranch_vccnz pf_206
    v_mfma_f32_16x16x32_bf16 v[124:127], v[48:51], v[32:35], 0
    v_mfma_f32_16x16x32_bf16 v[124:127], v[52:55], v[36:39], v[124:127]
    v_mfma_f32_16x16x32_bf16 v[124:127], v[56:59], v[40:43], v[124:127]
    v_mfma_f32_16x16x32_bf16 v[124:127], v[60:63], v[44:47], v[124:127]
    v_mfma_f32_16x16x32_bf16 v[128:131], v[64:67], v[32:35], 0
    v_mfma_f32_16x16x32_bf16 v[128:131], v[68:71], v[36:39], v[128:131]
    v_mfma_f32_16x16x32_bf16 v[128:131], v[72:75], v[40:43], v[128:131]
    v_mfma_f32_16x16x32_bf16 v[128:131], v[76:79], v[44:47], v[128:131]
    s_nop 3
    v_cvt_pk_bf16_f32 v125, v124, v125
    v_lshlrev_b32 v124, 16, v125
    v_and_b32 v125, 0xffff0000, v125
    v_mul_f32 v124, s99, v124
    v_mul_f32 v125, s99, v125
    v_cvt_pk_bf16_f32 v125, v124, v125
    v_lshlrev_b32 v124, 16, v125
    v_and_b32 v125, 0xffff0000, v125
    v_cvt_pk_bf16_f32 v127, v126, v127
    v_lshlrev_b32 v126, 16, v127
    v_and_b32 v127, 0xffff0000, v127
    v_mul_f32 v126, s99, v126
    v_mul_f32 v127, s99, v127
    v_cvt_pk_bf16_f32 v127, v126, v127
    v_lshlrev_b32 v126, 16, v127
    v_and_b32 v127, 0xffff0000, v127
    v_cvt_pk_bf16_f32 v129, v128, v129
    v_lshlrev_b32 v128, 16, v129
    v_and_b32 v129, 0xffff0000, v129
    v_mul_f32 v128, s99, v128
    v_mul_f32 v129, s99, v129
    v_cvt_pk_bf16_f32 v129, v128, v129
    v_lshlrev_b32 v128, 16, v129
    v_and_b32 v129, 0xffff0000, v129
    v_cvt_pk_bf16_f32 v131, v130, v131
    v_lshlrev_b32 v130, 16, v131
    v_and_b32 v131, 0xffff0000, v131
    v_mul_f32 v130, s99, v130
    v_mul_f32 v131, s99, v131
    v_cvt_pk_bf16_f32 v131, v130, v131
    v_lshlrev_b32 v130, 16, v131
    v_and_b32 v131, 0xffff0000, v131
    v_mov_b32 v5, 3463342888
    v_cndmask_b32 v124, v124, v5, s[80:81]
    v_cndmask_b32 v125, v125, v5, s[82:83]
    v_cndmask_b32 v126, v126, v5, s[84:85]
    v_cndmask_b32 v127, v127, v5, s[86:87]
    v_cndmask_b32 v128, v128, v5, s[88:89]
    v_cndmask_b32 v129, v129, v5, s[90:91]
    v_cndmask_b32 v130, v130, v5, s[92:93]
    v_cndmask_b32 v131, v131, v5, s[94:95]
    s_lshl_b32 s72, s36, 7
    s_add_u32 s72, s72, 12288
    s_add_u32 s73, s40, 1
    s_cmp_ge_u32 s40, 62
    s_cselect_b32 s73, 61, s73
    s_cmp_lg_u32 s34, 0
    s_cbranch_scc1 polld_208
    v_mov_b32 v5, s72
    s_mov_b32 s79, 0
    s_mov_b64 exec, 1
poll_207:
    global_load_dword v6, v5, s[4:5] sc1
    s_add_u32 s79, s79, 1
    s_cmp_gt_u32 s79, 0x80000
    s_cbranch_scc1 L_fail
    s_waitcnt vmcnt(0)
    v_cmp_le_u32 vcc, s73, v6
    s_cbranch_vccnz polld_208
    s_sleep 2
    s_branch poll_207
polld_208:
    s_mov_b64 exec, -1
    s_barrier
    s_mov_b32 s79, 0
    s_mov_b32 s73, 2139193217
kmp_209:
    global_load_dwordx4 v[80:83], v198, s[52:53] offset:0 sc1
    global_load_dwordx4 v[84:87], v198, s[52:53] offset:64 sc1
    global_load_dwordx4 v[88:91], v198, s[52:53] offset:128 sc1
    global_load_dwordx4 v[92:95], v198, s[52:53] offset:192 sc1
    global_load_dword v112, v31, s[54:55] offset:0 sc1
    global_load_dword v114, v31, s[54:55] offset:256 sc1
    global_load_dword v116, v31, s[54:55] offset:512 sc1
    global_load_dword v118, v31, s[54:55] offset:768 sc1
    s_cmp_lt_u32 s40, 62
    s_cbranch_scc1 kmok_210
    s_add_u32 s79, s79, 1
    s_cmp_gt_u32 s79, 0x80000
    s_cbranch_scc1 L_fail
    s_waitcnt vmcnt(0)
    v_xor_b32 v160, s73, v80
    v_xor_b32 v161, s73, v81
    v_xor_b32 v162, s73, v82
    v_xor_b32 v163, s73, v83
    v_xor_b32 v164, s73, v84
    v_xor_b32 v165, s73, v85
    v_xor_b32 v166, s73, v86
    v_xor_b32 v167, s73, v87
    v_xor_b32 v168, s73, v88
    v_xor_b32 v169, s73, v89
    v_xor_b32 v170, s73, v90
    v_xor_b32 v171, s73, v91
    v_xor_b32 v172, s73, v92
    v_xor_b32 v173, s73, v93
    v_xor_b32 v174, s73, v94
    v_xor_b32 v175, s73, v95
    v_xor_b32 v176, s73, v112
    v_xor_b32 v177, s73, v114
    v_xor_b32 v178, s73, v116
    v_xor_b32 v179, s73, v118
    v_min3_u32 v5, v160, v161, v162
    v_min3_u32 v5, v5, v163, v164
    v_min3_u32 v5, v5, v165, v166
    v_min3_u32 v5, v5, v167, v168
    v_min3_u32 v5, v5, v169, v170
    v_min3_u32 v5, v5, v171, v172
    v_min3_u32 v5, v5, v173, v174
    v_min3_u32 v5, v5, v175, v176
    v_min3_u32 v5, v5, v177, v178
    v_min_u32 v5, v5, v179
    v_cmp_eq_u32 vcc, 0, v5
    s_cbranch_vccnz kmp_209
kmok_210:
    s_waitcnt vmcnt(7)
    v_mfma_f32_16x16x32_bf16 v[120:123], v[80:83], v[32:35], 0
    s_waitcnt vmcnt(6)
    v_mfma_f32_16x16x32_bf16 v[120:123], v[84:87], v[36:39], v[120:123]
    s_waitcnt vmcnt(5)
    v_mfma_f32_16x16x32_bf16 v[120:123], v[88:91], v[40:43], v[120:123]
    s_waitcnt vmcnt(4)
    v_mfma_f32_16x16x32_bf16 v[120:123], v[92:95], v[44:47], v[120:123]
    s_nop 7
    v_cvt_pk_bf16_f32 v121, v120, v121
    v_lshlrev_b32 v120, 16, v121
    v_and_b32 v121, 0xffff0000, v121
    v_mul_f32 v120, s99, v120
    v_mul_f32 v121, s99, v121
    v_cvt_pk_bf16_f32 v121, v120, v121
    v_lshlrev_b32 v120, 16, v121
    v_and_b32 v121, 0xffff0000, v121
    v_max3_f32 v5, v124, v125, v126
    v_max3_f32 v5, v5, v127, v128
    v_max3_f32 v5, v5, v129, v130
    v_max3_f32 v5, v5, v131, v120
    v_max_f32 v5, v5, v121
    v_mov_b32 v6, v5
    s_nop 1
    v_permlane32_swap_b32 v6, v5
    v_max_f32 v5, v6, v5
    v_mov_b32 v6, v5
    s_nop 1
    v_permlane16_swap_b32 v6, v5
    v_max_f32 v5, v6, v5
    v_sub_f32 v124, v124, v5
    v_mul_f32 v124, s98, v124
    v_exp_f32 v124, v124
    v_sub_f32 v125, v125, v5
    v_mul_f32 v125, s98, v125
    v_exp_f32 v125, v125
    v_sub_f32 v126, v126, v5
    v_mul_f32 v126, s98, v126
    v_exp_f32 v126, v126
    v_sub_f32 v127, v127, v5
    v_mul_f32 v127, s98, v127
    v_exp_f32 v127, v127
    v_sub_f32 v128, v128, v5
    v_mul_f32 v128, s98, v128
    v_exp_f32 v128, v128
    v_sub_f32 v129, v129, v5
    v_mul_f32 v129, s98, v129
    v_exp_f32 v129, v129
    v_sub_f32 v130, v130, v5
    v_mul_f32 v130, s98, v130
    v_exp_f32 v130, v130
    v_sub_f32 v131, v131, v5
    v_mul_f32 v131, s98, v131
    v_exp_f32 v131, v131
    v_sub_f32 v120, v120, v5
    v_mul_f32 v120, s98, v120
    v_exp_f32 v120, v120
    v_sub_f32 v121, v121, v5
    v_mul_f32 v121, s98, v121
    v_exp_f32 v121, v121
    v_add_f32 v7, v124, v125
    v_add_f32 v7, v7, v126
    v_add_f32 v7, v7, v127
    v_add_f32 v7, v7, v128
    v_add_f32 v7, v7, v129
    v_add_f32 v7, v7, v130
    v_add_f32 v7, v7, v131
    v_add_f32 v7, v7, v120
    v_add_f32 v7, v7, v121
    v_mov_b32 v6, v7
    s_nop 1
    v_permlane32_swap_b32 v6, v7
    v_add_f32 v7, v6, v7
    v_mov_b32 v6, v7
    s_nop 1
    v_permlane16_swap_b32 v6, v7
    v_add_f32 v7, v6, v7
    v_rcp_f32 v7, v7
    s_nop 0
    v_mul_f32 v124, v124, v7
    v_mul_f32 v125, v125, v7
    v_mul_f32 v126, v126, v7
    v_mul_f32 v127, v127, v7
    v_mul_f32 v128, v128, v7
    v_mul_f32 v129, v129, v7
    v_mul_f32 v130, v130, v7
    v_mul_f32 v131, v131, v7
    v_mul_f32 v120, v120, v7
    v_mul_f32 v121, v121, v7
    v_cvt_pk_bf16_f32 v132, v124, v125
    v_cvt_pk_bf16_f32 v133, v126, v127
    v_cvt_pk_bf16_f32 v134, v128, v129
    v_cvt_pk_bf16_f32 v135, v130, v131
    v_cvt_pk_bf16_f32 v136, v120, v121
    s_nop 0
    v_mfma_f32_16x16x32_bf16 v[140:143], v[96:99], v[132:135], 0
    v_mfma_f32_16x16x32_bf16 v[144:147], v[100:103], v[132:135], 0
    v_mfma_f32_16x16x32_bf16 v[148:151], v[104:107], v[132:135], 0
    v_mfma_f32_16x16x32_bf16 v[152:155], v[108:111], v[132:135], 0
    s_waitcnt vmcnt(0)
    s_nop 1
    v_mfma_f32_16x16x16_bf16 v[140:143], v[112:113], v[136:137], v[140:143]
    v_mfma_f32_16x16x16_bf16 v[144:147], v[114:115], v[136:137], v[144:147]
    v_mfma_f32_16x16x16_bf16 v[148:151], v[116:117], v[136:137], v[148:151]
    v_mfma_f32_16x16x16_bf16 v[152:155], v[118:119], v[136:137], v[152:155]
    s_nop 4
    v_cvt_pk_bf16_f32 v140, v140, v141
    v_cvt_pk_bf16_f32 v141, v142, v143
    ds_write_b64 v26, v[140:141] offset:0
    v_cvt_pk_bf16_f32 v144, v144, v145
    v_cvt_pk_bf16_f32 v145, v146, v147
    ds_write_b64 v26, v[144:145] offset:32
    v_cvt_pk_bf16_f32 v148, v148, v149
    v_cvt_pk_bf16_f32 v149, v150, v151
    ds_write_b64 v26, v[148:149] offset:64
    v_cvt_pk_bf16_f32 v152, v152, v153
    v_cvt_pk_bf16_f32 v153, v154, v155
    ds_write_b64 v26, v[152:153] offset:96
    s_waitcnt lgkmcnt(0)
    s_barrier
    ds_read_b128 v[160:163], v27 offset:0
    ds_read_b128 v[164:167], v27 offset:64
    ds_read_b128 v[168:171], v27 offset:128
    ds_read_b128 v[172:175], v27 offset:192
    ds_read_b128 v[176:179], v27 offset:4352
    ds_read_b128 v[180:183], v27 offset:4416
    ds_read_b128 v[184:187], v27 offset:4480
    ds_read_b128 v[188:191], v27 offset:4544
    s_waitcnt lgkmcnt(0)
    v_mfma_f32_16x16x32_bf16 v[32:35], a[0:3], v[160:163], 0
    v_mfma_f32_16x16x32_bf16 v[32:35], a[4:7], v[164:167], v[32:35]
    v_mfma_f32_16x16x32_bf16 v[32:35], a[8:11], v[168:171], v[32:35]
    v_mfma_f32_16x16x32_bf16 v[32:35], a[12:15], v[172:175], v[32:35]
    v_mfma_f32_16x16x32_bf16 v[36:39], a[16:19], v[160:163], 0
    v_mfma_f32_16x16x32_bf16 v[36:39], a[20:23], v[164:167], v[36:39]
    v_mfma_f32_16x16x32_bf16 v[36:39], a[24:27], v[168:171], v[36:39]
    v_mfma_f32_16x16x32_bf16 v[36:39], a[28:31], v[172:175], v[36:39]
    v_mfma_f32_16x16x32_bf16 v[40:43], a[32:35], v[160:163], 0
    v_mfma_f32_16x16x32_bf16 v[40:43], a[36:39], v[164:167], v[40:43]
    v_mfma_f32_16x16x32_bf16 v[40:43], a[40:43], v[168:171], v[40:43]
    v_mfma_f32_16x16x32_bf16 v[40:43], a[44:47], v[172:175], v[40:43]
    v_mfma_f32_16x16x32_bf16 v[44:47], a[48:51], v[160:163], 0
    v_mfma_f32_16x16x32_bf16 v[44:47], a[52:55], v[164:167], v[44:47]
    v_mfma_f32_16x16x32_bf16 v[44:47], a[56:59], v[168:171], v[44:47]
    v_mfma_f32_16x16x32_bf16 v[44:47], a[60:63], v[172:175], v[44:47]
    v_cvt_pk_bf16_f32 v140, v32, v33
    v_lshlrev_b32 v120, 16, v140
    v_and_b32 v121, 0xffff0000, v140
    v_sub_f32 v32, v32, v120
    v_sub_f32 v33, v33, v121
    v_cvt_pk_bf16_f32 v144, v32, v33
    v_cvt_pk_bf16_f32 v141, v34, v35
    v_lshlrev_b32 v120, 16, v141
    v_and_b32 v121, 0xffff0000, v141
    v_sub_f32 v34, v34, v120
    v_sub_f32 v35, v35, v121
    v_cvt_pk_bf16_f32 v145, v34, v35
    v_cvt_pk_bf16_f32 v142, v36, v37
    v_lshlrev_b32 v120, 16, v142
    v_and_b32 v121, 0xffff0000, v142
    v_sub_f32 v36, v36, v120
    v_sub_f32 v37, v37, v121
    v_cvt_pk_bf16_f32 v146, v36, v37
    v_cvt_pk_bf16_f32 v143, v38, v39
    v_lshlrev_b32 v120, 16, v143
    v_and_b32 v121, 0xffff0000, v143
    v_sub_f32 v38, v38, v120
    v_sub_f32 v39, v39, v121
    v_cvt_pk_bf16_f32 v147, v38, v39
    ds_write_b128 v28, v[140:143] offset:0
    ds_write_b128 v28, v[144:147] offset:1024
    v_mfma_f32_16x16x32_bf16 v[48:51], a[64:67], v[160:163], 0
    v_mfma_f32_16x16x32_bf16 v[48:51], a[68:71], v[164:167], v[48:51]
    v_mfma_f32_16x16x32_bf16 v[48:51], a[72:75], v[168:171], v[48:51]
    v_mfma_f32_16x16x32_bf16 v[48:51], a[76:79], v[172:175], v[48:51]
    v_mfma_f32_16x16x32_bf16 v[52:55], a[80:83], v[160:163], 0
    v_mfma_f32_16x16x32_bf16 v[52:55], a[84:87], v[164:167], v[52:55]
    v_mfma_f32_16x16x32_bf16 v[52:55], a[88:91], v[168:171], v[52:55]
    v_mfma_f32_16x16x32_bf16 v[52:55], a[92:95], v[172:175], v[52:55]
    v_cvt_pk_bf16_f32 v148, v40, v41
    v_lshlrev_b32 v120, 16, v148
    v_and_b32 v121, 0xffff0000, v148
    v_sub_f32 v40, v40, v120
    v_sub_f32 v41, v41, v121
    v_cvt_pk_bf16_f32 v152, v40, v41
    v_cvt_pk_bf16_f32 v149, v42, v43
    v_lshlrev_b32 v120, 16, v149
    v_and_b32 v121, 0xffff0000, v149
    v_sub_f32 v42, v42, v120
    v_sub_f32 v43, v43, v121
    v_cvt_pk_bf16_f32 v153, v42, v43
    v_cvt_pk_bf16_f32 v150, v44, v45
    v_lshlrev_b32 v120, 16, v150
    v_and_b32 v121, 0xffff0000, v150
    v_sub_f32 v44, v44, v120
    v_sub_f32 v45, v45, v121
    v_cvt_pk_bf16_f32 v154, v44, v45
    v_cvt_pk_bf16_f32 v151, v46, v47
    v_lshlrev_b32 v120, 16, v151
    v_and_b32 v121, 0xffff0000, v151
    v_sub_f32 v46, v46, v120
    v_sub_f32 v47, v47, v121
    v_cvt_pk_bf16_f32 v155, v46, v47
    ds_write_b128 v28, v[148:151] offset:64
    ds_write_b128 v28, v[152:155] offset:1088
    v_mfma_f32_16x16x32_bf16 v[56:59], a[96:99], v[160:163], 0
    v_mfma_f32_16x16x32_bf16 v[56:59], a[100:103], v[164:167], v[56:59]
    v_mfma_f32_16x16x32_bf16 v[56:59], a[104:107], v[168:171], v[56:59]
    v_mfma_f32_16x16x32_bf16 v[56:59], a[108:111], v[172:175], v[56:59]
    v_mfma_f32_16x16x32_bf16 v[60:63], a[112:115], v[160:163], 0
    v_mfma_f32_16x16x32_bf16 v[60:63], a[116:119], v[164:167], v[60:63]
    v_mfma_f32_16x16x32_bf16 v[60:63], a[120:123], v[168:171], v[60:63]
    v_mfma_f32_16x16x32_bf16 v[60:63], a[124:127], v[172:175], v[60:63]
    v_cvt_pk_bf16_f32 v140, v48, v49
    v_lshlrev_b32 v120, 16, v140
    v_and_b32 v121, 0xffff0000, v140
    v_sub_f32 v48, v48, v120
    v_sub_f32 v49, v49, v121
    v_cvt_pk_bf16_f32 v144, v48, v49
    v_cvt_pk_bf16_f32 v141, v50, v51
    v_lshlrev_b32 v120, 16, v141
    v_and_b32 v121, 0xffff0000, v141
    v_sub_f32 v50, v50, v120
    v_sub_f32 v51, v51, v121
    v_cvt_pk_bf16_f32 v145, v50, v51
    v_cvt_pk_bf16_f32 v142, v52, v53
    v_lshlrev_b32 v120, 16, v142
    v_and_b32 v121, 0xffff0000, v142
    v_sub_f32 v52, v52, v120
    v_sub_f32 v53, v53, v121
    v_cvt_pk_bf16_f32 v146, v52, v53
    v_cvt_pk_bf16_f32 v143, v54, v55
    v_lshlrev_b32 v120, 16, v143
    v_and_b32 v121, 0xffff0000, v143
    v_sub_f32 v54, v54, v120
    v_sub_f32 v55, v55, v121
    v_cvt_pk_bf16_f32 v147, v54, v55
    ds_write_b128 v28, v[140:143] offset:128
    ds_write_b128 v28, v[144:147] offset:1152
    v_mfma_f32_16x16x32_bf16 v[64:67], a[0:3], v[176:179], 0
    v_mfma_f32_16x16x32_bf16 v[64:67], a[4:7], v[180:183], v[64:67]
    v_mfma_f32_16x16x32_bf16 v[64:67], a[8:11], v[184:187], v[64:67]
    v_mfma_f32_16x16x32_bf16 v[64:67], a[12:15], v[188:191], v[64:67]
    v_mfma_f32_16x16x32_bf16 v[68:71], a[16:19], v[176:179], 0
    v_mfma_f32_16x16x32_bf16 v[68:71], a[20:23], v[180:183], v[68:71]
    v_mfma_f32_16x16x32_bf16 v[68:71], a[24:27], v[184:187], v[68:71]
    v_mfma_f32_16x16x32_bf16 v[68:71], a[28:31], v[188:191], v[68:71]
    v_cvt_pk_bf16_f32 v148, v56, v57
    v_lshlrev_b32 v120, 16, v148
    v_and_b32 v121, 0xffff0000, v148
    v_sub_f32 v56, v56, v120
    v_sub_f32 v57, v57, v121
    v_cvt_pk_bf16_f32 v152, v56, v57
    v_cvt_pk_bf16_f32 v149, v58, v59
    v_lshlrev_b32 v120, 16, v149
    v_and_b32 v121, 0xffff0000, v149
    v_sub_f32 v58, v58, v120
    v_sub_f32 v59, v59, v121
    v_cvt_pk_bf16_f32 v153, v58, v59
    v_cvt_pk_bf16_f32 v150, v60, v61
    v_lshlrev_b32 v120, 16, v150
    v_and_b32 v121, 0xffff0000, v150
    v_sub_f32 v60, v60, v120
    v_sub_f32 v61, v61, v121
    v_cvt_pk_bf16_f32 v154, v60, v61
    v_cvt_pk_bf16_f32 v151, v62, v63
    v_lshlrev_b32 v120, 16, v151
    v_and_b32 v121, 0xffff0000, v151
    v_sub_f32 v62, v62, v120
    v_sub_f32 v63, v63, v121
    v_cvt_pk_bf16_f32 v155, v62, v63
    ds_write_b128 v28, v[148:151] offset:192
    ds_write_b128 v28, v[152:155] offset:1216
    v_mfma_f32_16x16x32_bf16 v[72:75], a[32:35], v[176:179], 0
    v_mfma_f32_16x16x32_bf16 v[72:75], a[36:39], v[180:183], v[72:75]
    v_mfma_f32_16x16x32_bf16 v[72:75], a[40:43], v[184:187], v[72:75]
    v_mfma_f32_16x16x32_bf16 v[72:75], a[44:47], v[188:191], v[72:75]
    v_mfma_f32_16x16x32_bf16 v[76:79], a[48:51], v[176:179], 0
    v_mfma_f32_16x16x32_bf16 v[76:79], a[52:55], v[180:183], v[76:79]
    v_mfma_f32_16x16x32_bf16 v[76:79], a[56:59], v[184:187], v[76:79]
    v_mfma_f32_16x16x32_bf16 v[76:79], a[60:63], v[188:191], v[76:79]
    v_cvt_pk_bf16_f32 v140, v64, v65
    v_lshlrev_b32 v120, 16, v140
    v_and_b32 v121, 0xffff0000, v140
    v_sub_f32 v64, v64, v120
    v_sub_f32 v65, v65, v121
    v_cvt_pk_bf16_f32 v144, v64, v65
    v_cvt_pk_bf16_f32 v141, v66, v67
    v_lshlrev_b32 v120, 16, v141
    v_and_b32 v121, 0xffff0000, v141
    v_sub_f32 v66, v66, v120
    v_sub_f32 v67, v67, v121
    v_cvt_pk_bf16_f32 v145, v66, v67
    v_cvt_pk_bf16_f32 v142, v68, v69
    v_lshlrev_b32 v120, 16, v142
    v_and_b32 v121, 0xffff0000, v142
    v_sub_f32 v68, v68, v120
    v_sub_f32 v69, v69, v121
    v_cvt_pk_bf16_f32 v146, v68, v69
    v_cvt_pk_bf16_f32 v143, v70, v71
    v_lshlrev_b32 v120, 16, v143
    v_and_b32 v121, 0xffff0000, v143
    v_sub_f32 v70, v70, v120
    v_sub_f32 v71, v71, v121
    v_cvt_pk_bf16_f32 v147, v70, v71
    ds_write_b128 v28, v[140:143] offset:33024
    ds_write_b128 v28, v[144:147] offset:34048
    v_mfma_f32_16x16x32_bf16 v[80:83], a[64:67], v[176:179], 0
    v_mfma_f32_16x16x32_bf16 v[80:83], a[68:71], v[180:183], v[80:83]
    v_mfma_f32_16x16x32_bf16 v[80:83], a[72:75], v[184:187], v[80:83]
    v_mfma_f32_16x16x32_bf16 v[80:83], a[76:79], v[188:191], v[80:83]
    v_mfma_f32_16x16x32_bf16 v[84:87], a[80:83], v[176:179], 0
    v_mfma_f32_16x16x32_bf16 v[84:87], a[84:87], v[180:183], v[84:87]
    v_mfma_f32_16x16x32_bf16 v[84:87], a[88:91], v[184:187], v[84:87]
    v_mfma_f32_16x16x32_bf16 v[84:87], a[92:95], v[188:191], v[84:87]
    v_cvt_pk_bf16_f32 v148, v72, v73
    v_lshlrev_b32 v120, 16, v148
    v_and_b32 v121, 0xffff0000, v148
    v_sub_f32 v72, v72, v120
    v_sub_f32 v73, v73, v121
    v_cvt_pk_bf16_f32 v152, v72, v73
    v_cvt_pk_bf16_f32 v149, v74, v75
    v_lshlrev_b32 v120, 16, v149
    v_and_b32 v121, 0xffff0000, v149
    v_sub_f32 v74, v74, v120
    v_sub_f32 v75, v75, v121
    v_cvt_pk_bf16_f32 v153, v74, v75
    v_cvt_pk_bf16_f32 v150, v76, v77
    v_lshlrev_b32 v120, 16, v150
    v_and_b32 v121, 0xffff0000, v150
    v_sub_f32 v76, v76, v120
    v_sub_f32 v77, v77, v121
    v_cvt_pk_bf16_f32 v154, v76, v77
    v_cvt_pk_bf16_f32 v151, v78, v79
    v_lshlrev_b32 v120, 16, v151
    v_and_b32 v121, 0xffff0000, v151
    v_sub_f32 v78, v78, v120
    v_sub_f32 v79, v79, v121
    v_cvt_pk_bf16_f32 v155, v78, v79
    ds_write_b128 v28, v[148:151] offset:33088
    ds_write_b128 v28, v[152:155] offset:34112
    v_mfma_f32_16x16x32_bf16 v[88:91], a[96:99], v[176:179], 0
    v_mfma_f32_16x16x32_bf16 v[88:91], a[100:103], v[180:183], v[88:91]
    v_mfma_f32_16x16x32_bf16 v[88:91], a[104:107], v[184:187], v[88:91]
    v_mfma_f32_16x16x32_bf16 v[88:91], a[108:111], v[188:191], v[88:91]
    v_mfma_f32_16x16x32_bf16 v[92:95], a[112:115], v[176:179], 0
    v_mfma_f32_16x16x32_bf16 v[92:95], a[116:119], v[180:183], v[92:95]
    v_mfma_f32_16x16x32_bf16 v[92:95], a[120:123], v[184:187], v[92:95]
    v_mfma_f32_16x16x32_bf16 v[92:95], a[124:127], v[188:191], v[92:95]
    v_cvt_pk_bf16_f32 v140, v80, v81
    v_lshlrev_b32 v120, 16, v140
    v_and_b32 v121, 0xffff0000, v140
    v_sub_f32 v80, v80, v120
    v_sub_f32 v81, v81, v121
    v_cvt_pk_bf16_f32 v144, v80, v81
    v_cvt_pk_bf16_f32 v141, v82, v83
    v_lshlrev_b32 v120, 16, v141
    v_and_b32 v121, 0xffff0000, v141
    v_sub_f32 v82, v82, v120
    v_sub_f32 v83, v83, v121
    v_cvt_pk_bf16_f32 v145, v82, v83
    v_cvt_pk_bf16_f32 v142, v84, v85
    v_lshlrev_b32 v120, 16, v142
    v_and_b32 v121, 0xffff0000, v142
    v_sub_f32 v84, v84, v120
    v_sub_f32 v85, v85, v121
    v_cvt_pk_bf16_f32 v146, v84, v85
    v_cvt_pk_bf16_f32 v143, v86, v87
    v_lshlrev_b32 v120, 16, v143
    v_and_b32 v121, 0xffff0000, v143
    v_sub_f32 v86, v86, v120
    v_sub_f32 v87, v87, v121
    v_cvt_pk_bf16_f32 v147, v86, v87
    ds_write_b128 v28, v[140:143] offset:33152
    ds_write_b128 v28, v[144:147] offset:34176
    v_cvt_pk_bf16_f32 v148, v88, v89
    v_lshlrev_b32 v120, 16, v148
    v_and_b32 v121, 0xffff0000, v148
    v_sub_f32 v88, v88, v120
    v_sub_f32 v89, v89, v121
    v_cvt_pk_bf16_f32 v152, v88, v89
    v_cvt_pk_bf16_f32 v149, v90, v91
    v_lshlrev_b32 v120, 16, v149
    v_and_b32 v121, 0xffff0000, v149
    v_sub_f32 v90, v90, v120
    v_sub_f32 v91, v91, v121
    v_cvt_pk_bf16_f32 v153, v90, v91
    v_cvt_pk_bf16_f32 v150, v92, v93
    v_lshlrev_b32 v120, 16, v150
    v_and_b32 v121, 0xffff0000, v150
    v_sub_f32 v92, v92, v120
    v_sub_f32 v93, v93, v121
    v_cvt_pk_bf16_f32 v154, v92, v93
    v_cvt_pk_bf16_f32 v151, v94, v95
    v_lshlrev_b32 v120, 16, v151
    v_and_b32 v121, 0xffff0000, v151
    v_sub_f32 v94, v94, v120
    v_sub_f32 v95, v95, v121
    v_cvt_pk_bf16_f32 v155, v94, v95
    ds_write_b128 v28, v[148:151] offset:33216
    ds_write_b128 v28, v[152:155] offset:34240
    s_waitcnt lgkmcnt(0)
    s_barrier
    ds_read_b128 v[32:35], v196 offset:0
    ds_read_b128 v[36:39], v196 offset:1024
    ds_read_b128 v[40:43], v196 offset:2064
    ds_read_b128 v[44:47], v196 offset:3088
    ds_read_b128 v[48:51], v196 offset:4128
    ds_read_b128 v[52:55], v196 offset:5152
    ds_read_b128 v[56:59], v196 offset:6192
    ds_read_b128 v[60:63], v196 offset:7216
    ds_read_b128 v[64:67], v196 offset:8256
    ds_read_b128 v[68:71], v196 offset:9280
    ds_read_b128 v[72:75], v196 offset:10320
    ds_read_b128 v[76:79], v196 offset:11344
    ds_read_b128 v[80:83], v196 offset:12384
    ds_read_b128 v[84:87], v196 offset:13408
    ds_read_b128 v[88:91], v196 offset:14448
    ds_read_b128 v[92:95], v196 offset:15472
    v_mov_b32 v7, v197
    s_waitcnt lgkmcnt(14)
    global_store_dwordx4 v7, v[32:35], s[42:43] offset:0 sc1
    global_store_dwordx4 v7, v[36:39], s[42:43] offset:1024 sc1
    v_add_u32 v7, 0x10000, v7
    s_waitcnt lgkmcnt(12)
    global_store_dwordx4 v7, v[40:43], s[42:43] offset:0 sc1
    global_store_dwordx4 v7, v[44:47], s[42:43] offset:1024 sc1
    v_add_u32 v7, 0x10000, v7
    s_waitcnt lgkmcnt(10)
    global_store_dwordx4 v7, v[48:51], s[42:43] offset:0 sc1
    global_store_dwordx4 v7, v[52:55], s[42:43] offset:1024 sc1
    v_add_u32 v7, 0x10000, v7
    s_waitcnt lgkmcnt(8)
    global_store_dwordx4 v7, v[56:59], s[42:43] offset:0 sc1
    global_store_dwordx4 v7, v[60:63], s[42:43] offset:1024 sc1
    v_add_u32 v7, 0x10000, v7
    s_waitcnt lgkmcnt(6)
    global_store_dwordx4 v7, v[64:67], s[42:43] offset:0 sc1
    global_store_dwordx4 v7, v[68:71], s[42:43] offset:1024 sc1
    v_add_u32 v7, 0x10000, v7
    s_waitcnt lgkmcnt(4)
    global_store_dwordx4 v7, v[72:75], s[42:43] offset:0 sc1
    global_store_dwordx4 v7, v[76:79], s[42:43] offset:1024 sc1
    v_add_u32 v7, 0x10000, v7
    s_waitcnt lgkmcnt(2)
    global_store_dwordx4 v7, v[80:83], s[42:43] offset:0 sc1
    global_store_dwordx4 v7, v[84:87], s[42:43] offset:1024 sc1
    v_add_u32 v7, 0x10000, v7
    s_waitcnt lgkmcnt(0)
    global_store_dwordx4 v7, v[88:91], s[42:43] offset:0 sc1
    global_store_dwordx4 v7, v[92:95], s[42:43] offset:1024 sc1
    s_add_u32 s41, s41, 1
    s_waitcnt vmcnt(0)
    s_barrier
    s_cmp_lg_u32 s34, 0
    s_cbranch_scc1 sf_211
    s_lshl_b32 s70, s36, 2
    s_add_u32 s70, s70, s96
    v_mov_b32 v5, s70
    v_mov_b32 v6, s41
    s_mov_b64 exec, 1
    global_store_dword v5, v6, s[4:5] sc1
    s_mov_b64 exec, -1
sf_211:
    v_and_b32 v5, 31, v1
    v_lshl_add_u32 v5, v5, 2, s96
    s_mov_b32 s79, 0
pf_212:
    global_load_dword v6, v5, s[4:5] sc1
    s_add_u32 s79, s79, 1
    s_cmp_gt_u32 s79, 0x80000
    s_cbranch_scc1 L_fail
    s_waitcnt vmcnt(0)
    v_cmp_gt_u32 vcc, s41, v6
    s_cbranch_vccnz pf_212
    v_mov_b32 v7, v29
    global_load_dwordx4 v[40:43], v7, s[42:43] sc1
    v_add_u32 v7, 4096, v7
    global_load_dwordx4 v[44:47], v7, s[42:43] sc1
    v_add_u32 v7, 4096, v7
    global_load_dwordx4 v[48:51], v7, s[42:43] sc1
    v_add_u32 v7, 4096, v7
    global_load_dwordx4 v[52:55], v7, s[42:43] sc1
    v_add_u32 v7, 4096, v7
    global_load_dwordx4 v[56:59], v7, s[42:43] sc1
    v_add_u32 v7, 4096, v7
    global_load_dwordx4 v[60:63], v7, s[42:43] sc1
    v_add_u32 v7, 4096, v7
    global_load_dwordx4 v[64:67], v7, s[42:43] sc1
    v_add_u32 v7, 4096, v7
    global_load_dwordx4 v[68:71], v7, s[42:43] sc1
    v_add_u32 v7, 4096, v7
    global_load_dwordx4 v[72:75], v7, s[42:43] sc1
    v_add_u32 v7, 4096, v7
    global_load_dwordx4 v[76:79], v7, s[42:43] sc1
    v_add_u32 v7, 4096, v7
    global_load_dwordx4 v[80:83], v7, s[42:43] sc1
    v_add_u32 v7, 4096, v7
    global_load_dwordx4 v[84:87], v7, s[42:43] sc1
    v_add_u32 v7, 4096, v7
    global_load_dwordx4 v[88:91], v7, s[42:43] sc1
    v_add_u32 v7, 4096, v7
    global_load_dwordx4 v[92:95], v7, s[42:43] sc1
    v_add_u32 v7, 4096, v7
    global_load_dwordx4 v[160:163], v7, s[42:43] sc1
    v_add_u32 v7, 4096, v7
    global_load_dwordx4 v[164:167], v7, s[42:43] sc1
    s_waitcnt vmcnt(15)
    v_mfma_f32_16x16x32_bf16 v[32:35], v[192:195], v[40:43], 0
    s_waitcnt vmcnt(14)
    v_mfma_f32_16x16x32_bf16 v[32:35], v[192:195], v[44:47], v[32:35]
    s_waitcnt vmcnt(13)
    v_mfma_f32_16x16x32_bf16 v[32:35], v[192:195], v[48:51], v[32:35]
    s_waitcnt vmcnt(12)
    v_mfma_f32_16x16x32_bf16 v[32:35], v[192:195], v[52:55], v[32:35]
    s_waitcnt vmcnt(11)
    v_mfma_f32_16x16x32_bf16 v[32:35], v[192:195], v[56:59], v[32:35]
    s_waitcnt vmcnt(10)
    v_mfma_f32_16x16x32_bf16 v[32:35], v[192:195], v[60:63], v[32:35]
    s_waitcnt vmcnt(9)
    v_mfma_f32_16x16x32_bf16 v[32:35], v[192:195], v[64:67], v[32:35]
    s_waitcnt vmcnt(8)
    v_mfma_f32_16x16x32_bf16 v[32:35], v[192:195], v[68:71], v[32:35]
    s_waitcnt vmcnt(7)
    v_mfma_f32_16x16x32_bf16 v[32:35], v[192:195], v[72:75], v[32:35]
    s_waitcnt vmcnt(6)
    v_mfma_f32_16x16x32_bf16 v[32:35], v[192:195], v[76:79], v[32:35]
    s_waitcnt vmcnt(5)
    v_mfma_f32_16x16x32_bf16 v[32:35], v[192:195], v[80:83], v[32:35]
    s_waitcnt vmcnt(4)
    v_mfma_f32_16x16x32_bf16 v[32:35], v[192:195], v[84:87], v[32:35]
    s_waitcnt vmcnt(3)
    v_mfma_f32_16x16x32_bf16 v[32:35], v[192:195], v[88:91], v[32:35]
    s_waitcnt vmcnt(2)
    v_mfma_f32_16x16x32_bf16 v[32:35], v[192:195], v[92:95], v[32:35]
    s_waitcnt vmcnt(1)
    v_mfma_f32_16x16x32_bf16 v[32:35], v[192:195], v[160:163], v[32:35]
    s_waitcnt vmcnt(0)
    v_mfma_f32_16x16x32_bf16 v[32:35], v[192:195], v[164:167], v[32:35]
    s_nop 7
    v_permlane32_swap_b32 v32, v34
    v_permlane32_swap_b32 v33, v35
    v_cvt_pk_bf16_f32 v33, v32, v33
    v_lshlrev_b32 v32, 16, v33
    v_and_b32 v33, 0xffff0000, v33
    v_pk_mul_f32 v[32:33], v[32:33], v[16:17]
    v_cvt_pk_bf16_f32 v33, v32, v33
    v_lshlrev_b32 v32, 16, v33
    v_and_b32 v33, 0xffff0000, v33
    v_lshlrev_b32 v40, 16, v15
    v_and_b32 v41, 0xffff0000, v15
    v_pk_add_f32 v[40:41], v[40:41], v[32:33]
    v_cvt_pk_bf16_f32 v36, v40, v41
    v_add_u32 v37, 3145728, v14
    global_store_dword v37, v36, s[4:5] sc1
    v_lshlrev_b32 v40, 16, v36
    v_and_b32 v41, 0xffff0000, v36
    v_add_f32 v42, v40, v41
    s_nop 1
    v_add_f32_dpp v42, v42, v42 row_ror:8 row_mask:0xf bank_mask:0xf
    s_nop 1
    v_add_f32_dpp v42, v42, v42 row_ror:4 row_mask:0xf bank_mask:0xf
    s_nop 1
    v_add_f32_dpp v42, v42, v42 row_ror:2 row_mask:0xf bank_mask:0xf
    s_nop 1
    v_add_f32_dpp v42, v42, v42 row_ror:1 row_mask:0xf bank_mask:0xf
    v_mov_b32 v48, v42
    s_nop 1
    v_permlane32_swap_b32 v48, v42
    v_add_f32 v42, v48, v42
    v_mov_b32 v48, v42
    s_nop 1
    v_permlane16_swap_b32 v48, v42
    v_add_f32 v42, v48, v42
    s_lshl_b32 s70, s34, 2
    s_add_u32 s70, s70, 9216
    v_mov_b32 v48, s70
    ds_write_b32 v48, v42
    v_mov_b32 v48, 9216
    s_waitcnt lgkmcnt(0)
    s_barrier
    ds_read_b128 v[50:53], v48
    s_waitcnt lgkmcnt(0)
    v_add_f32 v50, v50, v51
    v_add_f32 v52, v52, v53
    v_add_f32 v42, v50, v52
    s_cmp_lg_u32 s34, 0
    s_cbranch_scc1 sf_213
    s_lshl_b32 s70, s36, 2
    s_add_u32 s70, s70, s97
    v_mov_b32 v5, s70
    v_mov_b32 v6, s41
    s_mov_b64 exec, 1
    global_store_dword v5, v6, s[4:5] sc1
    s_mov_b64 exec, -1
sf_213:
    v_mul_f32 v42, 989855744, v42
    v_sub_f32 v44, v40, v42
    v_sub_f32 v45, v41, v42
    v_mul_f32 v44, v44, v44
    v_fmac_f32 v44, v45, v45
    s_nop 1
    v_add_f32_dpp v44, v44, v44 row_ror:8 row_mask:0xf bank_mask:0xf
    s_nop 1
    v_add_f32_dpp v44, v44, v44 row_ror:4 row_mask:0xf bank_mask:0xf
    s_nop 1
    v_add_f32_dpp v44, v44, v44 row_ror:2 row_mask:0xf bank_mask:0xf
    s_nop 1
    v_add_f32_dpp v44, v44, v44 row_ror:1 row_mask:0xf bank_mask:0xf
    v_mov_b32 v48, v44
    s_nop 1
    v_permlane32_swap_b32 v48, v44
    v_add_f32 v44, v48, v44
    v_mov_b32 v48, v44
    s_nop 1
    v_permlane16_swap_b32 v48, v44
    v_add_f32 v44, v48, v44
    s_lshl_b32 s70, s34, 2
    s_add_u32 s70, s70, 9232
    v_mov_b32 v48, s70
    ds_write_b32 v48, v44
    v_mov_b32 v48, 9232
    s_waitcnt lgkmcnt(0)
    s_barrier
    ds_read_b128 v[50:53], v48
    s_waitcnt lgkmcnt(0)
    v_add_f32 v50, v50, v51
    v_add_f32 v52, v52, v53
    v_add_f32 v44, v50, v52
    v_mul_f32 v44, 989855744, v44
    v_cvt_pk_bf16_f32 v44, v44, v44
    v_lshlrev_b32 v44, 16, v44
    v_add_f32 v44, 925353388, v44
    v_cvt_pk_bf16_f32 v44, v44, v44
    v_lshlrev_b32 v44, 16, v44
    v_sqrt_f32 v44, v44
    s_nop 0
    v_cvt_pk_bf16_f32 v44, v44, v44
    v_lshlrev_b32 v44, 16, v44
    v_rcp_f32 v44, v44
    v_cvt_pk_bf16_f32 v42, v42, v42
    v_lshlrev_b32 v42, 16, v42
    v_sub_f32 v32, v40, v42
    v_sub_f32 v33, v41, v42
    v_cvt_pk_bf16_f32 v33, v32, v33
    v_lshlrev_b32 v32, 16, v33
    v_and_b32 v33, 0xffff0000, v33
    v_mul_f32 v32, v32, v44
    v_mul_f32 v33, v33, v44
    v_cvt_pk_bf16_f32 v33, v32, v33
    v_lshlrev_b32 v32, 16, v33
    v_and_b32 v33, 0xffff0000, v33
    v_pk_mul_f32 v[32:33], v[32:33], v[20:21]
    v_cvt_pk_bf16_f32 v33, v32, v33
    v_lshlrev_b32 v32, 16, v33
    v_and_b32 v33, 0xffff0000, v33
    v_pk_add_f32 v[32:33], v[32:33], v[18:19]
    v_cvt_pk_bf16_f32 v36, v32, v33
    v_add_u32 v37, 5242880, v14
    global_store_dword v37, v36, s[4:5] sc1
    v_lshlrev_b32 v32, 16, v36
    v_and_b32 v33, 0xffff0000, v36
    v_mul_f32 v42, v32, v24
    v_fmac_f32 v42, v33, v25
    v_pk_mul_f32 v[32:33], v[32:33], v[22:23]
    v_cvt_pk_bf16_f32 v33, v32, v33
    v_lshlrev_b32 v32, 16, v33
    v_and_b32 v33, 0xffff0000, v33
    v_pk_add_f32 v[32:33], v[32:33], v[40:41]
    v_cvt_pk_bf16_f32 v36, v32, v33
    global_store_dword v14, v36, s[20:21] sc1
    s_waitcnt vmcnt(0)
    v_add_f32_dpp v42, v42, v42 row_ror:8 row_mask:0xf bank_mask:0xf
    s_nop 1
    v_add_f32_dpp v42, v42, v42 row_ror:4 row_mask:0xf bank_mask:0xf
    s_nop 1
    v_add_f32_dpp v42, v42, v42 row_ror:2 row_mask:0xf bank_mask:0xf
    s_nop 1
    v_add_f32_dpp v42, v42, v42 row_ror:1 row_mask:0xf bank_mask:0xf
    v_mov_b32 v48, v42
    s_nop 1
    v_permlane32_swap_b32 v48, v42
    v_add_f32 v42, v48, v42
    v_mov_b32 v48, v42
    s_nop 1
    v_permlane16_swap_b32 v48, v42
    v_add_f32 v42, v48, v42
    s_lshl_b32 s70, s34, 2
    s_add_u32 s70, s70, 9248
    v_mov_b32 v48, s70
    ds_write_b32 v48, v42
    v_mov_b32 v48, 9248
    s_waitcnt lgkmcnt(0)
    s_barrier
    ds_read_b128 v[50:53], v48
    s_waitcnt lgkmcnt(0)
    v_add_f32 v50, v50, v51
    v_add_f32 v52, v52, v53
    v_add_f32 v42, v50, v52
    v_cvt_pk_bf16_f32 v42, v42, v42
    v_lshlrev_b32 v42, 16, v42
    v_ashrrev_i32 v48, 31, v42
    v_or_b32 v48, 0x80000000, v48
    v_xor_b32 v42, v42, v48
    v_and_b32 v42, 0xffff0000, v42
    s_sub_u32 s75, 6143, s74
    v_or_b32 v42, s75, v42
    s_lshl_b32 s74, s74, 2
    s_add_u32 s74, s74, 49152
    v_mov_b32 v48, s74
    s_mov_b64 exec, 1
    global_store_dword v48, v42, s[4:5] sc1
    s_mov_b64 exec, -1
    s_add_u32 s40, s40, 7
    s_cmp_lt_u32 s40, 64
    s_cbranch_scc1 efloop_201
    s_cmp_lg_u32 s35, 2
    s_cbranch_scc1 L_exit
    s_mov_b32 s44, 0
    s_cmp_eq_u32 s34, 3
    s_cselect_b32 s48, 0xff000000, 0
    s_cselect_b32 s49, -1, 0
round_214:
    s_lshl_b32 s70, s34, 11
    s_add_u32 s70, s70, 49152
    v_add_u32 v5, s70, v4
    s_mov_b32 s79, 0
keys_216:
    global_load_dwordx4 v[32:35], v5, s[4:5] sc1
    global_load_dwordx4 v[36:39], v5, s[4:5] offset:1024 sc1
    s_add_u32 s79, s79, 1
    s_cmp_gt_u32 s79, 0x80000
    s_cbranch_scc1 L_fail
    s_sleep 2
    s_waitcnt vmcnt(0)
    v_cndmask_b32 v36, v36, 1, s[48:49]
    v_cndmask_b32 v37, v37, 1, s[48:49]
    v_cndmask_b32 v38, v38, 1, s[48:49]
    v_cndmask_b32 v39, v39, 1, s[48:49]
    v_min3_u32 v40, v32, v33, v34
    v_min3_u32 v40, v40, v35, v36
    v_min3_u32 v40, v40, v37, v38
    v_min_u32 v40, v40, v39
    v_cmp_eq_u32 vcc, 0, v40
    s_cbranch_vccnz keys_216
    v_max_u32 v40, v32, v33
    v_min_u32 v41, v32, v33
    v_med3_u32 v41, v40, v41, v34
    v_max_u32 v40, v40, v34
    v_med3_u32 v41, v40, v41, v35
    v_max_u32 v40, v40, v35
    v_med3_u32 v41, v40, v41, v36
    v_max_u32 v40, v40, v36
    v_med3_u32 v41, v40, v41, v37
    v_max_u32 v40, v40, v37
    v_med3_u32 v41, v40, v41, v38
    v_max_u32 v40, v40, v38
    v_med3_u32 v41, v40, v41, v39
    v_max_u32 v40, v40, v39
    s_nop 1
    v_mov_b32_dpp v42, v40 row_ror:8 row_mask:0xf bank_mask:0xf
    v_mov_b32_dpp v43, v41 row_ror:8 row_mask:0xf bank_mask:0xf
    v_min_u32 v44, v40, v42
    v_max_u32 v40, v40, v42
    v_max3_u32 v41, v44, v41, v43
    s_nop 0
    v_mov_b32_dpp v42, v40 row_ror:4 row_mask:0xf bank_mask:0xf
    v_mov_b32_dpp v43, v41 row_ror:4 row_mask:0xf bank_mask:0xf
    v_min_u32 v44, v40, v42
    v_max_u32 v40, v40, v42
    v_max3_u32 v41, v44, v41, v43
    s_nop 0
    v_mov_b32_dpp v42, v40 row_ror:2 row_mask:0xf bank_mask:0xf
    v_mov_b32_dpp v43, v41 row_ror:2 row_mask:0xf bank_mask:0xf
    v_min_u32 v44, v40, v42
    v_max_u32 v40, v40, v42
    v_max3_u32 v41, v44, v41, v43
    s_nop 0
    v_mov_b32_dpp v42, v40 row_ror:1 row_mask:0xf bank_mask:0xf
    v_mov_b32_dpp v43, v41 row_ror:1 row_mask:0xf bank_mask:0xf
    v_min_u32 v44, v40, v42
    v_max_u32 v40, v40, v42
    v_max3_u32 v41, v44, v41, v43
    v_mov_b32 v42, v40
    v_mov_b32 v43, v41
    s_nop 0
    v_permlane16_swap_b32 v42, v40
    v_permlane16_swap_b32 v43, v41
    v_min_u32 v44, v40, v42
    v_max_u32 v40, v40, v42
    v_max3_u32 v41, v44, v41, v43
    v_mov_b32 v42, v40
    v_mov_b32 v43, v41
    s_nop 0
    v_permlane32_swap_b32 v42, v40
    v_permlane32_swap_b32 v43, v41
    v_min_u32 v44, v40, v42
    v_max_u32 v40, v40, v42
    v_max3_u32 v41, v44, v41, v43
    s_lshl_b32 s70, s34, 3
    s_add_u32 s70, s70, 9280
    v_mov_b32 v5, s70
    ds_write_b64 v5, v[40:41]
    v_mov_b32 v5, 9280
    s_waitcnt lgkmcnt(0)
    s_barrier
    ds_read_b128 v[32:35], v5
    ds_read_b128 v[36:39], v5 offset:16
    s_waitcnt lgkmcnt(0)
    v_mov_b32 v40, v32
    v_mov_b32 v41, v33
    v_mov_b32 v42, v34
    v_mov_b32 v43, v35
    v_min_u32 v44, v40, v42
    v_max_u32 v40, v40, v42
    v_max3_u32 v41, v44, v41, v43
    v_mov_b32 v42, v36
    v_mov_b32 v43, v37
    v_min_u32 v44, v40, v42
    v_max_u32 v40, v40, v42
    v_max3_u32 v41, v44, v41, v43
    v_mov_b32 v42, v38
    v_mov_b32 v43, v39
    v_min_u32 v44, v40, v42
    v_max_u32 v40, v40, v42
    v_max3_u32 v41, v44, v41, v43
    v_readfirstlane_b32 s40, v40
    v_readfirstlane_b32 s41, v41
    s_barrier
    s_cmp_eq_u32 s44, 0
    s_cbranch_scc1 fgo_217
    s_cmp_lg_u32 s40, s45
    s_cbranch_scc1 fgo_217
    s_cmp_eq_u32 s41, s46
    s_cbranch_scc1 fwrite_215
fgo_217:
    s_lshl_b32 s47, s44, 13
    s_and_b32 s42, s40, 0x7ff
    s_sub_u32 s42, 2047, s42
    s_lshl_b32 s42, s42, 10
    s_and_b32 s43, s41, 0x7ff
    s_sub_u32 s43, 2047, s43
    s_lshl_b32 s43, s43, 10
    v_mov_b32 v5, s42
    v_mov_b32 v6, s43
    v_and_b32 v7, 1, v3
    v_cmp_eq_u32 vcc, 1, v7
    s_nop 1
    v_cndmask_b32 v8, v5, v6, vcc
    s_lshl_b32 s76, s36, 2
    s_add_u32 s76, s76, s34
    s_cmp_ge_u32 s76, 86
    s_cbranch_scc1 ffn_s1_218
    v_lshl_add_u32 v9, v2, 4, v8
    v_add_u32 v9, 5242880, v9
    global_load_dwordx4 v[48:51], v9, s[4:5] offset:0 sc1
    global_load_dwordx4 v[52:55], v9, s[4:5] offset:64 sc1
    global_load_dwordx4 v[56:59], v9, s[4:5] offset:128 sc1
    global_load_dwordx4 v[60:63], v9, s[4:5] offset:192 sc1
    global_load_dwordx4 v[64:67], v9, s[4:5] offset:256 sc1
    global_load_dwordx4 v[68:71], v9, s[4:5] offset:320 sc1
    global_load_dwordx4 v[72:75], v9, s[4:5] offset:384 sc1
    global_load_dwordx4 v[76:79], v9, s[4:5] offset:448 sc1
    global_load_dwordx4 v[80:83], v9, s[4:5] offset:512 sc1
    global_load_dwordx4 v[84:87], v9, s[4:5] offset:576 sc1
    global_load_dwordx4 v[88:91], v9, s[4:5] offset:640 sc1
    global_load_dwordx4 v[92:95], v9, s[4:5] offset:704 sc1
    global_load_dwordx4 v[96:99], v9, s[4:5] offset:768 sc1
    global_load_dwordx4 v[100:103], v9, s[4:5] offset:832 sc1
    global_load_dwordx4 v[104:107], v9, s[4:5] offset:896 sc1
    global_load_dwordx4 v[108:111], v9, s[4:5] offset:960 sc1
    s_waitcnt vmcnt(15)
    v_mfma_f32_16x16x32_bf16 v[32:35], v[48:51], a[128:131], 0
    v_mfma_f32_16x16x32_bf16 v[36:39], v[48:51], a[192:195], 0
    s_waitcnt vmcnt(14)
    v_mfma_f32_16x16x32_bf16 v[32:35], v[52:55], a[132:135], v[32:35]
    v_mfma_f32_16x16x32_bf16 v[36:39], v[52:55], a[196:199], v[36:39]
    s_waitcnt vmcnt(13)
    v_mfma_f32_16x16x32_bf16 v[32:35], v[56:59], a[136:139], v[32:35]
    v_mfma_f32_16x16x32_bf16 v[36:39], v[56:59], a[200:203], v[36:39]
    s_waitcnt vmcnt(12)
    v_mfma_f32_16x16x32_bf16 v[32:35], v[60:63], a[140:143], v[32:35]
    v_mfma_f32_16x16x32_bf16 v[36:39], v[60:63], a[204:207], v[36:39]
    s_waitcnt vmcnt(11)
    v_mfma_f32_16x16x32_bf16 v[32:35], v[64:67], a[144:147], v[32:35]
    v_mfma_f32_16x16x32_bf16 v[36:39], v[64:67], a[208:211], v[36:39]
    s_waitcnt vmcnt(10)
    v_mfma_f32_16x16x32_bf16 v[32:35], v[68:71], a[148:151], v[32:35]
    v_mfma_f32_16x16x32_bf16 v[36:39], v[68:71], a[212:215], v[36:39]
    s_waitcnt vmcnt(9)
    v_mfma_f32_16x16x32_bf16 v[32:35], v[72:75], a[152:155], v[32:35]
    v_mfma_f32_16x16x32_bf16 v[36:39], v[72:75], a[216:219], v[36:39]
    s_waitcnt vmcnt(8)
    v_mfma_f32_16x16x32_bf16 v[32:35], v[76:79], a[156:159], v[32:35]
    v_mfma_f32_16x16x32_bf16 v[36:39], v[76:79], a[220:223], v[36:39]
    s_waitcnt vmcnt(7)
    v_mfma_f32_16x16x32_bf16 v[32:35], v[80:83], a[160:163], v[32:35]
    v_mfma_f32_16x16x32_bf16 v[36:39], v[80:83], a[224:227], v[36:39]
    s_waitcnt vmcnt(6)
    v_mfma_f32_16x16x32_bf16 v[32:35], v[84:87], a[164:167], v[32:35]
    v_mfma_f32_16x16x32_bf16 v[36:39], v[84:87], a[228:231], v[36:39]
    s_waitcnt vmcnt(5)
    v_mfma_f32_16x16x32_bf16 v[32:35], v[88:91], a[168:171], v[32:35]
    v_mfma_f32_16x16x32_bf16 v[36:39], v[88:91], a[232:235], v[36:39]
    s_waitcnt vmcnt(4)
    v_mfma_f32_16x16x32_bf16 v[32:35], v[92:95], a[172:175], v[32:35]
    v_mfma_f32_16x16x32_bf16 v[36:39], v[92:95], a[236:239], v[36:39]
    s_waitcnt vmcnt(3)
    v_mfma_f32_16x16x32_bf16 v[32:35], v[96:99], a[176:179], v[32:35]
    v_mfma_f32_16x16x32_bf16 v[36:39], v[96:99], a[240:243], v[36:39]
    s_waitcnt vmcnt(2)
    v_mfma_f32_16x16x32_bf16 v[32:35], v[100:103], a[180:183], v[32:35]
    v_mfma_f32_16x16x32_bf16 v[36:39], v[100:103], a[244:247], v[36:39]
    s_waitcnt vmcnt(1)
    v_mfma_f32_16x16x32_bf16 v[32:35], v[104:107], a[184:187], v[32:35]
    v_mfma_f32_16x16x32_bf16 v[36:39], v[104:107], a[248:251], v[36:39]
    s_waitcnt vmcnt(0)
    v_mfma_f32_16x16x32_bf16 v[32:35], v[108:111], a[188:191], v[32:35]
    v_mfma_f32_16x16x32_bf16 v[36:39], v[108:111], a[252:255], v[36:39]
    s_nop 6
    v_cvt_pk_bf16_f32 v33, v32, v33
    v_lshlrev_b32 v32, 16, v33
    v_and_b32 v33, 0xffff0000, v33
    v_cvt_pk_bf16_f32 v37, v36, v37
    v_lshlrev_b32 v36, 16, v37
    v_and_b32 v37, 0xffff0000, v37
    s_mov_b32 s70, 3216550459
    v_mul_f32 v34, s70, v32
    v_exp_f32 v34, v34
    s_nop 0
    v_add_f32 v34, 1.0, v34
    v_rcp_f32 v34, v34
    s_nop 0
    v_mul_f32 v32, v32, v34
    v_mul_f32 v35, s70, v33
    v_exp_f32 v35, v35
    s_nop 0
    v_add_f32 v35, 1.0, v35
    v_rcp_f32 v35, v35
    s_nop 0
    v_mul_f32 v33, v33, v35
    v_cvt_pk_bf16_f32 v33, v32, v33
    v_lshlrev_b32 v32, 16, v33
    v_and_b32 v33, 0xffff0000, v33
    v_pk_mul_f32 v[32:33], v[32:33], v[36:37]
    s_nop 1
    v_mov_b32_dpp v34, v32 quad_perm:[1,0,3,2] row_mask:0xf bank_mask:0xf
    v_cvt_pk_bf16_f32 v32, v32, v34
    v_min_u32 v32, -2, v32
    v_mov_b32_dpp v35, v33 quad_perm:[1,0,3,2] row_mask:0xf bank_mask:0xf
    v_cvt_pk_bf16_f32 v33, v33, v35
    v_min_u32 v33, -2, v33
    s_lshl_b32 s70, s76, 5
    s_add_u32 s70, s70, 131072
    s_add_u32 s70, s70, s47
    v_lshl_add_u32 v9, v3, 1, s70
    s_mov_b64 exec, 0x5555
    global_store_dword v9, v32, s[4:5] sc1
    global_store_dword v9, v33, s[4:5] offset:2752 sc1
    s_mov_b64 exec, -1
ffn_s1_218:
    s_lshl_b32 s70, s36, 5
    v_lshl_add_u32 v10, v3, 1, s70
    v_add_u32 v120, s42, v10
    v_add_u32 v11, 5242880, v120
    global_load_ushort v112, v11, s[4:5] sc1
    v_add_u32 v11, 3145728, v120
    global_load_ushort v114, v11, s[4:5] sc1
    v_add_u32 v121, s43, v10
    v_add_u32 v11, 5242880, v121
    global_load_ushort v113, v11, s[4:5] sc1
    v_add_u32 v11, 3145728, v121
    global_load_ushort v115, v11, s[4:5] sc1
    v_lshlrev_b32 v11, 1, v10
    v_add_u32 v11, 75776, v11
    global_load_dword v116, v11, s[4:5] sc1
    v_mul_u32_u24 v9, 2752, v7
    v_lshl_add_u32 v9, v2, 4, v9
    s_lshl_b32 s70, s34, 6
    s_add_u32 s70, s70, 131072
    s_add_u32 s70, s70, s47
    v_add_u32 v9, s70, v9
    s_cmp_eq_u32 s34, 3
    s_cselect_b32 s77, 0, 256
    v_add_u32 v11, s77, v9
    s_mov_b32 s79, 0
actpoll_219:
    global_load_dwordx4 v[48:51], v9, s[4:5] offset:0 sc1
    global_load_dwordx4 v[52:55], v9, s[4:5] offset:256 sc1
    global_load_dwordx4 v[56:59], v9, s[4:5] offset:512 sc1
    global_load_dwordx4 v[60:63], v9, s[4:5] offset:768 sc1
    global_load_dwordx4 v[64:67], v9, s[4:5] offset:1024 sc1
    global_load_dwordx4 v[68:71], v9, s[4:5] offset:1280 sc1
    global_load_dwordx4 v[72:75], v9, s[4:5] offset:1536 sc1
    global_load_dwordx4 v[76:79], v9, s[4:5] offset:1792 sc1
    global_load_dwordx4 v[80:83], v9, s[4:5] offset:2048 sc1
    global_load_dwordx4 v[84:87], v9, s[4:5] offset:2304 sc1
    global_load_dwordx4 v[88:91], v11, s[4:5] offset:2304 sc1
    s_add_u32 s79, s79, 1
    s_cmp_gt_u32 s79, 0x80000
    s_cbranch_scc1 L_fail
    s_waitcnt vmcnt(0)
    v_max3_u32 v12, v48, v49, v50
    v_max3_u32 v12, v12, v51, v52
    v_max3_u32 v12, v12, v53, v54
    v_max3_u32 v12, v12, v55, v56
    v_max3_u32 v12, v12, v57, v58
    v_max3_u32 v12, v12, v59, v60
    v_max3_u32 v12, v12, v61, v62
    v_max3_u32 v12, v12, v63, v64
    v_max3_u32 v12, v12, v65, v66
    v_max3_u32 v12, v12, v67, v68
    v_max3_u32 v12, v12, v69, v70
    v_max3_u32 v12, v12, v71, v72
    v_max3_u32 v12, v12, v73, v74
    v_max3_u32 v12, v12, v75, v76
    v_max3_u32 v12, v12, v77, v78
    v_max3_u32 v12, v12, v79, v80
    v_max3_u32 v12, v12, v81, v82
    v_max3_u32 v12, v12, v83, v84
    v_max3_u32 v12, v12, v85, v86
    v_max3_u32 v12, v12, v87, v88
    v_max3_u32 v12, v12, v89, v90
    v_max_u32 v12, v12, v91
    v_cmp_eq_u32 vcc, -1, v12
    s_cbranch_vccnz actpoll_219
    v_mfma_f32_16x16x32_bf16 v[32:35], v[48:51], v[200:203], 0
    v_mfma_f32_16x16x32_bf16 v[32:35], v[52:55], v[204:207], v[32:35]
    v_mfma_f32_16x16x32_bf16 v[32:35], v[56:59], v[208:211], v[32:35]
    v_mfma_f32_16x16x32_bf16 v[32:35], v[60:63], v[212:215], v[32:35]
    v_mfma_f32_16x16x32_bf16 v[32:35], v[64:67], v[216:219], v[32:35]
    v_mfma_f32_16x16x32_bf16 v[32:35], v[68:71], v[220:223], v[32:35]
    v_mfma_f32_16x16x32_bf16 v[32:35], v[72:75], v[224:227], v[32:35]
    v_mfma_f32_16x16x32_bf16 v[32:35], v[76:79], v[228:231], v[32:35]
    v_mfma_f32_16x16x32_bf16 v[32:35], v[80:83], v[232:235], v[32:35]
    v_mfma_f32_16x16x32_bf16 v[32:35], v[84:87], v[236:239], v[32:35]
    s_cmp_eq_u32 s34, 3
    s_cbranch_scc1 y3_220
    v_mfma_f32_16x16x32_bf16 v[32:35], v[88:91], v[240:243], v[32:35]
y3_220:
    s_nop 7
    s_lshl_b32 s70, s34, 7
    s_add_u32 s70, s70, 9344
    v_lshl_add_u32 v9, v3, 3, s70
    s_mov_b64 exec, 0xffff
    ds_write_b64 v9, v[32:33]
    s_mov_b64 exec, -1
    v_lshlrev_b32 v9, 3, v3
    v_add_u32 v9, 9344, v9
    s_waitcnt lgkmcnt(0)
    s_barrier
    s_cmp_lg_u32 s34, 0
    s_cbranch_scc1 fdone_221
    ds_read_b64 v[32:33], v9 offset:0
    ds_read_b64 v[34:35], v9 offset:128
    ds_read_b64 v[36:37], v9 offset:256
    ds_read_b64 v[38:39], v9 offset:384
    s_waitcnt lgkmcnt(0)
    v_pk_add_f32 v[32:33], v[32:33], v[34:35]
    v_pk_add_f32 v[36:37], v[36:37], v[38:39]
    v_pk_add_f32 v[32:33], v[32:33], v[36:37]
    v_cvt_pk_bf16_f32 v33, v32, v33
    v_lshlrev_b32 v32, 16, v33
    v_and_b32 v33, 0xffff0000, v33
    s_and_b32 s70, s40, 0xffff0000
    s_xor_b32 s71, s70, 0x80000000
    s_not_b32 s72, s70
    s_and_b32 s72, s72, 0xffff0000
    s_bitcmp1_b32 s70, 31
    s_cselect_b32 s70, s71, s72
    v_mov_b32 v34, s70
    v_mul_f32 v34, 3216550459, v34
    v_exp_f32 v34, v34
    s_nop 0
    v_add_f32 v34, 1.0, v34
    v_rcp_f32 v34, v34
    s_and_b32 s70, s41, 0xffff0000
    s_xor_b32 s71, s70, 0x80000000
    s_not_b32 s72, s70
    s_and_b32 s72, s72, 0xffff0000
    s_bitcmp1_b32 s70, 31
    s_cselect_b32 s70, s71, s72
    v_mov_b32 v35, s70
    v_mul_f32 v35, 3216550459, v35
    v_exp_f32 v35, v35
    s_nop 0
    v_add_f32 v35, 1.0, v35
    v_rcp_f32 v35, v35
    s_nop 0
    v_cvt_pk_bf16_f32 v35, v34, v35
    v_lshlrev_b32 v34, 16, v35
    v_and_b32 v35, 0xffff0000, v35
    v_pk_mul_f32 v[32:33], v[32:33], v[34:35]
    v_cvt_pk_bf16_f32 v33, v32, v33
    v_lshlrev_b32 v32, 16, v33
    v_and_b32 v33, 0xffff0000, v33
    v_lshlrev_b32 v112, 16, v112
    v_lshlrev_b32 v113, 16, v113
    v_lshlrev_b32 v114, 16, v114
    v_lshlrev_b32 v115, 16, v115
    v_pk_add_f32 v[32:33], v[32:33], v[112:113]
    v_cvt_pk_bf16_f32 v33, v32, v33
    v_lshlrev_b32 v32, 16, v33
    v_and_b32 v33, 0xffff0000, v33
    v_mul_f32 v32, v32, v116
    v_mul_f32 v33, v33, v116
    v_cvt_pk_bf16_f32 v33, v32, v33
    v_lshlrev_b32 v32, 16, v33
    v_and_b32 v33, 0xffff0000, v33
    v_pk_add_f32 v[32:33], v[32:33], v[114:115]
    v_cvt_pk_bf16_f32 v122, v32, v33
    v_lshrrev_b32 v123, 16, v122
fdone_221:
    s_nop 1
    s_cmp_lg_u32 s44, 0
    s_cbranch_scc1 fwrite_215
    s_mov_b32 s44, 1
    s_mov_b32 s45, s40
    s_mov_b32 s46, s41
    s_mov_b64 s[48:49], 0
    s_branch round_214
fwrite_215:
    s_cmp_lg_u32 s34, 0
    s_cbranch_scc1 fend_222
    s_mov_b64 exec, 0xffff
    global_store_short v120, v122, s[20:21] sc1
    global_store_short v121, v123, s[20:21] sc1
    s_mov_b64 exec, -1
fend_222:
    s_endpgm
L_fail:
    s_mov_b64 exec, -1
    v_mov_b32 v1, 0
    v_mov_b32 v2, 0xdead
    global_store_dword v1, v2, s[6:7] offset:252
L_exit:
    s_endpgm
L_code_end:

.section .rodata,"a"
.p2align 6
.amdhsa_kernel adaLN_cond__memory_aug_recurrent_mem_tr__moe_arch_mod__prompt_kernel
  .amdhsa_next_free_vgpr 512
  .amdhsa_next_free_sgpr 102
  .amdhsa_accum_offset 256
  .amdhsa_group_segment_fixed_size 0
  .amdhsa_kernarg_size 136
  .amdhsa_user_sgpr_count 2
  .amdhsa_user_sgpr_kernarg_segment_ptr 1
  .amdhsa_system_sgpr_workgroup_id_x 1
.end_amdhsa_kernel
```
